```python
import torch

def _softmax(x, axis=-1):
    return torch.softmax(x, dim=axis)

def _gelu(x):
    return torch.nn.functional.gelu(x, approximate='tanh')

def _silu(x):
    return torch.nn.functional.silu(x)

def _sigmoid(x):
    return torch.sigmoid(x)

def _layernorm(x, axis=-1, eps=1e-05):
    m = x.mean(dim=axis, keepdim=True)
    v = x.var(dim=axis, keepdim=True, unbiased=False)
    return (x - m) / torch.sqrt(v + eps)

def _scatter_add(tgt, idx, src, axis=0):
    return tgt.clone().index_add_(axis, idx, src)

def _segment_sum(src, seg, n):
    out = torch.zeros((n,) + src.shape[1:], dtype=src.dtype)
    return out.index_add_(0, seg, src)

def _pad(x, pw):
    flat = tuple((v for pair in reversed(pw) for v in pair))
    return torch.nn.functional.pad(x, flat)
kernel_name = 'parallel_sum__memory_aug_recurrent_mem_tr__dense_activation_relu__prompt'

def setup_inputs():

    _w = lambda a: (lambda t: t.to(torch.bfloat16) if t.is_floating_point() else t)(torch.as_tensor(a))

    def _A_setup():
        B, S, Dm = (1, 2048, 1024)
        H, Dh = (32, 128)
        M, seg = (8, 32)
        seg = min(seg, S)
        S = S // seg * seg
        return {'x': _w((lambda *s: torch.randn(*s, dtype=torch.bfloat16) * 0.05)(B, S, Dm)), 'mem0': _w((lambda *s: torch.randn(*s, dtype=torch.bfloat16) * 1.6)(B, M, Dm)), 'Wq': _w((lambda *s: torch.randn(*s, dtype=torch.bfloat16) * 0.8)(Dm, H, Dh) * Dm ** (-0.5)), 'Wk': _w((lambda *s: torch.randn(*s, dtype=torch.bfloat16) * 0.8)(Dm, H, Dh) * Dm ** (-0.5)), 'Wv': _w((lambda *s: torch.randn(*s, dtype=torch.bfloat16) * 1.6)(Dm, H, Dh) * Dm ** (-0.5)), 'Wo': _w((lambda *s: torch.randn(*s, dtype=torch.bfloat16) * 1.6)(H, Dh, Dm) * (H * Dh) ** (-0.5)), 'seg_len': seg}
    _A_in = _A_setup()

    def _B_setup():
        B, S, D, Dff = (1, 2048, 1024, 3584)
        return {'x': _w((lambda *s: torch.randn(*s, dtype=torch.bfloat16) * 0.05)(B, S, D)), 'w1': _w((lambda *s: torch.randn(*s, dtype=torch.bfloat16) * 0.05)(D, Dff)), 'w2': _w((lambda *s: torch.randn(*s, dtype=torch.bfloat16) * 0.05)(Dff, D))}
    _B_in = _B_setup()
    return {'A_x': _A_in['x'], 'A_mem0': _A_in['mem0'], 'A_Wq': _A_in['Wq'], 'A_Wk': _A_in['Wk'], 'A_Wv': _A_in['Wv'], 'A_Wo': _A_in['Wo'], 'A_seg_len': _A_in['seg_len'], 'B_x': _B_in['x'], 'B_w1': _B_in['w1'], 'B_w2': _B_in['w2']}

def reference(A_x, A_mem0, A_Wq, A_Wk, A_Wv, A_Wo, A_seg_len, B_x, B_w1, B_w2):

    def _A_ref(x, mem0, Wq, Wk, Wv, Wo, seg_len):
        B, S, Dm = x.shape
        H, Dh = (Wq.shape[1], Wq.shape[2])
        M = mem0.shape[1]
        scale = Dh ** (-0.5)
        n_seg = S // seg_len
        L = M + seg_len
        idx = torch.arange(L)
        mask = (idx[:, None] < M) | (idx[:, None] >= idx[None, :])
        mem = mem0
        outs = []
        for s in range(n_seg):
            xs = x[:, s * seg_len:(s + 1) * seg_len, :].clone()
            h = torch.concatenate([mem, xs], axis=1)
            q = torch.einsum('btd,dhe->bhte', h, Wq)
            k = torch.einsum('btd,dhe->bhte', h, Wk)
            v = torch.einsum('btd,dhe->bhte', h, Wv)
            scores = torch.einsum('bhqe,bhke->bhqk', q, k) * scale
            scores = torch.where(mask[None, None], scores, -1000000000.0)
            p = _softmax(scores, axis=-1)
            o = torch.einsum('bhqk,bhke->bhqe', p, v)
            o = torch.einsum('bhte,hed->btd', o, Wo)
            mem = o[:, :M, :].clone()
            outs.append(o[:, M:, :])
        return torch.concatenate(outs, axis=1)

    def _B_ref(x, w1, w2):
        h = torch.einsum('bsd,df->bsf', x, w1)
        zero = torch.zeros_like(h)
        h = torch.maximum(h, zero)
        return torch.einsum('bsf,fd->bsd', h, w2)
    x = A_x
    xn = _layernorm(x, axis=-1)
    return x + _A_ref(xn, A_mem0, A_Wq, A_Wk, A_Wv, A_Wo, A_seg_len) + _B_ref(xn, B_w1, B_w2)
```

```asm
; @launch grid=(256,1,1) block=(256,1,1) lds=163840
.amdgcn_target "amdgcn-amd-amdhsa--gfx950"
.text
.globl parallel_sum__memory_aug_recurrent_mem_tr__dense_activation_relu__prompt_kernel
.p2align 8
.type parallel_sum__memory_aug_recurrent_mem_tr__dense_activation_relu__prompt_kernel,@function
parallel_sum__memory_aug_recurrent_mem_tr__dense_activation_relu__prompt_kernel:
 s_cmp_ge_u32 s2, 256
 s_cbranch_scc1 L_end
 s_load_dwordx8 s[4:11], s[0:1], 0
 s_load_dwordx4 s[12:15], s[0:1], 32
 s_load_dwordx4 s[16:19], s[0:1], 64
 s_load_dwordx4 s[20:23], s[0:1], 80
 s_load_dwordx2 s[24:25], s[0:1], 96
 v_lshrrev_b32 v1, 6, v0
 v_and_b32 v0, 63, v0
 s_getreg_b32 s3, hwreg(HW_REG_XCC_ID, 0, 4)
 v_readfirstlane_b32 s40, v1
 s_mov_b32 s26, 0x100000
 s_waitcnt lgkmcnt(0)
 s_mov_b32 s28, s24
 s_and_b32 s29, s25, 0xffff
 s_mov_b32 s30, 0x10000000
 s_mov_b32 s31, 0x20000
 s_and_b32 s41, s2, 7
 s_lshr_b32 s42, s2, 3
 s_cmp_ge_u32 s41, 2
 s_cbranch_scc1 L_gemm
 s_cmp_lt_u32 s42, 16
 s_cbranch_scc1 L_qk
 s_sub_u32 s42, s42, 16
L_vo:
 s_lshl_b32 s48, s41, 4
 s_add_u32 s48, s48, s42
 s_lshl_b32 s45, s40, 15
 s_lshl_b32 s46, s40, 13
 s_add_u32 s46, s46, 131072
 v_lshlrev_b32 v3, 3, v0
 v_add_u32 v14, s46, v3
 v_add_u32 v3, s45, v3
 v_lshlrev_b32 v2, 4, v0
 v_add_u32 v2, 131072, v2
 v_cmp_eq_u32 vcc, 0, v0
 v_mov_b32 v13, 0x40000000
 s_nop 0
 v_cndmask_b32 v13, v13, 0, vcc
 v_and_b32 v8, 8, v0
 v_cmp_eq_u32 vcc, 0, v8
 v_mov_b32 v8, 0xeeee
 v_mov_b32 v1, 0x4444
 v_cndmask_b32 v8, v8, v1, vcc
 s_mov_b32 s32, s12
 s_and_b32 s33, s13, 0xffff
 s_mov_b32 s34, 0x800000
 s_mov_b32 s35, 0x20000
 s_mov_b32 s36, s14
 s_and_b32 s37, s15, 0xffff
 s_mov_b32 s38, 0x800000
 s_mov_b32 s39, 0x20000
 s_and_b32 s47, s40, 1
 s_lshl_b32 s47, s47, 6
 v_add_u32 v16, s47, v0
 v_lshlrev_b32 v9, 4, v16
 v_lshlrev_b32 v10, 3, v16
 s_lshl_b32 s50, s41, 16
 s_add_u32 s50, s50, 131072
 s_lshl_b32 s47, s42, 10
 s_add_u32 s58, s50, s47
 s_lshl_b32 s51, s41, 17
 s_add_u32 s51, s51, 262144
 s_lshl_b32 s52, s48, 13
 s_add_u32 s52, s52, 524288
 s_lshl_b32 s53, s48, 11
 s_add_u32 s53, s53, 0x800000
 s_lshl_b32 s55, s48, 16
 s_xor_b32 s54, s55, 1048576
 s_add_u32 s54, s54, 0x6000000
 s_add_u32 s55, s55, 0x6000000
 s_lshl_b32 s56, s48, 7
 s_add_u32 s56, s56, 36864
 s_and_b32 s63, s40, 1
 s_lshl_b32 s63, s63, 13
 s_lshr_b32 s47, s40, 1
 s_lshl_b32 s47, s47, 10
 s_add_u32 s63, s63, s47
 s_add_u32 s63, s63, s55
 s_add_u32 s63, s63, 32768
 s_lshl_b32 s27, s41, 10
 s_lshl_b32 s59, s40, 8
 s_add_u32 s59, s59, s27
 s_add_u32 s59, s59, 40960
 s_add_u32 s96, s59, 2048
 s_lshr_b32 s47, s42, 2
 s_lshl_b32 s47, s47, 8
 s_add_u32 s27, s27, s47
 s_and_b32 s47, s42, 3
 s_lshl_b32 s47, s47, 3
 s_add_u32 s27, s27, s47
 s_and_b32 s47, s40, 1
 s_lshl_b32 s47, s47, 2
 s_add_u32 s27, s27, s47
 s_add_u32 s27, s27, 40960
 s_lshl_b32 s47, s40, 9
 v_lshlrev_b32 v11, 3, v0
 v_add_u32 v11, s47, v11
 v_lshrrev_b32 v17, 4, v16
 v_lshlrev_b32 v17, 3, v17
 v_and_b32 v18, 1, v0
 v_lshl_add_u32 v17, v18, 2, v17
 v_bfe_u32 v18, v0, 1, 3
 v_mul_u32_u24 v19, 320, v18
 v_lshl_add_u32 v19, v17, 2, v19
 v_add_u32 v7, 147456, v19
 v_lshlrev_b32 v18, 11, v18
 v_lshl_add_u32 v17, v17, 1, v18
 s_lshl_b32 s47, s42, 7
 v_add_u32 v17, s47, v17
 global_load_dwordx2 v[28:29], v17, s[6:7]
 v_bfe_u32 v16, v0, 3, 2
 v_bfe_u32 v17, v0, 1, 2
 v_and_b32 v24, 1, v0
 v_lshrrev_b32 v22, 1, v16
 v_lshlrev_b32 v22, 4, v22
 v_and_b32 v25, 1, v16
 v_lshl_add_u32 v22, v25, 2, v22
 v_lshrrev_b32 v25, 1, v17
 v_lshl_add_u32 v22, v25, 3, v22
 v_and_b32 v25, 1, v17
 v_add_u32 v22, v25, v22
 s_lshl_b32 s47, s48, 8
 s_lshl_b32 s49, s40, 6
 s_add_u32 s49, s49, s47
 v_lshlrev_b32 v4, 13, v22
 v_lshl_add_u32 v4, v24, 4, v4
 v_add_u32 v4, s49, v4
 v_lshrrev_b32 v25, 5, v0
 v_lshl_add_u32 v4, v25, 5, v4
 v_lshrrev_b32 v22, 1, v17
 v_lshlrev_b32 v22, 5, v22
 v_and_b32 v25, 1, v16
 v_lshl_add_u32 v22, v25, 4, v22
 v_lshrrev_b32 v25, 1, v16
 v_lshl_add_u32 v22, v25, 2, v22
 v_and_b32 v25, 1, v17
 v_add_u32 v22, v25, v22
 s_lshl_b32 s47, s41, 22
 s_lshl_b32 s49, s40, 20
 s_add_u32 s47, s47, s49
 s_lshl_b32 s49, s42, 7
 s_add_u32 s49, s49, s47
 v_lshlrev_b32 v12, 11, v22
 v_lshl_add_u32 v12, v24, 4, v12
 v_add_u32 v12, s49, v12
 v_lshrrev_b32 v25, 5, v0
 v_lshl_add_u32 v12, v25, 5, v12
 s_mov_b32 m0, s46
 s_mov_b32 s47, 0x0
 buffer_load_dwordx4 v4, s[32:35], s47 offen lds
 s_add_u32 m0, s46, 1024
 s_mov_b32 s47, 0x4000
 buffer_load_dwordx4 v4, s[32:35], s47 offen lds
 s_add_u32 m0, s46, 2048
 s_mov_b32 s47, 0x40000
 buffer_load_dwordx4 v4, s[32:35], s47 offen lds
 s_add_u32 m0, s46, 3072
 s_mov_b32 s47, 0x44000
 buffer_load_dwordx4 v4, s[32:35], s47 offen lds
 s_add_u32 m0, s46, 4096
 s_mov_b32 s47, 0x80000
 buffer_load_dwordx4 v4, s[32:35], s47 offen lds
 s_add_u32 m0, s46, 5120
 s_mov_b32 s47, 0x84000
 buffer_load_dwordx4 v4, s[32:35], s47 offen lds
 s_add_u32 m0, s46, 6144
 s_mov_b32 s47, 0xc0000
 buffer_load_dwordx4 v4, s[32:35], s47 offen lds
 s_add_u32 m0, s46, 7168
 s_mov_b32 s47, 0xc4000
 buffer_load_dwordx4 v4, s[32:35], s47 offen lds
 s_mov_b32 m0, s45
 s_mov_b32 s47, 0x100000
 buffer_load_dwordx4 v4, s[32:35], s47 offen lds
 s_add_u32 m0, s45, 1024
 s_mov_b32 s47, 0x104000
 buffer_load_dwordx4 v4, s[32:35], s47 offen lds
 s_add_u32 m0, s45, 2048
 s_mov_b32 s47, 0x140000
 buffer_load_dwordx4 v4, s[32:35], s47 offen lds
 s_add_u32 m0, s45, 3072
 s_mov_b32 s47, 0x144000
 buffer_load_dwordx4 v4, s[32:35], s47 offen lds
 s_add_u32 m0, s45, 4096
 s_mov_b32 s47, 0x180000
 buffer_load_dwordx4 v4, s[32:35], s47 offen lds
 s_add_u32 m0, s45, 5120
 s_mov_b32 s47, 0x184000
 buffer_load_dwordx4 v4, s[32:35], s47 offen lds
 s_add_u32 m0, s45, 6144
 s_mov_b32 s47, 0x1c0000
 buffer_load_dwordx4 v4, s[32:35], s47 offen lds
 s_add_u32 m0, s45, 7168
 s_mov_b32 s47, 0x1c4000
 buffer_load_dwordx4 v4, s[32:35], s47 offen lds
 s_add_u32 m0, s45, 8192
 s_mov_b32 s47, 0x200000
 buffer_load_dwordx4 v4, s[32:35], s47 offen lds
 s_add_u32 m0, s45, 9216
 s_mov_b32 s47, 0x204000
 buffer_load_dwordx4 v4, s[32:35], s47 offen lds
 s_add_u32 m0, s45, 10240
 s_mov_b32 s47, 0x240000
 buffer_load_dwordx4 v4, s[32:35], s47 offen lds
 s_add_u32 m0, s45, 11264
 s_mov_b32 s47, 0x244000
 buffer_load_dwordx4 v4, s[32:35], s47 offen lds
 s_add_u32 m0, s45, 12288
 s_mov_b32 s47, 0x280000
 buffer_load_dwordx4 v4, s[32:35], s47 offen lds
 s_add_u32 m0, s45, 13312
 s_mov_b32 s47, 0x284000
 buffer_load_dwordx4 v4, s[32:35], s47 offen lds
 s_add_u32 m0, s45, 14336
 s_mov_b32 s47, 0x2c0000
 buffer_load_dwordx4 v4, s[32:35], s47 offen lds
 s_add_u32 m0, s45, 15360
 s_mov_b32 s47, 0x2c4000
 buffer_load_dwordx4 v4, s[32:35], s47 offen lds
 s_add_u32 m0, s45, 16384
 s_mov_b32 s47, 0x300000
 buffer_load_dwordx4 v4, s[32:35], s47 offen lds
 s_add_u32 m0, s45, 17408
 s_mov_b32 s47, 0x304000
 buffer_load_dwordx4 v4, s[32:35], s47 offen lds
 s_add_u32 m0, s45, 18432
 s_mov_b32 s47, 0x340000
 buffer_load_dwordx4 v4, s[32:35], s47 offen lds
 s_add_u32 m0, s45, 19456
 s_mov_b32 s47, 0x344000
 buffer_load_dwordx4 v4, s[32:35], s47 offen lds
 s_add_u32 m0, s45, 20480
 s_mov_b32 s47, 0x380000
 buffer_load_dwordx4 v4, s[32:35], s47 offen lds
 s_add_u32 m0, s45, 21504
 s_mov_b32 s47, 0x384000
 buffer_load_dwordx4 v4, s[32:35], s47 offen lds
 s_add_u32 m0, s45, 22528
 s_mov_b32 s47, 0x3c0000
 buffer_load_dwordx4 v4, s[32:35], s47 offen lds
 s_add_u32 m0, s45, 23552
 s_mov_b32 s47, 0x3c4000
 buffer_load_dwordx4 v4, s[32:35], s47 offen lds
 s_add_u32 m0, s45, 24576
 s_mov_b32 s47, 0x400000
 buffer_load_dwordx4 v4, s[32:35], s47 offen lds
 s_add_u32 m0, s45, 25600
 s_mov_b32 s47, 0x404000
 buffer_load_dwordx4 v4, s[32:35], s47 offen lds
 s_add_u32 m0, s45, 26624
 s_mov_b32 s47, 0x440000
 buffer_load_dwordx4 v4, s[32:35], s47 offen lds
 s_add_u32 m0, s45, 27648
 s_mov_b32 s47, 0x444000
 buffer_load_dwordx4 v4, s[32:35], s47 offen lds
 s_add_u32 m0, s45, 28672
 s_mov_b32 s47, 0x480000
 buffer_load_dwordx4 v4, s[32:35], s47 offen lds
 s_add_u32 m0, s45, 29696
 s_mov_b32 s47, 0x484000
 buffer_load_dwordx4 v4, s[32:35], s47 offen lds
 s_add_u32 m0, s45, 30720
 s_mov_b32 s47, 0x4c0000
 buffer_load_dwordx4 v4, s[32:35], s47 offen lds
 s_add_u32 m0, s45, 31744
 s_mov_b32 s47, 0x4c4000
 buffer_load_dwordx4 v4, s[32:35], s47 offen lds
 v_mov_b32 v20, -1
 v_mov_b32 v21, -1
 v_mov_b32 v22, -1
 v_mov_b32 v23, -1
 s_add_u32 s47, s58, 16384
 buffer_store_dwordx2 v[20:21], v10, s[28:31], s47 offen sc1
 s_add_u32 s47, s58, 32768
 buffer_store_dwordx2 v[20:21], v10, s[28:31], s47 offen sc1
 s_add_u32 s47, s58, 49152
 buffer_store_dwordx2 v[20:21], v10, s[28:31], s47 offen sc1
 s_add_u32 s47, s52, 0
 buffer_store_dwordx2 v[20:21], v11, s[28:31], s47 offen sc1
 s_add_u32 s47, s52, 2048
 buffer_store_dwordx2 v[20:21], v11, s[28:31], s47 offen sc1
 s_add_u32 s47, s52, 4096
 buffer_store_dwordx2 v[20:21], v11, s[28:31], s47 offen sc1
 s_add_u32 s47, s52, 6144
 buffer_store_dwordx2 v[20:21], v11, s[28:31], s47 offen sc1
 s_add_u32 s47, s55, 0
 buffer_store_dwordx4 v[20:23], v9, s[28:31], s47 offen sc1
 s_add_u32 s47, s55, 2048
 buffer_store_dwordx4 v[20:23], v9, s[28:31], s47 offen sc1
 s_add_u32 s47, s55, 4096
 buffer_store_dwordx4 v[20:23], v9, s[28:31], s47 offen sc1
 s_add_u32 s47, s55, 6144
 buffer_store_dwordx4 v[20:23], v9, s[28:31], s47 offen sc1
 s_add_u32 s47, s55, 8192
 buffer_store_dwordx4 v[20:23], v9, s[28:31], s47 offen sc1
 s_add_u32 s47, s55, 10240
 buffer_store_dwordx4 v[20:23], v9, s[28:31], s47 offen sc1
 s_add_u32 s47, s55, 12288
 buffer_store_dwordx4 v[20:23], v9, s[28:31], s47 offen sc1
 s_add_u32 s47, s55, 14336
 buffer_store_dwordx4 v[20:23], v9, s[28:31], s47 offen sc1
 v_mov_b32 v25, 0
 buffer_store_dword v25, v13, s[28:31], s56 offen sc1
 buffer_store_dword v25, v13, s[28:31], s27 offen sc1
 s_waitcnt vmcnt(57)
 v_min_u32 v28, -2, v28
 v_min_u32 v29, -2, v29
 buffer_store_dwordx2 v[28:29], v10, s[28:31], s58 offen sc1
 s_add_u32 s58, s58, 16384
 s_lshl_b32 s47, s2, 2
 s_add_u32 s47, s47, 0
 v_mov_b32 v1, s3
 buffer_store_dword v1, v13, s[28:31], s47 offen sc1
 s_waitcnt vmcnt(58)
 ds_read_b64_tr_b16 v[128:129], v14 offset:0
 ds_read_b64_tr_b16 a[192:193], v14 offset:512
 s_waitcnt vmcnt(57)
 ds_read_b64_tr_b16 v[130:131], v14 offset:1024
 ds_read_b64_tr_b16 a[194:195], v14 offset:1536
 s_waitcnt vmcnt(56)
 ds_read_b64_tr_b16 v[132:133], v14 offset:2048
 ds_read_b64_tr_b16 a[196:197], v14 offset:2560
 s_waitcnt vmcnt(55)
 ds_read_b64_tr_b16 v[134:135], v14 offset:3072
 ds_read_b64_tr_b16 a[198:199], v14 offset:3584
 s_waitcnt lgkmcnt(6)
 s_mov_b32 m0, s46
 s_mov_b32 s47, 0x500000
 buffer_load_dwordx4 v4, s[32:35], s47 offen lds
 s_waitcnt vmcnt(55)
 ds_read_b64_tr_b16 v[136:137], v14 offset:4096
 ds_read_b64_tr_b16 a[200:201], v14 offset:4608
 s_waitcnt lgkmcnt(6)
 s_add_u32 m0, s46, 1024
 s_mov_b32 s47, 0x504000
 buffer_load_dwordx4 v4, s[32:35], s47 offen lds
 s_waitcnt vmcnt(55)
 ds_read_b64_tr_b16 v[138:139], v14 offset:5120
 ds_read_b64_tr_b16 a[202:203], v14 offset:5632
 s_waitcnt lgkmcnt(6)
 s_add_u32 m0, s46, 2048
 s_mov_b32 s47, 0x540000
 buffer_load_dwordx4 v4, s[32:35], s47 offen lds
 s_waitcnt vmcnt(55)
 ds_read_b64_tr_b16 v[140:141], v14 offset:6144
 ds_read_b64_tr_b16 a[204:205], v14 offset:6656
 s_waitcnt lgkmcnt(6)
 s_add_u32 m0, s46, 3072
 s_mov_b32 s47, 0x544000
 buffer_load_dwordx4 v4, s[32:35], s47 offen lds
 s_waitcnt vmcnt(55)
 ds_read_b64_tr_b16 v[142:143], v14 offset:7168
 ds_read_b64_tr_b16 a[206:207], v14 offset:7680
 s_waitcnt lgkmcnt(6)
 s_add_u32 m0, s46, 4096
 s_mov_b32 s47, 0x580000
 buffer_load_dwordx4 v4, s[32:35], s47 offen lds
 s_waitcnt vmcnt(55)
 ds_read_b64_tr_b16 v[144:145], v3 offset:0
 ds_read_b64_tr_b16 a[208:209], v3 offset:512
 s_waitcnt lgkmcnt(6)
 s_add_u32 m0, s46, 5120
 s_mov_b32 s47, 0x584000
 buffer_load_dwordx4 v4, s[32:35], s47 offen lds
 s_waitcnt vmcnt(55)
 ds_read_b64_tr_b16 v[146:147], v3 offset:1024
 ds_read_b64_tr_b16 a[210:211], v3 offset:1536
 s_waitcnt lgkmcnt(6)
 s_add_u32 m0, s46, 6144
 s_mov_b32 s47, 0x5c0000
 buffer_load_dwordx4 v4, s[32:35], s47 offen lds
 s_waitcnt vmcnt(55)
 ds_read_b64_tr_b16 v[148:149], v3 offset:2048
 ds_read_b64_tr_b16 a[212:213], v3 offset:2560
 s_waitcnt lgkmcnt(6)
 s_add_u32 m0, s46, 7168
 s_mov_b32 s47, 0x5c4000
 buffer_load_dwordx4 v4, s[32:35], s47 offen lds
 s_waitcnt vmcnt(55)
 ds_read_b64_tr_b16 v[150:151], v3 offset:3072
 ds_read_b64_tr_b16 a[214:215], v3 offset:3584
 s_waitcnt lgkmcnt(6)
 s_mov_b32 m0, s45
 s_mov_b32 s47, 0x600000
 buffer_load_dwordx4 v4, s[32:35], s47 offen lds
 s_waitcnt vmcnt(55)
 ds_read_b64_tr_b16 v[152:153], v3 offset:4096
 ds_read_b64_tr_b16 a[216:217], v3 offset:4608
 s_waitcnt lgkmcnt(6)
 s_add_u32 m0, s45, 1024
 s_mov_b32 s47, 0x604000
 buffer_load_dwordx4 v4, s[32:35], s47 offen lds
 s_waitcnt vmcnt(55)
 ds_read_b64_tr_b16 v[154:155], v3 offset:5120
 ds_read_b64_tr_b16 a[218:219], v3 offset:5632
 s_waitcnt lgkmcnt(6)
 s_add_u32 m0, s45, 2048
 s_mov_b32 s47, 0x640000
 buffer_load_dwordx4 v4, s[32:35], s47 offen lds
 s_waitcnt vmcnt(55)
 ds_read_b64_tr_b16 v[156:157], v3 offset:6144
 ds_read_b64_tr_b16 a[220:221], v3 offset:6656
 s_waitcnt lgkmcnt(6)
 s_add_u32 m0, s45, 3072
 s_mov_b32 s47, 0x644000
 buffer_load_dwordx4 v4, s[32:35], s47 offen lds
 s_waitcnt vmcnt(55)
 ds_read_b64_tr_b16 v[158:159], v3 offset:7168
 ds_read_b64_tr_b16 a[222:223], v3 offset:7680
 s_waitcnt lgkmcnt(6)
 s_add_u32 m0, s45, 4096
 s_mov_b32 s47, 0x680000
 buffer_load_dwordx4 v4, s[32:35], s47 offen lds
 s_waitcnt vmcnt(55)
 ds_read_b64_tr_b16 v[160:161], v3 offset:8192
 ds_read_b64_tr_b16 a[224:225], v3 offset:8704
 s_waitcnt lgkmcnt(6)
 s_add_u32 m0, s45, 5120
 s_mov_b32 s47, 0x684000
 buffer_load_dwordx4 v4, s[32:35], s47 offen lds
 s_waitcnt vmcnt(55)
 ds_read_b64_tr_b16 v[162:163], v3 offset:9216
 ds_read_b64_tr_b16 a[226:227], v3 offset:9728
 s_waitcnt lgkmcnt(6)
 s_add_u32 m0, s45, 6144
 s_mov_b32 s47, 0x6c0000
 buffer_load_dwordx4 v4, s[32:35], s47 offen lds
 s_waitcnt vmcnt(55)
 ds_read_b64_tr_b16 v[164:165], v3 offset:10240
 ds_read_b64_tr_b16 a[228:229], v3 offset:10752
 s_waitcnt lgkmcnt(6)
 s_add_u32 m0, s45, 7168
 s_mov_b32 s47, 0x6c4000
 buffer_load_dwordx4 v4, s[32:35], s47 offen lds
 s_waitcnt vmcnt(55)
 ds_read_b64_tr_b16 v[166:167], v3 offset:11264
 ds_read_b64_tr_b16 a[230:231], v3 offset:11776
 s_waitcnt lgkmcnt(6)
 s_add_u32 m0, s45, 8192
 s_mov_b32 s47, 0x700000
 buffer_load_dwordx4 v4, s[32:35], s47 offen lds
 s_waitcnt vmcnt(55)
 ds_read_b64_tr_b16 v[168:169], v3 offset:12288
 ds_read_b64_tr_b16 a[232:233], v3 offset:12800
 s_waitcnt lgkmcnt(6)
 s_add_u32 m0, s45, 9216
 s_mov_b32 s47, 0x704000
 buffer_load_dwordx4 v4, s[32:35], s47 offen lds
 s_waitcnt vmcnt(55)
 ds_read_b64_tr_b16 v[170:171], v3 offset:13312
 ds_read_b64_tr_b16 a[234:235], v3 offset:13824
 s_waitcnt lgkmcnt(6)
 s_add_u32 m0, s45, 10240
 s_mov_b32 s47, 0x740000
 buffer_load_dwordx4 v4, s[32:35], s47 offen lds
 s_waitcnt vmcnt(55)
 ds_read_b64_tr_b16 v[172:173], v3 offset:14336
 ds_read_b64_tr_b16 a[236:237], v3 offset:14848
 s_waitcnt lgkmcnt(6)
 s_add_u32 m0, s45, 11264
 s_mov_b32 s47, 0x744000
 buffer_load_dwordx4 v4, s[32:35], s47 offen lds
 s_waitcnt vmcnt(55)
 ds_read_b64_tr_b16 v[174:175], v3 offset:15360
 ds_read_b64_tr_b16 a[238:239], v3 offset:15872
 s_waitcnt lgkmcnt(6)
 s_add_u32 m0, s45, 12288
 s_mov_b32 s47, 0x780000
 buffer_load_dwordx4 v4, s[32:35], s47 offen lds
 s_waitcnt vmcnt(55)
 ds_read_b64_tr_b16 v[176:177], v3 offset:16384
 ds_read_b64_tr_b16 a[240:241], v3 offset:16896
 s_waitcnt lgkmcnt(6)
 s_add_u32 m0, s45, 13312
 s_mov_b32 s47, 0x784000
 buffer_load_dwordx4 v4, s[32:35], s47 offen lds
 s_waitcnt vmcnt(55)
 ds_read_b64_tr_b16 v[178:179], v3 offset:17408
 ds_read_b64_tr_b16 a[242:243], v3 offset:17920
 s_waitcnt lgkmcnt(6)
 s_add_u32 m0, s45, 14336
 s_mov_b32 s47, 0x7c0000
 buffer_load_dwordx4 v4, s[32:35], s47 offen lds
 s_waitcnt vmcnt(55)
 ds_read_b64_tr_b16 v[180:181], v3 offset:18432
 ds_read_b64_tr_b16 a[244:245], v3 offset:18944
 s_waitcnt lgkmcnt(6)
 s_add_u32 m0, s45, 15360
 s_mov_b32 s47, 0x7c4000
 buffer_load_dwordx4 v4, s[32:35], s47 offen lds
 s_waitcnt vmcnt(55)
 ds_read_b64_tr_b16 v[182:183], v3 offset:19456
 ds_read_b64_tr_b16 a[246:247], v3 offset:19968
 s_waitcnt lgkmcnt(6)
 s_add_u32 m0, s45, 16384
 s_mov_b32 s47, 0x0
 buffer_load_dwordx4 v12, s[36:39], s47 offen lds
 s_waitcnt vmcnt(55)
 ds_read_b64_tr_b16 v[184:185], v3 offset:20480
 ds_read_b64_tr_b16 a[248:249], v3 offset:20992
 s_waitcnt lgkmcnt(6)
 s_add_u32 m0, s45, 17408
 s_mov_b32 s47, 0x1000
 buffer_load_dwordx4 v12, s[36:39], s47 offen lds
 s_waitcnt vmcnt(55)
 ds_read_b64_tr_b16 v[186:187], v3 offset:21504
 ds_read_b64_tr_b16 a[250:251], v3 offset:22016
 s_waitcnt lgkmcnt(6)
 s_add_u32 m0, s45, 18432
 s_mov_b32 s47, 0x4000
 buffer_load_dwordx4 v12, s[36:39], s47 offen lds
 s_waitcnt vmcnt(55)
 ds_read_b64_tr_b16 v[188:189], v3 offset:22528
 ds_read_b64_tr_b16 a[252:253], v3 offset:23040
 s_waitcnt lgkmcnt(6)
 s_add_u32 m0, s45, 19456
 s_mov_b32 s47, 0x5000
 buffer_load_dwordx4 v12, s[36:39], s47 offen lds
 s_waitcnt vmcnt(55)
 ds_read_b64_tr_b16 v[190:191], v3 offset:23552
 ds_read_b64_tr_b16 a[254:255], v3 offset:24064
 s_waitcnt lgkmcnt(6)
 s_add_u32 m0, s45, 20480
 s_mov_b32 s47, 0x20000
 buffer_load_dwordx4 v12, s[36:39], s47 offen lds
 s_waitcnt vmcnt(55)
 ds_read_b64_tr_b16 v[192:193], v3 offset:24576
 ds_read_b64_tr_b16 v[16:17], v3 offset:25088
 s_waitcnt lgkmcnt(6)
 s_add_u32 m0, s45, 21504
 s_mov_b32 s47, 0x21000
 buffer_load_dwordx4 v12, s[36:39], s47 offen lds
 s_waitcnt vmcnt(55)
 ds_read_b64_tr_b16 v[194:195], v3 offset:25600
 ds_read_b64_tr_b16 v[18:19], v3 offset:26112
 s_waitcnt lgkmcnt(6)
 s_add_u32 m0, s45, 22528
 s_mov_b32 s47, 0x24000
 buffer_load_dwordx4 v12, s[36:39], s47 offen lds
 s_waitcnt vmcnt(55)
 ds_read_b64_tr_b16 v[196:197], v3 offset:26624
 ds_read_b64_tr_b16 v[20:21], v3 offset:27136
 s_waitcnt lgkmcnt(6)
 s_add_u32 m0, s45, 23552
 s_mov_b32 s47, 0x25000
 buffer_load_dwordx4 v12, s[36:39], s47 offen lds
 s_waitcnt vmcnt(55)
 ds_read_b64_tr_b16 v[198:199], v3 offset:27648
 ds_read_b64_tr_b16 v[22:23], v3 offset:28160
 s_waitcnt lgkmcnt(6)
 s_add_u32 m0, s45, 24576
 s_mov_b32 s47, 0x40
 buffer_load_dwordx4 v12, s[36:39], s47 offen lds
 s_waitcnt vmcnt(55)
 ds_read_b64_tr_b16 v[200:201], v3 offset:28672
 ds_read_b64_tr_b16 v[24:25], v3 offset:29184
 s_waitcnt lgkmcnt(6)
 s_add_u32 m0, s45, 25600
 s_mov_b32 s47, 0x1040
 buffer_load_dwordx4 v12, s[36:39], s47 offen lds
 s_waitcnt vmcnt(55)
 ds_read_b64_tr_b16 v[202:203], v3 offset:29696
 ds_read_b64_tr_b16 v[26:27], v3 offset:30208
 s_waitcnt lgkmcnt(6)
 s_add_u32 m0, s45, 26624
 s_mov_b32 s47, 0x4040
 buffer_load_dwordx4 v12, s[36:39], s47 offen lds
 s_waitcnt vmcnt(55)
 ds_read_b64_tr_b16 v[204:205], v3 offset:30720
 ds_read_b64_tr_b16 v[28:29], v3 offset:31232
 s_waitcnt lgkmcnt(6)
 s_add_u32 m0, s45, 27648
 s_mov_b32 s47, 0x5040
 buffer_load_dwordx4 v12, s[36:39], s47 offen lds
 s_waitcnt vmcnt(55)
 ds_read_b64_tr_b16 v[206:207], v3 offset:31744
 ds_read_b64_tr_b16 v[30:31], v3 offset:32256
 s_waitcnt lgkmcnt(6)
 s_add_u32 m0, s45, 28672
 s_mov_b32 s47, 0x20040
 buffer_load_dwordx4 v12, s[36:39], s47 offen lds
 s_waitcnt vmcnt(36)
 s_barrier
 s_cmp_lg_u32 s40, 0
 s_cbranch_scc1 arr_1
 s_mov_b64 exec, 1
 v_mov_b32 v1, 0
 v_mov_b32 v5, 1
 global_atomic_add v1, v5, s[22:23] offset:192 sc1
 s_mov_b64 exec, -1
arr_1:
 ds_read_b64_tr_b16 v[208:209], v14 offset:0
 ds_read_b64_tr_b16 v[32:33], v14 offset:512
 s_waitcnt lgkmcnt(6)
 s_add_u32 m0, s45, 29696
 s_mov_b32 s47, 0x21040
 buffer_load_dwordx4 v12, s[36:39], s47 offen lds
 s_waitcnt vmcnt(36)
 ds_read_b64_tr_b16 v[210:211], v14 offset:1024
 ds_read_b64_tr_b16 v[34:35], v14 offset:1536
 s_waitcnt lgkmcnt(6)
 s_add_u32 m0, s45, 30720
 s_mov_b32 s47, 0x24040
 buffer_load_dwordx4 v12, s[36:39], s47 offen lds
 s_waitcnt vmcnt(36)
 ds_read_b64_tr_b16 v[212:213], v14 offset:2048
 ds_read_b64_tr_b16 v[36:37], v14 offset:2560
 s_waitcnt lgkmcnt(6)
 s_add_u32 m0, s45, 31744
 s_mov_b32 s47, 0x25040
 buffer_load_dwordx4 v12, s[36:39], s47 offen lds
 s_waitcnt vmcnt(36)
 ds_read_b64_tr_b16 v[214:215], v14 offset:3072
 ds_read_b64_tr_b16 v[38:39], v14 offset:3584
 s_waitcnt lgkmcnt(6)
 s_mov_b32 m0, s46
 s_mov_b32 s47, 0x40000
 buffer_load_dwordx4 v12, s[36:39], s47 offen lds
 s_waitcnt vmcnt(36)
 ds_read_b64_tr_b16 v[216:217], v14 offset:4096
 ds_read_b64_tr_b16 v[40:41], v14 offset:4608
 s_waitcnt lgkmcnt(6)
 s_add_u32 m0, s46, 1024
 s_mov_b32 s47, 0x41000
 buffer_load_dwordx4 v12, s[36:39], s47 offen lds
 s_waitcnt vmcnt(36)
 ds_read_b64_tr_b16 v[218:219], v14 offset:5120
 ds_read_b64_tr_b16 v[42:43], v14 offset:5632
 s_waitcnt lgkmcnt(6)
 s_add_u32 m0, s46, 2048
 s_mov_b32 s47, 0x44000
 buffer_load_dwordx4 v12, s[36:39], s47 offen lds
 s_waitcnt vmcnt(36)
 ds_read_b64_tr_b16 v[220:221], v14 offset:6144
 ds_read_b64_tr_b16 v[44:45], v14 offset:6656
 s_waitcnt lgkmcnt(6)
 s_add_u32 m0, s46, 3072
 s_mov_b32 s47, 0x45000
 buffer_load_dwordx4 v12, s[36:39], s47 offen lds
 s_waitcnt vmcnt(36)
 ds_read_b64_tr_b16 v[222:223], v14 offset:7168
 ds_read_b64_tr_b16 v[46:47], v14 offset:7680
 s_waitcnt lgkmcnt(6)
 s_add_u32 m0, s46, 4096
 s_mov_b32 s47, 0x60000
 buffer_load_dwordx4 v12, s[36:39], s47 offen lds
 s_waitcnt vmcnt(36)
 ds_read_b64_tr_b16 v[224:225], v3 offset:0
 ds_read_b64_tr_b16 v[48:49], v3 offset:512
 s_waitcnt lgkmcnt(6)
 s_add_u32 m0, s46, 5120
 s_mov_b32 s47, 0x61000
 buffer_load_dwordx4 v12, s[36:39], s47 offen lds
 s_waitcnt vmcnt(36)
 ds_read_b64_tr_b16 v[226:227], v3 offset:1024
 ds_read_b64_tr_b16 v[50:51], v3 offset:1536
 s_waitcnt lgkmcnt(6)
 s_add_u32 m0, s46, 6144
 s_mov_b32 s47, 0x64000
 buffer_load_dwordx4 v12, s[36:39], s47 offen lds
 s_waitcnt vmcnt(36)
 ds_read_b64_tr_b16 v[228:229], v3 offset:2048
 ds_read_b64_tr_b16 v[52:53], v3 offset:2560
 s_waitcnt lgkmcnt(6)
 s_add_u32 m0, s46, 7168
 s_mov_b32 s47, 0x65000
 buffer_load_dwordx4 v12, s[36:39], s47 offen lds
 s_waitcnt vmcnt(36)
 ds_read_b64_tr_b16 v[230:231], v3 offset:3072
 ds_read_b64_tr_b16 v[54:55], v3 offset:3584
 s_waitcnt lgkmcnt(6)
 s_mov_b32 m0, s45
 s_mov_b32 s47, 0x40040
 buffer_load_dwordx4 v12, s[36:39], s47 offen lds
 s_waitcnt vmcnt(36)
 ds_read_b64_tr_b16 v[232:233], v3 offset:4096
 ds_read_b64_tr_b16 v[56:57], v3 offset:4608
 s_waitcnt lgkmcnt(6)
 s_add_u32 m0, s45, 1024
 s_mov_b32 s47, 0x41040
 buffer_load_dwordx4 v12, s[36:39], s47 offen lds
 s_waitcnt vmcnt(36)
 ds_read_b64_tr_b16 v[234:235], v3 offset:5120
 ds_read_b64_tr_b16 v[58:59], v3 offset:5632
 s_waitcnt lgkmcnt(6)
 s_add_u32 m0, s45, 2048
 s_mov_b32 s47, 0x44040
 buffer_load_dwordx4 v12, s[36:39], s47 offen lds
 s_waitcnt vmcnt(36)
 ds_read_b64_tr_b16 v[236:237], v3 offset:6144
 ds_read_b64_tr_b16 v[60:61], v3 offset:6656
 s_waitcnt lgkmcnt(6)
 s_add_u32 m0, s45, 3072
 s_mov_b32 s47, 0x45040
 buffer_load_dwordx4 v12, s[36:39], s47 offen lds
 s_waitcnt vmcnt(36)
 ds_read_b64_tr_b16 v[238:239], v3 offset:7168
 ds_read_b64_tr_b16 v[62:63], v3 offset:7680
 s_waitcnt lgkmcnt(6)
 s_add_u32 m0, s45, 4096
 s_mov_b32 s47, 0x60040
 buffer_load_dwordx4 v12, s[36:39], s47 offen lds
 s_waitcnt vmcnt(36)
 ds_read_b64_tr_b16 v[240:241], v3 offset:8192
 ds_read_b64_tr_b16 v[64:65], v3 offset:8704
 s_waitcnt lgkmcnt(6)
 s_add_u32 m0, s45, 5120
 s_mov_b32 s47, 0x61040
 buffer_load_dwordx4 v12, s[36:39], s47 offen lds
 s_waitcnt vmcnt(36)
 ds_read_b64_tr_b16 v[242:243], v3 offset:9216
 ds_read_b64_tr_b16 v[66:67], v3 offset:9728
 s_waitcnt lgkmcnt(6)
 s_add_u32 m0, s45, 6144
 s_mov_b32 s47, 0x64040
 buffer_load_dwordx4 v12, s[36:39], s47 offen lds
 s_waitcnt vmcnt(36)
 ds_read_b64_tr_b16 v[244:245], v3 offset:10240
 ds_read_b64_tr_b16 v[68:69], v3 offset:10752
 s_waitcnt lgkmcnt(6)
 s_add_u32 m0, s45, 7168
 s_mov_b32 s47, 0x65040
 buffer_load_dwordx4 v12, s[36:39], s47 offen lds
 s_waitcnt vmcnt(36)
 ds_read_b64_tr_b16 v[246:247], v3 offset:11264
 ds_read_b64_tr_b16 v[70:71], v3 offset:11776
 s_waitcnt lgkmcnt(6)
 s_add_u32 m0, s45, 8192
 s_mov_b32 s47, 0x80000
 buffer_load_dwordx4 v12, s[36:39], s47 offen lds
 s_waitcnt vmcnt(36)
 ds_read_b64_tr_b16 v[248:249], v3 offset:12288
 ds_read_b64_tr_b16 v[72:73], v3 offset:12800
 s_waitcnt lgkmcnt(6)
 s_add_u32 m0, s45, 9216
 s_mov_b32 s47, 0x81000
 buffer_load_dwordx4 v12, s[36:39], s47 offen lds
 s_waitcnt vmcnt(36)
 ds_read_b64_tr_b16 v[250:251], v3 offset:13312
 ds_read_b64_tr_b16 v[74:75], v3 offset:13824
 s_waitcnt lgkmcnt(6)
 s_add_u32 m0, s45, 10240
 s_mov_b32 s47, 0x84000
 buffer_load_dwordx4 v12, s[36:39], s47 offen lds
 s_waitcnt vmcnt(36)
 ds_read_b64_tr_b16 v[252:253], v3 offset:14336
 ds_read_b64_tr_b16 v[76:77], v3 offset:14848
 s_waitcnt lgkmcnt(6)
 s_add_u32 m0, s45, 11264
 s_mov_b32 s47, 0x85000
 buffer_load_dwordx4 v12, s[36:39], s47 offen lds
 s_waitcnt vmcnt(36)
 ds_read_b64_tr_b16 v[254:255], v3 offset:15360
 ds_read_b64_tr_b16 v[78:79], v3 offset:15872
 s_waitcnt lgkmcnt(6)
 s_add_u32 m0, s45, 12288
 s_mov_b32 s47, 0xa0000
 buffer_load_dwordx4 v12, s[36:39], s47 offen lds
 s_waitcnt vmcnt(36)
 ds_read_b64_tr_b16 a[0:1], v3 offset:16384
 ds_read_b64_tr_b16 a[8:9], v3 offset:16896
 s_waitcnt lgkmcnt(6)
 s_add_u32 m0, s45, 13312
 s_mov_b32 s47, 0xa1000
 buffer_load_dwordx4 v12, s[36:39], s47 offen lds
 s_waitcnt vmcnt(36)
 ds_read_b64_tr_b16 a[2:3], v3 offset:17408
 ds_read_b64_tr_b16 a[10:11], v3 offset:17920
 s_waitcnt lgkmcnt(6)
 s_add_u32 m0, s45, 14336
 s_mov_b32 s47, 0xa4000
 buffer_load_dwordx4 v12, s[36:39], s47 offen lds
 s_waitcnt vmcnt(36)
 ds_read_b64_tr_b16 a[4:5], v3 offset:18432
 ds_read_b64_tr_b16 a[12:13], v3 offset:18944
 s_waitcnt lgkmcnt(6)
 s_add_u32 m0, s45, 15360
 s_mov_b32 s47, 0xa5000
 buffer_load_dwordx4 v12, s[36:39], s47 offen lds
 s_waitcnt vmcnt(36)
 ds_read_b64_tr_b16 a[6:7], v3 offset:19456
 ds_read_b64_tr_b16 a[14:15], v3 offset:19968
 s_waitcnt lgkmcnt(6)
 s_add_u32 m0, s45, 16384
 s_mov_b32 s47, 0x80040
 buffer_load_dwordx4 v12, s[36:39], s47 offen lds
 s_waitcnt vmcnt(36)
 ds_read_b64_tr_b16 a[24:25], v3 offset:20480
 ds_read_b64_tr_b16 a[32:33], v3 offset:20992
 s_waitcnt lgkmcnt(6)
 s_add_u32 m0, s45, 17408
 s_mov_b32 s47, 0x81040
 buffer_load_dwordx4 v12, s[36:39], s47 offen lds
 s_waitcnt vmcnt(36)
 ds_read_b64_tr_b16 a[26:27], v3 offset:21504
 ds_read_b64_tr_b16 a[34:35], v3 offset:22016
 s_waitcnt lgkmcnt(6)
 s_add_u32 m0, s45, 18432
 s_mov_b32 s47, 0x84040
 buffer_load_dwordx4 v12, s[36:39], s47 offen lds
 s_waitcnt vmcnt(36)
 ds_read_b64_tr_b16 a[28:29], v3 offset:22528
 ds_read_b64_tr_b16 a[36:37], v3 offset:23040
 s_waitcnt lgkmcnt(6)
 s_add_u32 m0, s45, 19456
 s_mov_b32 s47, 0x85040
 buffer_load_dwordx4 v12, s[36:39], s47 offen lds
 s_waitcnt vmcnt(36)
 ds_read_b64_tr_b16 a[30:31], v3 offset:23552
 ds_read_b64_tr_b16 a[38:39], v3 offset:24064
 s_waitcnt lgkmcnt(6)
 s_add_u32 m0, s45, 20480
 s_mov_b32 s47, 0xa0040
 buffer_load_dwordx4 v12, s[36:39], s47 offen lds
 s_waitcnt vmcnt(36)
 ds_read_b64_tr_b16 a[16:17], v3 offset:24576
 ds_read_b64_tr_b16 v[80:81], v3 offset:25088
 s_waitcnt lgkmcnt(6)
 s_add_u32 m0, s45, 21504
 s_mov_b32 s47, 0xa1040
 buffer_load_dwordx4 v12, s[36:39], s47 offen lds
 s_waitcnt vmcnt(36)
 ds_read_b64_tr_b16 a[18:19], v3 offset:25600
 ds_read_b64_tr_b16 v[82:83], v3 offset:26112
 s_waitcnt lgkmcnt(6)
 s_add_u32 m0, s45, 22528
 s_mov_b32 s47, 0xa4040
 buffer_load_dwordx4 v12, s[36:39], s47 offen lds
 s_waitcnt vmcnt(36)
 ds_read_b64_tr_b16 a[20:21], v3 offset:26624
 ds_read_b64_tr_b16 v[84:85], v3 offset:27136
 s_waitcnt lgkmcnt(6)
 s_add_u32 m0, s45, 23552
 s_mov_b32 s47, 0xa5040
 buffer_load_dwordx4 v12, s[36:39], s47 offen lds
 s_waitcnt vmcnt(36)
 ds_read_b64_tr_b16 a[22:23], v3 offset:27648
 ds_read_b64_tr_b16 v[86:87], v3 offset:28160
 s_waitcnt lgkmcnt(6)
 s_add_u32 m0, s45, 24576
 s_mov_b32 s47, 0xc0000
 buffer_load_dwordx4 v12, s[36:39], s47 offen lds
 s_waitcnt vmcnt(36)
 ds_read_b64_tr_b16 a[40:41], v3 offset:28672
 ds_read_b64_tr_b16 v[88:89], v3 offset:29184
 s_waitcnt lgkmcnt(6)
 s_add_u32 m0, s45, 25600
 s_mov_b32 s47, 0xc1000
 buffer_load_dwordx4 v12, s[36:39], s47 offen lds
 s_waitcnt vmcnt(36)
 ds_read_b64_tr_b16 a[42:43], v3 offset:29696
 ds_read_b64_tr_b16 v[90:91], v3 offset:30208
 s_waitcnt lgkmcnt(6)
 s_add_u32 m0, s45, 26624
 s_mov_b32 s47, 0xc4000
 buffer_load_dwordx4 v12, s[36:39], s47 offen lds
 s_waitcnt vmcnt(36)
 ds_read_b64_tr_b16 a[44:45], v3 offset:30720
 ds_read_b64_tr_b16 v[92:93], v3 offset:31232
 s_waitcnt lgkmcnt(6)
 s_add_u32 m0, s45, 27648
 s_mov_b32 s47, 0xc5000
 buffer_load_dwordx4 v12, s[36:39], s47 offen lds
 s_waitcnt vmcnt(36)
 ds_read_b64_tr_b16 a[46:47], v3 offset:31744
 ds_read_b64_tr_b16 v[94:95], v3 offset:32256
 s_waitcnt lgkmcnt(6)
 s_add_u32 m0, s45, 28672
 s_mov_b32 s47, 0xe0000
 buffer_load_dwordx4 v12, s[36:39], s47 offen lds
 s_waitcnt vmcnt(36)
 ds_read_b64_tr_b16 a[48:49], v14 offset:0
 ds_read_b64_tr_b16 a[56:57], v14 offset:512
 s_waitcnt lgkmcnt(6)
 s_add_u32 m0, s45, 29696
 s_mov_b32 s47, 0xe1000
 buffer_load_dwordx4 v12, s[36:39], s47 offen lds
 s_waitcnt vmcnt(36)
 ds_read_b64_tr_b16 a[50:51], v14 offset:1024
 ds_read_b64_tr_b16 a[58:59], v14 offset:1536
 s_waitcnt lgkmcnt(6)
 s_add_u32 m0, s45, 30720
 s_mov_b32 s47, 0xe4000
 buffer_load_dwordx4 v12, s[36:39], s47 offen lds
 s_waitcnt vmcnt(36)
 ds_read_b64_tr_b16 a[52:53], v14 offset:2048
 ds_read_b64_tr_b16 a[60:61], v14 offset:2560
 s_waitcnt lgkmcnt(6)
 s_add_u32 m0, s45, 31744
 s_mov_b32 s47, 0xe5000
 buffer_load_dwordx4 v12, s[36:39], s47 offen lds
 s_waitcnt vmcnt(36)
 ds_read_b64_tr_b16 a[54:55], v14 offset:3072
 ds_read_b64_tr_b16 a[62:63], v14 offset:3584
 s_waitcnt lgkmcnt(6)
 s_mov_b32 m0, s46
 s_mov_b32 s47, 0xc0040
 buffer_load_dwordx4 v12, s[36:39], s47 offen lds
 s_waitcnt vmcnt(36)
 ds_read_b64_tr_b16 a[72:73], v14 offset:4096
 ds_read_b64_tr_b16 a[80:81], v14 offset:4608
 s_waitcnt lgkmcnt(6)
 s_add_u32 m0, s46, 1024
 s_mov_b32 s47, 0xc1040
 buffer_load_dwordx4 v12, s[36:39], s47 offen lds
 s_waitcnt vmcnt(36)
 ds_read_b64_tr_b16 a[74:75], v14 offset:5120
 ds_read_b64_tr_b16 a[82:83], v14 offset:5632
 s_waitcnt lgkmcnt(6)
 s_add_u32 m0, s46, 2048
 s_mov_b32 s47, 0xc4040
 buffer_load_dwordx4 v12, s[36:39], s47 offen lds
 s_waitcnt vmcnt(36)
 ds_read_b64_tr_b16 a[76:77], v14 offset:6144
 ds_read_b64_tr_b16 a[84:85], v14 offset:6656
 s_waitcnt lgkmcnt(6)
 s_add_u32 m0, s46, 3072
 s_mov_b32 s47, 0xc5040
 buffer_load_dwordx4 v12, s[36:39], s47 offen lds
 s_waitcnt vmcnt(36)
 ds_read_b64_tr_b16 a[78:79], v14 offset:7168
 ds_read_b64_tr_b16 a[86:87], v14 offset:7680
 s_waitcnt lgkmcnt(6)
 s_add_u32 m0, s46, 4096
 s_mov_b32 s47, 0xe0040
 buffer_load_dwordx4 v12, s[36:39], s47 offen lds
 s_waitcnt vmcnt(36)
 ds_read_b64_tr_b16 a[64:65], v3 offset:0
 ds_read_b64_tr_b16 v[96:97], v3 offset:512
 s_waitcnt lgkmcnt(6)
 s_add_u32 m0, s46, 5120
 s_mov_b32 s47, 0xe1040
 buffer_load_dwordx4 v12, s[36:39], s47 offen lds
 s_waitcnt vmcnt(36)
 ds_read_b64_tr_b16 a[66:67], v3 offset:1024
 ds_read_b64_tr_b16 v[98:99], v3 offset:1536
 s_waitcnt lgkmcnt(6)
 s_add_u32 m0, s46, 6144
 s_mov_b32 s47, 0xe4040
 buffer_load_dwordx4 v12, s[36:39], s47 offen lds
 s_waitcnt vmcnt(36)
 ds_read_b64_tr_b16 a[68:69], v3 offset:2048
 ds_read_b64_tr_b16 v[100:101], v3 offset:2560
 s_waitcnt lgkmcnt(6)
 s_add_u32 m0, s46, 7168
 s_mov_b32 s47, 0xe5040
 buffer_load_dwordx4 v12, s[36:39], s47 offen lds
 s_waitcnt vmcnt(36)
 ds_read_b64_tr_b16 a[70:71], v3 offset:3072
 ds_read_b64_tr_b16 v[102:103], v3 offset:3584
 s_waitcnt vmcnt(35)
 ds_read_b64_tr_b16 a[88:89], v3 offset:4096
 ds_read_b64_tr_b16 v[104:105], v3 offset:4608
 s_waitcnt vmcnt(34)
 ds_read_b64_tr_b16 a[90:91], v3 offset:5120
 ds_read_b64_tr_b16 v[106:107], v3 offset:5632
 s_waitcnt vmcnt(33)
 ds_read_b64_tr_b16 a[92:93], v3 offset:6144
 ds_read_b64_tr_b16 v[108:109], v3 offset:6656
 s_waitcnt vmcnt(32)
 ds_read_b64_tr_b16 a[94:95], v3 offset:7168
 ds_read_b64_tr_b16 v[110:111], v3 offset:7680
 s_waitcnt vmcnt(31)
 ds_read_b64_tr_b16 a[96:97], v3 offset:8192
 ds_read_b64_tr_b16 a[104:105], v3 offset:8704
 s_waitcnt vmcnt(30)
 ds_read_b64_tr_b16 a[98:99], v3 offset:9216
 ds_read_b64_tr_b16 a[106:107], v3 offset:9728
 s_waitcnt vmcnt(29)
 ds_read_b64_tr_b16 a[100:101], v3 offset:10240
 ds_read_b64_tr_b16 a[108:109], v3 offset:10752
 s_waitcnt vmcnt(28)
 ds_read_b64_tr_b16 a[102:103], v3 offset:11264
 ds_read_b64_tr_b16 a[110:111], v3 offset:11776
 s_waitcnt vmcnt(27)
 ds_read_b64_tr_b16 a[120:121], v3 offset:12288
 ds_read_b64_tr_b16 a[128:129], v3 offset:12800
 s_waitcnt vmcnt(26)
 ds_read_b64_tr_b16 a[122:123], v3 offset:13312
 ds_read_b64_tr_b16 a[130:131], v3 offset:13824
 s_waitcnt vmcnt(25)
 ds_read_b64_tr_b16 a[124:125], v3 offset:14336
 ds_read_b64_tr_b16 a[132:133], v3 offset:14848
 s_waitcnt vmcnt(24)
 ds_read_b64_tr_b16 a[126:127], v3 offset:15360
 ds_read_b64_tr_b16 a[134:135], v3 offset:15872
 s_waitcnt vmcnt(23)
 ds_read_b64_tr_b16 a[112:113], v3 offset:16384
 ds_read_b64_tr_b16 v[112:113], v3 offset:16896
 s_waitcnt vmcnt(22)
 ds_read_b64_tr_b16 a[114:115], v3 offset:17408
 ds_read_b64_tr_b16 v[114:115], v3 offset:17920
 s_waitcnt vmcnt(21)
 ds_read_b64_tr_b16 a[116:117], v3 offset:18432
 ds_read_b64_tr_b16 v[116:117], v3 offset:18944
 s_waitcnt vmcnt(20)
 ds_read_b64_tr_b16 a[118:119], v3 offset:19456
 ds_read_b64_tr_b16 v[118:119], v3 offset:19968
 s_waitcnt vmcnt(19)
 ds_read_b64_tr_b16 a[136:137], v3 offset:20480
 ds_read_b64_tr_b16 v[120:121], v3 offset:20992
 s_waitcnt vmcnt(18)
 ds_read_b64_tr_b16 a[138:139], v3 offset:21504
 ds_read_b64_tr_b16 v[122:123], v3 offset:22016
 s_waitcnt vmcnt(17)
 ds_read_b64_tr_b16 a[140:141], v3 offset:22528
 ds_read_b64_tr_b16 v[124:125], v3 offset:23040
 s_waitcnt vmcnt(16)
 ds_read_b64_tr_b16 a[142:143], v3 offset:23552
 ds_read_b64_tr_b16 v[126:127], v3 offset:24064
 s_waitcnt vmcnt(15)
 ds_read_b64_tr_b16 a[144:145], v3 offset:24576
 ds_read_b64_tr_b16 a[152:153], v3 offset:25088
 s_waitcnt vmcnt(14)
 ds_read_b64_tr_b16 a[146:147], v3 offset:25600
 ds_read_b64_tr_b16 a[154:155], v3 offset:26112
 s_waitcnt vmcnt(13)
 ds_read_b64_tr_b16 a[148:149], v3 offset:26624
 ds_read_b64_tr_b16 a[156:157], v3 offset:27136
 s_waitcnt vmcnt(12)
 ds_read_b64_tr_b16 a[150:151], v3 offset:27648
 ds_read_b64_tr_b16 a[158:159], v3 offset:28160
 s_waitcnt vmcnt(11)
 ds_read_b64_tr_b16 a[168:169], v3 offset:28672
 ds_read_b64_tr_b16 a[176:177], v3 offset:29184
 s_waitcnt vmcnt(10)
 ds_read_b64_tr_b16 a[170:171], v3 offset:29696
 ds_read_b64_tr_b16 a[178:179], v3 offset:30208
 s_waitcnt vmcnt(9)
 ds_read_b64_tr_b16 a[172:173], v3 offset:30720
 ds_read_b64_tr_b16 a[180:181], v3 offset:31232
 s_waitcnt vmcnt(8)
 ds_read_b64_tr_b16 a[174:175], v3 offset:31744
 ds_read_b64_tr_b16 a[182:183], v3 offset:32256
 v_lshlrev_b32 v5, 4, v0
 v_add_u32 v5, s45, v5
 s_waitcnt lgkmcnt(0)
 ds_write_b128 v5, v[16:19] offset:0
 ds_write_b128 v5, v[20:23] offset:1024
 ds_write_b128 v5, v[24:27] offset:2048
 ds_write_b128 v5, v[28:31] offset:3072
 ds_write_b128 v5, v[32:35] offset:4096
 ds_write_b128 v5, v[36:39] offset:5120
 ds_write_b128 v5, v[40:43] offset:6144
 ds_write_b128 v5, v[44:47] offset:7168
 ds_write_b128 v5, v[48:51] offset:8192
 ds_write_b128 v5, v[52:55] offset:9216
 ds_write_b128 v5, v[56:59] offset:10240
 ds_write_b128 v5, v[60:63] offset:11264
 ds_write_b128 v5, v[64:67] offset:12288
 ds_write_b128 v5, v[68:71] offset:13312
 ds_write_b128 v5, v[72:75] offset:14336
 ds_write_b128 v5, v[76:79] offset:15360
 ds_write_b128 v5, v[80:83] offset:16384
 ds_write_b128 v5, v[84:87] offset:17408
 ds_write_b128 v5, v[88:91] offset:18432
 ds_write_b128 v5, v[92:95] offset:19456
 ds_write_b128 v5, v[96:99] offset:20480
 ds_write_b128 v5, v[100:103] offset:21504
 ds_write_b128 v5, v[104:107] offset:22528
 ds_write_b128 v5, v[108:111] offset:23552
 ds_write_b128 v5, v[112:115] offset:24576
 ds_write_b128 v5, v[116:119] offset:25600
 ds_write_b128 v5, v[120:123] offset:26624
 ds_write_b128 v5, v[124:127] offset:27648
 s_waitcnt lgkmcnt(0)
 s_waitcnt vmcnt(7)
 ds_read_b64_tr_b16 a[160:161], v14 offset:0
 ds_read_b64_tr_b16 v[16:17], v14 offset:512
 s_waitcnt vmcnt(6)
 ds_read_b64_tr_b16 a[162:163], v14 offset:1024
 ds_read_b64_tr_b16 v[18:19], v14 offset:1536
 s_waitcnt vmcnt(5)
 ds_read_b64_tr_b16 a[164:165], v14 offset:2048
 ds_read_b64_tr_b16 v[20:21], v14 offset:2560
 s_waitcnt vmcnt(4)
 ds_read_b64_tr_b16 a[166:167], v14 offset:3072
 ds_read_b64_tr_b16 v[22:23], v14 offset:3584
 s_waitcnt vmcnt(3)
 ds_read_b64_tr_b16 a[184:185], v14 offset:4096
 ds_read_b64_tr_b16 v[24:25], v14 offset:4608
 s_waitcnt vmcnt(2)
 ds_read_b64_tr_b16 a[186:187], v14 offset:5120
 ds_read_b64_tr_b16 v[26:27], v14 offset:5632
 s_waitcnt vmcnt(1)
 ds_read_b64_tr_b16 a[188:189], v14 offset:6144
 ds_read_b64_tr_b16 v[28:29], v14 offset:6656
 s_waitcnt vmcnt(0)
 ds_read_b64_tr_b16 a[190:191], v14 offset:7168
 ds_read_b64_tr_b16 v[30:31], v14 offset:7680
 s_waitcnt lgkmcnt(0)
 ds_write_b128 v5, v[16:19] offset:28672
 ds_write_b128 v5, v[20:23] offset:29696
 ds_write_b128 v5, v[24:27] offset:30720
 ds_write_b128 v5, v[28:31] offset:31744
 s_waitcnt lgkmcnt(0)
 v_mov_b32 v3, v5
 v_lshlrev_b32 v16, 4, v0
 s_lshl_b32 s47, s40, 12
 v_add_u32 v4, s47, v16
 v_and_b32 v5, 7, v0
 v_lshlrev_b32 v5, 2, v5
 v_and_b32 v14, 15, v0
 v_lshlrev_b32 v14, 2, v14
 s_add_u32 m0, s47, 131072
 s_lshl_b32 s47, s40, 13
 v_add_u32 v12, s47, v16
 v_lshrrev_b32 v16, 5, v0
 v_lshlrev_b32 v16, 4, v16
 v_and_b32 v17, 15, v0
 v_add_u32 v16, v16, v17
 v_lshlrev_b32 v16, 2, v16
 v_bfe_u32 v17, v0, 4, 1
 v_mul_u32_u24 v17, 1280, v17
 v_add_u32 v16, v17, v16
 s_mul_i32 s47, s40, 2560
 s_add_u32 s47, s47, 147456
 v_add_u32 v6, s47, v16
 v_add_u32 v15, 128, v6
 v_mov_b32 v16, 0
gw_2:
 global_load_dword v18, v16, s[22:23] offset:192 sc1
 s_waitcnt vmcnt(0)
 v_readfirstlane_b32 s48, v18
 s_cmp_ge_u32 s48, 64
 s_cbranch_scc1 gwd_3
 s_sub_u32 s26, s26, 1
 s_cbranch_scc1 L_end
 s_sleep 2
 s_branch gw_2
gwd_3:
 v_and_b32 v16, 31, v0
 v_lshlrev_b32 v16, 5, v16
 s_and_b32 s47, s2, 7
 s_lshl_b32 s47, s47, 2
 s_add_u32 s47, s47, 0
 buffer_load_dword v18, v16, s[28:31], s47 offen sc1
 s_waitcnt vmcnt(0)
 v_cmp_ne_u32 vcc, s3, v18
 s_cmp_eq_u64 vcc, 0
 s_cselect_b32 s44, 1, 0
 s_barrier
 s_mov_b32 s43, 0
 s_mov_b32 s66, -1
 s_mov_b32 s98, 0
 s_mov_b32 s97, 0
 s_add_u32 s47, s51, 98304
 s_and_b32 s47, s47, 98304
 s_andn2_b32 s49, s51, 98304
 s_or_b32 s47, s47, s49
 s_mov_b32 s51, s47
 s_add_u32 s47, s58, 49152
 s_and_b32 s47, s47, 49152
 s_andn2_b32 s49, s58, 49152
 s_or_b32 s47, s47, s49
 s_mov_b32 s58, s47
 s_add_u32 s47, s52, 6144
 s_and_b32 s47, s47, 6144
 s_andn2_b32 s49, s52, 6144
 s_or_b32 s47, s47, s49
 s_mov_b32 s52, s47
 s_add_u32 s47, s54, 6144
 s_and_b32 s47, s47, 6144
 s_andn2_b32 s49, s54, 6144
 s_or_b32 s47, s47, s49
 s_mov_b32 s54, s47
 s_add_u32 s47, s55, 6144
 s_and_b32 s47, s47, 6144
 s_andn2_b32 s49, s55, 6144
 s_or_b32 s47, s47, s49
 s_mov_b32 s55, s47
 s_lshr_b32 s99, s40, 1
 s_lshl_b32 s99, s99, 30
 s_cmp_eq_u32 s44, 1
 s_cbranch_scc0 L_vo_step_g
L_vo_step_l:
 buffer_load_dword v32, v5, s[28:31], s59 offen sc1
 buffer_load_dword v33, v5, s[28:31], s59 offen sc1
wb_4_0:
 s_waitcnt vmcnt(1)
 v_cmp_gt_u32 vcc, s43, v32
 s_cbranch_vccnz wb_4_r0
 s_branch wb_4_ok
wb_4_r0:
 buffer_load_dword v32, v5, s[28:31], s59 offen sc1
wb_4_1:
 s_waitcnt vmcnt(1)
 v_cmp_gt_u32 vcc, s43, v33
 s_cbranch_vccnz wb_4_r1
wb_4_ok:
 buffer_load_dwordx4 v4, s[28:31], s50 offen offset:0 sc1 lds
 buffer_load_dwordx4 v4, s[28:31], s50 offen offset:1024 sc1 lds
 buffer_load_dwordx4 v4, s[28:31], s50 offen offset:2048 sc1 lds
 buffer_load_dwordx4 v4, s[28:31], s50 offen offset:3072 sc1 lds
 ds_read_b128 v[64:67], v3 offset:0
 ds_read_b128 v[68:71], v3 offset:1024
 ds_read_b128 v[72:75], v3 offset:2048
 ds_read_b128 v[76:79], v3 offset:3072
 ds_read_b128 v[80:83], v3 offset:4096
 ds_read_b128 v[84:87], v3 offset:5120
 ds_read_b128 v[88:91], v3 offset:6144
 ds_read_b128 v[92:95], v3 offset:7168
 ds_read_b128 v[96:99], v3 offset:8192
 ds_read_b128 v[100:103], v3 offset:9216
 ds_read_b128 v[104:107], v3 offset:10240
 ds_read_b128 v[108:111], v3 offset:11264
 ds_read_b128 v[112:115], v3 offset:12288
 ds_read_b128 v[116:119], v3 offset:13312
 ds_read_b128 v[120:123], v3 offset:14336
 ds_read_b128 v[124:127], v3 offset:15360
 v_mov_b32 v16, 0
 v_mov_b32 v17, 0
 v_mov_b32 v18, 0
 v_mov_b32 v19, 0
 v_mov_b32 v20, 0
 v_mov_b32 v21, 0
 v_mov_b32 v22, 0
 v_mov_b32 v23, 0
 v_mov_b32 v24, -1
 v_mov_b32 v25, -1
 v_mov_b32 v26, -1
 v_mov_b32 v27, -1
 v_mov_b32 v28, s43
 v_or_b32 v29, s99, v9
 s_mov_b32 s61, s52
 s_mov_b32 s62, s55
 s_add_u32 s49, s51, 32768
 s_and_b32 s49, s49, 98304
 s_andn2_b32 s51, s51, 98304
 s_or_b32 s51, s51, s49
 s_add_u32 s49, s58, 16384
 s_and_b32 s49, s49, 49152
 s_andn2_b32 s58, s58, 49152
 s_or_b32 s58, s58, s49
 s_add_u32 s49, s52, 2048
 s_and_b32 s49, s49, 6144
 s_andn2_b32 s52, s52, 6144
 s_or_b32 s52, s52, s49
 s_add_u32 s49, s54, 2048
 s_and_b32 s49, s49, 6144
 s_andn2_b32 s54, s54, 6144
 s_or_b32 s54, s54, s49
 s_add_u32 s49, s55, 2048
 s_and_b32 s49, s49, 6144
 s_andn2_b32 s55, s55, 6144
 s_or_b32 s55, s55, s49
 s_add_u32 s60, s58, 32768
 s_and_b32 s60, s60, 49152
 s_andn2_b32 s49, s58, 49152
 s_or_b32 s60, s60, s49
 s_add_u32 s67, s43, 1
 s_waitcnt vmcnt(0) lgkmcnt(0)
L_vo_step_l_go:
 s_barrier
 ds_read_b128 v[48:51], v2 offset:0
 ds_read_b128 v[52:55], v2 offset:1024
 ds_read_b128 v[56:59], v2 offset:2048
 ds_read_b128 v[60:63], v2 offset:3072
 s_waitcnt lgkmcnt(3)
 v_smfmac_f32_16x16x64_bf16 v[16:19], v[48:51], v[128:135], v8
 buffer_store_dwordx2 v[24:25], v10, s[28:31], s60 offen
 v_smfmac_f32_16x16x64_bf16 v[20:23], v[48:51], a[192:199], v8
 ds_read_b128 v[48:51], v2 offset:4096
 s_waitcnt lgkmcnt(3)
 v_smfmac_f32_16x16x64_bf16 v[16:19], v[52:55], v[136:143], v8
 buffer_store_dwordx2 v[24:25], v11, s[28:31], s61 offen
 v_smfmac_f32_16x16x64_bf16 v[20:23], v[52:55], a[200:207], v8
 ds_read_b128 v[52:55], v2 offset:5120
 s_waitcnt lgkmcnt(3)
 v_smfmac_f32_16x16x64_bf16 v[16:19], v[56:59], v[144:151], v8
 buffer_store_dword v28, v13, s[28:31], s56 offen sc1
 v_smfmac_f32_16x16x64_bf16 v[20:23], v[56:59], a[208:215], v8
 ds_read_b128 v[56:59], v2 offset:6144
 s_waitcnt lgkmcnt(3)
 v_smfmac_f32_16x16x64_bf16 v[16:19], v[60:63], v[152:159], v8
 s_add_u32 s48, s62, 0
 v_smfmac_f32_16x16x64_bf16 v[20:23], v[60:63], a[216:223], v8
 ds_read_b128 v[60:63], v2 offset:7168
 s_waitcnt lgkmcnt(3)
 v_smfmac_f32_16x16x64_bf16 v[16:19], v[48:51], v[160:167], v8
 buffer_store_dwordx4 v[24:27], v29, s[28:31], s48 offen sc1
 v_smfmac_f32_16x16x64_bf16 v[20:23], v[48:51], a[224:231], v8
 ds_read_b128 v[48:51], v2 offset:8192
 s_waitcnt lgkmcnt(3)
 v_smfmac_f32_16x16x64_bf16 v[16:19], v[52:55], v[168:175], v8
 v_smfmac_f32_16x16x64_bf16 v[20:23], v[52:55], a[232:239], v8
 ds_read_b128 v[52:55], v2 offset:9216
 s_waitcnt lgkmcnt(3)
 v_smfmac_f32_16x16x64_bf16 v[16:19], v[56:59], v[176:183], v8
 v_smfmac_f32_16x16x64_bf16 v[20:23], v[56:59], a[240:247], v8
 ds_read_b128 v[56:59], v2 offset:10240
 s_waitcnt lgkmcnt(3)
 v_smfmac_f32_16x16x64_bf16 v[16:19], v[60:63], v[184:191], v8
 v_smfmac_f32_16x16x64_bf16 v[20:23], v[60:63], a[248:255], v8
 ds_read_b128 v[60:63], v2 offset:11264
 s_waitcnt lgkmcnt(3)
 v_smfmac_f32_16x16x64_bf16 v[16:19], v[48:51], v[192:199], v8
 v_smfmac_f32_16x16x64_bf16 v[20:23], v[48:51], v[64:71], v8
 ds_read_b128 v[48:51], v2 offset:12288
 s_waitcnt lgkmcnt(3)
 v_smfmac_f32_16x16x64_bf16 v[16:19], v[52:55], v[200:207], v8
 v_smfmac_f32_16x16x64_bf16 v[20:23], v[52:55], v[72:79], v8
 ds_read_b128 v[52:55], v2 offset:13312
 s_waitcnt lgkmcnt(3)
 v_smfmac_f32_16x16x64_bf16 v[16:19], v[56:59], v[208:215], v8
 v_smfmac_f32_16x16x64_bf16 v[20:23], v[56:59], v[80:87], v8
 ds_read_b128 v[56:59], v2 offset:14336
 s_waitcnt lgkmcnt(3)
 v_smfmac_f32_16x16x64_bf16 v[16:19], v[60:63], v[216:223], v8
 v_smfmac_f32_16x16x64_bf16 v[20:23], v[60:63], v[88:95], v8
 ds_read_b128 v[60:63], v2 offset:15360
 s_waitcnt lgkmcnt(3)
 v_smfmac_f32_16x16x64_bf16 v[16:19], v[48:51], v[224:231], v8
 v_smfmac_f32_16x16x64_bf16 v[20:23], v[48:51], v[96:103], v8
 s_waitcnt lgkmcnt(2)
 v_smfmac_f32_16x16x64_bf16 v[16:19], v[52:55], v[232:239], v8
 v_smfmac_f32_16x16x64_bf16 v[20:23], v[52:55], v[104:111], v8
 s_waitcnt lgkmcnt(1)
 v_smfmac_f32_16x16x64_bf16 v[16:19], v[56:59], v[240:247], v8
 v_smfmac_f32_16x16x64_bf16 v[20:23], v[56:59], v[112:119], v8
 s_waitcnt lgkmcnt(0)
 v_smfmac_f32_16x16x64_bf16 v[16:19], v[60:63], v[248:255], v8
 v_smfmac_f32_16x16x64_bf16 v[20:23], v[60:63], v[120:127], v8
 s_nop 7
 v_permlane32_swap_b32 v16, v20
 v_permlane32_swap_b32 v17, v21
 v_permlane32_swap_b32 v18, v22
 v_permlane32_swap_b32 v19, v23
 v_pk_add_f32 v[16:17], v[16:17], v[20:21]
 v_pk_add_f32 v[18:19], v[18:19], v[22:23]
 v_cmp_u_f32 vcc, v16, v17
 v_cmp_u_f32 s[64:65], v18, v19
 v_cvt_pk_bf16_f32 v20, v16, v17
 v_cvt_pk_bf16_f32 v21, v18, v19
 v_min_u32 v20, -2, v20
 s_or_b64 vcc, vcc, s[64:65]
 s_cbranch_vccnz L_vo_step_l_nan
L_vo_step_l_ok:
 buffer_store_dwordx2 v[20:21], v11, s[28:31], s52 offen
 buffer_store_dwordx2 v[20:21], v11, s[28:31], s53 offen sc1
 s_add_u32 s53, s53, 65536
 s_cmp_eq_u32 s43, 63
 s_cbranch_scc1 L_vo_last
 ds_read_b128 v[64:67], v3 offset:16384
 ds_read_b128 v[68:71], v3 offset:17408
 ds_read_b128 v[72:75], v3 offset:18432
 ds_read_b128 v[76:79], v3 offset:19456
 ds_read_b128 v[80:83], v3 offset:20480
 ds_read_b128 v[84:87], v3 offset:21504
 ds_read_b128 v[88:91], v3 offset:22528
 ds_read_b128 v[92:95], v3 offset:23552
 ds_read_b128 v[96:99], v3 offset:24576
 ds_read_b128 v[100:103], v3 offset:25600
 ds_read_b128 v[104:107], v3 offset:26624
 ds_read_b128 v[108:111], v3 offset:27648
 ds_read_b128 v[112:115], v3 offset:28672
 ds_read_b128 v[116:119], v3 offset:29696
 ds_read_b128 v[120:123], v3 offset:30720
 ds_read_b128 v[124:127], v3 offset:31744
 v_mov_b32 v16, 0
 v_mov_b32 v17, 0
 v_mov_b32 v18, 0
 v_mov_b32 v19, 0
 v_mov_b32 v20, 0
 v_mov_b32 v21, 0
 v_mov_b32 v22, 0
 v_mov_b32 v23, 0
 v_mov_b32 v24, 0
 v_mov_b32 v25, 0
 v_mov_b32 v26, 0
 v_mov_b32 v27, 0
 v_mov_b32 v28, 0
 v_mov_b32 v29, 0
 v_mov_b32 v30, 0
 v_mov_b32 v31, 0
 s_add_u32 s57, s51, 4096
 s_cmp_lt_u32 s43, 6
 s_cbranch_scc1 op_5_early
op_5_cal:
 v_mov_b32 v0, s67
 s_waitcnt lgkmcnt(0)
 buffer_load_dword v32, v14, s[28:31], s96 offen sc1
 buffer_load_dword v33, v14, s[28:31], s96 offen sc1
 buffer_load_dword v34, v14, s[28:31], s96 offen sc1
 buffer_load_dword v35, v14, s[28:31], s96 offen sc1
wb_6_0:
 s_waitcnt vmcnt(3)
 v_cmp_gt_u32 vcc, s67, v32
 s_cbranch_vccnz wb_6_r0
 buffer_load_dwordx4 v[32:35], v12, s[28:31], s51 offen offset:0 sc1
 s_branch wb_6_ok
wb_6_r0:
 buffer_load_dword v32, v14, s[28:31], s96 offen sc1
wb_6_1:
 s_waitcnt vmcnt(3)
 v_cmp_gt_u32 vcc, s67, v33
 s_cbranch_vccnz wb_6_r1
 buffer_load_dwordx4 v[32:35], v12, s[28:31], s51 offen offset:0 sc1
 s_branch wb_6_ok
wb_6_r1:
 buffer_load_dword v33, v14, s[28:31], s96 offen sc1
wb_6_2:
 s_waitcnt vmcnt(3)
 v_cmp_gt_u32 vcc, s67, v34
 s_cbranch_vccnz wb_6_r2
 buffer_load_dwordx4 v[32:35], v12, s[28:31], s51 offen offset:0 sc1
 s_branch wb_6_ok
wb_6_r2:
 buffer_load_dword v34, v14, s[28:31], s96 offen sc1
wb_6_3:
 s_waitcnt vmcnt(3)
 v_cmp_gt_u32 vcc, s67, v35
 s_cbranch_vccnz wb_6_r3
 buffer_load_dwordx4 v[32:35], v12, s[28:31], s51 offen offset:0 sc1
wb_6_ok:
 buffer_load_dwordx4 v[36:39], v12, s[28:31], s51 offen offset:1024 sc1
 buffer_load_dwordx4 v[40:43], v12, s[28:31], s51 offen offset:2048 sc1
 buffer_load_dwordx4 v[44:47], v12, s[28:31], s51 offen offset:3072 sc1
 buffer_load_dwordx4 v[48:51], v12, s[28:31], s57 offen offset:0 sc1
 s_waitcnt vmcnt(4)
 v_cmp_eq_u32 vcc, -1, v32
 s_cbranch_vccnz op_5_f0
op_5_c0:
 v_smfmac_f32_16x16x64_bf16 v[16:19], v[32:35], a[0:7], v8
 buffer_load_dwordx4 v[52:55], v12, s[28:31], s57 offen offset:1024 sc1
 v_smfmac_f32_16x16x64_bf16 v[20:23], v[32:35], a[8:15], v8
 s_waitcnt vmcnt(4)
 v_cmp_eq_u32 vcc, -1, v36
 v_smfmac_f32_16x16x64_bf16 v[24:27], v[32:35], a[16:23], v8
 v_smfmac_f32_16x16x64_bf16 v[28:31], v[32:35], v[64:71], v8
 s_cbranch_vccnz op_5_f1
op_5_c1:
 v_smfmac_f32_16x16x64_bf16 v[16:19], v[36:39], a[24:31], v8
 buffer_load_dwordx4 v[56:59], v12, s[28:31], s57 offen offset:2048 sc1
 v_smfmac_f32_16x16x64_bf16 v[20:23], v[36:39], a[32:39], v8
 s_waitcnt vmcnt(4)
 v_cmp_eq_u32 vcc, -1, v40
 v_smfmac_f32_16x16x64_bf16 v[24:27], v[36:39], a[40:47], v8
 v_smfmac_f32_16x16x64_bf16 v[28:31], v[36:39], v[72:79], v8
 s_cbranch_vccnz op_5_f2
op_5_c2:
 v_smfmac_f32_16x16x64_bf16 v[16:19], v[40:43], a[48:55], v8
 buffer_load_dwordx4 v[60:63], v12, s[28:31], s57 offen offset:3072 sc1
 v_smfmac_f32_16x16x64_bf16 v[20:23], v[40:43], a[56:63], v8
 s_waitcnt vmcnt(4)
 v_cmp_eq_u32 vcc, -1, v44
 v_smfmac_f32_16x16x64_bf16 v[24:27], v[40:43], a[64:71], v8
 v_smfmac_f32_16x16x64_bf16 v[28:31], v[40:43], v[80:87], v8
 s_cbranch_vccnz op_5_f3
op_5_c3:
 v_smfmac_f32_16x16x64_bf16 v[16:19], v[44:47], a[72:79], v8
 v_smfmac_f32_16x16x64_bf16 v[20:23], v[44:47], a[80:87], v8
 s_waitcnt vmcnt(3)
 v_cmp_eq_u32 vcc, -1, v48
 v_smfmac_f32_16x16x64_bf16 v[24:27], v[44:47], a[88:95], v8
 v_smfmac_f32_16x16x64_bf16 v[28:31], v[44:47], v[88:95], v8
 s_cbranch_vccnz op_5_f4
op_5_c4:
 v_smfmac_f32_16x16x64_bf16 v[16:19], v[48:51], a[96:103], v8
 v_smfmac_f32_16x16x64_bf16 v[20:23], v[48:51], a[104:111], v8
 s_waitcnt vmcnt(2)
 v_cmp_eq_u32 vcc, -1, v52
 v_smfmac_f32_16x16x64_bf16 v[24:27], v[48:51], a[112:119], v8
 v_smfmac_f32_16x16x64_bf16 v[28:31], v[48:51], v[96:103], v8
 s_cbranch_vccnz op_5_f5
op_5_c5:
 v_smfmac_f32_16x16x64_bf16 v[16:19], v[52:55], a[120:127], v8
 v_smfmac_f32_16x16x64_bf16 v[20:23], v[52:55], a[128:135], v8
 s_waitcnt vmcnt(1)
 v_cmp_eq_u32 vcc, -1, v56
 v_smfmac_f32_16x16x64_bf16 v[24:27], v[52:55], a[136:143], v8
 v_smfmac_f32_16x16x64_bf16 v[28:31], v[52:55], v[104:111], v8
 s_cbranch_vccnz op_5_f6
op_5_c6:
 v_smfmac_f32_16x16x64_bf16 v[16:19], v[56:59], a[144:151], v8
 v_smfmac_f32_16x16x64_bf16 v[20:23], v[56:59], a[152:159], v8
 s_waitcnt vmcnt(0)
 v_cmp_eq_u32 vcc, -1, v60
 v_smfmac_f32_16x16x64_bf16 v[24:27], v[56:59], a[160:167], v8
 v_smfmac_f32_16x16x64_bf16 v[28:31], v[56:59], v[112:119], v8
 s_cbranch_vccnz op_5_f7
op_5_c7:
 v_smfmac_f32_16x16x64_bf16 v[16:19], v[60:63], a[168:175], v8
 v_smfmac_f32_16x16x64_bf16 v[20:23], v[60:63], a[176:183], v8
 v_smfmac_f32_16x16x64_bf16 v[24:27], v[60:63], a[184:191], v8
 v_smfmac_f32_16x16x64_bf16 v[28:31], v[60:63], v[120:127], v8
op_5_done:
 v_permlane32_swap_b32 v16, v20
 v_permlane32_swap_b32 v17, v21
 v_permlane32_swap_b32 v18, v22
 v_permlane32_swap_b32 v19, v23
 v_pk_add_f32 v[16:17], v[16:17], v[20:21]
 v_pk_add_f32 v[18:19], v[18:19], v[22:23]
 ds_write2_b32 v6, v16, v17 offset0:0 offset1:80
 ds_write2_b32 v6, v18, v19 offset0:160 offset1:240
 v_permlane32_swap_b32 v24, v28
 v_permlane32_swap_b32 v25, v29
 v_permlane32_swap_b32 v26, v30
 v_permlane32_swap_b32 v27, v31
 v_pk_add_f32 v[24:25], v[24:25], v[28:29]
 v_pk_add_f32 v[26:27], v[26:27], v[30:31]
 ds_write2_b32 v15, v24, v25 offset0:0 offset1:80
 ds_write2_b32 v15, v26, v27 offset0:160 offset1:240
 s_cmp_ge_u32 s40, 2
 s_waitcnt lgkmcnt(0)
 s_barrier
 ds_read_b128 v[16:19], v7 offset:0
 ds_read_b128 v[20:23], v7 offset:2560
 ds_read_b128 v[24:27], v7 offset:5120
 ds_read_b128 v[28:31], v7 offset:7680
 s_waitcnt lgkmcnt(2)
 v_pk_add_f32 v[16:17], v[16:17], v[20:21]
 v_pk_add_f32 v[18:19], v[18:19], v[22:23]
 s_waitcnt lgkmcnt(0)
 v_pk_add_f32 v[24:25], v[24:25], v[28:29]
 v_pk_add_f32 v[26:27], v[26:27], v[30:31]
 v_pk_add_f32 v[16:17], v[16:17], v[24:25]
 v_pk_add_f32 v[18:19], v[18:19], v[26:27]
 s_cbranch_scc1 L_vo_step_l_ld
 v_min_u32 v16, -2, v16
 buffer_store_dwordx4 v[16:19], v9, s[28:31], s54 offen offset:0 sc1
 s_branch L_vo_step_l_fin
L_vo_step_l_ld:
 s_sleep 6
 buffer_load_dwordx4 v[32:35], v9, s[28:31], s55 offen offset:0 sc1
got_7_l:
 s_waitcnt vmcnt(0)
 v_cmp_eq_u32 vcc, -1, v32
 s_cbranch_vccnz got_7_again
 v_pk_add_f32 v[16:17], v[16:17], v[32:33]
 v_pk_add_f32 v[18:19], v[18:19], v[34:35]
got_7_fin:
 buffer_store_dword v0, v13, s[28:31], s27 offen
 v_cvt_pk_bf16_f32 v28, v16, v17
 v_cvt_pk_bf16_f32 v29, v18, v19
 v_min_u32 v28, -2, v28
 v_min_u32 v29, -2, v29
 buffer_store_dwordx2 v[28:29], v10, s[28:31], s58 offen
L_vo_step_l_fin:
 s_add_u32 s49, s50, 16384
 s_and_b32 s49, s49, 49152
 s_andn2_b32 s50, s50, 49152
 s_or_b32 s50, s50, s49
 s_add_u32 s43, s43, 1
 s_branch L_vo_step_l
wb_4_r1:
 buffer_load_dword v33, v5, s[28:31], s59 offen sc1
 s_sub_u32 s26, s26, 1
 s_cbranch_scc1 L_end
 s_branch wb_4_0
L_vo_step_l_nan:
 s_mov_b64 s[64:65], 0
 s_mov_b64 vcc, 0
 s_cmp_eq_u32 s66, s43
 s_cbranch_scc1 L_vo_step_l_ok
 s_mov_b32 s66, s43
L_vo_step_l_nan_again:
 s_waitcnt vmcnt(0) lgkmcnt(0)
 s_barrier
 buffer_load_dwordx4 v4, s[28:31], s50 offen offset:0 sc1 lds
 buffer_load_dwordx4 v4, s[28:31], s50 offen offset:1024 sc1 lds
 buffer_load_dwordx4 v4, s[28:31], s50 offen offset:2048 sc1 lds
 buffer_load_dwordx4 v4, s[28:31], s50 offen offset:3072 sc1 lds
 s_sub_u32 s26, s26, 1
 s_cbranch_scc1 L_end
 s_waitcnt vmcnt(0)
 s_barrier
 v_mov_b32 v1, 0
 ds_read_b128 v[48:51], v2 offset:0
 s_waitcnt lgkmcnt(0)
 v_max3_u32 v1, v1, v48, v49
 v_max3_u32 v1, v1, v50, v51
 ds_read_b128 v[48:51], v2 offset:1024
 s_waitcnt lgkmcnt(0)
 v_max3_u32 v1, v1, v48, v49
 v_max3_u32 v1, v1, v50, v51
 ds_read_b128 v[48:51], v2 offset:2048
 s_waitcnt lgkmcnt(0)
 v_max3_u32 v1, v1, v48, v49
 v_max3_u32 v1, v1, v50, v51
 ds_read_b128 v[48:51], v2 offset:3072
 s_waitcnt lgkmcnt(0)
 v_max3_u32 v1, v1, v48, v49
 v_max3_u32 v1, v1, v50, v51
 ds_read_b128 v[48:51], v2 offset:4096
 s_waitcnt lgkmcnt(0)
 v_max3_u32 v1, v1, v48, v49
 v_max3_u32 v1, v1, v50, v51
 ds_read_b128 v[48:51], v2 offset:5120
 s_waitcnt lgkmcnt(0)
 v_max3_u32 v1, v1, v48, v49
 v_max3_u32 v1, v1, v50, v51
 ds_read_b128 v[48:51], v2 offset:6144
 s_waitcnt lgkmcnt(0)
 v_max3_u32 v1, v1, v48, v49
 v_max3_u32 v1, v1, v50, v51
 ds_read_b128 v[48:51], v2 offset:7168
 s_waitcnt lgkmcnt(0)
 v_max3_u32 v1, v1, v48, v49
 v_max3_u32 v1, v1, v50, v51
 ds_read_b128 v[48:51], v2 offset:8192
 s_waitcnt lgkmcnt(0)
 v_max3_u32 v1, v1, v48, v49
 v_max3_u32 v1, v1, v50, v51
 ds_read_b128 v[48:51], v2 offset:9216
 s_waitcnt lgkmcnt(0)
 v_max3_u32 v1, v1, v48, v49
 v_max3_u32 v1, v1, v50, v51
 ds_read_b128 v[48:51], v2 offset:10240
 s_waitcnt lgkmcnt(0)
 v_max3_u32 v1, v1, v48, v49
 v_max3_u32 v1, v1, v50, v51
 ds_read_b128 v[48:51], v2 offset:11264
 s_waitcnt lgkmcnt(0)
 v_max3_u32 v1, v1, v48, v49
 v_max3_u32 v1, v1, v50, v51
 ds_read_b128 v[48:51], v2 offset:12288
 s_waitcnt lgkmcnt(0)
 v_max3_u32 v1, v1, v48, v49
 v_max3_u32 v1, v1, v50, v51
 ds_read_b128 v[48:51], v2 offset:13312
 s_waitcnt lgkmcnt(0)
 v_max3_u32 v1, v1, v48, v49
 v_max3_u32 v1, v1, v50, v51
 ds_read_b128 v[48:51], v2 offset:14336
 s_waitcnt lgkmcnt(0)
 v_max3_u32 v1, v1, v48, v49
 v_max3_u32 v1, v1, v50, v51
 ds_read_b128 v[48:51], v2 offset:15360
 s_waitcnt lgkmcnt(0)
 v_max3_u32 v1, v1, v48, v49
 v_max3_u32 v1, v1, v50, v51
 v_cmp_eq_u32 vcc, -1, v1
 s_cbranch_vccnz L_vo_step_l_nan_again
 v_mov_b32 v16, 0
 v_mov_b32 v17, 0
 v_mov_b32 v18, 0
 v_mov_b32 v19, 0
 v_mov_b32 v20, 0
 v_mov_b32 v21, 0
 v_mov_b32 v22, 0
 v_mov_b32 v23, 0
 s_waitcnt lgkmcnt(0)
 s_branch L_vo_step_l_go
op_5_early:
 s_cmp_eq_u32 s43, 2
 s_cbranch_scc1 op_5_probe
 s_cmp_eq_u32 s43, 5
 s_cbranch_scc1 op_5_pick
 s_cmp_lg_u32 s43, 1
 s_cbranch_scc1 op_5_cal
 v_and_b32 v32, 0x3ff, v9
 buffer_store_dwordx4 v[16:19], v32, s[28:31], s63 offen sc1
 s_branch op_5_cal
op_5_probe:
 s_waitcnt vmcnt(0) lgkmcnt(0)
 s_mov_b32 s64, -1
 s_memtime s[68:69]
 s_waitcnt lgkmcnt(0)
 s_mov_b32 s65, s68
 buffer_load_dword v32, v13, s[28:31], s63 offen offset:0 sc1
 s_waitcnt vmcnt(0)
 s_memtime s[68:69]
 s_waitcnt lgkmcnt(0)
 s_sub_u32 s68, s68, s65
 s_min_u32 s64, s64, s68
 s_memtime s[68:69]
 s_waitcnt lgkmcnt(0)
 s_mov_b32 s65, s68
 buffer_load_dword v32, v13, s[28:31], s63 offen offset:256 sc1
 s_waitcnt vmcnt(0)
 s_memtime s[68:69]
 s_waitcnt lgkmcnt(0)
 s_sub_u32 s68, s68, s65
 s_min_u32 s64, s64, s68
 s_memtime s[68:69]
 s_waitcnt lgkmcnt(0)
 s_mov_b32 s65, s68
 buffer_load_dword v32, v13, s[28:31], s63 offen offset:512 sc1
 s_waitcnt vmcnt(0)
 s_memtime s[68:69]
 s_waitcnt lgkmcnt(0)
 s_sub_u32 s68, s68, s65
 s_min_u32 s64, s64, s68
 s_lshl_b32 s47, s40, 2
 v_mov_b32 v33, 147456
 v_add_u32 v34, s47, v33
 v_mov_b32 v32, s64
 ds_write_b32 v34, v32
 s_waitcnt lgkmcnt(0)
 s_barrier
 ds_read_b128 v[36:39], v33
 s_waitcnt lgkmcnt(0)
 s_barrier
 v_min_u32 v36, v36, v38
 v_min_u32 v37, v37, v39
 v_cmp_lt_u32 vcc, v37, v36
 s_lshl_b32 s47, s41, 3
 s_lshl_b32 s47, 0x100, s47
 s_cmp_eq_u64 vcc, 0
 s_cselect_b32 s47, 0, s47
 s_add_u32 s47, s47, 1
 s_cmp_lg_u32 s40, 0
 s_cbranch_scc1 op_5_cal
 s_mov_b64 exec, 1
 v_mov_b32 v32, 0
 v_mov_b32 v33, s47
 global_atomic_add v32, v33, s[22:23] offset:196 sc1
 s_mov_b64 exec, -1
 s_branch op_5_cal
op_5_pick:
 v_mov_b32 v32, 0
 global_load_dword v33, v32, s[22:23] offset:196 sc1
 s_sub_u32 s26, s26, 1
 s_cbranch_scc1 L_end
 s_waitcnt vmcnt(0)
 v_readfirstlane_b32 s48, v33
 s_and_b32 s47, s48, 0xff
 s_cmp_lt_u32 s47, 32
 s_cbranch_scc1 op_5_pick
 s_xor_b32 s47, s41, 0
 s_lshl_b32 s47, s47, 3
 s_add_u32 s47, s47, 8
 s_lshr_b32 s47, s48, s47
 s_and_b32 s47, s47, 0xff
 s_cmp_gt_u32 s47, 8
 s_cselect_b32 s47, 8192, 0
 s_add_u32 s55, s55, s47
 s_xor_b32 s47, s41, 1
 s_lshl_b32 s47, s47, 3
 s_add_u32 s47, s47, 8
 s_lshr_b32 s47, s48, s47
 s_and_b32 s47, s47, 0xff
 s_cmp_gt_u32 s47, 8
 s_cselect_b32 s47, 8192, 0
 s_add_u32 s54, s54, s47
 s_branch op_5_cal
wb_6_r3:
 buffer_load_dword v35, v14, s[28:31], s96 offen sc1
 s_sub_u32 s26, s26, 1
 s_cbranch_scc1 L_end
 s_branch wb_6_0
op_5_f0:
 buffer_load_dwordx4 v[32:35], v12, s[28:31], s51 offen offset:0 sc1
 buffer_load_dwordx4 v[36:39], v12, s[28:31], s51 offen offset:1024 sc1
 buffer_load_dwordx4 v[40:43], v12, s[28:31], s51 offen offset:2048 sc1
 buffer_load_dwordx4 v[44:47], v12, s[28:31], s51 offen offset:3072 sc1
 buffer_load_dwordx4 v[48:51], v12, s[28:31], s57 offen offset:0 sc1
 s_sub_u32 s26, s26, 1
 s_cbranch_scc1 L_end
 s_waitcnt vmcnt(4)
 v_cmp_eq_u32 vcc, -1, v32
 s_cbranch_vccnz op_5_f0
 s_branch op_5_c0
op_5_f1:
 buffer_load_dwordx4 v[36:39], v12, s[28:31], s51 offen offset:1024 sc1
 buffer_load_dwordx4 v[40:43], v12, s[28:31], s51 offen offset:2048 sc1
 buffer_load_dwordx4 v[44:47], v12, s[28:31], s51 offen offset:3072 sc1
 buffer_load_dwordx4 v[48:51], v12, s[28:31], s57 offen offset:0 sc1
 buffer_load_dwordx4 v[52:55], v12, s[28:31], s57 offen offset:1024 sc1
 s_sub_u32 s26, s26, 1
 s_cbranch_scc1 L_end
 s_waitcnt vmcnt(4)
 v_cmp_eq_u32 vcc, -1, v36
 s_cbranch_vccnz op_5_f1
 s_branch op_5_c1
op_5_f2:
 buffer_load_dwordx4 v[40:43], v12, s[28:31], s51 offen offset:2048 sc1
 buffer_load_dwordx4 v[44:47], v12, s[28:31], s51 offen offset:3072 sc1
 buffer_load_dwordx4 v[48:51], v12, s[28:31], s57 offen offset:0 sc1
 buffer_load_dwordx4 v[52:55], v12, s[28:31], s57 offen offset:1024 sc1
 buffer_load_dwordx4 v[56:59], v12, s[28:31], s57 offen offset:2048 sc1
 s_sub_u32 s26, s26, 1
 s_cbranch_scc1 L_end
 s_waitcnt vmcnt(4)
 v_cmp_eq_u32 vcc, -1, v40
 s_cbranch_vccnz op_5_f2
 s_branch op_5_c2
op_5_f3:
 buffer_load_dwordx4 v[44:47], v12, s[28:31], s51 offen offset:3072 sc1
 buffer_load_dwordx4 v[48:51], v12, s[28:31], s57 offen offset:0 sc1
 buffer_load_dwordx4 v[52:55], v12, s[28:31], s57 offen offset:1024 sc1
 buffer_load_dwordx4 v[56:59], v12, s[28:31], s57 offen offset:2048 sc1
 buffer_load_dwordx4 v[60:63], v12, s[28:31], s57 offen offset:3072 sc1
 s_sub_u32 s26, s26, 1
 s_cbranch_scc1 L_end
 s_waitcnt vmcnt(4)
 v_cmp_eq_u32 vcc, -1, v44
 s_cbranch_vccnz op_5_f3
 s_branch op_5_c3
op_5_f4:
 buffer_load_dwordx4 v[48:51], v12, s[28:31], s57 offen offset:0 sc1
 buffer_load_dwordx4 v[52:55], v12, s[28:31], s57 offen offset:1024 sc1
 buffer_load_dwordx4 v[56:59], v12, s[28:31], s57 offen offset:2048 sc1
 buffer_load_dwordx4 v[60:63], v12, s[28:31], s57 offen offset:3072 sc1
 s_sub_u32 s26, s26, 1
 s_cbranch_scc1 L_end
 s_waitcnt vmcnt(3)
 v_cmp_eq_u32 vcc, -1, v48
 s_cbranch_vccnz op_5_f4
 s_branch op_5_c4
op_5_f5:
 buffer_load_dwordx4 v[52:55], v12, s[28:31], s57 offen offset:1024 sc1
 buffer_load_dwordx4 v[56:59], v12, s[28:31], s57 offen offset:2048 sc1
 buffer_load_dwordx4 v[60:63], v12, s[28:31], s57 offen offset:3072 sc1
 s_sub_u32 s26, s26, 1
 s_cbranch_scc1 L_end
 s_waitcnt vmcnt(2)
 v_cmp_eq_u32 vcc, -1, v52
 s_cbranch_vccnz op_5_f5
 s_branch op_5_c5
op_5_f6:
 buffer_load_dwordx4 v[56:59], v12, s[28:31], s57 offen offset:2048 sc1
 buffer_load_dwordx4 v[60:63], v12, s[28:31], s57 offen offset:3072 sc1
 s_sub_u32 s26, s26, 1
 s_cbranch_scc1 L_end
 s_waitcnt vmcnt(1)
 v_cmp_eq_u32 vcc, -1, v56
 s_cbranch_vccnz op_5_f6
 s_branch op_5_c6
op_5_f7:
 buffer_load_dwordx4 v[60:63], v12, s[28:31], s57 offen offset:3072 sc1
 s_sub_u32 s26, s26, 1
 s_cbranch_scc1 L_end
 s_waitcnt vmcnt(0)
 v_cmp_eq_u32 vcc, -1, v60
 s_cbranch_vccnz op_5_f7
 s_branch op_5_c7
got_7_again:
 buffer_load_dwordx4 v[32:35], v9, s[28:31], s55 offen offset:0 sc1
 s_sub_u32 s26, s26, 1
 s_cbranch_scc1 L_end
 s_branch got_7_l
L_vo_step_g:
 buffer_load_dword v32, v5, s[28:31], s59 offen sc1
 buffer_load_dword v33, v5, s[28:31], s59 offen sc1
wb_8_0:
 s_waitcnt vmcnt(1)
 v_cmp_gt_u32 vcc, s43, v32
 s_cbranch_vccnz wb_8_r0
 s_branch wb_8_ok
wb_8_r0:
 buffer_load_dword v32, v5, s[28:31], s59 offen sc1
wb_8_1:
 s_waitcnt vmcnt(1)
 v_cmp_gt_u32 vcc, s43, v33
 s_cbranch_vccnz wb_8_r1
wb_8_ok:
 buffer_load_dwordx4 v4, s[28:31], s50 offen offset:0 sc1 lds
 buffer_load_dwordx4 v4, s[28:31], s50 offen offset:1024 sc1 lds
 buffer_load_dwordx4 v4, s[28:31], s50 offen offset:2048 sc1 lds
 buffer_load_dwordx4 v4, s[28:31], s50 offen offset:3072 sc1 lds
 ds_read_b128 v[64:67], v3 offset:0
 ds_read_b128 v[68:71], v3 offset:1024
 ds_read_b128 v[72:75], v3 offset:2048
 ds_read_b128 v[76:79], v3 offset:3072
 ds_read_b128 v[80:83], v3 offset:4096
 ds_read_b128 v[84:87], v3 offset:5120
 ds_read_b128 v[88:91], v3 offset:6144
 ds_read_b128 v[92:95], v3 offset:7168
 ds_read_b128 v[96:99], v3 offset:8192
 ds_read_b128 v[100:103], v3 offset:9216
 ds_read_b128 v[104:107], v3 offset:10240
 ds_read_b128 v[108:111], v3 offset:11264
 ds_read_b128 v[112:115], v3 offset:12288
 ds_read_b128 v[116:119], v3 offset:13312
 ds_read_b128 v[120:123], v3 offset:14336
 ds_read_b128 v[124:127], v3 offset:15360
 v_mov_b32 v16, 0
 v_mov_b32 v17, 0
 v_mov_b32 v18, 0
 v_mov_b32 v19, 0
 v_mov_b32 v20, 0
 v_mov_b32 v21, 0
 v_mov_b32 v22, 0
 v_mov_b32 v23, 0
 v_mov_b32 v24, -1
 v_mov_b32 v25, -1
 v_mov_b32 v26, -1
 v_mov_b32 v27, -1
 v_mov_b32 v28, s43
 v_or_b32 v29, s99, v9
 s_mov_b32 s61, s52
 s_mov_b32 s62, s55
 s_add_u32 s49, s51, 32768
 s_and_b32 s49, s49, 98304
 s_andn2_b32 s51, s51, 98304
 s_or_b32 s51, s51, s49
 s_add_u32 s49, s58, 16384
 s_and_b32 s49, s49, 49152
 s_andn2_b32 s58, s58, 49152
 s_or_b32 s58, s58, s49
 s_add_u32 s49, s52, 2048
 s_and_b32 s49, s49, 6144
 s_andn2_b32 s52, s52, 6144
 s_or_b32 s52, s52, s49
 s_add_u32 s49, s54, 2048
 s_and_b32 s49, s49, 6144
 s_andn2_b32 s54, s54, 6144
 s_or_b32 s54, s54, s49
 s_add_u32 s49, s55, 2048
 s_and_b32 s49, s49, 6144
 s_andn2_b32 s55, s55, 6144
 s_or_b32 s55, s55, s49
 s_add_u32 s60, s58, 32768
 s_and_b32 s60, s60, 49152
 s_andn2_b32 s49, s58, 49152
 s_or_b32 s60, s60, s49
 s_add_u32 s67, s43, 1
 s_waitcnt vmcnt(0) lgkmcnt(0)
L_vo_step_g_go:
 s_barrier
 ds_read_b128 v[48:51], v2 offset:0
 ds_read_b128 v[52:55], v2 offset:1024
 ds_read_b128 v[56:59], v2 offset:2048
 ds_read_b128 v[60:63], v2 offset:3072
 s_waitcnt lgkmcnt(3)
 v_smfmac_f32_16x16x64_bf16 v[16:19], v[48:51], v[128:135], v8
 buffer_store_dwordx2 v[24:25], v10, s[28:31], s60 offen sc1
 v_smfmac_f32_16x16x64_bf16 v[20:23], v[48:51], a[192:199], v8
 ds_read_b128 v[48:51], v2 offset:4096
 s_waitcnt lgkmcnt(3)
 v_smfmac_f32_16x16x64_bf16 v[16:19], v[52:55], v[136:143], v8
 buffer_store_dwordx2 v[24:25], v11, s[28:31], s61 offen sc1
 v_smfmac_f32_16x16x64_bf16 v[20:23], v[52:55], a[200:207], v8
 ds_read_b128 v[52:55], v2 offset:5120
 s_waitcnt lgkmcnt(3)
 v_smfmac_f32_16x16x64_bf16 v[16:19], v[56:59], v[144:151], v8
 buffer_store_dword v28, v13, s[28:31], s56 offen sc1
 v_smfmac_f32_16x16x64_bf16 v[20:23], v[56:59], a[208:215], v8
 ds_read_b128 v[56:59], v2 offset:6144
 s_waitcnt lgkmcnt(3)
 v_smfmac_f32_16x16x64_bf16 v[16:19], v[60:63], v[152:159], v8
 s_add_u32 s48, s62, 0
 v_smfmac_f32_16x16x64_bf16 v[20:23], v[60:63], a[216:223], v8
 ds_read_b128 v[60:63], v2 offset:7168
 s_waitcnt lgkmcnt(3)
 v_smfmac_f32_16x16x64_bf16 v[16:19], v[48:51], v[160:167], v8
 buffer_store_dwordx4 v[24:27], v29, s[28:31], s48 offen sc1
 v_smfmac_f32_16x16x64_bf16 v[20:23], v[48:51], a[224:231], v8
 ds_read_b128 v[48:51], v2 offset:8192
 s_waitcnt lgkmcnt(3)
 v_smfmac_f32_16x16x64_bf16 v[16:19], v[52:55], v[168:175], v8
 v_smfmac_f32_16x16x64_bf16 v[20:23], v[52:55], a[232:239], v8
 ds_read_b128 v[52:55], v2 offset:9216
 s_waitcnt lgkmcnt(3)
 v_smfmac_f32_16x16x64_bf16 v[16:19], v[56:59], v[176:183], v8
 v_smfmac_f32_16x16x64_bf16 v[20:23], v[56:59], a[240:247], v8
 ds_read_b128 v[56:59], v2 offset:10240
 s_waitcnt lgkmcnt(3)
 v_smfmac_f32_16x16x64_bf16 v[16:19], v[60:63], v[184:191], v8
 v_smfmac_f32_16x16x64_bf16 v[20:23], v[60:63], a[248:255], v8
 ds_read_b128 v[60:63], v2 offset:11264
 s_waitcnt lgkmcnt(3)
 v_smfmac_f32_16x16x64_bf16 v[16:19], v[48:51], v[192:199], v8
 v_smfmac_f32_16x16x64_bf16 v[20:23], v[48:51], v[64:71], v8
 ds_read_b128 v[48:51], v2 offset:12288
 s_waitcnt lgkmcnt(3)
 v_smfmac_f32_16x16x64_bf16 v[16:19], v[52:55], v[200:207], v8
 v_smfmac_f32_16x16x64_bf16 v[20:23], v[52:55], v[72:79], v8
 ds_read_b128 v[52:55], v2 offset:13312
 s_waitcnt lgkmcnt(3)
 v_smfmac_f32_16x16x64_bf16 v[16:19], v[56:59], v[208:215], v8
 v_smfmac_f32_16x16x64_bf16 v[20:23], v[56:59], v[80:87], v8
 ds_read_b128 v[56:59], v2 offset:14336
 s_waitcnt lgkmcnt(3)
 v_smfmac_f32_16x16x64_bf16 v[16:19], v[60:63], v[216:223], v8
 v_smfmac_f32_16x16x64_bf16 v[20:23], v[60:63], v[88:95], v8
 ds_read_b128 v[60:63], v2 offset:15360
 s_waitcnt lgkmcnt(3)
 v_smfmac_f32_16x16x64_bf16 v[16:19], v[48:51], v[224:231], v8
 v_smfmac_f32_16x16x64_bf16 v[20:23], v[48:51], v[96:103], v8
 s_waitcnt lgkmcnt(2)
 v_smfmac_f32_16x16x64_bf16 v[16:19], v[52:55], v[232:239], v8
 v_smfmac_f32_16x16x64_bf16 v[20:23], v[52:55], v[104:111], v8
 s_waitcnt lgkmcnt(1)
 v_smfmac_f32_16x16x64_bf16 v[16:19], v[56:59], v[240:247], v8
 v_smfmac_f32_16x16x64_bf16 v[20:23], v[56:59], v[112:119], v8
 s_waitcnt lgkmcnt(0)
 v_smfmac_f32_16x16x64_bf16 v[16:19], v[60:63], v[248:255], v8
 v_smfmac_f32_16x16x64_bf16 v[20:23], v[60:63], v[120:127], v8
 s_nop 7
 v_permlane32_swap_b32 v16, v20
 v_permlane32_swap_b32 v17, v21
 v_permlane32_swap_b32 v18, v22
 v_permlane32_swap_b32 v19, v23
 v_pk_add_f32 v[16:17], v[16:17], v[20:21]
 v_pk_add_f32 v[18:19], v[18:19], v[22:23]
 v_cmp_u_f32 vcc, v16, v17
 v_cmp_u_f32 s[64:65], v18, v19
 v_cvt_pk_bf16_f32 v20, v16, v17
 v_cvt_pk_bf16_f32 v21, v18, v19
 v_min_u32 v20, -2, v20
 s_or_b64 vcc, vcc, s[64:65]
 s_cbranch_vccnz L_vo_step_g_nan
L_vo_step_g_ok:
 buffer_store_dwordx2 v[20:21], v11, s[28:31], s52 offen sc1
 buffer_store_dwordx2 v[20:21], v11, s[28:31], s53 offen sc1
 s_add_u32 s53, s53, 65536
 s_cmp_eq_u32 s43, 63
 s_cbranch_scc1 L_vo_last
 ds_read_b128 v[64:67], v3 offset:16384
 ds_read_b128 v[68:71], v3 offset:17408
 ds_read_b128 v[72:75], v3 offset:18432
 ds_read_b128 v[76:79], v3 offset:19456
 ds_read_b128 v[80:83], v3 offset:20480
 ds_read_b128 v[84:87], v3 offset:21504
 ds_read_b128 v[88:91], v3 offset:22528
 ds_read_b128 v[92:95], v3 offset:23552
 ds_read_b128 v[96:99], v3 offset:24576
 ds_read_b128 v[100:103], v3 offset:25600
 ds_read_b128 v[104:107], v3 offset:26624
 ds_read_b128 v[108:111], v3 offset:27648
 ds_read_b128 v[112:115], v3 offset:28672
 ds_read_b128 v[116:119], v3 offset:29696
 ds_read_b128 v[120:123], v3 offset:30720
 ds_read_b128 v[124:127], v3 offset:31744
 v_mov_b32 v16, 0
 v_mov_b32 v17, 0
 v_mov_b32 v18, 0
 v_mov_b32 v19, 0
 v_mov_b32 v20, 0
 v_mov_b32 v21, 0
 v_mov_b32 v22, 0
 v_mov_b32 v23, 0
 v_mov_b32 v24, 0
 v_mov_b32 v25, 0
 v_mov_b32 v26, 0
 v_mov_b32 v27, 0
 v_mov_b32 v28, 0
 v_mov_b32 v29, 0
 v_mov_b32 v30, 0
 v_mov_b32 v31, 0
 s_add_u32 s57, s51, 4096
 s_cmp_lt_u32 s43, 6
 s_cbranch_scc1 op_9_early
op_9_cal:
 v_mov_b32 v0, s67
 s_waitcnt lgkmcnt(0)
 buffer_load_dword v32, v14, s[28:31], s96 offen sc1
 buffer_load_dword v33, v14, s[28:31], s96 offen sc1
 buffer_load_dword v34, v14, s[28:31], s96 offen sc1
 buffer_load_dword v35, v14, s[28:31], s96 offen sc1
wb_10_0:
 s_waitcnt vmcnt(3)
 v_cmp_gt_u32 vcc, s67, v32
 s_cbranch_vccnz wb_10_r0
 buffer_load_dwordx4 v[32:35], v12, s[28:31], s51 offen offset:0 sc1
 s_branch wb_10_ok
wb_10_r0:
 buffer_load_dword v32, v14, s[28:31], s96 offen sc1
wb_10_1:
 s_waitcnt vmcnt(3)
 v_cmp_gt_u32 vcc, s67, v33
 s_cbranch_vccnz wb_10_r1
 buffer_load_dwordx4 v[32:35], v12, s[28:31], s51 offen offset:0 sc1
 s_branch wb_10_ok
wb_10_r1:
 buffer_load_dword v33, v14, s[28:31], s96 offen sc1
wb_10_2:
 s_waitcnt vmcnt(3)
 v_cmp_gt_u32 vcc, s67, v34
 s_cbranch_vccnz wb_10_r2
 buffer_load_dwordx4 v[32:35], v12, s[28:31], s51 offen offset:0 sc1
 s_branch wb_10_ok
wb_10_r2:
 buffer_load_dword v34, v14, s[28:31], s96 offen sc1
wb_10_3:
 s_waitcnt vmcnt(3)
 v_cmp_gt_u32 vcc, s67, v35
 s_cbranch_vccnz wb_10_r3
 buffer_load_dwordx4 v[32:35], v12, s[28:31], s51 offen offset:0 sc1
wb_10_ok:
 buffer_load_dwordx4 v[36:39], v12, s[28:31], s51 offen offset:1024 sc1
 buffer_load_dwordx4 v[40:43], v12, s[28:31], s51 offen offset:2048 sc1
 buffer_load_dwordx4 v[44:47], v12, s[28:31], s51 offen offset:3072 sc1
 buffer_load_dwordx4 v[48:51], v12, s[28:31], s57 offen offset:0 sc1
 s_waitcnt vmcnt(4)
 v_cmp_eq_u32 vcc, -1, v32
 s_cbranch_vccnz op_9_f0
op_9_c0:
 v_smfmac_f32_16x16x64_bf16 v[16:19], v[32:35], a[0:7], v8
 buffer_load_dwordx4 v[52:55], v12, s[28:31], s57 offen offset:1024 sc1
 v_smfmac_f32_16x16x64_bf16 v[20:23], v[32:35], a[8:15], v8
 s_waitcnt vmcnt(4)
 v_cmp_eq_u32 vcc, -1, v36
 v_smfmac_f32_16x16x64_bf16 v[24:27], v[32:35], a[16:23], v8
 v_smfmac_f32_16x16x64_bf16 v[28:31], v[32:35], v[64:71], v8
 s_cbranch_vccnz op_9_f1
op_9_c1:
 v_smfmac_f32_16x16x64_bf16 v[16:19], v[36:39], a[24:31], v8
 buffer_load_dwordx4 v[56:59], v12, s[28:31], s57 offen offset:2048 sc1
 v_smfmac_f32_16x16x64_bf16 v[20:23], v[36:39], a[32:39], v8
 s_waitcnt vmcnt(4)
 v_cmp_eq_u32 vcc, -1, v40
 v_smfmac_f32_16x16x64_bf16 v[24:27], v[36:39], a[40:47], v8
 v_smfmac_f32_16x16x64_bf16 v[28:31], v[36:39], v[72:79], v8
 s_cbranch_vccnz op_9_f2
op_9_c2:
 v_smfmac_f32_16x16x64_bf16 v[16:19], v[40:43], a[48:55], v8
 buffer_load_dwordx4 v[60:63], v12, s[28:31], s57 offen offset:3072 sc1
 v_smfmac_f32_16x16x64_bf16 v[20:23], v[40:43], a[56:63], v8
 s_waitcnt vmcnt(4)
 v_cmp_eq_u32 vcc, -1, v44
 v_smfmac_f32_16x16x64_bf16 v[24:27], v[40:43], a[64:71], v8
 v_smfmac_f32_16x16x64_bf16 v[28:31], v[40:43], v[80:87], v8
 s_cbranch_vccnz op_9_f3
op_9_c3:
 v_smfmac_f32_16x16x64_bf16 v[16:19], v[44:47], a[72:79], v8
 v_smfmac_f32_16x16x64_bf16 v[20:23], v[44:47], a[80:87], v8
 s_waitcnt vmcnt(3)
 v_cmp_eq_u32 vcc, -1, v48
 v_smfmac_f32_16x16x64_bf16 v[24:27], v[44:47], a[88:95], v8
 v_smfmac_f32_16x16x64_bf16 v[28:31], v[44:47], v[88:95], v8
 s_cbranch_vccnz op_9_f4
op_9_c4:
 v_smfmac_f32_16x16x64_bf16 v[16:19], v[48:51], a[96:103], v8
 v_smfmac_f32_16x16x64_bf16 v[20:23], v[48:51], a[104:111], v8
 s_waitcnt vmcnt(2)
 v_cmp_eq_u32 vcc, -1, v52
 v_smfmac_f32_16x16x64_bf16 v[24:27], v[48:51], a[112:119], v8
 v_smfmac_f32_16x16x64_bf16 v[28:31], v[48:51], v[96:103], v8
 s_cbranch_vccnz op_9_f5
op_9_c5:
 v_smfmac_f32_16x16x64_bf16 v[16:19], v[52:55], a[120:127], v8
 v_smfmac_f32_16x16x64_bf16 v[20:23], v[52:55], a[128:135], v8
 s_waitcnt vmcnt(1)
 v_cmp_eq_u32 vcc, -1, v56
 v_smfmac_f32_16x16x64_bf16 v[24:27], v[52:55], a[136:143], v8
 v_smfmac_f32_16x16x64_bf16 v[28:31], v[52:55], v[104:111], v8
 s_cbranch_vccnz op_9_f6
op_9_c6:
 v_smfmac_f32_16x16x64_bf16 v[16:19], v[56:59], a[144:151], v8
 v_smfmac_f32_16x16x64_bf16 v[20:23], v[56:59], a[152:159], v8
 s_waitcnt vmcnt(0)
 v_cmp_eq_u32 vcc, -1, v60
 v_smfmac_f32_16x16x64_bf16 v[24:27], v[56:59], a[160:167], v8
 v_smfmac_f32_16x16x64_bf16 v[28:31], v[56:59], v[112:119], v8
 s_cbranch_vccnz op_9_f7
op_9_c7:
 v_smfmac_f32_16x16x64_bf16 v[16:19], v[60:63], a[168:175], v8
 v_smfmac_f32_16x16x64_bf16 v[20:23], v[60:63], a[176:183], v8
 v_smfmac_f32_16x16x64_bf16 v[24:27], v[60:63], a[184:191], v8
 v_smfmac_f32_16x16x64_bf16 v[28:31], v[60:63], v[120:127], v8
op_9_done:
 v_permlane32_swap_b32 v16, v20
 v_permlane32_swap_b32 v17, v21
 v_permlane32_swap_b32 v18, v22
 v_permlane32_swap_b32 v19, v23
 v_pk_add_f32 v[16:17], v[16:17], v[20:21]
 v_pk_add_f32 v[18:19], v[18:19], v[22:23]
 ds_write2_b32 v6, v16, v17 offset0:0 offset1:80
 ds_write2_b32 v6, v18, v19 offset0:160 offset1:240
 v_permlane32_swap_b32 v24, v28
 v_permlane32_swap_b32 v25, v29
 v_permlane32_swap_b32 v26, v30
 v_permlane32_swap_b32 v27, v31
 v_pk_add_f32 v[24:25], v[24:25], v[28:29]
 v_pk_add_f32 v[26:27], v[26:27], v[30:31]
 ds_write2_b32 v15, v24, v25 offset0:0 offset1:80
 ds_write2_b32 v15, v26, v27 offset0:160 offset1:240
 s_cmp_ge_u32 s40, 2
 s_waitcnt lgkmcnt(0)
 s_barrier
 ds_read_b128 v[16:19], v7 offset:0
 ds_read_b128 v[20:23], v7 offset:2560
 ds_read_b128 v[24:27], v7 offset:5120
 ds_read_b128 v[28:31], v7 offset:7680
 s_waitcnt lgkmcnt(2)
 v_pk_add_f32 v[16:17], v[16:17], v[20:21]
 v_pk_add_f32 v[18:19], v[18:19], v[22:23]
 s_waitcnt lgkmcnt(0)
 v_pk_add_f32 v[24:25], v[24:25], v[28:29]
 v_pk_add_f32 v[26:27], v[26:27], v[30:31]
 v_pk_add_f32 v[16:17], v[16:17], v[24:25]
 v_pk_add_f32 v[18:19], v[18:19], v[26:27]
 s_cbranch_scc1 L_vo_step_g_ld
 v_min_u32 v16, -2, v16
 buffer_store_dwordx4 v[16:19], v9, s[28:31], s54 offen offset:0 sc1
 s_branch L_vo_step_g_fin
L_vo_step_g_ld:
 s_sleep 6
 buffer_load_dwordx4 v[32:35], v9, s[28:31], s55 offen offset:0 sc1
got_11_l:
 s_waitcnt vmcnt(0)
 v_cmp_eq_u32 vcc, -1, v32
 s_cbranch_vccnz got_11_again
 v_pk_add_f32 v[16:17], v[16:17], v[32:33]
 v_pk_add_f32 v[18:19], v[18:19], v[34:35]
got_11_fin:
 buffer_store_dword v0, v13, s[28:31], s27 offen sc1
 v_cvt_pk_bf16_f32 v28, v16, v17
 v_cvt_pk_bf16_f32 v29, v18, v19
 v_min_u32 v28, -2, v28
 v_min_u32 v29, -2, v29
 buffer_store_dwordx2 v[28:29], v10, s[28:31], s58 offen sc1
L_vo_step_g_fin:
 s_add_u32 s49, s50, 16384
 s_and_b32 s49, s49, 49152
 s_andn2_b32 s50, s50, 49152
 s_or_b32 s50, s50, s49
 s_add_u32 s43, s43, 1
 s_branch L_vo_step_g
wb_8_r1:
 buffer_load_dword v33, v5, s[28:31], s59 offen sc1
 s_sub_u32 s26, s26, 1
 s_cbranch_scc1 L_end
 s_branch wb_8_0
L_vo_step_g_nan:
 s_mov_b64 s[64:65], 0
 s_mov_b64 vcc, 0
 s_cmp_eq_u32 s66, s43
 s_cbranch_scc1 L_vo_step_g_ok
 s_mov_b32 s66, s43
L_vo_step_g_nan_again:
 s_waitcnt vmcnt(0) lgkmcnt(0)
 s_barrier
 buffer_load_dwordx4 v4, s[28:31], s50 offen offset:0 sc1 lds
 buffer_load_dwordx4 v4, s[28:31], s50 offen offset:1024 sc1 lds
 buffer_load_dwordx4 v4, s[28:31], s50 offen offset:2048 sc1 lds
 buffer_load_dwordx4 v4, s[28:31], s50 offen offset:3072 sc1 lds
 s_sub_u32 s26, s26, 1
 s_cbranch_scc1 L_end
 s_waitcnt vmcnt(0)
 s_barrier
 v_mov_b32 v1, 0
 ds_read_b128 v[48:51], v2 offset:0
 s_waitcnt lgkmcnt(0)
 v_max3_u32 v1, v1, v48, v49
 v_max3_u32 v1, v1, v50, v51
 ds_read_b128 v[48:51], v2 offset:1024
 s_waitcnt lgkmcnt(0)
 v_max3_u32 v1, v1, v48, v49
 v_max3_u32 v1, v1, v50, v51
 ds_read_b128 v[48:51], v2 offset:2048
 s_waitcnt lgkmcnt(0)
 v_max3_u32 v1, v1, v48, v49
 v_max3_u32 v1, v1, v50, v51
 ds_read_b128 v[48:51], v2 offset:3072
 s_waitcnt lgkmcnt(0)
 v_max3_u32 v1, v1, v48, v49
 v_max3_u32 v1, v1, v50, v51
 ds_read_b128 v[48:51], v2 offset:4096
 s_waitcnt lgkmcnt(0)
 v_max3_u32 v1, v1, v48, v49
 v_max3_u32 v1, v1, v50, v51
 ds_read_b128 v[48:51], v2 offset:5120
 s_waitcnt lgkmcnt(0)
 v_max3_u32 v1, v1, v48, v49
 v_max3_u32 v1, v1, v50, v51
 ds_read_b128 v[48:51], v2 offset:6144
 s_waitcnt lgkmcnt(0)
 v_max3_u32 v1, v1, v48, v49
 v_max3_u32 v1, v1, v50, v51
 ds_read_b128 v[48:51], v2 offset:7168
 s_waitcnt lgkmcnt(0)
 v_max3_u32 v1, v1, v48, v49
 v_max3_u32 v1, v1, v50, v51
 ds_read_b128 v[48:51], v2 offset:8192
 s_waitcnt lgkmcnt(0)
 v_max3_u32 v1, v1, v48, v49
 v_max3_u32 v1, v1, v50, v51
 ds_read_b128 v[48:51], v2 offset:9216
 s_waitcnt lgkmcnt(0)
 v_max3_u32 v1, v1, v48, v49
 v_max3_u32 v1, v1, v50, v51
 ds_read_b128 v[48:51], v2 offset:10240
 s_waitcnt lgkmcnt(0)
 v_max3_u32 v1, v1, v48, v49
 v_max3_u32 v1, v1, v50, v51
 ds_read_b128 v[48:51], v2 offset:11264
 s_waitcnt lgkmcnt(0)
 v_max3_u32 v1, v1, v48, v49
 v_max3_u32 v1, v1, v50, v51
 ds_read_b128 v[48:51], v2 offset:12288
 s_waitcnt lgkmcnt(0)
 v_max3_u32 v1, v1, v48, v49
 v_max3_u32 v1, v1, v50, v51
 ds_read_b128 v[48:51], v2 offset:13312
 s_waitcnt lgkmcnt(0)
 v_max3_u32 v1, v1, v48, v49
 v_max3_u32 v1, v1, v50, v51
 ds_read_b128 v[48:51], v2 offset:14336
 s_waitcnt lgkmcnt(0)
 v_max3_u32 v1, v1, v48, v49
 v_max3_u32 v1, v1, v50, v51
 ds_read_b128 v[48:51], v2 offset:15360
 s_waitcnt lgkmcnt(0)
 v_max3_u32 v1, v1, v48, v49
 v_max3_u32 v1, v1, v50, v51
 v_cmp_eq_u32 vcc, -1, v1
 s_cbranch_vccnz L_vo_step_g_nan_again
 v_mov_b32 v16, 0
 v_mov_b32 v17, 0
 v_mov_b32 v18, 0
 v_mov_b32 v19, 0
 v_mov_b32 v20, 0
 v_mov_b32 v21, 0
 v_mov_b32 v22, 0
 v_mov_b32 v23, 0
 s_waitcnt lgkmcnt(0)
 s_branch L_vo_step_g_go
op_9_early:
 s_cmp_eq_u32 s43, 2
 s_cbranch_scc1 op_9_probe
 s_cmp_eq_u32 s43, 5
 s_cbranch_scc1 op_9_pick
 s_cmp_lg_u32 s43, 1
 s_cbranch_scc1 op_9_cal
 v_and_b32 v32, 0x3ff, v9
 buffer_store_dwordx4 v[16:19], v32, s[28:31], s63 offen sc1
 s_branch op_9_cal
op_9_probe:
 s_waitcnt vmcnt(0) lgkmcnt(0)
 s_mov_b32 s64, -1
 s_memtime s[68:69]
 s_waitcnt lgkmcnt(0)
 s_mov_b32 s65, s68
 buffer_load_dword v32, v13, s[28:31], s63 offen offset:0 sc1
 s_waitcnt vmcnt(0)
 s_memtime s[68:69]
 s_waitcnt lgkmcnt(0)
 s_sub_u32 s68, s68, s65
 s_min_u32 s64, s64, s68
 s_memtime s[68:69]
 s_waitcnt lgkmcnt(0)
 s_mov_b32 s65, s68
 buffer_load_dword v32, v13, s[28:31], s63 offen offset:256 sc1
 s_waitcnt vmcnt(0)
 s_memtime s[68:69]
 s_waitcnt lgkmcnt(0)
 s_sub_u32 s68, s68, s65
 s_min_u32 s64, s64, s68
 s_memtime s[68:69]
 s_waitcnt lgkmcnt(0)
 s_mov_b32 s65, s68
 buffer_load_dword v32, v13, s[28:31], s63 offen offset:512 sc1
 s_waitcnt vmcnt(0)
 s_memtime s[68:69]
 s_waitcnt lgkmcnt(0)
 s_sub_u32 s68, s68, s65
 s_min_u32 s64, s64, s68
 s_lshl_b32 s47, s40, 2
 v_mov_b32 v33, 147456
 v_add_u32 v34, s47, v33
 v_mov_b32 v32, s64
 ds_write_b32 v34, v32
 s_waitcnt lgkmcnt(0)
 s_barrier
 ds_read_b128 v[36:39], v33
 s_waitcnt lgkmcnt(0)
 s_barrier
 v_min_u32 v36, v36, v38
 v_min_u32 v37, v37, v39
 v_cmp_lt_u32 vcc, v37, v36
 s_lshl_b32 s47, s41, 3
 s_lshl_b32 s47, 0x100, s47
 s_cmp_eq_u64 vcc, 0
 s_cselect_b32 s47, 0, s47
 s_add_u32 s47, s47, 1
 s_cmp_lg_u32 s40, 0
 s_cbranch_scc1 op_9_cal
 s_mov_b64 exec, 1
 v_mov_b32 v32, 0
 v_mov_b32 v33, s47
 global_atomic_add v32, v33, s[22:23] offset:196 sc1
 s_mov_b64 exec, -1
 s_branch op_9_cal
op_9_pick:
 v_mov_b32 v32, 0
 global_load_dword v33, v32, s[22:23] offset:196 sc1
 s_sub_u32 s26, s26, 1
 s_cbranch_scc1 L_end
 s_waitcnt vmcnt(0)
 v_readfirstlane_b32 s48, v33
 s_and_b32 s47, s48, 0xff
 s_cmp_lt_u32 s47, 32
 s_cbranch_scc1 op_9_pick
 s_xor_b32 s47, s41, 0
 s_lshl_b32 s47, s47, 3
 s_add_u32 s47, s47, 8
 s_lshr_b32 s47, s48, s47
 s_and_b32 s47, s47, 0xff
 s_cmp_gt_u32 s47, 8
 s_cselect_b32 s47, 8192, 0
 s_add_u32 s55, s55, s47
 s_xor_b32 s47, s41, 1
 s_lshl_b32 s47, s47, 3
 s_add_u32 s47, s47, 8
 s_lshr_b32 s47, s48, s47
 s_and_b32 s47, s47, 0xff
 s_cmp_gt_u32 s47, 8
 s_cselect_b32 s47, 8192, 0
 s_add_u32 s54, s54, s47
 s_branch op_9_cal
wb_10_r3:
 buffer_load_dword v35, v14, s[28:31], s96 offen sc1
 s_sub_u32 s26, s26, 1
 s_cbranch_scc1 L_end
 s_branch wb_10_0
op_9_f0:
 buffer_load_dwordx4 v[32:35], v12, s[28:31], s51 offen offset:0 sc1
 buffer_load_dwordx4 v[36:39], v12, s[28:31], s51 offen offset:1024 sc1
 buffer_load_dwordx4 v[40:43], v12, s[28:31], s51 offen offset:2048 sc1
 buffer_load_dwordx4 v[44:47], v12, s[28:31], s51 offen offset:3072 sc1
 buffer_load_dwordx4 v[48:51], v12, s[28:31], s57 offen offset:0 sc1
 s_sub_u32 s26, s26, 1
 s_cbranch_scc1 L_end
 s_waitcnt vmcnt(4)
 v_cmp_eq_u32 vcc, -1, v32
 s_cbranch_vccnz op_9_f0
 s_branch op_9_c0
op_9_f1:
 buffer_load_dwordx4 v[36:39], v12, s[28:31], s51 offen offset:1024 sc1
 buffer_load_dwordx4 v[40:43], v12, s[28:31], s51 offen offset:2048 sc1
 buffer_load_dwordx4 v[44:47], v12, s[28:31], s51 offen offset:3072 sc1
 buffer_load_dwordx4 v[48:51], v12, s[28:31], s57 offen offset:0 sc1
 buffer_load_dwordx4 v[52:55], v12, s[28:31], s57 offen offset:1024 sc1
 s_sub_u32 s26, s26, 1
 s_cbranch_scc1 L_end
 s_waitcnt vmcnt(4)
 v_cmp_eq_u32 vcc, -1, v36
 s_cbranch_vccnz op_9_f1
 s_branch op_9_c1
op_9_f2:
 buffer_load_dwordx4 v[40:43], v12, s[28:31], s51 offen offset:2048 sc1
 buffer_load_dwordx4 v[44:47], v12, s[28:31], s51 offen offset:3072 sc1
 buffer_load_dwordx4 v[48:51], v12, s[28:31], s57 offen offset:0 sc1
 buffer_load_dwordx4 v[52:55], v12, s[28:31], s57 offen offset:1024 sc1
 buffer_load_dwordx4 v[56:59], v12, s[28:31], s57 offen offset:2048 sc1
 s_sub_u32 s26, s26, 1
 s_cbranch_scc1 L_end
 s_waitcnt vmcnt(4)
 v_cmp_eq_u32 vcc, -1, v40
 s_cbranch_vccnz op_9_f2
 s_branch op_9_c2
op_9_f3:
 buffer_load_dwordx4 v[44:47], v12, s[28:31], s51 offen offset:3072 sc1
 buffer_load_dwordx4 v[48:51], v12, s[28:31], s57 offen offset:0 sc1
 buffer_load_dwordx4 v[52:55], v12, s[28:31], s57 offen offset:1024 sc1
 buffer_load_dwordx4 v[56:59], v12, s[28:31], s57 offen offset:2048 sc1
 buffer_load_dwordx4 v[60:63], v12, s[28:31], s57 offen offset:3072 sc1
 s_sub_u32 s26, s26, 1
 s_cbranch_scc1 L_end
 s_waitcnt vmcnt(4)
 v_cmp_eq_u32 vcc, -1, v44
 s_cbranch_vccnz op_9_f3
 s_branch op_9_c3
op_9_f4:
 buffer_load_dwordx4 v[48:51], v12, s[28:31], s57 offen offset:0 sc1
 buffer_load_dwordx4 v[52:55], v12, s[28:31], s57 offen offset:1024 sc1
 buffer_load_dwordx4 v[56:59], v12, s[28:31], s57 offen offset:2048 sc1
 buffer_load_dwordx4 v[60:63], v12, s[28:31], s57 offen offset:3072 sc1
 s_sub_u32 s26, s26, 1
 s_cbranch_scc1 L_end
 s_waitcnt vmcnt(3)
 v_cmp_eq_u32 vcc, -1, v48
 s_cbranch_vccnz op_9_f4
 s_branch op_9_c4
op_9_f5:
 buffer_load_dwordx4 v[52:55], v12, s[28:31], s57 offen offset:1024 sc1
 buffer_load_dwordx4 v[56:59], v12, s[28:31], s57 offen offset:2048 sc1
 buffer_load_dwordx4 v[60:63], v12, s[28:31], s57 offen offset:3072 sc1
 s_sub_u32 s26, s26, 1
 s_cbranch_scc1 L_end
 s_waitcnt vmcnt(2)
 v_cmp_eq_u32 vcc, -1, v52
 s_cbranch_vccnz op_9_f5
 s_branch op_9_c5
op_9_f6:
 buffer_load_dwordx4 v[56:59], v12, s[28:31], s57 offen offset:2048 sc1
 buffer_load_dwordx4 v[60:63], v12, s[28:31], s57 offen offset:3072 sc1
 s_sub_u32 s26, s26, 1
 s_cbranch_scc1 L_end
 s_waitcnt vmcnt(1)
 v_cmp_eq_u32 vcc, -1, v56
 s_cbranch_vccnz op_9_f6
 s_branch op_9_c6
op_9_f7:
 buffer_load_dwordx4 v[60:63], v12, s[28:31], s57 offen offset:3072 sc1
 s_sub_u32 s26, s26, 1
 s_cbranch_scc1 L_end
 s_waitcnt vmcnt(0)
 v_cmp_eq_u32 vcc, -1, v60
 s_cbranch_vccnz op_9_f7
 s_branch op_9_c7
got_11_again:
 buffer_load_dwordx4 v[32:35], v9, s[28:31], s55 offen offset:0 sc1
 s_sub_u32 s26, s26, 1
 s_cbranch_scc1 L_end
 s_branch got_11_l
L_vo_last:
 s_waitcnt vmcnt(0)
 s_barrier
 v_mov_b32 v40, 64
 buffer_store_dword v40, v13, s[28:31], s56 offen sc1
 s_branch L_end
L_qk:
 s_lshl_b32 s48, s41, 4
 s_add_u32 s48, s48, s42
 s_lshl_b32 s45, s40, 15
 s_lshl_b32 s46, s40, 13
 s_add_u32 s46, s46, 131072
 v_lshlrev_b32 v3, 3, v0
 v_add_u32 v14, s46, v3
 v_add_u32 v3, s45, v3
 v_lshlrev_b32 v2, 4, v0
 v_add_u32 v2, 131072, v2
 v_cmp_eq_u32 vcc, 0, v0
 v_mov_b32 v13, 0x40000000
 s_nop 0
 v_cndmask_b32 v13, v13, 0, vcc
 v_and_b32 v8, 8, v0
 v_cmp_eq_u32 vcc, 0, v8
 v_mov_b32 v8, 0xeeee
 v_mov_b32 v1, 0x4444
 v_cndmask_b32 v8, v8, v1, vcc
 s_mov_b32 s32, s10
 s_and_b32 s33, s11, 0xffff
 s_mov_b32 s34, 0x800000
 s_mov_b32 s35, 0x20000
 s_mov_b32 s36, s8
 s_and_b32 s37, s9, 0xffff
 s_mov_b32 s38, 0x800000
 s_mov_b32 s39, 0x20000
 s_lshr_b32 s47, s40, 1
 s_lshl_b32 s49, s42, 1
 s_add_u32 s47, s47, s49
 s_lshl_b32 s47, s47, 10
 s_and_b32 s49, s40, 1
 s_lshl_b32 s49, s49, 7
 s_add_u32 s47, s47, s49
 v_lshlrev_b32 v12, 4, v0
 v_add_u32 v10, s47, v12
 v_and_b32 v16, 8, v0
 v_lshlrev_b32 v16, 27, v16
 v_or_b32 v10, v10, v16
 v_lshrrev_b32 v17, 4, v0
 v_lshlrev_b32 v17, 7, v17
 v_and_b32 v18, 7, v0
 v_lshl_add_u32 v17, v18, 4, v17
 s_lshl_b32 s47, s40, 9
 v_add_u32 v17, s47, v17
 v_or_b32 v15, v17, v16
 s_lshl_b32 s51, s41, 17
 s_add_u32 s51, s51, 262144
 s_lshl_b32 s50, s41, 16
 s_add_u32 s50, s50, 131072
 s_lshl_b32 s52, s48, 13
 s_add_u32 s52, s52, 524288
 s_lshl_b32 s53, s48, 13
 s_add_u32 s54, s53, 0x3000000
 s_add_u32 s53, s53, 0x2000000
 s_lshl_b32 s47, s40, 11
 s_add_u32 s54, s54, s47
 s_lshl_b32 s55, s48, 11
 s_add_u32 s55, s55, 0x400000
 s_lshl_b32 s57, s48, 7
 s_add_u32 s57, s57, 32768
 s_lshl_b32 s63, s41, 10
 s_lshl_b32 s59, s40, 8
 s_add_u32 s59, s59, s63
 s_add_u32 s59, s59, 40960
 s_lshr_b32 s47, s42, 2
 s_lshl_b32 s47, s47, 8
 s_add_u32 s63, s63, s47
 s_and_b32 s47, s42, 3
 s_lshl_b32 s47, s47, 4
 s_add_u32 s63, s63, s47
 s_lshl_b32 s47, s40, 2
 s_add_u32 s63, s63, s47
 s_add_u32 s63, s63, 43008
 s_lshl_b32 s58, s48, 8
 s_add_u32 s58, s58, 12288
 s_mov_b32 s60, 0x3e0293ee
 s_mov_b32 s61, 0x3e0293ee
 s_mov_b32 s62, 0xbe0293ee
 v_bfe_u32 v16, v0, 3, 2
 v_bfe_u32 v17, v0, 1, 2
 v_and_b32 v18, 1, v0
 v_lshrrev_b32 v19, 1, v16
 v_lshlrev_b32 v19, 4, v19
 v_and_b32 v25, 1, v16
 v_lshl_add_u32 v19, v25, 2, v19
 v_lshrrev_b32 v25, 1, v17
 v_lshl_add_u32 v19, v25, 3, v19
 v_and_b32 v25, 1, v17
 v_add_u32 v19, v25, v19
 s_lshl_b32 s47, s48, 8
 s_lshl_b32 s49, s40, 6
 s_add_u32 s49, s49, s47
 v_lshlrev_b32 v4, 13, v19
 v_lshl_add_u32 v4, v18, 4, v4
 v_add_u32 v4, s49, v4
 v_lshrrev_b32 v25, 5, v0
 v_lshl_add_u32 v4, v25, 5, v4
 s_mov_b32 m0, s46
 s_mov_b32 s47, 0x0
 buffer_load_dwordx4 v4, s[32:35], s47 offen lds
 s_add_u32 m0, s46, 1024
 s_mov_b32 s47, 0x4000
 buffer_load_dwordx4 v4, s[32:35], s47 offen lds
 s_add_u32 m0, s46, 2048
 s_mov_b32 s47, 0x40000
 buffer_load_dwordx4 v4, s[32:35], s47 offen lds
 s_add_u32 m0, s46, 3072
 s_mov_b32 s47, 0x44000
 buffer_load_dwordx4 v4, s[32:35], s47 offen lds
 s_add_u32 m0, s46, 4096
 s_mov_b32 s47, 0x80000
 buffer_load_dwordx4 v4, s[32:35], s47 offen lds
 s_add_u32 m0, s46, 5120
 s_mov_b32 s47, 0x84000
 buffer_load_dwordx4 v4, s[32:35], s47 offen lds
 s_add_u32 m0, s46, 6144
 s_mov_b32 s47, 0xc0000
 buffer_load_dwordx4 v4, s[32:35], s47 offen lds
 s_add_u32 m0, s46, 7168
 s_mov_b32 s47, 0xc4000
 buffer_load_dwordx4 v4, s[32:35], s47 offen lds
 s_mov_b32 m0, s45
 s_mov_b32 s47, 0x100000
 buffer_load_dwordx4 v4, s[32:35], s47 offen lds
 s_add_u32 m0, s45, 1024
 s_mov_b32 s47, 0x104000
 buffer_load_dwordx4 v4, s[32:35], s47 offen lds
 s_add_u32 m0, s45, 2048
 s_mov_b32 s47, 0x140000
 buffer_load_dwordx4 v4, s[32:35], s47 offen lds
 s_add_u32 m0, s45, 3072
 s_mov_b32 s47, 0x144000
 buffer_load_dwordx4 v4, s[32:35], s47 offen lds
 s_add_u32 m0, s45, 4096
 s_mov_b32 s47, 0x180000
 buffer_load_dwordx4 v4, s[32:35], s47 offen lds
 s_add_u32 m0, s45, 5120
 s_mov_b32 s47, 0x184000
 buffer_load_dwordx4 v4, s[32:35], s47 offen lds
 s_add_u32 m0, s45, 6144
 s_mov_b32 s47, 0x1c0000
 buffer_load_dwordx4 v4, s[32:35], s47 offen lds
 s_add_u32 m0, s45, 7168
 s_mov_b32 s47, 0x1c4000
 buffer_load_dwordx4 v4, s[32:35], s47 offen lds
 s_add_u32 m0, s45, 8192
 s_mov_b32 s47, 0x200000
 buffer_load_dwordx4 v4, s[32:35], s47 offen lds
 s_add_u32 m0, s45, 9216
 s_mov_b32 s47, 0x204000
 buffer_load_dwordx4 v4, s[32:35], s47 offen lds
 s_add_u32 m0, s45, 10240
 s_mov_b32 s47, 0x240000
 buffer_load_dwordx4 v4, s[32:35], s47 offen lds
 s_add_u32 m0, s45, 11264
 s_mov_b32 s47, 0x244000
 buffer_load_dwordx4 v4, s[32:35], s47 offen lds
 s_add_u32 m0, s45, 12288
 s_mov_b32 s47, 0x280000
 buffer_load_dwordx4 v4, s[32:35], s47 offen lds
 s_add_u32 m0, s45, 13312
 s_mov_b32 s47, 0x284000
 buffer_load_dwordx4 v4, s[32:35], s47 offen lds
 s_add_u32 m0, s45, 14336
 s_mov_b32 s47, 0x2c0000
 buffer_load_dwordx4 v4, s[32:35], s47 offen lds
 s_add_u32 m0, s45, 15360
 s_mov_b32 s47, 0x2c4000
 buffer_load_dwordx4 v4, s[32:35], s47 offen lds
 s_add_u32 m0, s45, 16384
 s_mov_b32 s47, 0x300000
 buffer_load_dwordx4 v4, s[32:35], s47 offen lds
 s_add_u32 m0, s45, 17408
 s_mov_b32 s47, 0x304000
 buffer_load_dwordx4 v4, s[32:35], s47 offen lds
 s_add_u32 m0, s45, 18432
 s_mov_b32 s47, 0x340000
 buffer_load_dwordx4 v4, s[32:35], s47 offen lds
 s_add_u32 m0, s45, 19456
 s_mov_b32 s47, 0x344000
 buffer_load_dwordx4 v4, s[32:35], s47 offen lds
 s_add_u32 m0, s45, 20480
 s_mov_b32 s47, 0x380000
 buffer_load_dwordx4 v4, s[32:35], s47 offen lds
 s_add_u32 m0, s45, 21504
 s_mov_b32 s47, 0x384000
 buffer_load_dwordx4 v4, s[32:35], s47 offen lds
 s_add_u32 m0, s45, 22528
 s_mov_b32 s47, 0x3c0000
 buffer_load_dwordx4 v4, s[32:35], s47 offen lds
 s_add_u32 m0, s45, 23552
 s_mov_b32 s47, 0x3c4000
 buffer_load_dwordx4 v4, s[32:35], s47 offen lds
 s_add_u32 m0, s45, 24576
 s_mov_b32 s47, 0x400000
 buffer_load_dwordx4 v4, s[32:35], s47 offen lds
 s_add_u32 m0, s45, 25600
 s_mov_b32 s47, 0x404000
 buffer_load_dwordx4 v4, s[32:35], s47 offen lds
 s_add_u32 m0, s45, 26624
 s_mov_b32 s47, 0x440000
 buffer_load_dwordx4 v4, s[32:35], s47 offen lds
 s_add_u32 m0, s45, 27648
 s_mov_b32 s47, 0x444000
 buffer_load_dwordx4 v4, s[32:35], s47 offen lds
 s_add_u32 m0, s45, 28672
 s_mov_b32 s47, 0x480000
 buffer_load_dwordx4 v4, s[32:35], s47 offen lds
 s_add_u32 m0, s45, 29696
 s_mov_b32 s47, 0x484000
 buffer_load_dwordx4 v4, s[32:35], s47 offen lds
 s_add_u32 m0, s45, 30720
 s_mov_b32 s47, 0x4c0000
 buffer_load_dwordx4 v4, s[32:35], s47 offen lds
 s_add_u32 m0, s45, 31744
 s_mov_b32 s47, 0x4c4000
 buffer_load_dwordx4 v4, s[32:35], s47 offen lds
 s_lshl_b32 s47, s2, 2
 s_add_u32 s47, s47, 0
 v_mov_b32 v1, s3
 buffer_store_dword v1, v13, s[28:31], s47 offen sc1
 v_mov_b32 v20, -1
 v_mov_b32 v21, -1
 v_mov_b32 v22, -1
 v_mov_b32 v23, -1
 s_add_u32 s47, s51, 0
 buffer_store_dwordx4 v[20:23], v10, s[28:31], s47 offen sc1
 s_add_u32 s47, s51, 32768
 buffer_store_dwordx4 v[20:23], v10, s[28:31], s47 offen sc1
 s_add_u32 s47, s51, 65536
 buffer_store_dwordx4 v[20:23], v10, s[28:31], s47 offen sc1
 s_add_u32 s47, s51, 98304
 buffer_store_dwordx4 v[20:23], v10, s[28:31], s47 offen sc1
 v_mov_b32 v24, 0
 buffer_store_dword v24, v13, s[28:31], s57 offen sc1
 buffer_store_dword v24, v13, s[28:31], s63 offen sc1
 s_waitcnt vmcnt(46)
 ds_read_b64_tr_b16 a[0:1], v14 offset:0
 ds_read_b64_tr_b16 a[8:9], v14 offset:512
 s_waitcnt vmcnt(45)
 ds_read_b64_tr_b16 a[2:3], v14 offset:1024
 ds_read_b64_tr_b16 a[10:11], v14 offset:1536
 s_waitcnt vmcnt(44)
 ds_read_b64_tr_b16 a[4:5], v14 offset:2048
 ds_read_b64_tr_b16 a[12:13], v14 offset:2560
 s_waitcnt vmcnt(43)
 ds_read_b64_tr_b16 a[6:7], v14 offset:3072
 ds_read_b64_tr_b16 a[14:15], v14 offset:3584
 s_waitcnt lgkmcnt(6)
 s_mov_b32 m0, s46
 s_mov_b32 s47, 0x500000
 buffer_load_dwordx4 v4, s[32:35], s47 offen lds
 s_waitcnt vmcnt(43)
 ds_read_b64_tr_b16 a[16:17], v14 offset:4096
 ds_read_b64_tr_b16 a[24:25], v14 offset:4608
 s_waitcnt lgkmcnt(6)
 s_add_u32 m0, s46, 1024
 s_mov_b32 s47, 0x504000
 buffer_load_dwordx4 v4, s[32:35], s47 offen lds
 s_waitcnt vmcnt(43)
 ds_read_b64_tr_b16 a[18:19], v14 offset:5120
 ds_read_b64_tr_b16 a[26:27], v14 offset:5632
 s_waitcnt lgkmcnt(6)
 s_add_u32 m0, s46, 2048
 s_mov_b32 s47, 0x540000
 buffer_load_dwordx4 v4, s[32:35], s47 offen lds
 s_waitcnt vmcnt(43)
 ds_read_b64_tr_b16 a[20:21], v14 offset:6144
 ds_read_b64_tr_b16 a[28:29], v14 offset:6656
 s_waitcnt lgkmcnt(6)
 s_add_u32 m0, s46, 3072
 s_mov_b32 s47, 0x544000
 buffer_load_dwordx4 v4, s[32:35], s47 offen lds
 s_waitcnt vmcnt(43)
 ds_read_b64_tr_b16 a[22:23], v14 offset:7168
 ds_read_b64_tr_b16 a[30:31], v14 offset:7680
 s_waitcnt lgkmcnt(6)
 s_add_u32 m0, s46, 4096
 s_mov_b32 s47, 0x580000
 buffer_load_dwordx4 v4, s[32:35], s47 offen lds
 s_waitcnt vmcnt(43)
 ds_read_b64_tr_b16 a[32:33], v3 offset:0
 ds_read_b64_tr_b16 a[40:41], v3 offset:512
 s_waitcnt lgkmcnt(6)
 s_add_u32 m0, s46, 5120
 s_mov_b32 s47, 0x584000
 buffer_load_dwordx4 v4, s[32:35], s47 offen lds
 s_waitcnt vmcnt(43)
 ds_read_b64_tr_b16 a[34:35], v3 offset:1024
 ds_read_b64_tr_b16 a[42:43], v3 offset:1536
 s_waitcnt lgkmcnt(6)
 s_add_u32 m0, s46, 6144
 s_mov_b32 s47, 0x5c0000
 buffer_load_dwordx4 v4, s[32:35], s47 offen lds
 s_waitcnt vmcnt(43)
 ds_read_b64_tr_b16 a[36:37], v3 offset:2048
 ds_read_b64_tr_b16 a[44:45], v3 offset:2560
 s_waitcnt lgkmcnt(6)
 s_add_u32 m0, s46, 7168
 s_mov_b32 s47, 0x5c4000
 buffer_load_dwordx4 v4, s[32:35], s47 offen lds
 s_waitcnt vmcnt(43)
 ds_read_b64_tr_b16 a[38:39], v3 offset:3072
 ds_read_b64_tr_b16 a[46:47], v3 offset:3584
 s_waitcnt lgkmcnt(6)
 s_mov_b32 m0, s45
 s_mov_b32 s47, 0x600000
 buffer_load_dwordx4 v4, s[32:35], s47 offen lds
 s_waitcnt vmcnt(43)
 ds_read_b64_tr_b16 a[48:49], v3 offset:4096
 ds_read_b64_tr_b16 a[56:57], v3 offset:4608
 s_waitcnt lgkmcnt(6)
 s_add_u32 m0, s45, 1024
 s_mov_b32 s47, 0x604000
 buffer_load_dwordx4 v4, s[32:35], s47 offen lds
 s_waitcnt vmcnt(43)
 ds_read_b64_tr_b16 a[50:51], v3 offset:5120
 ds_read_b64_tr_b16 a[58:59], v3 offset:5632
 s_waitcnt lgkmcnt(6)
 s_add_u32 m0, s45, 2048
 s_mov_b32 s47, 0x640000
 buffer_load_dwordx4 v4, s[32:35], s47 offen lds
 s_waitcnt vmcnt(43)
 ds_read_b64_tr_b16 a[52:53], v3 offset:6144
 ds_read_b64_tr_b16 a[60:61], v3 offset:6656
 s_waitcnt lgkmcnt(6)
 s_add_u32 m0, s45, 3072
 s_mov_b32 s47, 0x644000
 buffer_load_dwordx4 v4, s[32:35], s47 offen lds
 s_waitcnt vmcnt(43)
 ds_read_b64_tr_b16 a[54:55], v3 offset:7168
 ds_read_b64_tr_b16 a[62:63], v3 offset:7680
 s_waitcnt lgkmcnt(6)
 s_add_u32 m0, s45, 4096
 s_mov_b32 s47, 0x680000
 buffer_load_dwordx4 v4, s[32:35], s47 offen lds
 s_waitcnt vmcnt(43)
 ds_read_b64_tr_b16 a[64:65], v3 offset:8192
 ds_read_b64_tr_b16 a[72:73], v3 offset:8704
 s_waitcnt lgkmcnt(6)
 s_add_u32 m0, s45, 5120
 s_mov_b32 s47, 0x684000
 buffer_load_dwordx4 v4, s[32:35], s47 offen lds
 s_waitcnt vmcnt(43)
 ds_read_b64_tr_b16 a[66:67], v3 offset:9216
 ds_read_b64_tr_b16 a[74:75], v3 offset:9728
 s_waitcnt lgkmcnt(6)
 s_add_u32 m0, s45, 6144
 s_mov_b32 s47, 0x6c0000
 buffer_load_dwordx4 v4, s[32:35], s47 offen lds
 s_waitcnt vmcnt(43)
 ds_read_b64_tr_b16 a[68:69], v3 offset:10240
 ds_read_b64_tr_b16 a[76:77], v3 offset:10752
 s_waitcnt lgkmcnt(6)
 s_add_u32 m0, s45, 7168
 s_mov_b32 s47, 0x6c4000
 buffer_load_dwordx4 v4, s[32:35], s47 offen lds
 s_waitcnt vmcnt(43)
 ds_read_b64_tr_b16 a[70:71], v3 offset:11264
 ds_read_b64_tr_b16 a[78:79], v3 offset:11776
 s_waitcnt lgkmcnt(6)
 s_add_u32 m0, s45, 8192
 s_mov_b32 s47, 0x700000
 buffer_load_dwordx4 v4, s[32:35], s47 offen lds
 s_waitcnt vmcnt(43)
 ds_read_b64_tr_b16 a[80:81], v3 offset:12288
 ds_read_b64_tr_b16 a[88:89], v3 offset:12800
 s_waitcnt lgkmcnt(6)
 s_add_u32 m0, s45, 9216
 s_mov_b32 s47, 0x704000
 buffer_load_dwordx4 v4, s[32:35], s47 offen lds
 s_waitcnt vmcnt(43)
 ds_read_b64_tr_b16 a[82:83], v3 offset:13312
 ds_read_b64_tr_b16 a[90:91], v3 offset:13824
 s_waitcnt lgkmcnt(6)
 s_add_u32 m0, s45, 10240
 s_mov_b32 s47, 0x740000
 buffer_load_dwordx4 v4, s[32:35], s47 offen lds
 s_waitcnt vmcnt(43)
 ds_read_b64_tr_b16 a[84:85], v3 offset:14336
 ds_read_b64_tr_b16 a[92:93], v3 offset:14848
 s_waitcnt lgkmcnt(6)
 s_add_u32 m0, s45, 11264
 s_mov_b32 s47, 0x744000
 buffer_load_dwordx4 v4, s[32:35], s47 offen lds
 s_waitcnt vmcnt(43)
 ds_read_b64_tr_b16 a[86:87], v3 offset:15360
 ds_read_b64_tr_b16 a[94:95], v3 offset:15872
 s_waitcnt lgkmcnt(6)
 s_add_u32 m0, s45, 12288
 s_mov_b32 s47, 0x780000
 buffer_load_dwordx4 v4, s[32:35], s47 offen lds
 s_waitcnt vmcnt(43)
 ds_read_b64_tr_b16 a[96:97], v3 offset:16384
 ds_read_b64_tr_b16 a[104:105], v3 offset:16896
 s_waitcnt lgkmcnt(6)
 s_add_u32 m0, s45, 13312
 s_mov_b32 s47, 0x784000
 buffer_load_dwordx4 v4, s[32:35], s47 offen lds
 s_waitcnt vmcnt(43)
 ds_read_b64_tr_b16 a[98:99], v3 offset:17408
 ds_read_b64_tr_b16 a[106:107], v3 offset:17920
 s_waitcnt lgkmcnt(6)
 s_add_u32 m0, s45, 14336
 s_mov_b32 s47, 0x7c0000
 buffer_load_dwordx4 v4, s[32:35], s47 offen lds
 s_waitcnt vmcnt(43)
 ds_read_b64_tr_b16 a[100:101], v3 offset:18432
 ds_read_b64_tr_b16 a[108:109], v3 offset:18944
 s_waitcnt lgkmcnt(6)
 s_add_u32 m0, s45, 15360
 s_mov_b32 s47, 0x7c4000
 buffer_load_dwordx4 v4, s[32:35], s47 offen lds
 s_waitcnt vmcnt(43)
 ds_read_b64_tr_b16 a[102:103], v3 offset:19456
 ds_read_b64_tr_b16 a[110:111], v3 offset:19968
 s_waitcnt lgkmcnt(6)
 s_add_u32 m0, s45, 16384
 s_mov_b32 s47, 0x0
 buffer_load_dwordx4 v4, s[36:39], s47 offen lds
 s_waitcnt vmcnt(43)
 ds_read_b64_tr_b16 a[112:113], v3 offset:20480
 ds_read_b64_tr_b16 a[120:121], v3 offset:20992
 s_waitcnt lgkmcnt(6)
 s_add_u32 m0, s45, 17408
 s_mov_b32 s47, 0x4000
 buffer_load_dwordx4 v4, s[36:39], s47 offen lds
 s_waitcnt vmcnt(43)
 ds_read_b64_tr_b16 a[114:115], v3 offset:21504
 ds_read_b64_tr_b16 a[122:123], v3 offset:22016
 s_waitcnt lgkmcnt(6)
 s_add_u32 m0, s45, 18432
 s_mov_b32 s47, 0x40000
 buffer_load_dwordx4 v4, s[36:39], s47 offen lds
 s_waitcnt vmcnt(43)
 ds_read_b64_tr_b16 a[116:117], v3 offset:22528
 ds_read_b64_tr_b16 a[124:125], v3 offset:23040
 s_waitcnt lgkmcnt(6)
 s_add_u32 m0, s45, 19456
 s_mov_b32 s47, 0x44000
 buffer_load_dwordx4 v4, s[36:39], s47 offen lds
 s_waitcnt vmcnt(43)
 ds_read_b64_tr_b16 a[118:119], v3 offset:23552
 ds_read_b64_tr_b16 a[126:127], v3 offset:24064
 s_waitcnt lgkmcnt(6)
 s_add_u32 m0, s45, 20480
 s_mov_b32 s47, 0x80000
 buffer_load_dwordx4 v4, s[36:39], s47 offen lds
 s_waitcnt vmcnt(43)
 ds_read_b64_tr_b16 a[128:129], v3 offset:24576
 ds_read_b64_tr_b16 a[136:137], v3 offset:25088
 s_waitcnt lgkmcnt(6)
 s_add_u32 m0, s45, 21504
 s_mov_b32 s47, 0x84000
 buffer_load_dwordx4 v4, s[36:39], s47 offen lds
 s_waitcnt vmcnt(43)
 ds_read_b64_tr_b16 a[130:131], v3 offset:25600
 ds_read_b64_tr_b16 a[138:139], v3 offset:26112
 s_waitcnt lgkmcnt(6)
 s_add_u32 m0, s45, 22528
 s_mov_b32 s47, 0xc0000
 buffer_load_dwordx4 v4, s[36:39], s47 offen lds
 s_waitcnt vmcnt(43)
 ds_read_b64_tr_b16 a[132:133], v3 offset:26624
 ds_read_b64_tr_b16 a[140:141], v3 offset:27136
 s_waitcnt lgkmcnt(6)
 s_add_u32 m0, s45, 23552
 s_mov_b32 s47, 0xc4000
 buffer_load_dwordx4 v4, s[36:39], s47 offen lds
 s_waitcnt vmcnt(43)
 ds_read_b64_tr_b16 a[134:135], v3 offset:27648
 ds_read_b64_tr_b16 a[142:143], v3 offset:28160
 s_waitcnt lgkmcnt(6)
 s_add_u32 m0, s45, 24576
 s_mov_b32 s47, 0x100000
 buffer_load_dwordx4 v4, s[36:39], s47 offen lds
 s_waitcnt vmcnt(43)
 ds_read_b64_tr_b16 a[144:145], v3 offset:28672
 ds_read_b64_tr_b16 a[152:153], v3 offset:29184
 s_waitcnt lgkmcnt(6)
 s_add_u32 m0, s45, 25600
 s_mov_b32 s47, 0x104000
 buffer_load_dwordx4 v4, s[36:39], s47 offen lds
 s_waitcnt vmcnt(43)
 ds_read_b64_tr_b16 a[146:147], v3 offset:29696
 ds_read_b64_tr_b16 a[154:155], v3 offset:30208
 s_waitcnt lgkmcnt(6)
 s_add_u32 m0, s45, 26624
 s_mov_b32 s47, 0x140000
 buffer_load_dwordx4 v4, s[36:39], s47 offen lds
 s_waitcnt vmcnt(43)
 ds_read_b64_tr_b16 a[148:149], v3 offset:30720
 ds_read_b64_tr_b16 a[156:157], v3 offset:31232
 s_waitcnt lgkmcnt(6)
 s_add_u32 m0, s45, 27648
 s_mov_b32 s47, 0x144000
 buffer_load_dwordx4 v4, s[36:39], s47 offen lds
 s_waitcnt vmcnt(43)
 ds_read_b64_tr_b16 a[150:151], v3 offset:31744
 ds_read_b64_tr_b16 a[158:159], v3 offset:32256
 s_waitcnt lgkmcnt(6)
 s_add_u32 m0, s45, 28672
 s_mov_b32 s47, 0x180000
 buffer_load_dwordx4 v4, s[36:39], s47 offen lds
 s_waitcnt vmcnt(36)
 s_barrier
 s_cmp_lg_u32 s40, 0
 s_cbranch_scc1 arr_12
 s_mov_b64 exec, 1
 v_mov_b32 v1, 0
 v_mov_b32 v5, 1
 global_atomic_add v1, v5, s[22:23] offset:192 sc1
 s_mov_b64 exec, -1
arr_12:
 ds_read_b64_tr_b16 a[160:161], v14 offset:0
 ds_read_b64_tr_b16 a[168:169], v14 offset:512
 s_waitcnt lgkmcnt(6)
 s_add_u32 m0, s45, 29696
 s_mov_b32 s47, 0x184000
 buffer_load_dwordx4 v4, s[36:39], s47 offen lds
 s_waitcnt vmcnt(36)
 ds_read_b64_tr_b16 a[162:163], v14 offset:1024
 ds_read_b64_tr_b16 a[170:171], v14 offset:1536
 s_waitcnt lgkmcnt(6)
 s_add_u32 m0, s45, 30720
 s_mov_b32 s47, 0x1c0000
 buffer_load_dwordx4 v4, s[36:39], s47 offen lds
 s_waitcnt vmcnt(36)
 ds_read_b64_tr_b16 a[164:165], v14 offset:2048
 ds_read_b64_tr_b16 a[172:173], v14 offset:2560
 s_waitcnt lgkmcnt(6)
 s_add_u32 m0, s45, 31744
 s_mov_b32 s47, 0x1c4000
 buffer_load_dwordx4 v4, s[36:39], s47 offen lds
 s_waitcnt vmcnt(36)
 ds_read_b64_tr_b16 a[166:167], v14 offset:3072
 ds_read_b64_tr_b16 a[174:175], v14 offset:3584
 s_waitcnt lgkmcnt(6)
 s_mov_b32 m0, s46
 s_mov_b32 s47, 0x200000
 buffer_load_dwordx4 v4, s[36:39], s47 offen lds
 s_waitcnt vmcnt(36)
 ds_read_b64_tr_b16 a[176:177], v14 offset:4096
 ds_read_b64_tr_b16 a[184:185], v14 offset:4608
 s_waitcnt lgkmcnt(6)
 s_add_u32 m0, s46, 1024
 s_mov_b32 s47, 0x204000
 buffer_load_dwordx4 v4, s[36:39], s47 offen lds
 s_waitcnt vmcnt(36)
 ds_read_b64_tr_b16 a[178:179], v14 offset:5120
 ds_read_b64_tr_b16 a[186:187], v14 offset:5632
 s_waitcnt lgkmcnt(6)
 s_add_u32 m0, s46, 2048
 s_mov_b32 s47, 0x240000
 buffer_load_dwordx4 v4, s[36:39], s47 offen lds
 s_waitcnt vmcnt(36)
 ds_read_b64_tr_b16 a[180:181], v14 offset:6144
 ds_read_b64_tr_b16 a[188:189], v14 offset:6656
 s_waitcnt lgkmcnt(6)
 s_add_u32 m0, s46, 3072
 s_mov_b32 s47, 0x244000
 buffer_load_dwordx4 v4, s[36:39], s47 offen lds
 s_waitcnt vmcnt(36)
 ds_read_b64_tr_b16 a[182:183], v14 offset:7168
 ds_read_b64_tr_b16 a[190:191], v14 offset:7680
 s_waitcnt lgkmcnt(6)
 s_add_u32 m0, s46, 4096
 s_mov_b32 s47, 0x280000
 buffer_load_dwordx4 v4, s[36:39], s47 offen lds
 s_waitcnt vmcnt(36)
 ds_read_b64_tr_b16 a[192:193], v3 offset:0
 ds_read_b64_tr_b16 a[200:201], v3 offset:512
 s_waitcnt lgkmcnt(6)
 s_add_u32 m0, s46, 5120
 s_mov_b32 s47, 0x284000
 buffer_load_dwordx4 v4, s[36:39], s47 offen lds
 s_waitcnt vmcnt(36)
 ds_read_b64_tr_b16 a[194:195], v3 offset:1024
 ds_read_b64_tr_b16 a[202:203], v3 offset:1536
 s_waitcnt lgkmcnt(6)
 s_add_u32 m0, s46, 6144
 s_mov_b32 s47, 0x2c0000
 buffer_load_dwordx4 v4, s[36:39], s47 offen lds
 s_waitcnt vmcnt(36)
 ds_read_b64_tr_b16 a[196:197], v3 offset:2048
 ds_read_b64_tr_b16 a[204:205], v3 offset:2560
 s_waitcnt lgkmcnt(6)
 s_add_u32 m0, s46, 7168
 s_mov_b32 s47, 0x2c4000
 buffer_load_dwordx4 v4, s[36:39], s47 offen lds
 s_waitcnt vmcnt(36)
 ds_read_b64_tr_b16 a[198:199], v3 offset:3072
 ds_read_b64_tr_b16 a[206:207], v3 offset:3584
 s_waitcnt lgkmcnt(6)
 s_mov_b32 m0, s45
 s_mov_b32 s47, 0x300000
 buffer_load_dwordx4 v4, s[36:39], s47 offen lds
 s_waitcnt vmcnt(36)
 ds_read_b64_tr_b16 a[208:209], v3 offset:4096
 ds_read_b64_tr_b16 a[216:217], v3 offset:4608
 s_waitcnt lgkmcnt(6)
 s_add_u32 m0, s45, 1024
 s_mov_b32 s47, 0x304000
 buffer_load_dwordx4 v4, s[36:39], s47 offen lds
 s_waitcnt vmcnt(36)
 ds_read_b64_tr_b16 a[210:211], v3 offset:5120
 ds_read_b64_tr_b16 a[218:219], v3 offset:5632
 s_waitcnt lgkmcnt(6)
 s_add_u32 m0, s45, 2048
 s_mov_b32 s47, 0x340000
 buffer_load_dwordx4 v4, s[36:39], s47 offen lds
 s_waitcnt vmcnt(36)
 ds_read_b64_tr_b16 a[212:213], v3 offset:6144
 ds_read_b64_tr_b16 a[220:221], v3 offset:6656
 s_waitcnt lgkmcnt(6)
 s_add_u32 m0, s45, 3072
 s_mov_b32 s47, 0x344000
 buffer_load_dwordx4 v4, s[36:39], s47 offen lds
 s_waitcnt vmcnt(36)
 ds_read_b64_tr_b16 a[214:215], v3 offset:7168
 ds_read_b64_tr_b16 a[222:223], v3 offset:7680
 s_waitcnt lgkmcnt(6)
 s_add_u32 m0, s45, 4096
 s_mov_b32 s47, 0x380000
 buffer_load_dwordx4 v4, s[36:39], s47 offen lds
 s_waitcnt vmcnt(36)
 ds_read_b64_tr_b16 a[224:225], v3 offset:8192
 ds_read_b64_tr_b16 a[232:233], v3 offset:8704
 s_waitcnt lgkmcnt(6)
 s_add_u32 m0, s45, 5120
 s_mov_b32 s47, 0x384000
 buffer_load_dwordx4 v4, s[36:39], s47 offen lds
 s_waitcnt vmcnt(36)
 ds_read_b64_tr_b16 a[226:227], v3 offset:9216
 ds_read_b64_tr_b16 a[234:235], v3 offset:9728
 s_waitcnt lgkmcnt(6)
 s_add_u32 m0, s45, 6144
 s_mov_b32 s47, 0x3c0000
 buffer_load_dwordx4 v4, s[36:39], s47 offen lds
 s_waitcnt vmcnt(36)
 ds_read_b64_tr_b16 a[228:229], v3 offset:10240
 ds_read_b64_tr_b16 a[236:237], v3 offset:10752
 s_waitcnt lgkmcnt(6)
 s_add_u32 m0, s45, 7168
 s_mov_b32 s47, 0x3c4000
 buffer_load_dwordx4 v4, s[36:39], s47 offen lds
 s_waitcnt vmcnt(36)
 ds_read_b64_tr_b16 a[230:231], v3 offset:11264
 ds_read_b64_tr_b16 a[238:239], v3 offset:11776
 s_waitcnt lgkmcnt(6)
 s_add_u32 m0, s45, 8192
 s_mov_b32 s47, 0x400000
 buffer_load_dwordx4 v4, s[36:39], s47 offen lds
 s_waitcnt vmcnt(36)
 ds_read_b64_tr_b16 a[240:241], v3 offset:12288
 ds_read_b64_tr_b16 a[248:249], v3 offset:12800
 s_waitcnt lgkmcnt(6)
 s_add_u32 m0, s45, 9216
 s_mov_b32 s47, 0x404000
 buffer_load_dwordx4 v4, s[36:39], s47 offen lds
 s_waitcnt vmcnt(36)
 ds_read_b64_tr_b16 a[242:243], v3 offset:13312
 ds_read_b64_tr_b16 a[250:251], v3 offset:13824
 s_waitcnt lgkmcnt(6)
 s_add_u32 m0, s45, 10240
 s_mov_b32 s47, 0x440000
 buffer_load_dwordx4 v4, s[36:39], s47 offen lds
 s_waitcnt vmcnt(36)
 ds_read_b64_tr_b16 a[244:245], v3 offset:14336
 ds_read_b64_tr_b16 a[252:253], v3 offset:14848
 s_waitcnt lgkmcnt(6)
 s_add_u32 m0, s45, 11264
 s_mov_b32 s47, 0x444000
 buffer_load_dwordx4 v4, s[36:39], s47 offen lds
 s_waitcnt vmcnt(36)
 ds_read_b64_tr_b16 a[246:247], v3 offset:15360
 ds_read_b64_tr_b16 a[254:255], v3 offset:15872
 s_waitcnt lgkmcnt(6)
 s_add_u32 m0, s45, 12288
 s_mov_b32 s47, 0x480000
 buffer_load_dwordx4 v4, s[36:39], s47 offen lds
 s_waitcnt vmcnt(36)
 ds_read_b64_tr_b16 v[128:129], v3 offset:16384
 ds_read_b64_tr_b16 v[16:17], v3 offset:16896
 s_waitcnt lgkmcnt(6)
 s_add_u32 m0, s45, 13312
 s_mov_b32 s47, 0x484000
 buffer_load_dwordx4 v4, s[36:39], s47 offen lds
 s_waitcnt vmcnt(36)
 ds_read_b64_tr_b16 v[130:131], v3 offset:17408
 ds_read_b64_tr_b16 v[18:19], v3 offset:17920
 s_waitcnt lgkmcnt(6)
 s_add_u32 m0, s45, 14336
 s_mov_b32 s47, 0x4c0000
 buffer_load_dwordx4 v4, s[36:39], s47 offen lds
 s_waitcnt vmcnt(36)
 ds_read_b64_tr_b16 v[132:133], v3 offset:18432
 ds_read_b64_tr_b16 v[20:21], v3 offset:18944
 s_waitcnt lgkmcnt(6)
 s_add_u32 m0, s45, 15360
 s_mov_b32 s47, 0x4c4000
 buffer_load_dwordx4 v4, s[36:39], s47 offen lds
 s_waitcnt vmcnt(36)
 ds_read_b64_tr_b16 v[134:135], v3 offset:19456
 ds_read_b64_tr_b16 v[22:23], v3 offset:19968
 s_waitcnt lgkmcnt(6)
 s_add_u32 m0, s45, 16384
 s_mov_b32 s47, 0x500000
 buffer_load_dwordx4 v4, s[36:39], s47 offen lds
 s_waitcnt vmcnt(36)
 ds_read_b64_tr_b16 v[136:137], v3 offset:20480
 ds_read_b64_tr_b16 v[24:25], v3 offset:20992
 s_waitcnt lgkmcnt(6)
 s_add_u32 m0, s45, 17408
 s_mov_b32 s47, 0x504000
 buffer_load_dwordx4 v4, s[36:39], s47 offen lds
 s_waitcnt vmcnt(36)
 ds_read_b64_tr_b16 v[138:139], v3 offset:21504
 ds_read_b64_tr_b16 v[26:27], v3 offset:22016
 s_waitcnt lgkmcnt(6)
 s_add_u32 m0, s45, 18432
 s_mov_b32 s47, 0x540000
 buffer_load_dwordx4 v4, s[36:39], s47 offen lds
 s_waitcnt vmcnt(36)
 ds_read_b64_tr_b16 v[140:141], v3 offset:22528
 ds_read_b64_tr_b16 v[28:29], v3 offset:23040
 s_waitcnt lgkmcnt(6)
 s_add_u32 m0, s45, 19456
 s_mov_b32 s47, 0x544000
 buffer_load_dwordx4 v4, s[36:39], s47 offen lds
 s_waitcnt vmcnt(36)
 ds_read_b64_tr_b16 v[142:143], v3 offset:23552
 ds_read_b64_tr_b16 v[30:31], v3 offset:24064
 s_waitcnt lgkmcnt(6)
 s_add_u32 m0, s45, 20480
 s_mov_b32 s47, 0x580000
 buffer_load_dwordx4 v4, s[36:39], s47 offen lds
 s_waitcnt vmcnt(36)
 ds_read_b64_tr_b16 v[144:145], v3 offset:24576
 ds_read_b64_tr_b16 v[32:33], v3 offset:25088
 s_waitcnt lgkmcnt(6)
 s_add_u32 m0, s45, 21504
 s_mov_b32 s47, 0x584000
 buffer_load_dwordx4 v4, s[36:39], s47 offen lds
 s_waitcnt vmcnt(36)
 ds_read_b64_tr_b16 v[146:147], v3 offset:25600
 ds_read_b64_tr_b16 v[34:35], v3 offset:26112
 s_waitcnt lgkmcnt(6)
 s_add_u32 m0, s45, 22528
 s_mov_b32 s47, 0x5c0000
 buffer_load_dwordx4 v4, s[36:39], s47 offen lds
 s_waitcnt vmcnt(36)
 ds_read_b64_tr_b16 v[148:149], v3 offset:26624
 ds_read_b64_tr_b16 v[36:37], v3 offset:27136
 s_waitcnt lgkmcnt(6)
 s_add_u32 m0, s45, 23552
 s_mov_b32 s47, 0x5c4000
 buffer_load_dwordx4 v4, s[36:39], s47 offen lds
 s_waitcnt vmcnt(36)
 ds_read_b64_tr_b16 v[150:151], v3 offset:27648
 ds_read_b64_tr_b16 v[38:39], v3 offset:28160
 s_waitcnt lgkmcnt(6)
 s_add_u32 m0, s45, 24576
 s_mov_b32 s47, 0x600000
 buffer_load_dwordx4 v4, s[36:39], s47 offen lds
 s_waitcnt vmcnt(36)
 ds_read_b64_tr_b16 v[152:153], v3 offset:28672
 ds_read_b64_tr_b16 v[40:41], v3 offset:29184
 s_waitcnt lgkmcnt(6)
 s_add_u32 m0, s45, 25600
 s_mov_b32 s47, 0x604000
 buffer_load_dwordx4 v4, s[36:39], s47 offen lds
 s_waitcnt vmcnt(36)
 ds_read_b64_tr_b16 v[154:155], v3 offset:29696
 ds_read_b64_tr_b16 v[42:43], v3 offset:30208
 s_waitcnt lgkmcnt(6)
 s_add_u32 m0, s45, 26624
 s_mov_b32 s47, 0x640000
 buffer_load_dwordx4 v4, s[36:39], s47 offen lds
 s_waitcnt vmcnt(36)
 ds_read_b64_tr_b16 v[156:157], v3 offset:30720
 ds_read_b64_tr_b16 v[44:45], v3 offset:31232
 s_waitcnt lgkmcnt(6)
 s_add_u32 m0, s45, 27648
 s_mov_b32 s47, 0x644000
 buffer_load_dwordx4 v4, s[36:39], s47 offen lds
 s_waitcnt vmcnt(36)
 ds_read_b64_tr_b16 v[158:159], v3 offset:31744
 ds_read_b64_tr_b16 v[46:47], v3 offset:32256
 s_waitcnt lgkmcnt(6)
 s_add_u32 m0, s45, 28672
 s_mov_b32 s47, 0x680000
 buffer_load_dwordx4 v4, s[36:39], s47 offen lds
 s_waitcnt vmcnt(36)
 ds_read_b64_tr_b16 v[160:161], v14 offset:0
 ds_read_b64_tr_b16 v[48:49], v14 offset:512
 s_waitcnt lgkmcnt(6)
 s_add_u32 m0, s45, 29696
 s_mov_b32 s47, 0x684000
 buffer_load_dwordx4 v4, s[36:39], s47 offen lds
 s_waitcnt vmcnt(36)
 ds_read_b64_tr_b16 v[162:163], v14 offset:1024
 ds_read_b64_tr_b16 v[50:51], v14 offset:1536
 s_waitcnt lgkmcnt(6)
 s_add_u32 m0, s45, 30720
 s_mov_b32 s47, 0x6c0000
 buffer_load_dwordx4 v4, s[36:39], s47 offen lds
 s_waitcnt vmcnt(36)
 ds_read_b64_tr_b16 v[164:165], v14 offset:2048
 ds_read_b64_tr_b16 v[52:53], v14 offset:2560
 s_waitcnt lgkmcnt(6)
 s_add_u32 m0, s45, 31744
 s_mov_b32 s47, 0x6c4000
 buffer_load_dwordx4 v4, s[36:39], s47 offen lds
 s_waitcnt vmcnt(36)
 ds_read_b64_tr_b16 v[166:167], v14 offset:3072
 ds_read_b64_tr_b16 v[54:55], v14 offset:3584
 s_waitcnt lgkmcnt(6)
 s_mov_b32 m0, s46
 s_mov_b32 s47, 0x700000
 buffer_load_dwordx4 v4, s[36:39], s47 offen lds
 s_waitcnt vmcnt(36)
 ds_read_b64_tr_b16 v[168:169], v14 offset:4096
 ds_read_b64_tr_b16 v[56:57], v14 offset:4608
 s_waitcnt lgkmcnt(6)
 s_add_u32 m0, s46, 1024
 s_mov_b32 s47, 0x704000
 buffer_load_dwordx4 v4, s[36:39], s47 offen lds
 s_waitcnt vmcnt(36)
 ds_read_b64_tr_b16 v[170:171], v14 offset:5120
 ds_read_b64_tr_b16 v[58:59], v14 offset:5632
 s_waitcnt lgkmcnt(6)
 s_add_u32 m0, s46, 2048
 s_mov_b32 s47, 0x740000
 buffer_load_dwordx4 v4, s[36:39], s47 offen lds
 s_waitcnt vmcnt(36)
 ds_read_b64_tr_b16 v[172:173], v14 offset:6144
 ds_read_b64_tr_b16 v[60:61], v14 offset:6656
 s_waitcnt lgkmcnt(6)
 s_add_u32 m0, s46, 3072
 s_mov_b32 s47, 0x744000
 buffer_load_dwordx4 v4, s[36:39], s47 offen lds
 s_waitcnt vmcnt(36)
 ds_read_b64_tr_b16 v[174:175], v14 offset:7168
 ds_read_b64_tr_b16 v[62:63], v14 offset:7680
 s_waitcnt lgkmcnt(6)
 s_add_u32 m0, s46, 4096
 s_mov_b32 s47, 0x780000
 buffer_load_dwordx4 v4, s[36:39], s47 offen lds
 s_waitcnt vmcnt(36)
 ds_read_b64_tr_b16 v[176:177], v3 offset:0
 ds_read_b64_tr_b16 v[64:65], v3 offset:512
 s_waitcnt lgkmcnt(6)
 s_add_u32 m0, s46, 5120
 s_mov_b32 s47, 0x784000
 buffer_load_dwordx4 v4, s[36:39], s47 offen lds
 s_waitcnt vmcnt(36)
 ds_read_b64_tr_b16 v[178:179], v3 offset:1024
 ds_read_b64_tr_b16 v[66:67], v3 offset:1536
 s_waitcnt lgkmcnt(6)
 s_add_u32 m0, s46, 6144
 s_mov_b32 s47, 0x7c0000
 buffer_load_dwordx4 v4, s[36:39], s47 offen lds
 s_waitcnt vmcnt(36)
 ds_read_b64_tr_b16 v[180:181], v3 offset:2048
 ds_read_b64_tr_b16 v[68:69], v3 offset:2560
 s_waitcnt lgkmcnt(6)
 s_add_u32 m0, s46, 7168
 s_mov_b32 s47, 0x7c4000
 buffer_load_dwordx4 v4, s[36:39], s47 offen lds
 s_waitcnt vmcnt(36)
 ds_read_b64_tr_b16 v[182:183], v3 offset:3072
 ds_read_b64_tr_b16 v[70:71], v3 offset:3584
 s_waitcnt vmcnt(35)
 ds_read_b64_tr_b16 v[184:185], v3 offset:4096
 ds_read_b64_tr_b16 v[72:73], v3 offset:4608
 s_waitcnt vmcnt(34)
 ds_read_b64_tr_b16 v[186:187], v3 offset:5120
 ds_read_b64_tr_b16 v[74:75], v3 offset:5632
 s_waitcnt vmcnt(33)
 ds_read_b64_tr_b16 v[188:189], v3 offset:6144
 ds_read_b64_tr_b16 v[76:77], v3 offset:6656
 s_waitcnt vmcnt(32)
 ds_read_b64_tr_b16 v[190:191], v3 offset:7168
 ds_read_b64_tr_b16 v[78:79], v3 offset:7680
 s_waitcnt vmcnt(31)
 ds_read_b64_tr_b16 v[192:193], v3 offset:8192
 ds_read_b64_tr_b16 v[80:81], v3 offset:8704
 s_waitcnt vmcnt(30)
 ds_read_b64_tr_b16 v[194:195], v3 offset:9216
 ds_read_b64_tr_b16 v[82:83], v3 offset:9728
 s_waitcnt vmcnt(29)
 ds_read_b64_tr_b16 v[196:197], v3 offset:10240
 ds_read_b64_tr_b16 v[84:85], v3 offset:10752
 s_waitcnt vmcnt(28)
 ds_read_b64_tr_b16 v[198:199], v3 offset:11264
 ds_read_b64_tr_b16 v[86:87], v3 offset:11776
 s_waitcnt vmcnt(27)
 ds_read_b64_tr_b16 v[200:201], v3 offset:12288
 ds_read_b64_tr_b16 v[88:89], v3 offset:12800
 s_waitcnt vmcnt(26)
 ds_read_b64_tr_b16 v[202:203], v3 offset:13312
 ds_read_b64_tr_b16 v[90:91], v3 offset:13824
 s_waitcnt vmcnt(25)
 ds_read_b64_tr_b16 v[204:205], v3 offset:14336
 ds_read_b64_tr_b16 v[92:93], v3 offset:14848
 s_waitcnt vmcnt(24)
 ds_read_b64_tr_b16 v[206:207], v3 offset:15360
 ds_read_b64_tr_b16 v[94:95], v3 offset:15872
 s_waitcnt vmcnt(23)
 ds_read_b64_tr_b16 v[208:209], v3 offset:16384
 ds_read_b64_tr_b16 v[96:97], v3 offset:16896
 s_waitcnt vmcnt(22)
 ds_read_b64_tr_b16 v[210:211], v3 offset:17408
 ds_read_b64_tr_b16 v[98:99], v3 offset:17920
 s_waitcnt vmcnt(21)
 ds_read_b64_tr_b16 v[212:213], v3 offset:18432
 ds_read_b64_tr_b16 v[100:101], v3 offset:18944
 s_waitcnt vmcnt(20)
 ds_read_b64_tr_b16 v[214:215], v3 offset:19456
 ds_read_b64_tr_b16 v[102:103], v3 offset:19968
 s_waitcnt vmcnt(19)
 ds_read_b64_tr_b16 v[216:217], v3 offset:20480
 ds_read_b64_tr_b16 v[104:105], v3 offset:20992
 s_waitcnt vmcnt(18)
 ds_read_b64_tr_b16 v[218:219], v3 offset:21504
 ds_read_b64_tr_b16 v[106:107], v3 offset:22016
 s_waitcnt vmcnt(17)
 ds_read_b64_tr_b16 v[220:221], v3 offset:22528
 ds_read_b64_tr_b16 v[108:109], v3 offset:23040
 s_waitcnt vmcnt(16)
 ds_read_b64_tr_b16 v[222:223], v3 offset:23552
 ds_read_b64_tr_b16 v[110:111], v3 offset:24064
 s_waitcnt vmcnt(15)
 ds_read_b64_tr_b16 v[224:225], v3 offset:24576
 ds_read_b64_tr_b16 v[112:113], v3 offset:25088
 s_waitcnt vmcnt(14)
 ds_read_b64_tr_b16 v[226:227], v3 offset:25600
 ds_read_b64_tr_b16 v[114:115], v3 offset:26112
 s_waitcnt vmcnt(13)
 ds_read_b64_tr_b16 v[228:229], v3 offset:26624
 ds_read_b64_tr_b16 v[116:117], v3 offset:27136
 s_waitcnt vmcnt(12)
 ds_read_b64_tr_b16 v[230:231], v3 offset:27648
 ds_read_b64_tr_b16 v[118:119], v3 offset:28160
 s_waitcnt vmcnt(11)
 ds_read_b64_tr_b16 v[232:233], v3 offset:28672
 ds_read_b64_tr_b16 v[120:121], v3 offset:29184
 s_waitcnt vmcnt(10)
 ds_read_b64_tr_b16 v[234:235], v3 offset:29696
 ds_read_b64_tr_b16 v[122:123], v3 offset:30208
 s_waitcnt vmcnt(9)
 ds_read_b64_tr_b16 v[236:237], v3 offset:30720
 ds_read_b64_tr_b16 v[124:125], v3 offset:31232
 s_waitcnt vmcnt(8)
 ds_read_b64_tr_b16 v[238:239], v3 offset:31744
 ds_read_b64_tr_b16 v[126:127], v3 offset:32256
 v_lshlrev_b32 v5, 4, v0
 v_add_u32 v5, s45, v5
 s_waitcnt lgkmcnt(0)
 ds_write_b128 v5, v[16:19] offset:0
 ds_write_b128 v5, v[20:23] offset:1024
 ds_write_b128 v5, v[24:27] offset:2048
 ds_write_b128 v5, v[28:31] offset:3072
 ds_write_b128 v5, v[32:35] offset:4096
 ds_write_b128 v5, v[36:39] offset:5120
 ds_write_b128 v5, v[40:43] offset:6144
 ds_write_b128 v5, v[44:47] offset:7168
 ds_write_b128 v5, v[48:51] offset:8192
 ds_write_b128 v5, v[52:55] offset:9216
 ds_write_b128 v5, v[56:59] offset:10240
 ds_write_b128 v5, v[60:63] offset:11264
 ds_write_b128 v5, v[64:67] offset:12288
 ds_write_b128 v5, v[68:71] offset:13312
 ds_write_b128 v5, v[72:75] offset:14336
 ds_write_b128 v5, v[76:79] offset:15360
 ds_write_b128 v5, v[80:83] offset:16384
 ds_write_b128 v5, v[84:87] offset:17408
 ds_write_b128 v5, v[88:91] offset:18432
 ds_write_b128 v5, v[92:95] offset:19456
 ds_write_b128 v5, v[96:99] offset:20480
 ds_write_b128 v5, v[100:103] offset:21504
 ds_write_b128 v5, v[104:107] offset:22528
 ds_write_b128 v5, v[108:111] offset:23552
 ds_write_b128 v5, v[112:115] offset:24576
 ds_write_b128 v5, v[116:119] offset:25600
 ds_write_b128 v5, v[120:123] offset:26624
 ds_write_b128 v5, v[124:127] offset:27648
 s_waitcnt lgkmcnt(0)
 s_waitcnt vmcnt(7)
 ds_read_b64_tr_b16 v[240:241], v14 offset:0
 ds_read_b64_tr_b16 v[16:17], v14 offset:512
 s_waitcnt vmcnt(6)
 ds_read_b64_tr_b16 v[242:243], v14 offset:1024
 ds_read_b64_tr_b16 v[18:19], v14 offset:1536
 s_waitcnt vmcnt(5)
 ds_read_b64_tr_b16 v[244:245], v14 offset:2048
 ds_read_b64_tr_b16 v[20:21], v14 offset:2560
 s_waitcnt vmcnt(4)
 ds_read_b64_tr_b16 v[246:247], v14 offset:3072
 ds_read_b64_tr_b16 v[22:23], v14 offset:3584
 s_waitcnt vmcnt(3)
 ds_read_b64_tr_b16 v[248:249], v14 offset:4096
 ds_read_b64_tr_b16 v[24:25], v14 offset:4608
 s_waitcnt vmcnt(2)
 ds_read_b64_tr_b16 v[250:251], v14 offset:5120
 ds_read_b64_tr_b16 v[26:27], v14 offset:5632
 s_waitcnt vmcnt(1)
 ds_read_b64_tr_b16 v[252:253], v14 offset:6144
 ds_read_b64_tr_b16 v[28:29], v14 offset:6656
 s_waitcnt vmcnt(0)
 ds_read_b64_tr_b16 v[254:255], v14 offset:7168
 ds_read_b64_tr_b16 v[30:31], v14 offset:7680
 s_waitcnt lgkmcnt(0)
 ds_write_b128 v5, v[16:19] offset:28672
 ds_write_b128 v5, v[20:23] offset:29696
 ds_write_b128 v5, v[24:27] offset:30720
 ds_write_b128 v5, v[28:31] offset:31744
 s_waitcnt lgkmcnt(0)
 v_mov_b32 v3, v5
 s_lshl_b32 s47, s40, 12
 v_add_u32 v4, s47, v12
 v_and_b32 v5, 7, v0
 v_lshlrev_b32 v5, 2, v5
 s_add_u32 s68, s47, 131072
 s_lshr_b32 s47, s47, 1
 s_add_u32 s69, s47, 151680
 s_add_u32 s53, s53, s47
 v_lshrrev_b32 v16, 5, v0
 v_lshlrev_b32 v16, 4, v16
 v_and_b32 v17, 15, v0
 v_add_u32 v16, v16, v17
 v_lshlrev_b32 v16, 3, v16
 v_bfe_u32 v17, v0, 4, 1
 v_mul_u32_u24 v17, 2112, v17
 v_add_u32 v16, v17, v16
 s_lshl_b32 s47, s40, 8
 s_add_u32 s47, s47, 147456
 v_add_u32 v6, s47, v16
 v_lshrrev_b32 v16, 2, v0
 v_lshlrev_b32 v16, 3, v16
 v_and_b32 v17, 1, v0
 v_mul_u32_u24 v17, 2112, v17
 v_add_u32 v16, v17, v16
 v_add_u32 v7, 147456, v16
 v_add_u32 v14, s47, v16
 v_cmp_gt_u32 vcc, 32, v0
 v_mov_b32 v9, 0xff800000
 s_nop 0
 v_cndmask_b32 v9, v9, 0, vcc
 v_and_b32 v16, 31, v0
 v_lshlrev_b32 v16, 3, v16
 s_lshl_b32 s47, s40, 9
 v_add_u32 v11, s47, v16
 v_mov_b32 v112, 0x3f803f80
 v_mov_b32 v113, 0x3f803f80
 v_mov_b32 v114, 0x3f803f80
 v_mov_b32 v115, 0x3f803f80
 v_mov_b32 v118, 0
 v_mov_b32 v119, 0
 v_mov_b32 v122, 0
 v_mov_b32 v123, 0
 v_mov_b32 v16, 0
gw_13:
 global_load_dword v17, v16, s[22:23] offset:192 sc1
 s_waitcnt vmcnt(0)
 v_readfirstlane_b32 s48, v17
 s_cmp_ge_u32 s48, 64
 s_cbranch_scc1 gwd_14
 s_sub_u32 s26, s26, 1
 s_cbranch_scc1 L_end
 s_sleep 2
 s_branch gw_13
gwd_14:
 v_mov_b32 v16, 0
gw_15:
 global_load_dword v17, v16, s[22:23] offset:8 sc1
 s_waitcnt vmcnt(0)
 v_readfirstlane_b32 s48, v17
 s_cmp_ge_u32 s48, 192
 s_cbranch_scc1 gwd_16
 s_sub_u32 s26, s26, 1
 s_cbranch_scc1 L_end
 s_sleep 2
 s_branch gw_15
gwd_16:
 v_and_b32 v16, 31, v0
 v_lshlrev_b32 v16, 5, v16
 s_and_b32 s47, s2, 7
 s_lshl_b32 s47, s47, 2
 s_add_u32 s47, s47, 0
 buffer_load_dword v17, v16, s[28:31], s47 offen sc1
 s_waitcnt vmcnt(0)
 v_cmp_ne_u32 vcc, s3, v17
 s_cmp_eq_u64 vcc, 0
 s_cselect_b32 s44, 1, 0
 s_barrier
 s_mov_b32 s43, 0
 s_mov_b32 s56, 0
 s_mov_b32 s66, -1
 s_mov_b32 s98, 0
 s_add_u32 s48, s43, 1
 s_min_u32 s48, s48, 63
kvp_18:
 s_cmp_lt_u32 s48, s56
 s_cbranch_scc1 kvok_17
 v_and_b32 v16, 1, v0
 v_bfe_u32 v17, v0, 1, 1
 v_lshlrev_b32 v16, 7, v16
 v_lshl_add_u32 v16, v17, 13, v16
 buffer_load_dword v17, v16, s[28:31], s58 offen sc1
 s_waitcnt vmcnt(0)
 v_readlane_b32 s56, v17, 0
 v_readlane_b32 s47, v17, 1
 s_min_u32 s56, s56, s47
 v_readlane_b32 s47, v17, 2
 s_min_u32 s56, s56, s47
 v_readlane_b32 s47, v17, 3
 s_min_u32 s56, s56, s47
 s_sub_u32 s26, s26, 1
 s_cbranch_scc1 L_end
 s_branch kvp_18
kvok_17:
 s_mov_b32 m0, s69
 s_nop 0
 buffer_load_dwordx4 v12, s[28:31], s53 offen offset:0 sc1 lds
 buffer_load_dwordx4 v12, s[28:31], s53 offen offset:1024 sc1 lds
 s_waitcnt vmcnt(0)
 buffer_load_dwordx4 v[104:107], v12, s[28:31], s54 offen offset:0 sc1
 buffer_load_dwordx4 v[108:111], v12, s[28:31], s54 offen offset:1024 sc1
 s_mov_b32 m0, s68
 s_barrier
 v_add_u32 v16, 151680, v12
 ds_read_b128 v[72:75], v16 offset:0
 ds_read_b128 v[76:79], v16 offset:1024
 ds_read_b128 v[80:83], v16 offset:2048
 ds_read_b128 v[84:87], v16 offset:3072
 ds_read_b128 v[88:91], v16 offset:4096
 ds_read_b128 v[92:95], v16 offset:5120
 ds_read_b128 v[96:99], v16 offset:6144
 ds_read_b128 v[100:103], v16 offset:7168
 s_add_u32 s53, s53, 262144
 s_add_u32 s54, s54, 262144
 s_cmp_eq_u32 s44, 1
 s_cbranch_scc0 L_qk_step_g
L_qk_step_l:
 v_mov_b32 v56, 0
 v_mov_b32 v57, 0
 v_mov_b32 v58, 0
 v_mov_b32 v59, 0
 v_mov_b32 v60, 0
 v_mov_b32 v61, 0
 v_mov_b32 v62, 0
 v_mov_b32 v63, 0
 v_mov_b32 v64, 0
 v_mov_b32 v65, 0
 v_mov_b32 v66, 0
 v_mov_b32 v67, 0
 v_mov_b32 v68, 0
 v_mov_b32 v69, 0
 v_mov_b32 v70, 0
 v_mov_b32 v71, 0
 ds_read_b128 v[32:35], v3 offset:0
 ds_read_b128 v[36:39], v3 offset:1024
 ds_read_b128 v[40:43], v3 offset:8192
 ds_read_b128 v[44:47], v3 offset:9216
 ds_read_b128 v[48:51], v3 offset:16384
 ds_read_b128 v[52:55], v3 offset:17408
 s_add_u32 s67, s43, 1
 s_waitcnt lgkmcnt(0)
 buffer_load_dword v124, v5, s[28:31], s59 offen sc1
 buffer_load_dword v125, v5, s[28:31], s59 offen sc1
 buffer_load_dword v126, v5, s[28:31], s59 offen sc1
 buffer_load_dword v127, v5, s[28:31], s59 offen sc1
wb_19_0:
 s_waitcnt vmcnt(3)
 v_cmp_gt_u32 vcc, s43, v124
 s_cbranch_vccnz wb_19_r0
 buffer_load_dwordx4 v4, s[28:31], s50 offen offset:0 sc1 lds
 s_branch wb_19_ok
wb_19_r0:
 buffer_load_dword v124, v5, s[28:31], s59 offen sc1
wb_19_1:
 s_waitcnt vmcnt(3)
 v_cmp_gt_u32 vcc, s43, v125
 s_cbranch_vccnz wb_19_r1
 buffer_load_dwordx4 v4, s[28:31], s50 offen offset:0 sc1 lds
 s_branch wb_19_ok
wb_19_r1:
 buffer_load_dword v125, v5, s[28:31], s59 offen sc1
wb_19_2:
 s_waitcnt vmcnt(3)
 v_cmp_gt_u32 vcc, s43, v126
 s_cbranch_vccnz wb_19_r2
 buffer_load_dwordx4 v4, s[28:31], s50 offen offset:0 sc1 lds
 s_branch wb_19_ok
wb_19_r2:
 buffer_load_dword v126, v5, s[28:31], s59 offen sc1
wb_19_3:
 s_waitcnt vmcnt(3)
 v_cmp_gt_u32 vcc, s43, v127
 s_cbranch_vccnz wb_19_r3
 buffer_load_dwordx4 v4, s[28:31], s50 offen offset:0 sc1 lds
wb_19_ok:
 buffer_load_dwordx4 v4, s[28:31], s50 offen offset:1024 sc1 lds
 buffer_load_dwordx4 v4, s[28:31], s50 offen offset:2048 sc1 lds
 buffer_load_dwordx4 v4, s[28:31], s50 offen offset:3072 sc1 lds
 s_waitcnt vmcnt(3)
L_qk_step_l_go:
 s_barrier
 ds_read_b128 v[16:19], v2 offset:0
 ds_read_b128 v[20:23], v2 offset:4096
 ds_read_b128 v[24:27], v2 offset:8192
 ds_read_b128 v[28:31], v2 offset:12288
 s_waitcnt lgkmcnt(3)
 v_smfmac_f32_16x16x64_bf16 v[60:63], v[16:19], v[32:39], v8
 v_smfmac_f32_16x16x64_bf16 v[56:59], v[16:19], v[128:135], v8
 ds_read_b128 v[32:35], v3 offset:24576
 v_smfmac_f32_16x16x64_bf16 v[64:67], v[16:19], a[0:7], v8
 ds_read_b128 v[36:39], v3 offset:25600
 v_smfmac_f32_16x16x64_bf16 v[68:71], v[16:19], a[8:15], v8
 s_waitcnt lgkmcnt(4)
 v_smfmac_f32_16x16x64_bf16 v[60:63], v[20:23], v[40:47], v8
 s_waitcnt vmcnt(2)
 s_barrier
 ds_read_b128 v[16:19], v2 offset:1024
 v_smfmac_f32_16x16x64_bf16 v[56:59], v[20:23], v[160:167], v8
 ds_read_b128 v[40:43], v3 offset:2048
 v_smfmac_f32_16x16x64_bf16 v[64:67], v[20:23], a[64:71], v8
 ds_read_b128 v[44:47], v3 offset:3072
 v_smfmac_f32_16x16x64_bf16 v[68:71], v[20:23], a[72:79], v8
 s_waitcnt lgkmcnt(6)
 v_smfmac_f32_16x16x64_bf16 v[60:63], v[24:27], v[48:55], v8
 ds_read_b128 v[20:23], v2 offset:5120
 v_smfmac_f32_16x16x64_bf16 v[56:59], v[24:27], v[192:199], v8
 ds_read_b128 v[48:51], v3 offset:10240
 v_smfmac_f32_16x16x64_bf16 v[64:67], v[24:27], a[128:135], v8
 ds_read_b128 v[52:55], v3 offset:11264
 v_smfmac_f32_16x16x64_bf16 v[68:71], v[24:27], a[136:143], v8
 s_waitcnt lgkmcnt(6)
 v_smfmac_f32_16x16x64_bf16 v[60:63], v[28:31], v[32:39], v8
 ds_read_b128 v[24:27], v2 offset:9216
 v_smfmac_f32_16x16x64_bf16 v[56:59], v[28:31], v[224:231], v8
 ds_read_b128 v[32:35], v3 offset:18432
 v_smfmac_f32_16x16x64_bf16 v[64:67], v[28:31], a[192:199], v8
 ds_read_b128 v[36:39], v3 offset:19456
 v_smfmac_f32_16x16x64_bf16 v[68:71], v[28:31], a[200:207], v8
 s_waitcnt lgkmcnt(6)
 v_smfmac_f32_16x16x64_bf16 v[60:63], v[16:19], v[40:47], v8
 ds_read_b128 v[28:31], v2 offset:13312
 v_smfmac_f32_16x16x64_bf16 v[56:59], v[16:19], v[136:143], v8
 ds_read_b128 v[40:43], v3 offset:26624
 v_smfmac_f32_16x16x64_bf16 v[64:67], v[16:19], a[16:23], v8
 ds_read_b128 v[44:47], v3 offset:27648
 v_smfmac_f32_16x16x64_bf16 v[68:71], v[16:19], a[24:31], v8
 s_waitcnt lgkmcnt(6)
 v_smfmac_f32_16x16x64_bf16 v[60:63], v[20:23], v[48:55], v8
 s_waitcnt vmcnt(1)
 s_barrier
 ds_read_b128 v[16:19], v2 offset:2048
 v_smfmac_f32_16x16x64_bf16 v[56:59], v[20:23], v[168:175], v8
 ds_read_b128 v[48:51], v3 offset:4096
 v_smfmac_f32_16x16x64_bf16 v[64:67], v[20:23], a[80:87], v8
 ds_read_b128 v[52:55], v3 offset:5120
 v_smfmac_f32_16x16x64_bf16 v[68:71], v[20:23], a[88:95], v8
 s_waitcnt lgkmcnt(6)
 v_smfmac_f32_16x16x64_bf16 v[60:63], v[24:27], v[32:39], v8
 ds_read_b128 v[20:23], v2 offset:6144
 v_smfmac_f32_16x16x64_bf16 v[56:59], v[24:27], v[200:207], v8
 ds_read_b128 v[32:35], v3 offset:12288
 v_smfmac_f32_16x16x64_bf16 v[64:67], v[24:27], a[144:151], v8
 ds_read_b128 v[36:39], v3 offset:13312
 v_smfmac_f32_16x16x64_bf16 v[68:71], v[24:27], a[152:159], v8
 s_waitcnt lgkmcnt(6)
 v_smfmac_f32_16x16x64_bf16 v[60:63], v[28:31], v[40:47], v8
 ds_read_b128 v[24:27], v2 offset:10240
 v_smfmac_f32_16x16x64_bf16 v[56:59], v[28:31], v[232:239], v8
 ds_read_b128 v[40:43], v3 offset:20480
 v_smfmac_f32_16x16x64_bf16 v[64:67], v[28:31], a[208:215], v8
 ds_read_b128 v[44:47], v3 offset:21504
 v_smfmac_f32_16x16x64_bf16 v[68:71], v[28:31], a[216:223], v8
 s_waitcnt lgkmcnt(6)
 v_smfmac_f32_16x16x64_bf16 v[60:63], v[16:19], v[48:55], v8
 ds_read_b128 v[28:31], v2 offset:14336
 v_smfmac_f32_16x16x64_bf16 v[56:59], v[16:19], v[144:151], v8
 ds_read_b128 v[48:51], v3 offset:28672
 v_smfmac_f32_16x16x64_bf16 v[64:67], v[16:19], a[32:39], v8
 ds_read_b128 v[52:55], v3 offset:29696
 v_smfmac_f32_16x16x64_bf16 v[68:71], v[16:19], a[40:47], v8
 s_waitcnt lgkmcnt(6)
 v_smfmac_f32_16x16x64_bf16 v[60:63], v[20:23], v[32:39], v8
 s_waitcnt vmcnt(0)
 s_barrier
 ds_read_b128 v[16:19], v2 offset:3072
 v_smfmac_f32_16x16x64_bf16 v[56:59], v[20:23], v[176:183], v8
 ds_read_b128 v[32:35], v3 offset:6144
 v_smfmac_f32_16x16x64_bf16 v[64:67], v[20:23], a[96:103], v8
 ds_read_b128 v[36:39], v3 offset:7168
 v_smfmac_f32_16x16x64_bf16 v[68:71], v[20:23], a[104:111], v8
 s_waitcnt lgkmcnt(6)
 v_smfmac_f32_16x16x64_bf16 v[60:63], v[24:27], v[40:47], v8
 ds_read_b128 v[20:23], v2 offset:7168
 v_smfmac_f32_16x16x64_bf16 v[56:59], v[24:27], v[208:215], v8
 ds_read_b128 v[40:43], v3 offset:14336
 v_smfmac_f32_16x16x64_bf16 v[64:67], v[24:27], a[160:167], v8
 ds_read_b128 v[44:47], v3 offset:15360
 s_mov_b32 m0, s69
 v_smfmac_f32_16x16x64_bf16 v[68:71], v[24:27], a[168:175], v8
 buffer_load_dwordx4 v12, s[28:31], s53 offen offset:0 sc1 lds
 s_waitcnt lgkmcnt(6)
 v_smfmac_f32_16x16x64_bf16 v[60:63], v[28:31], v[48:55], v8
 ds_read_b128 v[24:27], v2 offset:11264
 v_smfmac_f32_16x16x64_bf16 v[56:59], v[28:31], v[240:247], v8
 ds_read_b128 v[48:51], v3 offset:22528
 v_smfmac_f32_16x16x64_bf16 v[64:67], v[28:31], a[224:231], v8
 ds_read_b128 v[52:55], v3 offset:23552
 v_smfmac_f32_16x16x64_bf16 v[68:71], v[28:31], a[232:239], v8
 buffer_load_dwordx4 v12, s[28:31], s53 offen offset:1024 sc1 lds
 s_waitcnt lgkmcnt(6)
 v_smfmac_f32_16x16x64_bf16 v[60:63], v[16:19], v[32:39], v8
 ds_read_b128 v[28:31], v2 offset:15360
 v_smfmac_f32_16x16x64_bf16 v[56:59], v[16:19], v[152:159], v8
 ds_read_b128 v[32:35], v3 offset:30720
 v_smfmac_f32_16x16x64_bf16 v[64:67], v[16:19], a[48:55], v8
 ds_read_b128 v[36:39], v3 offset:31744
 v_smfmac_f32_16x16x64_bf16 v[68:71], v[16:19], a[56:63], v8
 s_waitcnt lgkmcnt(6)
 v_smfmac_f32_16x16x64_bf16 v[56:59], v[20:23], v[184:191], v8
 v_smfmac_f32_16x16x64_bf16 v[60:63], v[20:23], v[40:47], v8
 v_smfmac_f32_16x16x64_bf16 v[64:67], v[20:23], a[112:119], v8
 v_smfmac_f32_16x16x64_bf16 v[68:71], v[20:23], a[120:127], v8
 s_waitcnt lgkmcnt(3)
 v_smfmac_f32_16x16x64_bf16 v[56:59], v[24:27], v[216:223], v8
 v_smfmac_f32_16x16x64_bf16 v[60:63], v[24:27], v[48:55], v8
 v_smfmac_f32_16x16x64_bf16 v[64:67], v[24:27], a[176:183], v8
 v_smfmac_f32_16x16x64_bf16 v[68:71], v[24:27], a[184:191], v8
 s_waitcnt lgkmcnt(0)
 v_smfmac_f32_16x16x64_bf16 v[56:59], v[28:31], v[248:255], v8
 v_smfmac_f32_16x16x64_bf16 v[60:63], v[28:31], v[32:39], v8
 v_smfmac_f32_16x16x64_bf16 v[64:67], v[28:31], a[240:247], v8
 v_smfmac_f32_16x16x64_bf16 v[68:71], v[28:31], a[248:255], v8
 v_permlane32_swap_b32 v56, v60
 v_permlane32_swap_b32 v57, v61
 v_permlane32_swap_b32 v58, v62
 v_permlane32_swap_b32 v59, v63
 v_pk_add_f32 v[56:57], v[56:57], v[60:61]
 v_pk_add_f32 v[58:59], v[58:59], v[62:63]
 v_cvt_pk_bf16_f32 v60, v56, v57
 v_cvt_pk_bf16_f32 v61, v58, v59
 ds_write_b64 v6, v[60:61] offset:0
 v_permlane32_swap_b32 v64, v68
 v_permlane32_swap_b32 v65, v69
 v_permlane32_swap_b32 v66, v70
 v_permlane32_swap_b32 v67, v71
 v_pk_add_f32 v[64:65], v[64:65], v[68:69]
 v_pk_add_f32 v[66:67], v[66:67], v[70:71]
 v_cvt_pk_bf16_f32 v68, v64, v65
 v_cvt_pk_bf16_f32 v69, v66, v67
 ds_write_b64 v6, v[68:69] offset:1024
 v_cmp_u_f32 vcc, v56, v57
 v_cmp_u_f32 s[64:65], v58, v59
 s_waitcnt lgkmcnt(0)
 s_barrier
L_qk_step_l_ok:
 ds_read_b64_tr_b16 v[16:17], v7 offset:0
 ds_read_b64_tr_b16 v[18:19], v7 offset:128
 ds_read_b64_tr_b16 v[20:21], v7 offset:256
 ds_read_b64_tr_b16 v[22:23], v7 offset:384
 ds_read_b64_tr_b16 v[32:33], v7 offset:1024
 ds_read_b64_tr_b16 v[34:35], v7 offset:1152
 s_or_b64 vcc, vcc, s[64:65]
 s_cmp_eq_u32 s43, 63
 s_waitcnt lgkmcnt(4)
 v_mfma_f32_16x16x32_bf16 v[56:59], v[72:75], v[16:19], 0
 ds_read_b64_tr_b16 v[24:25], v7 offset:512
 ds_read_b64_tr_b16 v[26:27], v7 offset:640
 v_mfma_f32_16x16x32_bf16 v[60:63], v[88:91], v[16:19], 0
 ds_read_b64_tr_b16 v[28:29], v7 offset:768
 ds_read_b64_tr_b16 v[30:31], v7 offset:896
 s_waitcnt lgkmcnt(6)
 v_mfma_f32_16x16x32_bf16 v[56:59], v[76:79], v[20:23], v[56:59]
 ds_read_b64_tr_b16 v[36:37], v7 offset:1280
 ds_read_b64_tr_b16 v[38:39], v7 offset:1408
 v_mfma_f32_16x16x32_bf16 v[60:63], v[92:95], v[20:23], v[60:63]
 ds_read_b64_tr_b16 v[40:41], v7 offset:1536
 ds_read_b64_tr_b16 v[42:43], v7 offset:1664
 s_waitcnt lgkmcnt(8)
 v_mfma_f32_16x16x32_bf16 v[64:67], v[32:35], v[16:19], 0
 ds_read_b64_tr_b16 v[44:45], v7 offset:1792
 ds_read_b64_tr_b16 v[46:47], v7 offset:1920
 s_waitcnt lgkmcnt(8)
 v_mfma_f32_16x16x32_bf16 v[56:59], v[80:83], v[24:27], v[56:59]
 s_cbranch_vccnz L_qk_step_l_nan
 v_mfma_f32_16x16x32_bf16 v[60:63], v[96:99], v[24:27], v[60:63]
 s_cbranch_scc1 L_qk_last
 s_waitcnt lgkmcnt(4)
 v_mfma_f32_16x16x32_bf16 v[64:67], v[36:39], v[20:23], v[64:67]
 v_mov_b32 v54, 0
 v_mov_b32 v55, 0
 v_mfma_f32_16x16x32_bf16 v[56:59], v[84:87], v[28:31], v[56:59]
 v_mov_b32 v71, s67
 s_waitcnt lgkmcnt(2)
 v_mfma_f32_16x16x32_bf16 v[60:63], v[100:103], v[28:31], v[60:63]
 v_mfma_f32_16x16x32_bf16 v[64:67], v[40:43], v[24:27], v[64:67]
 buffer_load_dwordx2 v[116:117], v11, s[28:31], s52 offen offset:0 sc1
 s_waitcnt lgkmcnt(0)
 v_mfma_f32_16x16x32_bf16 v[64:67], v[44:47], v[28:31], v[64:67]
 buffer_load_dwordx2 v[120:121], v11, s[28:31], s52 offen offset:256 sc1
 v_max3_f32 v68, v56, v57, v58
 v_max3_f32 v68, v68, v59, v60
 v_max3_f32 v68, v68, v61, v62
 v_max_f32 v68, v68, v63
 s_nop 2
 v_max3_f32 v68, v68, v64, v65
 v_max3_f32 v69, v68, v66, v67
 v_max3_f32 v68, v68, v66, v67
 s_nop 1
 v_permlane32_swap_b32 v68, v69
 v_max_f32 v70, v68, v69
 v_max_f32 v68, v68, v69
 s_nop 1
 v_permlane16_swap_b32 v68, v70
 v_max_f32 v68, v68, v70
 v_mul_f32 v68, s62, v68
 v_pk_fma_f32 v[56:57], v[56:57], s[60:61], v[68:69] op_sel_hi:[1,1,0]
 v_pk_fma_f32 v[58:59], v[58:59], s[60:61], v[68:69] op_sel_hi:[1,1,0]
 v_pk_fma_f32 v[60:61], v[60:61], s[60:61], v[68:69] op_sel_hi:[1,1,0]
 v_pk_fma_f32 v[62:63], v[62:63], s[60:61], v[68:69] op_sel_hi:[1,1,0]
 v_add_f32 v70, v68, v9
 v_exp_f32 v56, v56
 v_exp_f32 v57, v57
 v_exp_f32 v58, v58
 v_cvt_pk_bf16_f32 v48, v56, v57
 v_exp_f32 v59, v59
 v_exp_f32 v60, v60
 v_cvt_pk_bf16_f32 v49, v58, v59
 v_exp_f32 v61, v61
 v_exp_f32 v62, v62
 v_cvt_pk_bf16_f32 v50, v60, v61
 v_exp_f32 v63, v63
 v_pk_fma_f32 v[64:65], v[64:65], s[60:61], v[70:71] op_sel_hi:[1,1,0]
 v_cvt_pk_bf16_f32 v51, v62, v63
 v_pk_fma_f32 v[66:67], v[66:67], s[60:61], v[70:71] op_sel_hi:[1,1,0]
 v_exp_f32 v64, v64
 v_mfma_f32_16x16x32_bf16 v[124:127], v[112:115], v[48:51], 0
 v_exp_f32 v65, v65
 v_mfma_f32_16x16x32_bf16 v[24:27], v[104:107], v[48:51], 0
 v_exp_f32 v66, v66
 v_mfma_f32_16x16x32_bf16 v[28:31], v[108:111], v[48:51], 0
 buffer_store_dword v71, v13, s[28:31], s63 offen
 v_exp_f32 v67, v67
 s_waitcnt vmcnt(1)
vm_20:
 v_max_u32 v1, v116, v120
 v_cmp_eq_u32 vcc, -1, v1
 v_cvt_pk_bf16_f32 v52, v64, v65
 v_cvt_pk_bf16_f32 v53, v66, v67
 s_nop 0
 s_cbranch_vccnz vmd_21
 v_mfma_f32_16x16x32_bf16 v[124:127], v[112:115], v[52:55], v[124:127]
 v_mfma_f32_16x16x32_bf16 v[24:27], v[116:119], v[52:55], v[24:27]
 v_mfma_f32_16x16x32_bf16 v[28:31], v[120:123], v[52:55], v[28:31]
 s_nop 0
 v_rcp_f32 v68, v124
 s_nop 1
 v_pk_mul_f32 v[24:25], v[24:25], v[68:69] op_sel_hi:[1,0]
 v_pk_mul_f32 v[26:27], v[26:27], v[68:69] op_sel_hi:[1,0]
 v_cvt_pk_bf16_f32 v24, v24, v25
 v_cvt_pk_bf16_f32 v25, v26, v27
 v_pk_mul_f32 v[28:29], v[28:29], v[68:69] op_sel_hi:[1,0]
 v_pk_mul_f32 v[30:31], v[30:31], v[68:69] op_sel_hi:[1,0]
 v_min_u32 v24, -2, v24
 v_cvt_pk_bf16_f32 v26, v28, v29
 v_cvt_pk_bf16_f32 v27, v30, v31
 buffer_store_dwordx4 v[24:27], v10, s[28:31], s51 offen
 ds_read_b64_tr_b16 v[32:33], v14 offset:1024
 ds_read_b64_tr_b16 v[34:35], v14 offset:1152
 v_mov_b32 v36, -1
 v_mov_b32 v37, -1
 v_mov_b32 v38, -1
 v_mov_b32 v39, -1
 s_add_u32 s47, s51, 98304
 s_and_b32 s47, s47, 98304
 s_andn2_b32 s49, s51, 98304
 s_or_b32 s47, s47, s49
 buffer_store_dwordx4 v[36:39], v10, s[28:31], s47 offen
 v_mov_b32 v40, s43
 buffer_store_dword v40, v13, s[28:31], s57 offen sc1
 s_waitcnt lgkmcnt(0)
 buffer_store_dwordx4 v[32:35], v15, s[28:31], s55 offen sc1
 s_add_u32 s55, s55, 65536
 buffer_load_dwordx4 v[104:107], v12, s[28:31], s54 offen offset:0 sc1
 buffer_load_dwordx4 v[108:111], v12, s[28:31], s54 offen offset:1024 sc1
 s_mov_b32 m0, s68
 s_barrier
 v_add_u32 v16, 151680, v12
 ds_read_b128 v[72:75], v16 offset:0
 ds_read_b128 v[76:79], v16 offset:1024
 ds_read_b128 v[80:83], v16 offset:2048
 ds_read_b128 v[84:87], v16 offset:3072
 ds_read_b128 v[88:91], v16 offset:4096
 ds_read_b128 v[92:95], v16 offset:5120
 ds_read_b128 v[96:99], v16 offset:6144
 ds_read_b128 v[100:103], v16 offset:7168
 s_add_u32 s53, s53, 262144
 s_add_u32 s54, s54, 262144
 s_add_u32 s48, s43, 2
 s_min_u32 s48, s48, 63
kvp_23:
 s_cmp_lt_u32 s48, s56
 s_cbranch_scc1 kvok_22
 v_and_b32 v16, 1, v0
 v_bfe_u32 v17, v0, 1, 1
 v_lshlrev_b32 v16, 7, v16
 v_lshl_add_u32 v16, v17, 13, v16
 buffer_load_dword v17, v16, s[28:31], s58 offen sc1
 s_waitcnt vmcnt(0)
 v_readlane_b32 s56, v17, 0
 v_readlane_b32 s47, v17, 1
 s_min_u32 s56, s56, s47
 v_readlane_b32 s47, v17, 2
 s_min_u32 s56, s56, s47
 v_readlane_b32 s47, v17, 3
 s_min_u32 s56, s56, s47
 s_sub_u32 s26, s26, 1
 s_cbranch_scc1 L_end
 s_branch kvp_23
kvok_22:
 s_add_u32 s49, s51, 32768
 s_and_b32 s49, s49, 98304
 s_andn2_b32 s51, s51, 98304
 s_or_b32 s51, s51, s49
 s_add_u32 s49, s50, 16384
 s_and_b32 s49, s49, 49152
 s_andn2_b32 s50, s50, 49152
 s_or_b32 s50, s50, s49
 s_add_u32 s49, s52, 2048
 s_and_b32 s49, s49, 6144
 s_andn2_b32 s52, s52, 6144
 s_or_b32 s52, s52, s49
 s_add_u32 s43, s43, 1
 s_branch L_qk_step_l
wb_19_r3:
 buffer_load_dword v127, v5, s[28:31], s59 offen sc1
 s_sub_u32 s26, s26, 1
 s_cbranch_scc1 L_end
 s_branch wb_19_0
L_qk_step_l_nan:
 s_mov_b64 s[64:65], 0
 s_mov_b64 vcc, 0
 s_cmp_eq_u32 s66, s43
 s_cbranch_scc1 L_qk_step_l_ok
 s_mov_b32 s66, s43
 s_mov_b32 m0, s68
L_qk_step_l_nan_again:
 s_waitcnt vmcnt(0) lgkmcnt(0)
 s_barrier
 buffer_load_dwordx4 v4, s[28:31], s50 offen offset:0 sc1 lds
 buffer_load_dwordx4 v4, s[28:31], s50 offen offset:1024 sc1 lds
 buffer_load_dwordx4 v4, s[28:31], s50 offen offset:2048 sc1 lds
 buffer_load_dwordx4 v4, s[28:31], s50 offen offset:3072 sc1 lds
 s_sub_u32 s26, s26, 1
 s_cbranch_scc1 L_end
 s_waitcnt vmcnt(0)
 s_barrier
 v_mov_b32 v1, 0
 ds_read_b128 v[16:19], v2 offset:0
 s_waitcnt lgkmcnt(0)
 v_max3_u32 v1, v1, v16, v17
 v_max3_u32 v1, v1, v18, v19
 ds_read_b128 v[16:19], v2 offset:1024
 s_waitcnt lgkmcnt(0)
 v_max3_u32 v1, v1, v16, v17
 v_max3_u32 v1, v1, v18, v19
 ds_read_b128 v[16:19], v2 offset:2048
 s_waitcnt lgkmcnt(0)
 v_max3_u32 v1, v1, v16, v17
 v_max3_u32 v1, v1, v18, v19
 ds_read_b128 v[16:19], v2 offset:3072
 s_waitcnt lgkmcnt(0)
 v_max3_u32 v1, v1, v16, v17
 v_max3_u32 v1, v1, v18, v19
 ds_read_b128 v[16:19], v2 offset:4096
 s_waitcnt lgkmcnt(0)
 v_max3_u32 v1, v1, v16, v17
 v_max3_u32 v1, v1, v18, v19
 ds_read_b128 v[16:19], v2 offset:5120
 s_waitcnt lgkmcnt(0)
 v_max3_u32 v1, v1, v16, v17
 v_max3_u32 v1, v1, v18, v19
 ds_read_b128 v[16:19], v2 offset:6144
 s_waitcnt lgkmcnt(0)
 v_max3_u32 v1, v1, v16, v17
 v_max3_u32 v1, v1, v18, v19
 ds_read_b128 v[16:19], v2 offset:7168
 s_waitcnt lgkmcnt(0)
 v_max3_u32 v1, v1, v16, v17
 v_max3_u32 v1, v1, v18, v19
 ds_read_b128 v[16:19], v2 offset:8192
 s_waitcnt lgkmcnt(0)
 v_max3_u32 v1, v1, v16, v17
 v_max3_u32 v1, v1, v18, v19
 ds_read_b128 v[16:19], v2 offset:9216
 s_waitcnt lgkmcnt(0)
 v_max3_u32 v1, v1, v16, v17
 v_max3_u32 v1, v1, v18, v19
 ds_read_b128 v[16:19], v2 offset:10240
 s_waitcnt lgkmcnt(0)
 v_max3_u32 v1, v1, v16, v17
 v_max3_u32 v1, v1, v18, v19
 ds_read_b128 v[16:19], v2 offset:11264
 s_waitcnt lgkmcnt(0)
 v_max3_u32 v1, v1, v16, v17
 v_max3_u32 v1, v1, v18, v19
 ds_read_b128 v[16:19], v2 offset:12288
 s_waitcnt lgkmcnt(0)
 v_max3_u32 v1, v1, v16, v17
 v_max3_u32 v1, v1, v18, v19
 ds_read_b128 v[16:19], v2 offset:13312
 s_waitcnt lgkmcnt(0)
 v_max3_u32 v1, v1, v16, v17
 v_max3_u32 v1, v1, v18, v19
 ds_read_b128 v[16:19], v2 offset:14336
 s_waitcnt lgkmcnt(0)
 v_max3_u32 v1, v1, v16, v17
 v_max3_u32 v1, v1, v18, v19
 ds_read_b128 v[16:19], v2 offset:15360
 s_waitcnt lgkmcnt(0)
 v_max3_u32 v1, v1, v16, v17
 v_max3_u32 v1, v1, v18, v19
 v_cmp_eq_u32 vcc, -1, v1
 s_cbranch_vccnz L_qk_step_l_nan_again
 v_mov_b32 v56, 0
 v_mov_b32 v57, 0
 v_mov_b32 v58, 0
 v_mov_b32 v59, 0
 v_mov_b32 v60, 0
 v_mov_b32 v61, 0
 v_mov_b32 v62, 0
 v_mov_b32 v63, 0
 v_mov_b32 v64, 0
 v_mov_b32 v65, 0
 v_mov_b32 v66, 0
 v_mov_b32 v67, 0
 v_mov_b32 v68, 0
 v_mov_b32 v69, 0
 v_mov_b32 v70, 0
 v_mov_b32 v71, 0
 ds_read_b128 v[32:35], v3 offset:0
 ds_read_b128 v[36:39], v3 offset:1024
 ds_read_b128 v[40:43], v3 offset:8192
 ds_read_b128 v[44:47], v3 offset:9216
 ds_read_b128 v[48:51], v3 offset:16384
 ds_read_b128 v[52:55], v3 offset:17408
 s_waitcnt lgkmcnt(0)
 s_branch L_qk_step_l_go
vmd_21:
 buffer_load_dwordx2 v[116:117], v11, s[28:31], s52 offen offset:0 sc1
 buffer_load_dwordx2 v[120:121], v11, s[28:31], s52 offen offset:256 sc1
 s_sub_u32 s26, s26, 1
 s_cbranch_scc1 L_end
 s_waitcnt vmcnt(0)
 s_branch vm_20
L_qk_step_g:
 v_mov_b32 v56, 0
 v_mov_b32 v57, 0
 v_mov_b32 v58, 0
 v_mov_b32 v59, 0
 v_mov_b32 v60, 0
 v_mov_b32 v61, 0
 v_mov_b32 v62, 0
 v_mov_b32 v63, 0
 v_mov_b32 v64, 0
 v_mov_b32 v65, 0
 v_mov_b32 v66, 0
 v_mov_b32 v67, 0
 v_mov_b32 v68, 0
 v_mov_b32 v69, 0
 v_mov_b32 v70, 0
 v_mov_b32 v71, 0
 ds_read_b128 v[32:35], v3 offset:0
 ds_read_b128 v[36:39], v3 offset:1024
 ds_read_b128 v[40:43], v3 offset:8192
 ds_read_b128 v[44:47], v3 offset:9216
 ds_read_b128 v[48:51], v3 offset:16384
 ds_read_b128 v[52:55], v3 offset:17408
 s_add_u32 s67, s43, 1
 s_waitcnt lgkmcnt(0)
 buffer_load_dword v124, v5, s[28:31], s59 offen sc1
 buffer_load_dword v125, v5, s[28:31], s59 offen sc1
 buffer_load_dword v126, v5, s[28:31], s59 offen sc1
 buffer_load_dword v127, v5, s[28:31], s59 offen sc1
wb_24_0:
 s_waitcnt vmcnt(3)
 v_cmp_gt_u32 vcc, s43, v124
 s_cbranch_vccnz wb_24_r0
 buffer_load_dwordx4 v4, s[28:31], s50 offen offset:0 sc1 lds
 s_branch wb_24_ok
wb_24_r0:
 buffer_load_dword v124, v5, s[28:31], s59 offen sc1
wb_24_1:
 s_waitcnt vmcnt(3)
 v_cmp_gt_u32 vcc, s43, v125
 s_cbranch_vccnz wb_24_r1
 buffer_load_dwordx4 v4, s[28:31], s50 offen offset:0 sc1 lds
 s_branch wb_24_ok
wb_24_r1:
 buffer_load_dword v125, v5, s[28:31], s59 offen sc1
wb_24_2:
 s_waitcnt vmcnt(3)
 v_cmp_gt_u32 vcc, s43, v126
 s_cbranch_vccnz wb_24_r2
 buffer_load_dwordx4 v4, s[28:31], s50 offen offset:0 sc1 lds
 s_branch wb_24_ok
wb_24_r2:
 buffer_load_dword v126, v5, s[28:31], s59 offen sc1
wb_24_3:
 s_waitcnt vmcnt(3)
 v_cmp_gt_u32 vcc, s43, v127
 s_cbranch_vccnz wb_24_r3
 buffer_load_dwordx4 v4, s[28:31], s50 offen offset:0 sc1 lds
wb_24_ok:
 buffer_load_dwordx4 v4, s[28:31], s50 offen offset:1024 sc1 lds
 buffer_load_dwordx4 v4, s[28:31], s50 offen offset:2048 sc1 lds
 buffer_load_dwordx4 v4, s[28:31], s50 offen offset:3072 sc1 lds
 s_waitcnt vmcnt(3)
L_qk_step_g_go:
 s_barrier
 ds_read_b128 v[16:19], v2 offset:0
 ds_read_b128 v[20:23], v2 offset:4096
 ds_read_b128 v[24:27], v2 offset:8192
 ds_read_b128 v[28:31], v2 offset:12288
 s_waitcnt lgkmcnt(3)
 v_smfmac_f32_16x16x64_bf16 v[60:63], v[16:19], v[32:39], v8
 v_smfmac_f32_16x16x64_bf16 v[56:59], v[16:19], v[128:135], v8
 ds_read_b128 v[32:35], v3 offset:24576
 v_smfmac_f32_16x16x64_bf16 v[64:67], v[16:19], a[0:7], v8
 ds_read_b128 v[36:39], v3 offset:25600
 v_smfmac_f32_16x16x64_bf16 v[68:71], v[16:19], a[8:15], v8
 s_waitcnt lgkmcnt(4)
 v_smfmac_f32_16x16x64_bf16 v[60:63], v[20:23], v[40:47], v8
 s_waitcnt vmcnt(2)
 s_barrier
 ds_read_b128 v[16:19], v2 offset:1024
 v_smfmac_f32_16x16x64_bf16 v[56:59], v[20:23], v[160:167], v8
 ds_read_b128 v[40:43], v3 offset:2048
 v_smfmac_f32_16x16x64_bf16 v[64:67], v[20:23], a[64:71], v8
 ds_read_b128 v[44:47], v3 offset:3072
 v_smfmac_f32_16x16x64_bf16 v[68:71], v[20:23], a[72:79], v8
 s_waitcnt lgkmcnt(6)
 v_smfmac_f32_16x16x64_bf16 v[60:63], v[24:27], v[48:55], v8
 ds_read_b128 v[20:23], v2 offset:5120
 v_smfmac_f32_16x16x64_bf16 v[56:59], v[24:27], v[192:199], v8
 ds_read_b128 v[48:51], v3 offset:10240
 v_smfmac_f32_16x16x64_bf16 v[64:67], v[24:27], a[128:135], v8
 ds_read_b128 v[52:55], v3 offset:11264
 v_smfmac_f32_16x16x64_bf16 v[68:71], v[24:27], a[136:143], v8
 s_waitcnt lgkmcnt(6)
 v_smfmac_f32_16x16x64_bf16 v[60:63], v[28:31], v[32:39], v8
 ds_read_b128 v[24:27], v2 offset:9216
 v_smfmac_f32_16x16x64_bf16 v[56:59], v[28:31], v[224:231], v8
 ds_read_b128 v[32:35], v3 offset:18432
 v_smfmac_f32_16x16x64_bf16 v[64:67], v[28:31], a[192:199], v8
 ds_read_b128 v[36:39], v3 offset:19456
 v_smfmac_f32_16x16x64_bf16 v[68:71], v[28:31], a[200:207], v8
 s_waitcnt lgkmcnt(6)
 v_smfmac_f32_16x16x64_bf16 v[60:63], v[16:19], v[40:47], v8
 ds_read_b128 v[28:31], v2 offset:13312
 v_smfmac_f32_16x16x64_bf16 v[56:59], v[16:19], v[136:143], v8
 ds_read_b128 v[40:43], v3 offset:26624
 v_smfmac_f32_16x16x64_bf16 v[64:67], v[16:19], a[16:23], v8
 ds_read_b128 v[44:47], v3 offset:27648
 v_smfmac_f32_16x16x64_bf16 v[68:71], v[16:19], a[24:31], v8
 s_waitcnt lgkmcnt(6)
 v_smfmac_f32_16x16x64_bf16 v[60:63], v[20:23], v[48:55], v8
 s_waitcnt vmcnt(1)
 s_barrier
 ds_read_b128 v[16:19], v2 offset:2048
 v_smfmac_f32_16x16x64_bf16 v[56:59], v[20:23], v[168:175], v8
 ds_read_b128 v[48:51], v3 offset:4096
 v_smfmac_f32_16x16x64_bf16 v[64:67], v[20:23], a[80:87], v8
 ds_read_b128 v[52:55], v3 offset:5120
 v_smfmac_f32_16x16x64_bf16 v[68:71], v[20:23], a[88:95], v8
 s_waitcnt lgkmcnt(6)
 v_smfmac_f32_16x16x64_bf16 v[60:63], v[24:27], v[32:39], v8
 ds_read_b128 v[20:23], v2 offset:6144
 v_smfmac_f32_16x16x64_bf16 v[56:59], v[24:27], v[200:207], v8
 ds_read_b128 v[32:35], v3 offset:12288
 v_smfmac_f32_16x16x64_bf16 v[64:67], v[24:27], a[144:151], v8
 ds_read_b128 v[36:39], v3 offset:13312
 v_smfmac_f32_16x16x64_bf16 v[68:71], v[24:27], a[152:159], v8
 s_waitcnt lgkmcnt(6)
 v_smfmac_f32_16x16x64_bf16 v[60:63], v[28:31], v[40:47], v8
 ds_read_b128 v[24:27], v2 offset:10240
 v_smfmac_f32_16x16x64_bf16 v[56:59], v[28:31], v[232:239], v8
 ds_read_b128 v[40:43], v3 offset:20480
 v_smfmac_f32_16x16x64_bf16 v[64:67], v[28:31], a[208:215], v8
 ds_read_b128 v[44:47], v3 offset:21504
 v_smfmac_f32_16x16x64_bf16 v[68:71], v[28:31], a[216:223], v8
 s_waitcnt lgkmcnt(6)
 v_smfmac_f32_16x16x64_bf16 v[60:63], v[16:19], v[48:55], v8
 ds_read_b128 v[28:31], v2 offset:14336
 v_smfmac_f32_16x16x64_bf16 v[56:59], v[16:19], v[144:151], v8
 ds_read_b128 v[48:51], v3 offset:28672
 v_smfmac_f32_16x16x64_bf16 v[64:67], v[16:19], a[32:39], v8
 ds_read_b128 v[52:55], v3 offset:29696
 v_smfmac_f32_16x16x64_bf16 v[68:71], v[16:19], a[40:47], v8
 s_waitcnt lgkmcnt(6)
 v_smfmac_f32_16x16x64_bf16 v[60:63], v[20:23], v[32:39], v8
 s_waitcnt vmcnt(0)
 s_barrier
 ds_read_b128 v[16:19], v2 offset:3072
 v_smfmac_f32_16x16x64_bf16 v[56:59], v[20:23], v[176:183], v8
 ds_read_b128 v[32:35], v3 offset:6144
 v_smfmac_f32_16x16x64_bf16 v[64:67], v[20:23], a[96:103], v8
 ds_read_b128 v[36:39], v3 offset:7168
 v_smfmac_f32_16x16x64_bf16 v[68:71], v[20:23], a[104:111], v8
 s_waitcnt lgkmcnt(6)
 v_smfmac_f32_16x16x64_bf16 v[60:63], v[24:27], v[40:47], v8
 ds_read_b128 v[20:23], v2 offset:7168
 v_smfmac_f32_16x16x64_bf16 v[56:59], v[24:27], v[208:215], v8
 ds_read_b128 v[40:43], v3 offset:14336
 v_smfmac_f32_16x16x64_bf16 v[64:67], v[24:27], a[160:167], v8
 ds_read_b128 v[44:47], v3 offset:15360
 s_mov_b32 m0, s69
 v_smfmac_f32_16x16x64_bf16 v[68:71], v[24:27], a[168:175], v8
 buffer_load_dwordx4 v12, s[28:31], s53 offen offset:0 sc1 lds
 s_waitcnt lgkmcnt(6)
 v_smfmac_f32_16x16x64_bf16 v[60:63], v[28:31], v[48:55], v8
 ds_read_b128 v[24:27], v2 offset:11264
 v_smfmac_f32_16x16x64_bf16 v[56:59], v[28:31], v[240:247], v8
 ds_read_b128 v[48:51], v3 offset:22528
 v_smfmac_f32_16x16x64_bf16 v[64:67], v[28:31], a[224:231], v8
 ds_read_b128 v[52:55], v3 offset:23552
 v_smfmac_f32_16x16x64_bf16 v[68:71], v[28:31], a[232:239], v8
 buffer_load_dwordx4 v12, s[28:31], s53 offen offset:1024 sc1 lds
 s_waitcnt lgkmcnt(6)
 v_smfmac_f32_16x16x64_bf16 v[60:63], v[16:19], v[32:39], v8
 ds_read_b128 v[28:31], v2 offset:15360
 v_smfmac_f32_16x16x64_bf16 v[56:59], v[16:19], v[152:159], v8
 ds_read_b128 v[32:35], v3 offset:30720
 v_smfmac_f32_16x16x64_bf16 v[64:67], v[16:19], a[48:55], v8
 ds_read_b128 v[36:39], v3 offset:31744
 v_smfmac_f32_16x16x64_bf16 v[68:71], v[16:19], a[56:63], v8
 s_waitcnt lgkmcnt(6)
 v_smfmac_f32_16x16x64_bf16 v[56:59], v[20:23], v[184:191], v8
 v_smfmac_f32_16x16x64_bf16 v[60:63], v[20:23], v[40:47], v8
 v_smfmac_f32_16x16x64_bf16 v[64:67], v[20:23], a[112:119], v8
 v_smfmac_f32_16x16x64_bf16 v[68:71], v[20:23], a[120:127], v8
 s_waitcnt lgkmcnt(3)
 v_smfmac_f32_16x16x64_bf16 v[56:59], v[24:27], v[216:223], v8
 v_smfmac_f32_16x16x64_bf16 v[60:63], v[24:27], v[48:55], v8
 v_smfmac_f32_16x16x64_bf16 v[64:67], v[24:27], a[176:183], v8
 v_smfmac_f32_16x16x64_bf16 v[68:71], v[24:27], a[184:191], v8
 s_waitcnt lgkmcnt(0)
 v_smfmac_f32_16x16x64_bf16 v[56:59], v[28:31], v[248:255], v8
 v_smfmac_f32_16x16x64_bf16 v[60:63], v[28:31], v[32:39], v8
 v_smfmac_f32_16x16x64_bf16 v[64:67], v[28:31], a[240:247], v8
 v_smfmac_f32_16x16x64_bf16 v[68:71], v[28:31], a[248:255], v8
 v_permlane32_swap_b32 v56, v60
 v_permlane32_swap_b32 v57, v61
 v_permlane32_swap_b32 v58, v62
 v_permlane32_swap_b32 v59, v63
 v_pk_add_f32 v[56:57], v[56:57], v[60:61]
 v_pk_add_f32 v[58:59], v[58:59], v[62:63]
 v_cvt_pk_bf16_f32 v60, v56, v57
 v_cvt_pk_bf16_f32 v61, v58, v59
 ds_write_b64 v6, v[60:61] offset:0
 v_permlane32_swap_b32 v64, v68
 v_permlane32_swap_b32 v65, v69
 v_permlane32_swap_b32 v66, v70
 v_permlane32_swap_b32 v67, v71
 v_pk_add_f32 v[64:65], v[64:65], v[68:69]
 v_pk_add_f32 v[66:67], v[66:67], v[70:71]
 v_cvt_pk_bf16_f32 v68, v64, v65
 v_cvt_pk_bf16_f32 v69, v66, v67
 ds_write_b64 v6, v[68:69] offset:1024
 v_cmp_u_f32 vcc, v56, v57
 v_cmp_u_f32 s[64:65], v58, v59
 s_waitcnt lgkmcnt(0)
 s_barrier
L_qk_step_g_ok:
 ds_read_b64_tr_b16 v[16:17], v7 offset:0
 ds_read_b64_tr_b16 v[18:19], v7 offset:128
 ds_read_b64_tr_b16 v[20:21], v7 offset:256
 ds_read_b64_tr_b16 v[22:23], v7 offset:384
 ds_read_b64_tr_b16 v[32:33], v7 offset:1024
 ds_read_b64_tr_b16 v[34:35], v7 offset:1152
 s_or_b64 vcc, vcc, s[64:65]
 s_cmp_eq_u32 s43, 63
 s_waitcnt lgkmcnt(4)
 v_mfma_f32_16x16x32_bf16 v[56:59], v[72:75], v[16:19], 0
 ds_read_b64_tr_b16 v[24:25], v7 offset:512
 ds_read_b64_tr_b16 v[26:27], v7 offset:640
 v_mfma_f32_16x16x32_bf16 v[60:63], v[88:91], v[16:19], 0
 ds_read_b64_tr_b16 v[28:29], v7 offset:768
 ds_read_b64_tr_b16 v[30:31], v7 offset:896
 s_waitcnt lgkmcnt(6)
 v_mfma_f32_16x16x32_bf16 v[56:59], v[76:79], v[20:23], v[56:59]
 ds_read_b64_tr_b16 v[36:37], v7 offset:1280
 ds_read_b64_tr_b16 v[38:39], v7 offset:1408
 v_mfma_f32_16x16x32_bf16 v[60:63], v[92:95], v[20:23], v[60:63]
 ds_read_b64_tr_b16 v[40:41], v7 offset:1536
 ds_read_b64_tr_b16 v[42:43], v7 offset:1664
 s_waitcnt lgkmcnt(8)
 v_mfma_f32_16x16x32_bf16 v[64:67], v[32:35], v[16:19], 0
 ds_read_b64_tr_b16 v[44:45], v7 offset:1792
 ds_read_b64_tr_b16 v[46:47], v7 offset:1920
 s_waitcnt lgkmcnt(8)
 v_mfma_f32_16x16x32_bf16 v[56:59], v[80:83], v[24:27], v[56:59]
 s_cbranch_vccnz L_qk_step_g_nan
 v_mfma_f32_16x16x32_bf16 v[60:63], v[96:99], v[24:27], v[60:63]
 s_cbranch_scc1 L_qk_last
 s_waitcnt lgkmcnt(4)
 v_mfma_f32_16x16x32_bf16 v[64:67], v[36:39], v[20:23], v[64:67]
 v_mov_b32 v54, 0
 v_mov_b32 v55, 0
 v_mfma_f32_16x16x32_bf16 v[56:59], v[84:87], v[28:31], v[56:59]
 v_mov_b32 v71, s67
 s_waitcnt lgkmcnt(2)
 v_mfma_f32_16x16x32_bf16 v[60:63], v[100:103], v[28:31], v[60:63]
 v_mfma_f32_16x16x32_bf16 v[64:67], v[40:43], v[24:27], v[64:67]
 buffer_load_dwordx2 v[116:117], v11, s[28:31], s52 offen offset:0 sc1
 s_waitcnt lgkmcnt(0)
 v_mfma_f32_16x16x32_bf16 v[64:67], v[44:47], v[28:31], v[64:67]
 buffer_load_dwordx2 v[120:121], v11, s[28:31], s52 offen offset:256 sc1
 v_max3_f32 v68, v56, v57, v58
 v_max3_f32 v68, v68, v59, v60
 v_max3_f32 v68, v68, v61, v62
 v_max_f32 v68, v68, v63
 s_nop 2
 v_max3_f32 v68, v68, v64, v65
 v_max3_f32 v69, v68, v66, v67
 v_max3_f32 v68, v68, v66, v67
 s_nop 1
 v_permlane32_swap_b32 v68, v69
 v_max_f32 v70, v68, v69
 v_max_f32 v68, v68, v69
 s_nop 1
 v_permlane16_swap_b32 v68, v70
 v_max_f32 v68, v68, v70
 v_mul_f32 v68, s62, v68
 v_pk_fma_f32 v[56:57], v[56:57], s[60:61], v[68:69] op_sel_hi:[1,1,0]
 v_pk_fma_f32 v[58:59], v[58:59], s[60:61], v[68:69] op_sel_hi:[1,1,0]
 v_pk_fma_f32 v[60:61], v[60:61], s[60:61], v[68:69] op_sel_hi:[1,1,0]
 v_pk_fma_f32 v[62:63], v[62:63], s[60:61], v[68:69] op_sel_hi:[1,1,0]
 v_add_f32 v70, v68, v9
 v_exp_f32 v56, v56
 v_exp_f32 v57, v57
 v_exp_f32 v58, v58
 v_cvt_pk_bf16_f32 v48, v56, v57
 v_exp_f32 v59, v59
 v_exp_f32 v60, v60
 v_cvt_pk_bf16_f32 v49, v58, v59
 v_exp_f32 v61, v61
 v_exp_f32 v62, v62
 v_cvt_pk_bf16_f32 v50, v60, v61
 v_exp_f32 v63, v63
 v_pk_fma_f32 v[64:65], v[64:65], s[60:61], v[70:71] op_sel_hi:[1,1,0]
 v_cvt_pk_bf16_f32 v51, v62, v63
 v_pk_fma_f32 v[66:67], v[66:67], s[60:61], v[70:71] op_sel_hi:[1,1,0]
 v_exp_f32 v64, v64
 v_mfma_f32_16x16x32_bf16 v[124:127], v[112:115], v[48:51], 0
 v_exp_f32 v65, v65
 v_mfma_f32_16x16x32_bf16 v[24:27], v[104:107], v[48:51], 0
 v_exp_f32 v66, v66
 v_mfma_f32_16x16x32_bf16 v[28:31], v[108:111], v[48:51], 0
 buffer_store_dword v71, v13, s[28:31], s63 offen sc1
 v_exp_f32 v67, v67
 s_waitcnt vmcnt(1)
vm_25:
 v_max_u32 v1, v116, v120
 v_cmp_eq_u32 vcc, -1, v1
 v_cvt_pk_bf16_f32 v52, v64, v65
 v_cvt_pk_bf16_f32 v53, v66, v67
 s_nop 0
 s_cbranch_vccnz vmd_26
 v_mfma_f32_16x16x32_bf16 v[124:127], v[112:115], v[52:55], v[124:127]
 v_mfma_f32_16x16x32_bf16 v[24:27], v[116:119], v[52:55], v[24:27]
 v_mfma_f32_16x16x32_bf16 v[28:31], v[120:123], v[52:55], v[28:31]
 s_nop 0
 v_rcp_f32 v68, v124
 s_nop 1
 v_pk_mul_f32 v[24:25], v[24:25], v[68:69] op_sel_hi:[1,0]
 v_pk_mul_f32 v[26:27], v[26:27], v[68:69] op_sel_hi:[1,0]
 v_cvt_pk_bf16_f32 v24, v24, v25
 v_cvt_pk_bf16_f32 v25, v26, v27
 v_pk_mul_f32 v[28:29], v[28:29], v[68:69] op_sel_hi:[1,0]
 v_pk_mul_f32 v[30:31], v[30:31], v[68:69] op_sel_hi:[1,0]
 v_min_u32 v24, -2, v24
 v_cvt_pk_bf16_f32 v26, v28, v29
 v_cvt_pk_bf16_f32 v27, v30, v31
 buffer_store_dwordx4 v[24:27], v10, s[28:31], s51 offen sc1
 ds_read_b64_tr_b16 v[32:33], v14 offset:1024
 ds_read_b64_tr_b16 v[34:35], v14 offset:1152
 v_mov_b32 v36, -1
 v_mov_b32 v37, -1
 v_mov_b32 v38, -1
 v_mov_b32 v39, -1
 s_add_u32 s47, s51, 98304
 s_and_b32 s47, s47, 98304
 s_andn2_b32 s49, s51, 98304
 s_or_b32 s47, s47, s49
 buffer_store_dwordx4 v[36:39], v10, s[28:31], s47 offen sc1
 v_mov_b32 v40, s43
 buffer_store_dword v40, v13, s[28:31], s57 offen sc1
 s_waitcnt lgkmcnt(0)
 buffer_store_dwordx4 v[32:35], v15, s[28:31], s55 offen sc1
 s_add_u32 s55, s55, 65536
 buffer_load_dwordx4 v[104:107], v12, s[28:31], s54 offen offset:0 sc1
 buffer_load_dwordx4 v[108:111], v12, s[28:31], s54 offen offset:1024 sc1
 s_mov_b32 m0, s68
 s_barrier
 v_add_u32 v16, 151680, v12
 ds_read_b128 v[72:75], v16 offset:0
 ds_read_b128 v[76:79], v16 offset:1024
 ds_read_b128 v[80:83], v16 offset:2048
 ds_read_b128 v[84:87], v16 offset:3072
 ds_read_b128 v[88:91], v16 offset:4096
 ds_read_b128 v[92:95], v16 offset:5120
 ds_read_b128 v[96:99], v16 offset:6144
 ds_read_b128 v[100:103], v16 offset:7168
 s_add_u32 s53, s53, 262144
 s_add_u32 s54, s54, 262144
 s_add_u32 s48, s43, 2
 s_min_u32 s48, s48, 63
kvp_28:
 s_cmp_lt_u32 s48, s56
 s_cbranch_scc1 kvok_27
 v_and_b32 v16, 1, v0
 v_bfe_u32 v17, v0, 1, 1
 v_lshlrev_b32 v16, 7, v16
 v_lshl_add_u32 v16, v17, 13, v16
 buffer_load_dword v17, v16, s[28:31], s58 offen sc1
 s_waitcnt vmcnt(0)
 v_readlane_b32 s56, v17, 0
 v_readlane_b32 s47, v17, 1
 s_min_u32 s56, s56, s47
 v_readlane_b32 s47, v17, 2
 s_min_u32 s56, s56, s47
 v_readlane_b32 s47, v17, 3
 s_min_u32 s56, s56, s47
 s_sub_u32 s26, s26, 1
 s_cbranch_scc1 L_end
 s_branch kvp_28
kvok_27:
 s_add_u32 s49, s51, 32768
 s_and_b32 s49, s49, 98304
 s_andn2_b32 s51, s51, 98304
 s_or_b32 s51, s51, s49
 s_add_u32 s49, s50, 16384
 s_and_b32 s49, s49, 49152
 s_andn2_b32 s50, s50, 49152
 s_or_b32 s50, s50, s49
 s_add_u32 s49, s52, 2048
 s_and_b32 s49, s49, 6144
 s_andn2_b32 s52, s52, 6144
 s_or_b32 s52, s52, s49
 s_add_u32 s43, s43, 1
 s_branch L_qk_step_g
wb_24_r3:
 buffer_load_dword v127, v5, s[28:31], s59 offen sc1
 s_sub_u32 s26, s26, 1
 s_cbranch_scc1 L_end
 s_branch wb_24_0
L_qk_step_g_nan:
 s_mov_b64 s[64:65], 0
 s_mov_b64 vcc, 0
 s_cmp_eq_u32 s66, s43
 s_cbranch_scc1 L_qk_step_g_ok
 s_mov_b32 s66, s43
 s_mov_b32 m0, s68
L_qk_step_g_nan_again:
 s_waitcnt vmcnt(0) lgkmcnt(0)
 s_barrier
 buffer_load_dwordx4 v4, s[28:31], s50 offen offset:0 sc1 lds
 buffer_load_dwordx4 v4, s[28:31], s50 offen offset:1024 sc1 lds
 buffer_load_dwordx4 v4, s[28:31], s50 offen offset:2048 sc1 lds
 buffer_load_dwordx4 v4, s[28:31], s50 offen offset:3072 sc1 lds
 s_sub_u32 s26, s26, 1
 s_cbranch_scc1 L_end
 s_waitcnt vmcnt(0)
 s_barrier
 v_mov_b32 v1, 0
 ds_read_b128 v[16:19], v2 offset:0
 s_waitcnt lgkmcnt(0)
 v_max3_u32 v1, v1, v16, v17
 v_max3_u32 v1, v1, v18, v19
 ds_read_b128 v[16:19], v2 offset:1024
 s_waitcnt lgkmcnt(0)
 v_max3_u32 v1, v1, v16, v17
 v_max3_u32 v1, v1, v18, v19
 ds_read_b128 v[16:19], v2 offset:2048
 s_waitcnt lgkmcnt(0)
 v_max3_u32 v1, v1, v16, v17
 v_max3_u32 v1, v1, v18, v19
 ds_read_b128 v[16:19], v2 offset:3072
 s_waitcnt lgkmcnt(0)
 v_max3_u32 v1, v1, v16, v17
 v_max3_u32 v1, v1, v18, v19
 ds_read_b128 v[16:19], v2 offset:4096
 s_waitcnt lgkmcnt(0)
 v_max3_u32 v1, v1, v16, v17
 v_max3_u32 v1, v1, v18, v19
 ds_read_b128 v[16:19], v2 offset:5120
 s_waitcnt lgkmcnt(0)
 v_max3_u32 v1, v1, v16, v17
 v_max3_u32 v1, v1, v18, v19
 ds_read_b128 v[16:19], v2 offset:6144
 s_waitcnt lgkmcnt(0)
 v_max3_u32 v1, v1, v16, v17
 v_max3_u32 v1, v1, v18, v19
 ds_read_b128 v[16:19], v2 offset:7168
 s_waitcnt lgkmcnt(0)
 v_max3_u32 v1, v1, v16, v17
 v_max3_u32 v1, v1, v18, v19
 ds_read_b128 v[16:19], v2 offset:8192
 s_waitcnt lgkmcnt(0)
 v_max3_u32 v1, v1, v16, v17
 v_max3_u32 v1, v1, v18, v19
 ds_read_b128 v[16:19], v2 offset:9216
 s_waitcnt lgkmcnt(0)
 v_max3_u32 v1, v1, v16, v17
 v_max3_u32 v1, v1, v18, v19
 ds_read_b128 v[16:19], v2 offset:10240
 s_waitcnt lgkmcnt(0)
 v_max3_u32 v1, v1, v16, v17
 v_max3_u32 v1, v1, v18, v19
 ds_read_b128 v[16:19], v2 offset:11264
 s_waitcnt lgkmcnt(0)
 v_max3_u32 v1, v1, v16, v17
 v_max3_u32 v1, v1, v18, v19
 ds_read_b128 v[16:19], v2 offset:12288
 s_waitcnt lgkmcnt(0)
 v_max3_u32 v1, v1, v16, v17
 v_max3_u32 v1, v1, v18, v19
 ds_read_b128 v[16:19], v2 offset:13312
 s_waitcnt lgkmcnt(0)
 v_max3_u32 v1, v1, v16, v17
 v_max3_u32 v1, v1, v18, v19
 ds_read_b128 v[16:19], v2 offset:14336
 s_waitcnt lgkmcnt(0)
 v_max3_u32 v1, v1, v16, v17
 v_max3_u32 v1, v1, v18, v19
 ds_read_b128 v[16:19], v2 offset:15360
 s_waitcnt lgkmcnt(0)
 v_max3_u32 v1, v1, v16, v17
 v_max3_u32 v1, v1, v18, v19
 v_cmp_eq_u32 vcc, -1, v1
 s_cbranch_vccnz L_qk_step_g_nan_again
 v_mov_b32 v56, 0
 v_mov_b32 v57, 0
 v_mov_b32 v58, 0
 v_mov_b32 v59, 0
 v_mov_b32 v60, 0
 v_mov_b32 v61, 0
 v_mov_b32 v62, 0
 v_mov_b32 v63, 0
 v_mov_b32 v64, 0
 v_mov_b32 v65, 0
 v_mov_b32 v66, 0
 v_mov_b32 v67, 0
 v_mov_b32 v68, 0
 v_mov_b32 v69, 0
 v_mov_b32 v70, 0
 v_mov_b32 v71, 0
 ds_read_b128 v[32:35], v3 offset:0
 ds_read_b128 v[36:39], v3 offset:1024
 ds_read_b128 v[40:43], v3 offset:8192
 ds_read_b128 v[44:47], v3 offset:9216
 ds_read_b128 v[48:51], v3 offset:16384
 ds_read_b128 v[52:55], v3 offset:17408
 s_waitcnt lgkmcnt(0)
 s_branch L_qk_step_g_go
vmd_26:
 buffer_load_dwordx2 v[116:117], v11, s[28:31], s52 offen offset:0 sc1
 buffer_load_dwordx2 v[120:121], v11, s[28:31], s52 offen offset:256 sc1
 s_sub_u32 s26, s26, 1
 s_cbranch_scc1 L_end
 s_waitcnt vmcnt(0)
 s_branch vm_25
L_qk_last:
 ds_read_b64_tr_b16 v[32:33], v14 offset:1024
 ds_read_b64_tr_b16 v[34:35], v14 offset:1152
 s_waitcnt lgkmcnt(0)
 buffer_store_dwordx4 v[32:35], v15, s[28:31], s55 offen sc1
 s_waitcnt vmcnt(0)
 s_barrier
 v_mov_b32 v40, 64
 buffer_store_dword v40, v13, s[28:31], s57 offen sc1
 s_branch L_end
L_gemm:
 s_sub_u32 s51, s41, 2
 s_mov_b32 s52, s42
 s_lshl_b32 s50, s51, 5
 s_add_u32 s50, s50, s52
 s_lshl_b32 s45, s40, 15
 s_lshl_b32 s46, s40, 13
 s_add_u32 s46, s46, 131072
 v_lshlrev_b32 v3, 4, v0
 v_lshlrev_b32 v4, 3, v0
 v_add_u32 v5, s46, v4
 v_add_u32 v4, s45, v4
 v_cmp_eq_u32 vcc, 0, v0
 v_mov_b32 v2, 0x40000000
 s_nop 0
 v_cndmask_b32 v2, v2, 0, vcc
 s_mul_i32 s62, s52, 6
 s_add_u32 s62, s62, s51
 s_cmp_lt_u32 s62, 128
 s_cselect_b32 s63, 1, 0
 s_cselect_b32 s47, 127, 31
 s_and_b32 s62, s62, s47
 s_mov_b32 s36, s4
 s_and_b32 s37, s5, 0xffff
 s_mov_b32 s38, 0x400000
 s_mov_b32 s39, 0x20000
 v_and_b32 v16, 15, v0
 v_lshlrev_b32 v16, 11, v16
 v_lshrrev_b32 v17, 4, v0
 v_lshl_add_u32 v16, v17, 4, v16
 s_lshl_b32 s47, s62, 15
 s_lshl_b32 s48, s40, 9
 s_add_u32 s47, s47, s48
 buffer_load_dwordx4 v[32:35], v16, s[36:39], s47 offen offset:0
 buffer_load_dwordx4 v[36:39], v16, s[36:39], s47 offen offset:64
 buffer_load_dwordx4 v[40:43], v16, s[36:39], s47 offen offset:128
 buffer_load_dwordx4 v[44:47], v16, s[36:39], s47 offen offset:192
 buffer_load_dwordx4 v[48:51], v16, s[36:39], s47 offen offset:256
 buffer_load_dwordx4 v[52:55], v16, s[36:39], s47 offen offset:320
 buffer_load_dwordx4 v[56:59], v16, s[36:39], s47 offen offset:384
 buffer_load_dwordx4 v[60:63], v16, s[36:39], s47 offen offset:448
 s_lshl_b32 s47, s2, 2
 s_add_u32 s47, s47, 0
 v_mov_b32 v1, s3
 buffer_store_dword v1, v2, s[28:31], s47 offen sc1
 s_lshl_b32 s59, s50, 7
 s_add_u32 s59, s59, 4096
 v_mov_b32 v18, 0
 buffer_store_dword v18, v2, s[28:31], s59 offen sc1
 s_lshl_b32 s47, s51, 8
 s_lshl_b32 s48, s52, 2
 s_add_u32 s47, s47, s48
 s_add_u32 s47, s47, 49152
 buffer_store_dword v18, v2, s[28:31], s47 offen sc1
 s_mov_b32 s32, s14
 s_and_b32 s33, s15, 0xffff
 s_mov_b32 s34, 0x800000
 s_mov_b32 s35, 0x20000
 s_lshl_b32 s47, s50, 2
 s_add_u32 s47, s47, s40
 s_lshl_b32 s47, s47, 10
 buffer_load_dwordx4 v[128:131], v3, s[32:35], s47 offen
 s_add_u32 s47, s47, 786432
 buffer_load_dwordx4 v[132:135], v3, s[32:35], s47 offen
 s_add_u32 s47, s47, 786432
 buffer_load_dwordx4 v[136:139], v3, s[32:35], s47 offen
 s_add_u32 s47, s47, 786432
 buffer_load_dwordx4 v[140:143], v3, s[32:35], s47 offen
 s_add_u32 s47, s47, 786432
 buffer_load_dwordx4 v[144:147], v3, s[32:35], s47 offen
 s_add_u32 s47, s47, 786432
 buffer_load_dwordx4 v[148:151], v3, s[32:35], s47 offen
 s_add_u32 s47, s47, 786432
 buffer_load_dwordx4 v[152:155], v3, s[32:35], s47 offen
 s_add_u32 s47, s47, 786432
 buffer_load_dwordx4 v[156:159], v3, s[32:35], s47 offen
 s_add_u32 s47, s47, 786432
 buffer_load_dwordx4 v[160:163], v3, s[32:35], s47 offen
 s_add_u32 s47, s47, 786432
 buffer_load_dwordx4 v[164:167], v3, s[32:35], s47 offen
 s_add_u32 s47, s47, 786432
 buffer_load_dwordx4 v[168:171], v3, s[32:35], s47 offen
 s_add_u32 s47, s47, 786432
 s_lshr_b32 s47, s50, 6
 s_cmp_eq_u32 s47, 1
 s_cselect_b32 s32, s10, s8
 s_cselect_b32 s33, s11, s9
 s_cmp_eq_u32 s47, 2
 s_cselect_b32 s32, s12, s32
 s_cselect_b32 s33, s13, s33
 s_and_b32 s33, s33, 0xffff
 s_mov_b32 s34, 0x800000
 s_mov_b32 s35, 0x20000
 s_bfe_u32 s48, s50, 0x50001
 s_lshl_b32 s48, s48, 8
 s_lshl_b32 s49, s40, 6
 s_add_u32 s49, s49, s48
 v_bfe_u32 v16, v0, 3, 2
 v_bfe_u32 v17, v0, 1, 2
 v_lshl_add_u32 v16, v16, 3, v17
 v_mul_u32_u24 v16, 8192, v16
 v_and_b32 v17, 1, v0
 v_lshl_add_u32 v16, v17, 4, v16
 v_lshrrev_b32 v17, 5, v0
 v_lshl_add_u32 v16, v17, 5, v16
 v_add_u32 v6, s49, v16
 s_waitcnt vmcnt(11)
 s_barrier
 s_cmp_lg_u32 s40, 0
 s_cbranch_scc1 arr_29
 s_mov_b64 exec, 1
 v_mov_b32 v16, 0
 v_mov_b32 v17, 1
 global_atomic_add v16, v17, s[22:23] offset:8 sc1
 s_mov_b64 exec, -1
arr_29:
 v_lshlrev_b32 v64, 16, v32
 v_and_b32 v65, 0xffff0000, v32
 v_lshlrev_b32 v66, 16, v33
 v_and_b32 v67, 0xffff0000, v33
 v_lshlrev_b32 v68, 16, v34
 v_and_b32 v69, 0xffff0000, v34
 v_lshlrev_b32 v70, 16, v35
 v_and_b32 v71, 0xffff0000, v35
 v_lshlrev_b32 v72, 16, v36
 v_and_b32 v73, 0xffff0000, v36
 v_lshlrev_b32 v74, 16, v37
 v_and_b32 v75, 0xffff0000, v37
 v_lshlrev_b32 v76, 16, v38
 v_and_b32 v77, 0xffff0000, v38
 v_lshlrev_b32 v78, 16, v39
 v_and_b32 v79, 0xffff0000, v39
 v_lshlrev_b32 v80, 16, v40
 v_and_b32 v81, 0xffff0000, v40
 v_lshlrev_b32 v82, 16, v41
 v_and_b32 v83, 0xffff0000, v41
 v_lshlrev_b32 v84, 16, v42
 v_and_b32 v85, 0xffff0000, v42
 v_lshlrev_b32 v86, 16, v43
 v_and_b32 v87, 0xffff0000, v43
 v_lshlrev_b32 v88, 16, v44
 v_and_b32 v89, 0xffff0000, v44
 v_lshlrev_b32 v90, 16, v45
 v_and_b32 v91, 0xffff0000, v45
 v_lshlrev_b32 v92, 16, v46
 v_and_b32 v93, 0xffff0000, v46
 v_lshlrev_b32 v94, 16, v47
 v_and_b32 v95, 0xffff0000, v47
 v_lshlrev_b32 v96, 16, v48
 v_and_b32 v97, 0xffff0000, v48
 v_lshlrev_b32 v98, 16, v49
 v_and_b32 v99, 0xffff0000, v49
 v_lshlrev_b32 v100, 16, v50
 v_and_b32 v101, 0xffff0000, v50
 v_lshlrev_b32 v102, 16, v51
 v_and_b32 v103, 0xffff0000, v51
 v_lshlrev_b32 v104, 16, v52
 v_and_b32 v105, 0xffff0000, v52
 v_lshlrev_b32 v106, 16, v53
 v_and_b32 v107, 0xffff0000, v53
 v_lshlrev_b32 v108, 16, v54
 v_and_b32 v109, 0xffff0000, v54
 v_lshlrev_b32 v110, 16, v55
 v_and_b32 v111, 0xffff0000, v55
 v_lshlrev_b32 v112, 16, v56
 v_and_b32 v113, 0xffff0000, v56
 v_lshlrev_b32 v114, 16, v57
 v_and_b32 v115, 0xffff0000, v57
 v_lshlrev_b32 v116, 16, v58
 v_and_b32 v117, 0xffff0000, v58
 v_lshlrev_b32 v118, 16, v59
 v_and_b32 v119, 0xffff0000, v59
 v_lshlrev_b32 v120, 16, v60
 v_and_b32 v121, 0xffff0000, v60
 v_lshlrev_b32 v122, 16, v61
 v_and_b32 v123, 0xffff0000, v61
 v_lshlrev_b32 v124, 16, v62
 v_and_b32 v125, 0xffff0000, v62
 v_lshlrev_b32 v126, 16, v63
 v_and_b32 v127, 0xffff0000, v63
 v_and_b32 v20, 15, v0
 v_lshlrev_b32 v20, 4, v20
 v_add_u32 v20, 138240, v20
 s_lshl_b32 s47, s40, 2
 v_add_u32 v21, s47, v20
 v_pk_add_f32 v[16:17], v[64:65], v[66:67]
 v_pk_add_f32 v[16:17], v[16:17], v[68:69]
 v_pk_add_f32 v[16:17], v[16:17], v[70:71]
 v_pk_add_f32 v[16:17], v[16:17], v[72:73]
 v_pk_add_f32 v[16:17], v[16:17], v[74:75]
 v_pk_add_f32 v[16:17], v[16:17], v[76:77]
 v_pk_add_f32 v[16:17], v[16:17], v[78:79]
 v_pk_add_f32 v[16:17], v[16:17], v[80:81]
 v_pk_add_f32 v[16:17], v[16:17], v[82:83]
 v_pk_add_f32 v[16:17], v[16:17], v[84:85]
 v_pk_add_f32 v[16:17], v[16:17], v[86:87]
 v_pk_add_f32 v[16:17], v[16:17], v[88:89]
 v_pk_add_f32 v[16:17], v[16:17], v[90:91]
 v_pk_add_f32 v[16:17], v[16:17], v[92:93]
 v_pk_add_f32 v[16:17], v[16:17], v[94:95]
 v_pk_add_f32 v[16:17], v[16:17], v[96:97]
 v_pk_add_f32 v[16:17], v[16:17], v[98:99]
 v_pk_add_f32 v[16:17], v[16:17], v[100:101]
 v_pk_add_f32 v[16:17], v[16:17], v[102:103]
 v_pk_add_f32 v[16:17], v[16:17], v[104:105]
 v_pk_add_f32 v[16:17], v[16:17], v[106:107]
 v_pk_add_f32 v[16:17], v[16:17], v[108:109]
 v_pk_add_f32 v[16:17], v[16:17], v[110:111]
 v_pk_add_f32 v[16:17], v[16:17], v[112:113]
 v_pk_add_f32 v[16:17], v[16:17], v[114:115]
 v_pk_add_f32 v[16:17], v[16:17], v[116:117]
 v_pk_add_f32 v[16:17], v[16:17], v[118:119]
 v_pk_add_f32 v[16:17], v[16:17], v[120:121]
 v_pk_add_f32 v[16:17], v[16:17], v[122:123]
 v_pk_add_f32 v[16:17], v[16:17], v[124:125]
 v_pk_add_f32 v[16:17], v[16:17], v[126:127]
 v_add_f32 v16, v16, v17
 v_mov_b32 v17, v16
 s_nop 1
 v_permlane32_swap_b32 v16, v17
 v_add_f32 v16, v16, v17
 v_mov_b32 v17, v16
 s_nop 1
 v_permlane16_swap_b32 v16, v17
 v_add_f32 v16, v16, v17
 ds_write_b32 v21, v16 offset:0
 s_waitcnt lgkmcnt(0)
 s_barrier
 ds_read_b128 v[16:19], v20 offset:0
 s_waitcnt lgkmcnt(0)
 v_add_f32 v16, v16, v17
 v_add_f32 v18, v18, v19
 v_add_f32 v16, v16, v18
 v_mul_f32 v16, 0x3a800000, v16
 v_mov_b32 v22, v16
 v_cvt_pk_bf16_f32 v24, v16, v16
 v_and_b32 v24, 0xffff0000, v24
 v_pk_add_f32 v[18:19], v[64:65], v[22:23] op_sel_hi:[1,0] neg_lo:[0,1] neg_hi:[0,1]
 v_pk_mul_f32 v[16:17], v[18:19], v[18:19]
 v_pk_add_f32 v[18:19], v[66:67], v[22:23] op_sel_hi:[1,0] neg_lo:[0,1] neg_hi:[0,1]
 v_pk_fma_f32 v[16:17], v[18:19], v[18:19], v[16:17]
 v_pk_add_f32 v[18:19], v[68:69], v[22:23] op_sel_hi:[1,0] neg_lo:[0,1] neg_hi:[0,1]
 v_pk_fma_f32 v[16:17], v[18:19], v[18:19], v[16:17]
 v_pk_add_f32 v[18:19], v[70:71], v[22:23] op_sel_hi:[1,0] neg_lo:[0,1] neg_hi:[0,1]
 v_pk_fma_f32 v[16:17], v[18:19], v[18:19], v[16:17]
 v_pk_add_f32 v[18:19], v[72:73], v[22:23] op_sel_hi:[1,0] neg_lo:[0,1] neg_hi:[0,1]
 v_pk_fma_f32 v[16:17], v[18:19], v[18:19], v[16:17]
 v_pk_add_f32 v[18:19], v[74:75], v[22:23] op_sel_hi:[1,0] neg_lo:[0,1] neg_hi:[0,1]
 v_pk_fma_f32 v[16:17], v[18:19], v[18:19], v[16:17]
 v_pk_add_f32 v[18:19], v[76:77], v[22:23] op_sel_hi:[1,0] neg_lo:[0,1] neg_hi:[0,1]
 v_pk_fma_f32 v[16:17], v[18:19], v[18:19], v[16:17]
 v_pk_add_f32 v[18:19], v[78:79], v[22:23] op_sel_hi:[1,0] neg_lo:[0,1] neg_hi:[0,1]
 v_pk_fma_f32 v[16:17], v[18:19], v[18:19], v[16:17]
 v_pk_add_f32 v[18:19], v[80:81], v[22:23] op_sel_hi:[1,0] neg_lo:[0,1] neg_hi:[0,1]
 v_pk_fma_f32 v[16:17], v[18:19], v[18:19], v[16:17]
 v_pk_add_f32 v[18:19], v[82:83], v[22:23] op_sel_hi:[1,0] neg_lo:[0,1] neg_hi:[0,1]
 v_pk_fma_f32 v[16:17], v[18:19], v[18:19], v[16:17]
 v_pk_add_f32 v[18:19], v[84:85], v[22:23] op_sel_hi:[1,0] neg_lo:[0,1] neg_hi:[0,1]
 v_pk_fma_f32 v[16:17], v[18:19], v[18:19], v[16:17]
 v_pk_add_f32 v[18:19], v[86:87], v[22:23] op_sel_hi:[1,0] neg_lo:[0,1] neg_hi:[0,1]
 v_pk_fma_f32 v[16:17], v[18:19], v[18:19], v[16:17]
 v_pk_add_f32 v[18:19], v[88:89], v[22:23] op_sel_hi:[1,0] neg_lo:[0,1] neg_hi:[0,1]
 v_pk_fma_f32 v[16:17], v[18:19], v[18:19], v[16:17]
 v_pk_add_f32 v[18:19], v[90:91], v[22:23] op_sel_hi:[1,0] neg_lo:[0,1] neg_hi:[0,1]
 v_pk_fma_f32 v[16:17], v[18:19], v[18:19], v[16:17]
 v_pk_add_f32 v[18:19], v[92:93], v[22:23] op_sel_hi:[1,0] neg_lo:[0,1] neg_hi:[0,1]
 v_pk_fma_f32 v[16:17], v[18:19], v[18:19], v[16:17]
 v_pk_add_f32 v[18:19], v[94:95], v[22:23] op_sel_hi:[1,0] neg_lo:[0,1] neg_hi:[0,1]
 v_pk_fma_f32 v[16:17], v[18:19], v[18:19], v[16:17]
 v_pk_add_f32 v[18:19], v[96:97], v[22:23] op_sel_hi:[1,0] neg_lo:[0,1] neg_hi:[0,1]
 v_pk_fma_f32 v[16:17], v[18:19], v[18:19], v[16:17]
 v_pk_add_f32 v[18:19], v[98:99], v[22:23] op_sel_hi:[1,0] neg_lo:[0,1] neg_hi:[0,1]
 v_pk_fma_f32 v[16:17], v[18:19], v[18:19], v[16:17]
 v_pk_add_f32 v[18:19], v[100:101], v[22:23] op_sel_hi:[1,0] neg_lo:[0,1] neg_hi:[0,1]
 v_pk_fma_f32 v[16:17], v[18:19], v[18:19], v[16:17]
 v_pk_add_f32 v[18:19], v[102:103], v[22:23] op_sel_hi:[1,0] neg_lo:[0,1] neg_hi:[0,1]
 v_pk_fma_f32 v[16:17], v[18:19], v[18:19], v[16:17]
 v_pk_add_f32 v[18:19], v[104:105], v[22:23] op_sel_hi:[1,0] neg_lo:[0,1] neg_hi:[0,1]
 v_pk_fma_f32 v[16:17], v[18:19], v[18:19], v[16:17]
 v_pk_add_f32 v[18:19], v[106:107], v[22:23] op_sel_hi:[1,0] neg_lo:[0,1] neg_hi:[0,1]
 v_pk_fma_f32 v[16:17], v[18:19], v[18:19], v[16:17]
 v_pk_add_f32 v[18:19], v[108:109], v[22:23] op_sel_hi:[1,0] neg_lo:[0,1] neg_hi:[0,1]
 v_pk_fma_f32 v[16:17], v[18:19], v[18:19], v[16:17]
 v_pk_add_f32 v[18:19], v[110:111], v[22:23] op_sel_hi:[1,0] neg_lo:[0,1] neg_hi:[0,1]
 v_pk_fma_f32 v[16:17], v[18:19], v[18:19], v[16:17]
 v_pk_add_f32 v[18:19], v[112:113], v[22:23] op_sel_hi:[1,0] neg_lo:[0,1] neg_hi:[0,1]
 v_pk_fma_f32 v[16:17], v[18:19], v[18:19], v[16:17]
 v_pk_add_f32 v[18:19], v[114:115], v[22:23] op_sel_hi:[1,0] neg_lo:[0,1] neg_hi:[0,1]
 v_pk_fma_f32 v[16:17], v[18:19], v[18:19], v[16:17]
 v_pk_add_f32 v[18:19], v[116:117], v[22:23] op_sel_hi:[1,0] neg_lo:[0,1] neg_hi:[0,1]
 v_pk_fma_f32 v[16:17], v[18:19], v[18:19], v[16:17]
 v_pk_add_f32 v[18:19], v[118:119], v[22:23] op_sel_hi:[1,0] neg_lo:[0,1] neg_hi:[0,1]
 v_pk_fma_f32 v[16:17], v[18:19], v[18:19], v[16:17]
 v_pk_add_f32 v[18:19], v[120:121], v[22:23] op_sel_hi:[1,0] neg_lo:[0,1] neg_hi:[0,1]
 v_pk_fma_f32 v[16:17], v[18:19], v[18:19], v[16:17]
 v_pk_add_f32 v[18:19], v[122:123], v[22:23] op_sel_hi:[1,0] neg_lo:[0,1] neg_hi:[0,1]
 v_pk_fma_f32 v[16:17], v[18:19], v[18:19], v[16:17]
 v_pk_add_f32 v[18:19], v[124:125], v[22:23] op_sel_hi:[1,0] neg_lo:[0,1] neg_hi:[0,1]
 v_pk_fma_f32 v[16:17], v[18:19], v[18:19], v[16:17]
 v_pk_add_f32 v[18:19], v[126:127], v[22:23] op_sel_hi:[1,0] neg_lo:[0,1] neg_hi:[0,1]
 v_pk_fma_f32 v[16:17], v[18:19], v[18:19], v[16:17]
 v_add_f32 v16, v16, v17
 v_mov_b32 v17, v16
 s_nop 1
 v_permlane32_swap_b32 v16, v17
 v_add_f32 v16, v16, v17
 v_mov_b32 v17, v16
 s_nop 1
 v_permlane16_swap_b32 v16, v17
 v_add_f32 v16, v16, v17
 ds_write_b32 v21, v16 offset:256
 s_waitcnt lgkmcnt(0)
 s_barrier
 ds_read_b128 v[16:19], v20 offset:256
 s_waitcnt lgkmcnt(0)
 v_add_f32 v16, v16, v17
 v_add_f32 v18, v18, v19
 v_add_f32 v16, v16, v18
 v_mul_f32 v16, 0x3a800000, v16
 v_cvt_pk_bf16_f32 v16, v16, v16
 v_and_b32 v16, 0xffff0000, v16
 v_add_f32 v16, 0x3727c5ac, v16
 v_cvt_pk_bf16_f32 v16, v16, v16
 v_and_b32 v16, 0xffff0000, v16
 v_sqrt_f32 v16, v16
 s_nop 0
 v_cvt_pk_bf16_f32 v16, v16, v16
 v_and_b32 v16, 0xffff0000, v16
 v_rcp_f32 v26, v16
 v_pk_add_f32 v[18:19], v[64:65], v[24:25] op_sel_hi:[1,0] neg_lo:[0,1] neg_hi:[0,1]
 v_cvt_pk_bf16_f32 v17, v18, v19
 v_lshlrev_b32 v18, 16, v17
 v_and_b32 v19, 0xffff0000, v17
 v_pk_mul_f32 v[18:19], v[18:19], v[26:27] op_sel_hi:[1,0]
 v_cvt_pk_bf16_f32 v32, v18, v19
 v_pk_add_f32 v[18:19], v[66:67], v[24:25] op_sel_hi:[1,0] neg_lo:[0,1] neg_hi:[0,1]
 v_cvt_pk_bf16_f32 v17, v18, v19
 v_lshlrev_b32 v18, 16, v17
 v_and_b32 v19, 0xffff0000, v17
 v_pk_mul_f32 v[18:19], v[18:19], v[26:27] op_sel_hi:[1,0]
 v_cvt_pk_bf16_f32 v33, v18, v19
 v_pk_add_f32 v[18:19], v[68:69], v[24:25] op_sel_hi:[1,0] neg_lo:[0,1] neg_hi:[0,1]
 v_cvt_pk_bf16_f32 v17, v18, v19
 v_lshlrev_b32 v18, 16, v17
 v_and_b32 v19, 0xffff0000, v17
 v_pk_mul_f32 v[18:19], v[18:19], v[26:27] op_sel_hi:[1,0]
 v_cvt_pk_bf16_f32 v34, v18, v19
 v_pk_add_f32 v[18:19], v[70:71], v[24:25] op_sel_hi:[1,0] neg_lo:[0,1] neg_hi:[0,1]
 v_cvt_pk_bf16_f32 v17, v18, v19
 v_lshlrev_b32 v18, 16, v17
 v_and_b32 v19, 0xffff0000, v17
 v_pk_mul_f32 v[18:19], v[18:19], v[26:27] op_sel_hi:[1,0]
 v_cvt_pk_bf16_f32 v35, v18, v19
 v_pk_add_f32 v[18:19], v[72:73], v[24:25] op_sel_hi:[1,0] neg_lo:[0,1] neg_hi:[0,1]
 v_cvt_pk_bf16_f32 v17, v18, v19
 v_lshlrev_b32 v18, 16, v17
 v_and_b32 v19, 0xffff0000, v17
 v_pk_mul_f32 v[18:19], v[18:19], v[26:27] op_sel_hi:[1,0]
 v_cvt_pk_bf16_f32 v36, v18, v19
 v_pk_add_f32 v[18:19], v[74:75], v[24:25] op_sel_hi:[1,0] neg_lo:[0,1] neg_hi:[0,1]
 v_cvt_pk_bf16_f32 v17, v18, v19
 v_lshlrev_b32 v18, 16, v17
 v_and_b32 v19, 0xffff0000, v17
 v_pk_mul_f32 v[18:19], v[18:19], v[26:27] op_sel_hi:[1,0]
 v_cvt_pk_bf16_f32 v37, v18, v19
 v_pk_add_f32 v[18:19], v[76:77], v[24:25] op_sel_hi:[1,0] neg_lo:[0,1] neg_hi:[0,1]
 v_cvt_pk_bf16_f32 v17, v18, v19
 v_lshlrev_b32 v18, 16, v17
 v_and_b32 v19, 0xffff0000, v17
 v_pk_mul_f32 v[18:19], v[18:19], v[26:27] op_sel_hi:[1,0]
 v_cvt_pk_bf16_f32 v38, v18, v19
 v_pk_add_f32 v[18:19], v[78:79], v[24:25] op_sel_hi:[1,0] neg_lo:[0,1] neg_hi:[0,1]
 v_cvt_pk_bf16_f32 v17, v18, v19
 v_lshlrev_b32 v18, 16, v17
 v_and_b32 v19, 0xffff0000, v17
 v_pk_mul_f32 v[18:19], v[18:19], v[26:27] op_sel_hi:[1,0]
 v_cvt_pk_bf16_f32 v39, v18, v19
 v_pk_add_f32 v[18:19], v[80:81], v[24:25] op_sel_hi:[1,0] neg_lo:[0,1] neg_hi:[0,1]
 v_cvt_pk_bf16_f32 v17, v18, v19
 v_lshlrev_b32 v18, 16, v17
 v_and_b32 v19, 0xffff0000, v17
 v_pk_mul_f32 v[18:19], v[18:19], v[26:27] op_sel_hi:[1,0]
 v_cvt_pk_bf16_f32 v40, v18, v19
 v_pk_add_f32 v[18:19], v[82:83], v[24:25] op_sel_hi:[1,0] neg_lo:[0,1] neg_hi:[0,1]
 v_cvt_pk_bf16_f32 v17, v18, v19
 v_lshlrev_b32 v18, 16, v17
 v_and_b32 v19, 0xffff0000, v17
 v_pk_mul_f32 v[18:19], v[18:19], v[26:27] op_sel_hi:[1,0]
 v_cvt_pk_bf16_f32 v41, v18, v19
 v_pk_add_f32 v[18:19], v[84:85], v[24:25] op_sel_hi:[1,0] neg_lo:[0,1] neg_hi:[0,1]
 v_cvt_pk_bf16_f32 v17, v18, v19
 v_lshlrev_b32 v18, 16, v17
 v_and_b32 v19, 0xffff0000, v17
 v_pk_mul_f32 v[18:19], v[18:19], v[26:27] op_sel_hi:[1,0]
 v_cvt_pk_bf16_f32 v42, v18, v19
 v_pk_add_f32 v[18:19], v[86:87], v[24:25] op_sel_hi:[1,0] neg_lo:[0,1] neg_hi:[0,1]
 v_cvt_pk_bf16_f32 v17, v18, v19
 v_lshlrev_b32 v18, 16, v17
 v_and_b32 v19, 0xffff0000, v17
 v_pk_mul_f32 v[18:19], v[18:19], v[26:27] op_sel_hi:[1,0]
 v_cvt_pk_bf16_f32 v43, v18, v19
 v_pk_add_f32 v[18:19], v[88:89], v[24:25] op_sel_hi:[1,0] neg_lo:[0,1] neg_hi:[0,1]
 v_cvt_pk_bf16_f32 v17, v18, v19
 v_lshlrev_b32 v18, 16, v17
 v_and_b32 v19, 0xffff0000, v17
 v_pk_mul_f32 v[18:19], v[18:19], v[26:27] op_sel_hi:[1,0]
 v_cvt_pk_bf16_f32 v44, v18, v19
 v_pk_add_f32 v[18:19], v[90:91], v[24:25] op_sel_hi:[1,0] neg_lo:[0,1] neg_hi:[0,1]
 v_cvt_pk_bf16_f32 v17, v18, v19
 v_lshlrev_b32 v18, 16, v17
 v_and_b32 v19, 0xffff0000, v17
 v_pk_mul_f32 v[18:19], v[18:19], v[26:27] op_sel_hi:[1,0]
 v_cvt_pk_bf16_f32 v45, v18, v19
 v_pk_add_f32 v[18:19], v[92:93], v[24:25] op_sel_hi:[1,0] neg_lo:[0,1] neg_hi:[0,1]
 v_cvt_pk_bf16_f32 v17, v18, v19
 v_lshlrev_b32 v18, 16, v17
 v_and_b32 v19, 0xffff0000, v17
 v_pk_mul_f32 v[18:19], v[18:19], v[26:27] op_sel_hi:[1,0]
 v_cvt_pk_bf16_f32 v46, v18, v19
 v_pk_add_f32 v[18:19], v[94:95], v[24:25] op_sel_hi:[1,0] neg_lo:[0,1] neg_hi:[0,1]
 v_cvt_pk_bf16_f32 v17, v18, v19
 v_lshlrev_b32 v18, 16, v17
 v_and_b32 v19, 0xffff0000, v17
 v_pk_mul_f32 v[18:19], v[18:19], v[26:27] op_sel_hi:[1,0]
 v_cvt_pk_bf16_f32 v47, v18, v19
 v_pk_add_f32 v[18:19], v[96:97], v[24:25] op_sel_hi:[1,0] neg_lo:[0,1] neg_hi:[0,1]
 v_cvt_pk_bf16_f32 v17, v18, v19
 v_lshlrev_b32 v18, 16, v17
 v_and_b32 v19, 0xffff0000, v17
 v_pk_mul_f32 v[18:19], v[18:19], v[26:27] op_sel_hi:[1,0]
 v_cvt_pk_bf16_f32 v48, v18, v19
 v_pk_add_f32 v[18:19], v[98:99], v[24:25] op_sel_hi:[1,0] neg_lo:[0,1] neg_hi:[0,1]
 v_cvt_pk_bf16_f32 v17, v18, v19
 v_lshlrev_b32 v18, 16, v17
 v_and_b32 v19, 0xffff0000, v17
 v_pk_mul_f32 v[18:19], v[18:19], v[26:27] op_sel_hi:[1,0]
 v_cvt_pk_bf16_f32 v49, v18, v19
 v_pk_add_f32 v[18:19], v[100:101], v[24:25] op_sel_hi:[1,0] neg_lo:[0,1] neg_hi:[0,1]
 v_cvt_pk_bf16_f32 v17, v18, v19
 v_lshlrev_b32 v18, 16, v17
 v_and_b32 v19, 0xffff0000, v17
 v_pk_mul_f32 v[18:19], v[18:19], v[26:27] op_sel_hi:[1,0]
 v_cvt_pk_bf16_f32 v50, v18, v19
 v_pk_add_f32 v[18:19], v[102:103], v[24:25] op_sel_hi:[1,0] neg_lo:[0,1] neg_hi:[0,1]
 v_cvt_pk_bf16_f32 v17, v18, v19
 v_lshlrev_b32 v18, 16, v17
 v_and_b32 v19, 0xffff0000, v17
 v_pk_mul_f32 v[18:19], v[18:19], v[26:27] op_sel_hi:[1,0]
 v_cvt_pk_bf16_f32 v51, v18, v19
 v_pk_add_f32 v[18:19], v[104:105], v[24:25] op_sel_hi:[1,0] neg_lo:[0,1] neg_hi:[0,1]
 v_cvt_pk_bf16_f32 v17, v18, v19
 v_lshlrev_b32 v18, 16, v17
 v_and_b32 v19, 0xffff0000, v17
 v_pk_mul_f32 v[18:19], v[18:19], v[26:27] op_sel_hi:[1,0]
 v_cvt_pk_bf16_f32 v52, v18, v19
 v_pk_add_f32 v[18:19], v[106:107], v[24:25] op_sel_hi:[1,0] neg_lo:[0,1] neg_hi:[0,1]
 v_cvt_pk_bf16_f32 v17, v18, v19
 v_lshlrev_b32 v18, 16, v17
 v_and_b32 v19, 0xffff0000, v17
 v_pk_mul_f32 v[18:19], v[18:19], v[26:27] op_sel_hi:[1,0]
 v_cvt_pk_bf16_f32 v53, v18, v19
 v_pk_add_f32 v[18:19], v[108:109], v[24:25] op_sel_hi:[1,0] neg_lo:[0,1] neg_hi:[0,1]
 v_cvt_pk_bf16_f32 v17, v18, v19
 v_lshlrev_b32 v18, 16, v17
 v_and_b32 v19, 0xffff0000, v17
 v_pk_mul_f32 v[18:19], v[18:19], v[26:27] op_sel_hi:[1,0]
 v_cvt_pk_bf16_f32 v54, v18, v19
 v_pk_add_f32 v[18:19], v[110:111], v[24:25] op_sel_hi:[1,0] neg_lo:[0,1] neg_hi:[0,1]
 v_cvt_pk_bf16_f32 v17, v18, v19
 v_lshlrev_b32 v18, 16, v17
 v_and_b32 v19, 0xffff0000, v17
 v_pk_mul_f32 v[18:19], v[18:19], v[26:27] op_sel_hi:[1,0]
 v_cvt_pk_bf16_f32 v55, v18, v19
 v_pk_add_f32 v[18:19], v[112:113], v[24:25] op_sel_hi:[1,0] neg_lo:[0,1] neg_hi:[0,1]
 v_cvt_pk_bf16_f32 v17, v18, v19
 v_lshlrev_b32 v18, 16, v17
 v_and_b32 v19, 0xffff0000, v17
 v_pk_mul_f32 v[18:19], v[18:19], v[26:27] op_sel_hi:[1,0]
 v_cvt_pk_bf16_f32 v56, v18, v19
 v_pk_add_f32 v[18:19], v[114:115], v[24:25] op_sel_hi:[1,0] neg_lo:[0,1] neg_hi:[0,1]
 v_cvt_pk_bf16_f32 v17, v18, v19
 v_lshlrev_b32 v18, 16, v17
 v_and_b32 v19, 0xffff0000, v17
 v_pk_mul_f32 v[18:19], v[18:19], v[26:27] op_sel_hi:[1,0]
 v_cvt_pk_bf16_f32 v57, v18, v19
 v_pk_add_f32 v[18:19], v[116:117], v[24:25] op_sel_hi:[1,0] neg_lo:[0,1] neg_hi:[0,1]
 v_cvt_pk_bf16_f32 v17, v18, v19
 v_lshlrev_b32 v18, 16, v17
 v_and_b32 v19, 0xffff0000, v17
 v_pk_mul_f32 v[18:19], v[18:19], v[26:27] op_sel_hi:[1,0]
 v_cvt_pk_bf16_f32 v58, v18, v19
 v_pk_add_f32 v[18:19], v[118:119], v[24:25] op_sel_hi:[1,0] neg_lo:[0,1] neg_hi:[0,1]
 v_cvt_pk_bf16_f32 v17, v18, v19
 v_lshlrev_b32 v18, 16, v17
 v_and_b32 v19, 0xffff0000, v17
 v_pk_mul_f32 v[18:19], v[18:19], v[26:27] op_sel_hi:[1,0]
 v_cvt_pk_bf16_f32 v59, v18, v19
 v_pk_add_f32 v[18:19], v[120:121], v[24:25] op_sel_hi:[1,0] neg_lo:[0,1] neg_hi:[0,1]
 v_cvt_pk_bf16_f32 v17, v18, v19
 v_lshlrev_b32 v18, 16, v17
 v_and_b32 v19, 0xffff0000, v17
 v_pk_mul_f32 v[18:19], v[18:19], v[26:27] op_sel_hi:[1,0]
 v_cvt_pk_bf16_f32 v60, v18, v19
 v_pk_add_f32 v[18:19], v[122:123], v[24:25] op_sel_hi:[1,0] neg_lo:[0,1] neg_hi:[0,1]
 v_cvt_pk_bf16_f32 v17, v18, v19
 v_lshlrev_b32 v18, 16, v17
 v_and_b32 v19, 0xffff0000, v17
 v_pk_mul_f32 v[18:19], v[18:19], v[26:27] op_sel_hi:[1,0]
 v_cvt_pk_bf16_f32 v61, v18, v19
 v_pk_add_f32 v[18:19], v[124:125], v[24:25] op_sel_hi:[1,0] neg_lo:[0,1] neg_hi:[0,1]
 v_cvt_pk_bf16_f32 v17, v18, v19
 v_lshlrev_b32 v18, 16, v17
 v_and_b32 v19, 0xffff0000, v17
 v_pk_mul_f32 v[18:19], v[18:19], v[26:27] op_sel_hi:[1,0]
 v_cvt_pk_bf16_f32 v62, v18, v19
 v_pk_add_f32 v[18:19], v[126:127], v[24:25] op_sel_hi:[1,0] neg_lo:[0,1] neg_hi:[0,1]
 v_cvt_pk_bf16_f32 v17, v18, v19
 v_lshlrev_b32 v18, 16, v17
 v_and_b32 v19, 0xffff0000, v17
 v_pk_mul_f32 v[18:19], v[18:19], v[26:27] op_sel_hi:[1,0]
 v_cvt_pk_bf16_f32 v63, v18, v19
 s_lshl_b32 s47, s62, 15
 s_lshl_b32 s48, s40, 13
 s_add_u32 s47, s47, s48
 s_add_u32 s47, s47, 0xc00000
 buffer_store_dwordx4 v[32:35], v3, s[28:31], s47 offen offset:0 sc1
 buffer_store_dwordx4 v[36:39], v3, s[28:31], s47 offen offset:1024 sc1
 buffer_store_dwordx4 v[40:43], v3, s[28:31], s47 offen offset:2048 sc1
 buffer_store_dwordx4 v[44:47], v3, s[28:31], s47 offen offset:3072 sc1
 s_add_u32 s47, s47, 4096
 buffer_store_dwordx4 v[48:51], v3, s[28:31], s47 offen offset:0 sc1
 buffer_store_dwordx4 v[52:55], v3, s[28:31], s47 offen offset:1024 sc1
 buffer_store_dwordx4 v[56:59], v3, s[28:31], s47 offen offset:2048 sc1
 buffer_store_dwordx4 v[60:63], v3, s[28:31], s47 offen offset:3072 sc1
 s_add_u32 m0, s45, 14336
 s_mov_b32 s47, 0x0
 buffer_load_dwordx4 v6, s[32:35], s47 offen lds
 s_add_u32 m0, s45, 15360
 s_mov_b32 s47, 0x8000
 buffer_load_dwordx4 v6, s[32:35], s47 offen lds
 s_add_u32 m0, s45, 16384
 s_mov_b32 s47, 0x40000
 buffer_load_dwordx4 v6, s[32:35], s47 offen lds
 s_add_u32 m0, s45, 17408
 s_mov_b32 s47, 0x48000
 buffer_load_dwordx4 v6, s[32:35], s47 offen lds
 s_add_u32 m0, s45, 18432
 s_mov_b32 s47, 0x80000
 buffer_load_dwordx4 v6, s[32:35], s47 offen lds
 s_add_u32 m0, s45, 19456
 s_mov_b32 s47, 0x88000
 buffer_load_dwordx4 v6, s[32:35], s47 offen lds
 s_add_u32 m0, s45, 20480
 s_mov_b32 s47, 0xc0000
 buffer_load_dwordx4 v6, s[32:35], s47 offen lds
 s_add_u32 m0, s45, 21504
 s_mov_b32 s47, 0xc8000
 buffer_load_dwordx4 v6, s[32:35], s47 offen lds
 s_add_u32 m0, s45, 22528
 s_mov_b32 s47, 0x100000
 buffer_load_dwordx4 v6, s[32:35], s47 offen lds
 s_add_u32 m0, s45, 23552
 s_mov_b32 s47, 0x108000
 buffer_load_dwordx4 v6, s[32:35], s47 offen lds
 s_add_u32 m0, s45, 24576
 s_mov_b32 s47, 0x140000
 buffer_load_dwordx4 v6, s[32:35], s47 offen lds
 s_add_u32 m0, s45, 25600
 s_mov_b32 s47, 0x148000
 buffer_load_dwordx4 v6, s[32:35], s47 offen lds
 s_add_u32 m0, s45, 26624
 s_mov_b32 s47, 0x180000
 buffer_load_dwordx4 v6, s[32:35], s47 offen lds
 s_add_u32 m0, s45, 27648
 s_mov_b32 s47, 0x188000
 buffer_load_dwordx4 v6, s[32:35], s47 offen lds
 s_add_u32 m0, s45, 28672
 s_mov_b32 s47, 0x1c0000
 buffer_load_dwordx4 v6, s[32:35], s47 offen lds
 s_add_u32 m0, s45, 29696
 s_mov_b32 s47, 0x1c8000
 buffer_load_dwordx4 v6, s[32:35], s47 offen lds
 s_add_u32 m0, s45, 30720
 s_mov_b32 s47, 0x200000
 buffer_load_dwordx4 v6, s[32:35], s47 offen lds
 s_add_u32 m0, s45, 31744
 s_mov_b32 s47, 0x208000
 buffer_load_dwordx4 v6, s[32:35], s47 offen lds
 s_mov_b32 m0, s46
 s_mov_b32 s47, 0x240000
 buffer_load_dwordx4 v6, s[32:35], s47 offen lds
 s_add_u32 m0, s46, 1024
 s_mov_b32 s47, 0x248000
 buffer_load_dwordx4 v6, s[32:35], s47 offen lds
 s_add_u32 m0, s46, 2048
 s_mov_b32 s47, 0x280000
 buffer_load_dwordx4 v6, s[32:35], s47 offen lds
 s_add_u32 m0, s46, 3072
 s_mov_b32 s47, 0x288000
 buffer_load_dwordx4 v6, s[32:35], s47 offen lds
 s_add_u32 m0, s46, 4096
 s_mov_b32 s47, 0x2c0000
 buffer_load_dwordx4 v6, s[32:35], s47 offen lds
 s_add_u32 m0, s46, 5120
 s_mov_b32 s47, 0x2c8000
 buffer_load_dwordx4 v6, s[32:35], s47 offen lds
 s_add_u32 m0, s46, 6144
 s_mov_b32 s47, 0x300000
 buffer_load_dwordx4 v6, s[32:35], s47 offen lds
 s_mov_b32 m0, s45
 s_mov_b32 s47, 0x308000
 buffer_load_dwordx4 v6, s[32:35], s47 offen lds
 s_add_u32 m0, s45, 1024
 s_mov_b32 s47, 0x340000
 buffer_load_dwordx4 v6, s[32:35], s47 offen lds
 s_add_u32 m0, s45, 2048
 s_mov_b32 s47, 0x348000
 buffer_load_dwordx4 v6, s[32:35], s47 offen lds
 s_add_u32 m0, s45, 3072
 s_mov_b32 s47, 0x380000
 buffer_load_dwordx4 v6, s[32:35], s47 offen lds
 s_add_u32 m0, s45, 4096
 s_mov_b32 s47, 0x388000
 buffer_load_dwordx4 v6, s[32:35], s47 offen lds
 s_add_u32 m0, s45, 5120
 s_mov_b32 s47, 0x3c0000
 buffer_load_dwordx4 v6, s[32:35], s47 offen lds
 s_add_u32 m0, s45, 6144
 s_mov_b32 s47, 0x3c8000
 buffer_load_dwordx4 v6, s[32:35], s47 offen lds
 s_add_u32 m0, s45, 7168
 s_mov_b32 s47, 0x400000
 buffer_load_dwordx4 v6, s[32:35], s47 offen lds
 s_add_u32 m0, s45, 8192
 s_mov_b32 s47, 0x408000
 buffer_load_dwordx4 v6, s[32:35], s47 offen lds
 s_add_u32 m0, s45, 9216
 s_mov_b32 s47, 0x440000
 buffer_load_dwordx4 v6, s[32:35], s47 offen lds
 s_add_u32 m0, s45, 10240
 s_mov_b32 s47, 0x448000
 buffer_load_dwordx4 v6, s[32:35], s47 offen lds
 s_add_u32 m0, s45, 11264
 s_mov_b32 s47, 0x480000
 buffer_load_dwordx4 v6, s[32:35], s47 offen lds
 s_add_u32 m0, s45, 12288
 s_mov_b32 s47, 0x488000
 buffer_load_dwordx4 v6, s[32:35], s47 offen lds
 s_add_u32 m0, s45, 13312
 s_mov_b32 s47, 0x4c0000
 buffer_load_dwordx4 v6, s[32:35], s47 offen lds
 s_waitcnt vmcnt(39)
 s_barrier
 s_lshl_b32 s47, 1, s62
 s_cmp_lt_u32 s62, 16
 s_cselect_b32 s47, s47, 0
 s_cmp_lg_u32 s40, 0
 s_cbranch_scc1 L_lnarr
 s_mov_b64 exec, 1
 v_mov_b32 v16, 0
 v_mov_b32 v17, s47
 v_mov_b32 v18, s63
 s_cmp_eq_u32 s47, 0
 s_cbranch_scc1 L_lnarr1
 global_atomic_or v16, v17, s[22:23] sc1
L_lnarr1:
 s_cmp_eq_u32 s63, 0
 s_cbranch_scc1 L_lnarr2
 global_atomic_add v16, v18, s[22:23] offset:4 sc1
L_lnarr2:
 s_mov_b64 exec, -1
L_lnarr:
 s_waitcnt vmcnt(38)
 ds_read_b64_tr_b16 a[0:1], v4 offset:14336
 ds_read_b64_tr_b16 a[4:5], v4 offset:14848
 s_waitcnt vmcnt(37)
 ds_read_b64_tr_b16 a[2:3], v4 offset:15360
 ds_read_b64_tr_b16 a[6:7], v4 offset:15872
 s_waitcnt vmcnt(36)
 ds_read_b64_tr_b16 a[8:9], v4 offset:16384
 ds_read_b64_tr_b16 a[12:13], v4 offset:16896
 s_waitcnt vmcnt(35)
 ds_read_b64_tr_b16 a[10:11], v4 offset:17408
 ds_read_b64_tr_b16 a[14:15], v4 offset:17920
 s_waitcnt lgkmcnt(6)
 s_add_u32 m0, s45, 14336
 s_mov_b32 s47, 0x4c8000
 buffer_load_dwordx4 v6, s[32:35], s47 offen lds
 s_waitcnt vmcnt(35)
 ds_read_b64_tr_b16 a[16:17], v4 offset:18432
 ds_read_b64_tr_b16 a[20:21], v4 offset:18944
 s_waitcnt lgkmcnt(6)
 s_add_u32 m0, s45, 15360
 s_mov_b32 s47, 0x500000
 buffer_load_dwordx4 v6, s[32:35], s47 offen lds
 s_waitcnt vmcnt(35)
 ds_read_b64_tr_b16 a[18:19], v4 offset:19456
 ds_read_b64_tr_b16 a[22:23], v4 offset:19968
 s_waitcnt lgkmcnt(6)
 s_add_u32 m0, s45, 16384
 s_mov_b32 s47, 0x508000
 buffer_load_dwordx4 v6, s[32:35], s47 offen lds
 s_waitcnt vmcnt(35)
 ds_read_b64_tr_b16 a[24:25], v4 offset:20480
 ds_read_b64_tr_b16 a[28:29], v4 offset:20992
 s_waitcnt lgkmcnt(6)
 s_add_u32 m0, s45, 17408
 s_mov_b32 s47, 0x540000
 buffer_load_dwordx4 v6, s[32:35], s47 offen lds
 s_waitcnt vmcnt(35)
 ds_read_b64_tr_b16 a[26:27], v4 offset:21504
 ds_read_b64_tr_b16 a[30:31], v4 offset:22016
 s_waitcnt lgkmcnt(6)
 s_add_u32 m0, s45, 18432
 s_mov_b32 s47, 0x548000
 buffer_load_dwordx4 v6, s[32:35], s47 offen lds
 s_waitcnt vmcnt(35)
 ds_read_b64_tr_b16 a[32:33], v4 offset:22528
 ds_read_b64_tr_b16 a[36:37], v4 offset:23040
 s_waitcnt lgkmcnt(6)
 s_add_u32 m0, s45, 19456
 s_mov_b32 s47, 0x580000
 buffer_load_dwordx4 v6, s[32:35], s47 offen lds
 s_waitcnt vmcnt(35)
 ds_read_b64_tr_b16 a[34:35], v4 offset:23552
 ds_read_b64_tr_b16 a[38:39], v4 offset:24064
 s_waitcnt lgkmcnt(6)
 s_add_u32 m0, s45, 20480
 s_mov_b32 s47, 0x588000
 buffer_load_dwordx4 v6, s[32:35], s47 offen lds
 s_waitcnt vmcnt(35)
 ds_read_b64_tr_b16 a[40:41], v4 offset:24576
 ds_read_b64_tr_b16 a[44:45], v4 offset:25088
 s_waitcnt lgkmcnt(6)
 s_add_u32 m0, s45, 21504
 s_mov_b32 s47, 0x5c0000
 buffer_load_dwordx4 v6, s[32:35], s47 offen lds
 s_waitcnt vmcnt(35)
 ds_read_b64_tr_b16 a[42:43], v4 offset:25600
 ds_read_b64_tr_b16 a[46:47], v4 offset:26112
 s_waitcnt lgkmcnt(6)
 s_add_u32 m0, s45, 22528
 s_mov_b32 s47, 0x5c8000
 buffer_load_dwordx4 v6, s[32:35], s47 offen lds
 s_waitcnt vmcnt(35)
 ds_read_b64_tr_b16 a[48:49], v4 offset:26624
 ds_read_b64_tr_b16 a[52:53], v4 offset:27136
 s_waitcnt lgkmcnt(6)
 s_add_u32 m0, s45, 23552
 s_mov_b32 s47, 0x600000
 buffer_load_dwordx4 v6, s[32:35], s47 offen lds
 s_waitcnt vmcnt(35)
 ds_read_b64_tr_b16 a[50:51], v4 offset:27648
 ds_read_b64_tr_b16 a[54:55], v4 offset:28160
 s_waitcnt lgkmcnt(6)
 s_add_u32 m0, s45, 24576
 s_mov_b32 s47, 0x608000
 buffer_load_dwordx4 v6, s[32:35], s47 offen lds
 s_waitcnt vmcnt(35)
 ds_read_b64_tr_b16 a[56:57], v4 offset:28672
 ds_read_b64_tr_b16 a[60:61], v4 offset:29184
 s_waitcnt lgkmcnt(6)
 s_add_u32 m0, s45, 25600
 s_mov_b32 s47, 0x640000
 buffer_load_dwordx4 v6, s[32:35], s47 offen lds
 s_waitcnt vmcnt(35)
 ds_read_b64_tr_b16 a[58:59], v4 offset:29696
 ds_read_b64_tr_b16 a[62:63], v4 offset:30208
 s_waitcnt lgkmcnt(6)
 s_add_u32 m0, s45, 26624
 s_mov_b32 s47, 0x648000
 buffer_load_dwordx4 v6, s[32:35], s47 offen lds
 s_waitcnt vmcnt(35)
 ds_read_b64_tr_b16 a[64:65], v4 offset:30720
 ds_read_b64_tr_b16 a[68:69], v4 offset:31232
 s_waitcnt lgkmcnt(6)
 s_add_u32 m0, s45, 27648
 s_mov_b32 s47, 0x680000
 buffer_load_dwordx4 v6, s[32:35], s47 offen lds
 s_waitcnt vmcnt(35)
 ds_read_b64_tr_b16 a[66:67], v4 offset:31744
 ds_read_b64_tr_b16 a[70:71], v4 offset:32256
 s_waitcnt lgkmcnt(6)
 s_add_u32 m0, s45, 28672
 s_mov_b32 s47, 0x688000
 buffer_load_dwordx4 v6, s[32:35], s47 offen lds
 s_waitcnt vmcnt(35)
 ds_read_b64_tr_b16 a[72:73], v5 offset:0
 ds_read_b64_tr_b16 a[76:77], v5 offset:512
 s_waitcnt lgkmcnt(6)
 s_add_u32 m0, s45, 29696
 s_mov_b32 s47, 0x6c0000
 buffer_load_dwordx4 v6, s[32:35], s47 offen lds
 s_waitcnt vmcnt(35)
 ds_read_b64_tr_b16 a[74:75], v5 offset:1024
 ds_read_b64_tr_b16 a[78:79], v5 offset:1536
 s_waitcnt lgkmcnt(6)
 s_add_u32 m0, s45, 30720
 s_mov_b32 s47, 0x6c8000
 buffer_load_dwordx4 v6, s[32:35], s47 offen lds
 s_waitcnt vmcnt(35)
 ds_read_b64_tr_b16 a[80:81], v5 offset:2048
 ds_read_b64_tr_b16 a[84:85], v5 offset:2560
 s_waitcnt lgkmcnt(6)
 s_add_u32 m0, s45, 31744
 s_mov_b32 s47, 0x700000
 buffer_load_dwordx4 v6, s[32:35], s47 offen lds
 s_waitcnt vmcnt(35)
 ds_read_b64_tr_b16 a[82:83], v5 offset:3072
 ds_read_b64_tr_b16 a[86:87], v5 offset:3584
 s_waitcnt lgkmcnt(6)
 s_mov_b32 m0, s46
 s_mov_b32 s47, 0x708000
 buffer_load_dwordx4 v6, s[32:35], s47 offen lds
 s_waitcnt vmcnt(35)
 ds_read_b64_tr_b16 a[88:89], v5 offset:4096
 ds_read_b64_tr_b16 a[92:93], v5 offset:4608
 s_waitcnt lgkmcnt(6)
 s_add_u32 m0, s46, 1024
 s_mov_b32 s47, 0x740000
 buffer_load_dwordx4 v6, s[32:35], s47 offen lds
 s_waitcnt vmcnt(35)
 ds_read_b64_tr_b16 a[90:91], v5 offset:5120
 ds_read_b64_tr_b16 a[94:95], v5 offset:5632
 s_waitcnt lgkmcnt(6)
 s_add_u32 m0, s46, 2048
 s_mov_b32 s47, 0x748000
 buffer_load_dwordx4 v6, s[32:35], s47 offen lds
 s_waitcnt vmcnt(35)
 ds_read_b64_tr_b16 a[96:97], v5 offset:6144
 ds_read_b64_tr_b16 a[100:101], v5 offset:6656
 s_waitcnt lgkmcnt(6)
 s_add_u32 m0, s46, 3072
 s_mov_b32 s47, 0x780000
 buffer_load_dwordx4 v6, s[32:35], s47 offen lds
 s_waitcnt vmcnt(35)
 ds_read_b64_tr_b16 a[98:99], v4 offset:0
 ds_read_b64_tr_b16 a[102:103], v4 offset:512
 s_waitcnt lgkmcnt(6)
 s_add_u32 m0, s46, 4096
 s_mov_b32 s47, 0x788000
 buffer_load_dwordx4 v6, s[32:35], s47 offen lds
 s_waitcnt vmcnt(35)
 ds_read_b64_tr_b16 a[104:105], v4 offset:1024
 ds_read_b64_tr_b16 a[108:109], v4 offset:1536
 s_waitcnt lgkmcnt(6)
 s_add_u32 m0, s46, 5120
 s_mov_b32 s47, 0x7c0000
 buffer_load_dwordx4 v6, s[32:35], s47 offen lds
 s_waitcnt vmcnt(35)
 ds_read_b64_tr_b16 a[106:107], v4 offset:2048
 ds_read_b64_tr_b16 a[110:111], v4 offset:2560
 s_waitcnt lgkmcnt(6)
 s_add_u32 m0, s46, 6144
 s_mov_b32 s47, 0x7c8000
 buffer_load_dwordx4 v6, s[32:35], s47 offen lds
 s_waitcnt vmcnt(35)
 ds_read_b64_tr_b16 a[112:113], v4 offset:3072
 ds_read_b64_tr_b16 a[116:117], v4 offset:3584
 s_waitcnt vmcnt(34)
 ds_read_b64_tr_b16 a[114:115], v4 offset:4096
 ds_read_b64_tr_b16 a[118:119], v4 offset:4608
 s_waitcnt vmcnt(33)
 ds_read_b64_tr_b16 a[120:121], v4 offset:5120
 ds_read_b64_tr_b16 a[124:125], v4 offset:5632
 s_waitcnt vmcnt(32)
 ds_read_b64_tr_b16 a[122:123], v4 offset:6144
 ds_read_b64_tr_b16 a[126:127], v4 offset:6656
 s_waitcnt vmcnt(31)
 ds_read_b64_tr_b16 a[128:129], v4 offset:7168
 ds_read_b64_tr_b16 a[132:133], v4 offset:7680
 s_waitcnt vmcnt(30)
 ds_read_b64_tr_b16 a[130:131], v4 offset:8192
 ds_read_b64_tr_b16 a[134:135], v4 offset:8704
 s_waitcnt vmcnt(29)
 ds_read_b64_tr_b16 a[136:137], v4 offset:9216
 ds_read_b64_tr_b16 a[140:141], v4 offset:9728
 s_waitcnt vmcnt(28)
 ds_read_b64_tr_b16 a[138:139], v4 offset:10240
 ds_read_b64_tr_b16 a[142:143], v4 offset:10752
 s_waitcnt vmcnt(27)
 ds_read_b64_tr_b16 a[144:145], v4 offset:11264
 ds_read_b64_tr_b16 a[148:149], v4 offset:11776
 s_waitcnt vmcnt(26)
 ds_read_b64_tr_b16 a[146:147], v4 offset:12288
 ds_read_b64_tr_b16 a[150:151], v4 offset:12800
 s_waitcnt vmcnt(25)
 ds_read_b64_tr_b16 a[152:153], v4 offset:13312
 ds_read_b64_tr_b16 a[156:157], v4 offset:13824
 s_waitcnt vmcnt(24)
 ds_read_b64_tr_b16 a[154:155], v4 offset:14336
 ds_read_b64_tr_b16 a[158:159], v4 offset:14848
 s_waitcnt vmcnt(23)
 ds_read_b64_tr_b16 a[160:161], v4 offset:15360
 ds_read_b64_tr_b16 a[164:165], v4 offset:15872
 s_waitcnt vmcnt(22)
 ds_read_b64_tr_b16 a[162:163], v4 offset:16384
 ds_read_b64_tr_b16 a[166:167], v4 offset:16896
 s_waitcnt vmcnt(21)
 ds_read_b64_tr_b16 a[168:169], v4 offset:17408
 ds_read_b64_tr_b16 a[172:173], v4 offset:17920
 s_waitcnt vmcnt(20)
 ds_read_b64_tr_b16 a[170:171], v4 offset:18432
 ds_read_b64_tr_b16 a[174:175], v4 offset:18944
 s_waitcnt vmcnt(19)
 ds_read_b64_tr_b16 a[176:177], v4 offset:19456
 ds_read_b64_tr_b16 a[180:181], v4 offset:19968
 s_waitcnt vmcnt(18)
 ds_read_b64_tr_b16 a[178:179], v4 offset:20480
 ds_read_b64_tr_b16 a[182:183], v4 offset:20992
 s_waitcnt vmcnt(17)
 ds_read_b64_tr_b16 a[184:185], v4 offset:21504
 ds_read_b64_tr_b16 a[188:189], v4 offset:22016
 s_waitcnt vmcnt(16)
 ds_read_b64_tr_b16 a[186:187], v4 offset:22528
 ds_read_b64_tr_b16 a[190:191], v4 offset:23040
 s_waitcnt vmcnt(15)
 ds_read_b64_tr_b16 a[192:193], v4 offset:23552
 ds_read_b64_tr_b16 a[196:197], v4 offset:24064
 s_waitcnt vmcnt(14)
 ds_read_b64_tr_b16 a[194:195], v4 offset:24576
 ds_read_b64_tr_b16 a[198:199], v4 offset:25088
 s_waitcnt vmcnt(13)
 ds_read_b64_tr_b16 a[200:201], v4 offset:25600
 ds_read_b64_tr_b16 a[204:205], v4 offset:26112
 s_waitcnt vmcnt(12)
 ds_read_b64_tr_b16 a[202:203], v4 offset:26624
 ds_read_b64_tr_b16 a[206:207], v4 offset:27136
 s_waitcnt vmcnt(11)
 ds_read_b64_tr_b16 a[208:209], v4 offset:27648
 ds_read_b64_tr_b16 a[212:213], v4 offset:28160
 s_waitcnt vmcnt(10)
 ds_read_b64_tr_b16 a[210:211], v4 offset:28672
 ds_read_b64_tr_b16 a[214:215], v4 offset:29184
 s_waitcnt vmcnt(9)
 ds_read_b64_tr_b16 a[216:217], v4 offset:29696
 ds_read_b64_tr_b16 a[220:221], v4 offset:30208
 s_waitcnt vmcnt(8)
 ds_read_b64_tr_b16 a[218:219], v4 offset:30720
 ds_read_b64_tr_b16 a[222:223], v4 offset:31232
 s_waitcnt vmcnt(7)
 ds_read_b64_tr_b16 a[224:225], v4 offset:31744
 ds_read_b64_tr_b16 a[228:229], v4 offset:32256
 s_waitcnt vmcnt(6)
 ds_read_b64_tr_b16 a[226:227], v5 offset:0
 ds_read_b64_tr_b16 a[230:231], v5 offset:512
 s_waitcnt vmcnt(5)
 ds_read_b64_tr_b16 a[232:233], v5 offset:1024
 ds_read_b64_tr_b16 a[236:237], v5 offset:1536
 s_waitcnt vmcnt(4)
 ds_read_b64_tr_b16 a[234:235], v5 offset:2048
 ds_read_b64_tr_b16 a[238:239], v5 offset:2560
 s_waitcnt vmcnt(3)
 ds_read_b64_tr_b16 a[240:241], v5 offset:3072
 ds_read_b64_tr_b16 a[244:245], v5 offset:3584
 s_waitcnt vmcnt(2)
 ds_read_b64_tr_b16 a[242:243], v5 offset:4096
 ds_read_b64_tr_b16 a[246:247], v5 offset:4608
 s_waitcnt vmcnt(1)
 ds_read_b64_tr_b16 a[248:249], v5 offset:5120
 ds_read_b64_tr_b16 a[252:253], v5 offset:5632
 s_waitcnt vmcnt(0)
 ds_read_b64_tr_b16 a[250:251], v5 offset:6144
 ds_read_b64_tr_b16 a[254:255], v5 offset:6656
 s_waitcnt lgkmcnt(0)
 s_and_b32 s64, s50, 1
 s_lshr_b32 s47, s50, 6
 s_lshl_b32 s54, s47, 24
 s_add_u32 s54, s54, 0x1000000
 s_lshl_b32 s48, s64, 18
 s_add_u32 s54, s54, s48
 s_bfe_u32 s48, s50, 0x50001
 s_lshl_b32 s48, s48, 13
 s_add_u32 s54, s54, s48
 s_mov_b32 s56, 524288
 s_lshl_b32 s53, s64, 16
 s_lshr_b32 s48, s40, 1
 s_lshl_b32 s48, s48, 15
 s_add_u32 s53, s53, s48
 s_and_b32 s48, s40, 1
 s_lshl_b32 s48, s48, 12
 s_add_u32 s53, s53, s48
 s_add_u32 s53, s53, 0xc00000
 s_mov_b32 s58, 106496
 s_mov_b32 s57, 31
 s_mov_b32 s60, 0x80008000
 v_mov_b32 v7, v3
 v_add_u32 v8, 65536, v7
 v_mov_b32 v16, 0
gw_30:
 global_load_dword v17, v16, s[22:23] offset:0 sc1
 s_waitcnt vmcnt(0)
 v_readfirstlane_b32 s48, v17
 s_cmp_ge_u32 s48, 65535
 s_cbranch_scc1 gwd_31
 s_sub_u32 s26, s26, 1
 s_cbranch_scc1 L_end
 s_sleep 2
 s_branch gw_30
gwd_31:
 s_barrier
 s_cmp_ge_u32 s50, 128
 s_cbranch_scc1 L_projv
 s_lshl_b32 s48, s40, 10
 s_add_u32 s54, s54, s48
 s_add_u32 s55, s54, 4096
 s_lshl_b32 s61, s40, 12
 s_mov_b32 m0, s61
 s_nop 0
 buffer_load_dwordx4 v3, s[28:31], s53 offen offset:0 sc1 lds
 buffer_load_dwordx4 v3, s[28:31], s53 offen offset:1024 sc1 lds
 buffer_load_dwordx4 v3, s[28:31], s53 offen offset:2048 sc1 lds
 buffer_load_dwordx4 v3, s[28:31], s53 offen offset:3072 sc1 lds
 s_add_u32 s53, s53, 8192
 s_add_u32 m0, s61, 16384
 s_nop 0
 buffer_load_dwordx4 v3, s[28:31], s53 offen offset:0 sc1 lds
 buffer_load_dwordx4 v3, s[28:31], s53 offen offset:1024 sc1 lds
 buffer_load_dwordx4 v3, s[28:31], s53 offen offset:2048 sc1 lds
 buffer_load_dwordx4 v3, s[28:31], s53 offen offset:3072 sc1 lds
 s_add_u32 s53, s53, 8192
 s_add_u32 m0, s61, 32768
 s_nop 0
 buffer_load_dwordx4 v3, s[28:31], s53 offen offset:0 sc1 lds
 buffer_load_dwordx4 v3, s[28:31], s53 offen offset:1024 sc1 lds
 buffer_load_dwordx4 v3, s[28:31], s53 offen offset:2048 sc1 lds
 buffer_load_dwordx4 v3, s[28:31], s53 offen offset:3072 sc1 lds
 s_add_u32 s53, s53, 8192
 s_add_u32 m0, s61, 49152
 s_nop 0
 buffer_load_dwordx4 v3, s[28:31], s53 offen offset:0 sc1 lds
 buffer_load_dwordx4 v3, s[28:31], s53 offen offset:1024 sc1 lds
 buffer_load_dwordx4 v3, s[28:31], s53 offen offset:2048 sc1 lds
 buffer_load_dwordx4 v3, s[28:31], s53 offen offset:3072 sc1 lds
 s_add_u32 s53, s53, s58
 s_add_u32 m0, s61, 65536
 s_nop 0
 buffer_load_dwordx4 v3, s[28:31], s53 offen offset:0 sc1 lds
 buffer_load_dwordx4 v3, s[28:31], s53 offen offset:1024 sc1 lds
 buffer_load_dwordx4 v3, s[28:31], s53 offen offset:2048 sc1 lds
 buffer_load_dwordx4 v3, s[28:31], s53 offen offset:3072 sc1 lds
 s_add_u32 s53, s53, 8192
 s_add_u32 m0, s61, 81920
 s_nop 0
 buffer_load_dwordx4 v3, s[28:31], s53 offen offset:0 sc1 lds
 buffer_load_dwordx4 v3, s[28:31], s53 offen offset:1024 sc1 lds
 buffer_load_dwordx4 v3, s[28:31], s53 offen offset:2048 sc1 lds
 buffer_load_dwordx4 v3, s[28:31], s53 offen offset:3072 sc1 lds
 s_add_u32 s53, s53, 8192
 s_add_u32 m0, s61, 98304
 s_nop 0
 buffer_load_dwordx4 v3, s[28:31], s53 offen offset:0 sc1 lds
 buffer_load_dwordx4 v3, s[28:31], s53 offen offset:1024 sc1 lds
 buffer_load_dwordx4 v3, s[28:31], s53 offen offset:2048 sc1 lds
 buffer_load_dwordx4 v3, s[28:31], s53 offen offset:3072 sc1 lds
 s_add_u32 s53, s53, 8192
 s_waitcnt vmcnt(24)
 s_barrier
 ds_read_b128 v[48:51], v7 offset:0
 ds_read_b128 v[52:55], v7 offset:8192
 ds_read_b128 v[56:59], v7 offset:1024
 ds_read_b128 v[60:63], v7 offset:9216
 s_waitcnt lgkmcnt(2)
 v_mfma_f32_16x16x32_bf16 v[16:19], a[0:3], v[48:51], 0
 ds_read_b128 v[64:67], v7 offset:2048
 v_mfma_f32_16x16x32_bf16 v[20:23], a[4:7], v[48:51], 0
 ds_read_b128 v[68:71], v7 offset:10240
 v_mfma_f32_16x16x32_bf16 v[24:27], a[0:3], v[52:55], 0
 v_mfma_f32_16x16x32_bf16 v[28:31], a[4:7], v[52:55], 0
 s_waitcnt lgkmcnt(2)
 v_mfma_f32_16x16x32_bf16 v[16:19], a[8:11], v[56:59], v[16:19]
 ds_read_b128 v[72:75], v7 offset:3072
 v_mfma_f32_16x16x32_bf16 v[20:23], a[12:15], v[56:59], v[20:23]
 ds_read_b128 v[76:79], v7 offset:11264
 v_mfma_f32_16x16x32_bf16 v[24:27], a[8:11], v[60:63], v[24:27]
 v_mfma_f32_16x16x32_bf16 v[28:31], a[12:15], v[60:63], v[28:31]
 s_waitcnt lgkmcnt(2)
 v_mfma_f32_16x16x32_bf16 v[16:19], a[16:19], v[64:67], v[16:19]
 ds_read_b128 v[48:51], v7 offset:4096
 v_mfma_f32_16x16x32_bf16 v[20:23], a[20:23], v[64:67], v[20:23]
 ds_read_b128 v[52:55], v7 offset:12288
 v_mfma_f32_16x16x32_bf16 v[24:27], a[16:19], v[68:71], v[24:27]
 v_mfma_f32_16x16x32_bf16 v[28:31], a[20:23], v[68:71], v[28:31]
 s_waitcnt lgkmcnt(2)
 v_mfma_f32_16x16x32_bf16 v[16:19], a[24:27], v[72:75], v[16:19]
 ds_read_b128 v[56:59], v7 offset:5120
 v_mfma_f32_16x16x32_bf16 v[20:23], a[28:31], v[72:75], v[20:23]
 ds_read_b128 v[60:63], v7 offset:13312
 v_mfma_f32_16x16x32_bf16 v[24:27], a[24:27], v[76:79], v[24:27]
 v_mfma_f32_16x16x32_bf16 v[28:31], a[28:31], v[76:79], v[28:31]
 s_waitcnt lgkmcnt(2)
 v_mfma_f32_16x16x32_bf16 v[16:19], a[32:35], v[48:51], v[16:19]
 ds_read_b128 v[64:67], v7 offset:6144
 v_mfma_f32_16x16x32_bf16 v[20:23], a[36:39], v[48:51], v[20:23]
 ds_read_b128 v[68:71], v7 offset:14336
 v_mfma_f32_16x16x32_bf16 v[24:27], a[32:35], v[52:55], v[24:27]
 v_mfma_f32_16x16x32_bf16 v[28:31], a[36:39], v[52:55], v[28:31]
 s_waitcnt lgkmcnt(2)
 v_mfma_f32_16x16x32_bf16 v[16:19], a[40:43], v[56:59], v[16:19]
 ds_read_b128 v[72:75], v7 offset:7168
 v_mfma_f32_16x16x32_bf16 v[20:23], a[44:47], v[56:59], v[20:23]
 ds_read_b128 v[76:79], v7 offset:15360
 v_mfma_f32_16x16x32_bf16 v[24:27], a[40:43], v[60:63], v[24:27]
 v_mfma_f32_16x16x32_bf16 v[28:31], a[44:47], v[60:63], v[28:31]
 s_waitcnt lgkmcnt(2)
 v_mfma_f32_16x16x32_bf16 v[16:19], a[48:51], v[64:67], v[16:19]
 s_waitcnt vmcnt(20)
 s_barrier
 ds_read_b128 v[48:51], v7 offset:16384
 v_mfma_f32_16x16x32_bf16 v[20:23], a[52:55], v[64:67], v[20:23]
 ds_read_b128 v[52:55], v7 offset:24576
 v_mfma_f32_16x16x32_bf16 v[24:27], a[48:51], v[68:71], v[24:27]
 s_add_u32 m0, s61, 114688
 s_nop 0
 v_mfma_f32_16x16x32_bf16 v[28:31], a[52:55], v[68:71], v[28:31]
 buffer_load_dwordx4 v3, s[28:31], s53 offen offset:0 sc1 lds
 s_waitcnt lgkmcnt(2)
 v_mfma_f32_16x16x32_bf16 v[16:19], a[56:59], v[72:75], v[16:19]
 ds_read_b128 v[56:59], v7 offset:17408
 v_mfma_f32_16x16x32_bf16 v[20:23], a[60:63], v[72:75], v[20:23]
 ds_read_b128 v[60:63], v7 offset:25600
 v_mfma_f32_16x16x32_bf16 v[24:27], a[56:59], v[76:79], v[24:27]
 v_mfma_f32_16x16x32_bf16 v[28:31], a[60:63], v[76:79], v[28:31]
 s_waitcnt lgkmcnt(2)
 v_mfma_f32_16x16x32_bf16 v[16:19], a[64:67], v[48:51], v[16:19]
 ds_read_b128 v[64:67], v7 offset:18432
 v_mfma_f32_16x16x32_bf16 v[20:23], a[68:71], v[48:51], v[20:23]
 ds_read_b128 v[68:71], v7 offset:26624
 v_mfma_f32_16x16x32_bf16 v[24:27], a[64:67], v[52:55], v[24:27]
 buffer_load_dwordx4 v3, s[28:31], s53 offen offset:1024 sc1 lds
 v_mfma_f32_16x16x32_bf16 v[28:31], a[68:71], v[52:55], v[28:31]
 s_waitcnt lgkmcnt(2)
 v_mfma_f32_16x16x32_bf16 v[16:19], a[72:75], v[56:59], v[16:19]
 ds_read_b128 v[72:75], v7 offset:19456
 v_mfma_f32_16x16x32_bf16 v[20:23], a[76:79], v[56:59], v[20:23]
 ds_read_b128 v[76:79], v7 offset:27648
 v_mfma_f32_16x16x32_bf16 v[24:27], a[72:75], v[60:63], v[24:27]
 v_mfma_f32_16x16x32_bf16 v[28:31], a[76:79], v[60:63], v[28:31]
 s_waitcnt lgkmcnt(2)
 v_mfma_f32_16x16x32_bf16 v[16:19], a[80:83], v[64:67], v[16:19]
 ds_read_b128 v[48:51], v7 offset:20480
 v_mfma_f32_16x16x32_bf16 v[20:23], a[84:87], v[64:67], v[20:23]
 ds_read_b128 v[52:55], v7 offset:28672
 v_mfma_f32_16x16x32_bf16 v[24:27], a[80:83], v[68:71], v[24:27]
 buffer_load_dwordx4 v3, s[28:31], s53 offen offset:2048 sc1 lds
 v_mfma_f32_16x16x32_bf16 v[28:31], a[84:87], v[68:71], v[28:31]
 s_waitcnt lgkmcnt(2)
 v_mfma_f32_16x16x32_bf16 v[16:19], a[88:91], v[72:75], v[16:19]
 ds_read_b128 v[56:59], v7 offset:21504
 v_mfma_f32_16x16x32_bf16 v[20:23], a[92:95], v[72:75], v[20:23]
 ds_read_b128 v[60:63], v7 offset:29696
 v_mfma_f32_16x16x32_bf16 v[24:27], a[88:91], v[76:79], v[24:27]
 v_mfma_f32_16x16x32_bf16 v[28:31], a[92:95], v[76:79], v[28:31]
 s_waitcnt lgkmcnt(2)
 v_mfma_f32_16x16x32_bf16 v[16:19], a[96:99], v[48:51], v[16:19]
 ds_read_b128 v[64:67], v7 offset:22528
 v_mfma_f32_16x16x32_bf16 v[20:23], a[100:103], v[48:51], v[20:23]
 ds_read_b128 v[68:71], v7 offset:30720
 v_mfma_f32_16x16x32_bf16 v[24:27], a[96:99], v[52:55], v[24:27]
 buffer_load_dwordx4 v3, s[28:31], s53 offen offset:3072 sc1 lds
 v_mfma_f32_16x16x32_bf16 v[28:31], a[100:103], v[52:55], v[28:31]
 s_add_u32 s53, s53, s58
 s_waitcnt lgkmcnt(2)
 v_mfma_f32_16x16x32_bf16 v[16:19], a[104:107], v[56:59], v[16:19]
 ds_read_b128 v[72:75], v7 offset:23552
 v_mfma_f32_16x16x32_bf16 v[20:23], a[108:111], v[56:59], v[20:23]
 ds_read_b128 v[76:79], v7 offset:31744
 v_mfma_f32_16x16x32_bf16 v[24:27], a[104:107], v[60:63], v[24:27]
 v_mfma_f32_16x16x32_bf16 v[28:31], a[108:111], v[60:63], v[28:31]
 s_waitcnt lgkmcnt(2)
 v_mfma_f32_16x16x32_bf16 v[16:19], a[112:115], v[64:67], v[16:19]
 s_waitcnt vmcnt(20)
 s_barrier
 ds_read_b128 v[48:51], v7 offset:32768
 v_mfma_f32_16x16x32_bf16 v[20:23], a[116:119], v[64:67], v[20:23]
 ds_read_b128 v[52:55], v7 offset:40960
 v_mfma_f32_16x16x32_bf16 v[24:27], a[112:115], v[68:71], v[24:27]
 s_mov_b32 m0, s61
 s_nop 0
 v_mfma_f32_16x16x32_bf16 v[28:31], a[116:119], v[68:71], v[28:31]
 buffer_load_dwordx4 v3, s[28:31], s53 offen offset:0 sc1 lds
 s_waitcnt lgkmcnt(2)
 v_mfma_f32_16x16x32_bf16 v[16:19], a[120:123], v[72:75], v[16:19]
 ds_read_b128 v[56:59], v7 offset:33792
 v_mfma_f32_16x16x32_bf16 v[20:23], a[124:127], v[72:75], v[20:23]
 ds_read_b128 v[60:63], v7 offset:41984
 v_mfma_f32_16x16x32_bf16 v[24:27], a[120:123], v[76:79], v[24:27]
 v_mfma_f32_16x16x32_bf16 v[28:31], a[124:127], v[76:79], v[28:31]
 s_waitcnt lgkmcnt(2)
 v_mfma_f32_16x16x32_bf16 v[16:19], a[128:131], v[48:51], v[16:19]
 ds_read_b128 v[64:67], v7 offset:34816
 v_mfma_f32_16x16x32_bf16 v[20:23], a[132:135], v[48:51], v[20:23]
 ds_read_b128 v[68:71], v7 offset:43008
 v_mfma_f32_16x16x32_bf16 v[24:27], a[128:131], v[52:55], v[24:27]
 buffer_load_dwordx4 v3, s[28:31], s53 offen offset:1024 sc1 lds
 v_mfma_f32_16x16x32_bf16 v[28:31], a[132:135], v[52:55], v[28:31]
 s_waitcnt lgkmcnt(2)
 v_mfma_f32_16x16x32_bf16 v[16:19], a[136:139], v[56:59], v[16:19]
 ds_read_b128 v[72:75], v7 offset:35840
 v_mfma_f32_16x16x32_bf16 v[20:23], a[140:143], v[56:59], v[20:23]
 ds_read_b128 v[76:79], v7 offset:44032
 v_mfma_f32_16x16x32_bf16 v[24:27], a[136:139], v[60:63], v[24:27]
 v_mfma_f32_16x16x32_bf16 v[28:31], a[140:143], v[60:63], v[28:31]
 s_waitcnt lgkmcnt(2)
 v_mfma_f32_16x16x32_bf16 v[16:19], a[144:147], v[64:67], v[16:19]
 ds_read_b128 v[48:51], v7 offset:36864
 v_mfma_f32_16x16x32_bf16 v[20:23], a[148:151], v[64:67], v[20:23]
 ds_read_b128 v[52:55], v7 offset:45056
 v_mfma_f32_16x16x32_bf16 v[24:27], a[144:147], v[68:71], v[24:27]
 buffer_load_dwordx4 v3, s[28:31], s53 offen offset:2048 sc1 lds
 v_mfma_f32_16x16x32_bf16 v[28:31], a[148:151], v[68:71], v[28:31]
 s_waitcnt lgkmcnt(2)
 v_mfma_f32_16x16x32_bf16 v[16:19], a[152:155], v[72:75], v[16:19]
 ds_read_b128 v[56:59], v7 offset:37888
 v_mfma_f32_16x16x32_bf16 v[20:23], a[156:159], v[72:75], v[20:23]
 ds_read_b128 v[60:63], v7 offset:46080
 v_mfma_f32_16x16x32_bf16 v[24:27], a[152:155], v[76:79], v[24:27]
 v_mfma_f32_16x16x32_bf16 v[28:31], a[156:159], v[76:79], v[28:31]
 s_waitcnt lgkmcnt(2)
 v_mfma_f32_16x16x32_bf16 v[16:19], a[160:163], v[48:51], v[16:19]
 ds_read_b128 v[64:67], v7 offset:38912
 v_mfma_f32_16x16x32_bf16 v[20:23], a[164:167], v[48:51], v[20:23]
 ds_read_b128 v[68:71], v7 offset:47104
 v_mfma_f32_16x16x32_bf16 v[24:27], a[160:163], v[52:55], v[24:27]
 buffer_load_dwordx4 v3, s[28:31], s53 offen offset:3072 sc1 lds
 v_mfma_f32_16x16x32_bf16 v[28:31], a[164:167], v[52:55], v[28:31]
 s_add_u32 s53, s53, 8192
 s_waitcnt lgkmcnt(2)
 v_mfma_f32_16x16x32_bf16 v[16:19], a[168:171], v[56:59], v[16:19]
 ds_read_b128 v[72:75], v7 offset:39936
 v_mfma_f32_16x16x32_bf16 v[20:23], a[172:175], v[56:59], v[20:23]
 ds_read_b128 v[76:79], v7 offset:48128
 v_mfma_f32_16x16x32_bf16 v[24:27], a[168:171], v[60:63], v[24:27]
 v_mfma_f32_16x16x32_bf16 v[28:31], a[172:175], v[60:63], v[28:31]
 s_waitcnt lgkmcnt(2)
 v_mfma_f32_16x16x32_bf16 v[16:19], a[176:179], v[64:67], v[16:19]
 s_waitcnt vmcnt(20)
 s_barrier
 ds_read_b128 v[48:51], v7 offset:49152
 v_mfma_f32_16x16x32_bf16 v[20:23], a[180:183], v[64:67], v[20:23]
 ds_read_b128 v[52:55], v7 offset:57344
 v_mfma_f32_16x16x32_bf16 v[24:27], a[176:179], v[68:71], v[24:27]
 s_add_u32 m0, s61, 16384
 s_nop 0
 v_mfma_f32_16x16x32_bf16 v[28:31], a[180:183], v[68:71], v[28:31]
 buffer_load_dwordx4 v3, s[28:31], s53 offen offset:0 sc1 lds
 s_waitcnt lgkmcnt(2)
 v_mfma_f32_16x16x32_bf16 v[16:19], a[184:187], v[72:75], v[16:19]
 ds_read_b128 v[56:59], v7 offset:50176
 v_mfma_f32_16x16x32_bf16 v[20:23], a[188:191], v[72:75], v[20:23]
 ds_read_b128 v[60:63], v7 offset:58368
 v_mfma_f32_16x16x32_bf16 v[24:27], a[184:187], v[76:79], v[24:27]
 v_mfma_f32_16x16x32_bf16 v[28:31], a[188:191], v[76:79], v[28:31]
 s_waitcnt lgkmcnt(2)
 v_mfma_f32_16x16x32_bf16 v[16:19], a[192:195], v[48:51], v[16:19]
 ds_read_b128 v[64:67], v7 offset:51200
 v_mfma_f32_16x16x32_bf16 v[20:23], a[196:199], v[48:51], v[20:23]
 ds_read_b128 v[68:71], v7 offset:59392
 v_mfma_f32_16x16x32_bf16 v[24:27], a[192:195], v[52:55], v[24:27]
 buffer_load_dwordx4 v3, s[28:31], s53 offen offset:1024 sc1 lds
 v_mfma_f32_16x16x32_bf16 v[28:31], a[196:199], v[52:55], v[28:31]
 s_waitcnt lgkmcnt(2)
 v_mfma_f32_16x16x32_bf16 v[16:19], a[200:203], v[56:59], v[16:19]
 ds_read_b128 v[72:75], v7 offset:52224
 v_mfma_f32_16x16x32_bf16 v[20:23], a[204:207], v[56:59], v[20:23]
 ds_read_b128 v[76:79], v7 offset:60416
 v_mfma_f32_16x16x32_bf16 v[24:27], a[200:203], v[60:63], v[24:27]
 v_mfma_f32_16x16x32_bf16 v[28:31], a[204:207], v[60:63], v[28:31]
 s_waitcnt lgkmcnt(2)
 v_mfma_f32_16x16x32_bf16 v[16:19], a[208:211], v[64:67], v[16:19]
 ds_read_b128 v[48:51], v7 offset:53248
 v_mfma_f32_16x16x32_bf16 v[20:23], a[212:215], v[64:67], v[20:23]
 ds_read_b128 v[52:55], v7 offset:61440
 v_mfma_f32_16x16x32_bf16 v[24:27], a[208:211], v[68:71], v[24:27]
 buffer_load_dwordx4 v3, s[28:31], s53 offen offset:2048 sc1 lds
 v_mfma_f32_16x16x32_bf16 v[28:31], a[212:215], v[68:71], v[28:31]
 s_waitcnt lgkmcnt(2)
 v_mfma_f32_16x16x32_bf16 v[16:19], a[216:219], v[72:75], v[16:19]
 ds_read_b128 v[56:59], v7 offset:54272
 v_mfma_f32_16x16x32_bf16 v[20:23], a[220:223], v[72:75], v[20:23]
 ds_read_b128 v[60:63], v7 offset:62464
 v_mfma_f32_16x16x32_bf16 v[24:27], a[216:219], v[76:79], v[24:27]
 v_mfma_f32_16x16x32_bf16 v[28:31], a[220:223], v[76:79], v[28:31]
 s_waitcnt lgkmcnt(2)
 v_mfma_f32_16x16x32_bf16 v[16:19], a[224:227], v[48:51], v[16:19]
 ds_read_b128 v[64:67], v7 offset:55296
 v_mfma_f32_16x16x32_bf16 v[20:23], a[228:231], v[48:51], v[20:23]
 ds_read_b128 v[68:71], v7 offset:63488
 v_mfma_f32_16x16x32_bf16 v[24:27], a[224:227], v[52:55], v[24:27]
 buffer_load_dwordx4 v3, s[28:31], s53 offen offset:3072 sc1 lds
 v_mfma_f32_16x16x32_bf16 v[28:31], a[228:231], v[52:55], v[28:31]
 s_add_u32 s53, s53, 8192
 s_waitcnt lgkmcnt(2)
 v_mfma_f32_16x16x32_bf16 v[16:19], a[232:235], v[56:59], v[16:19]
 ds_read_b128 v[72:75], v7 offset:56320
 v_mfma_f32_16x16x32_bf16 v[20:23], a[236:239], v[56:59], v[20:23]
 ds_read_b128 v[76:79], v7 offset:64512
 v_mfma_f32_16x16x32_bf16 v[24:27], a[232:235], v[60:63], v[24:27]
 v_mfma_f32_16x16x32_bf16 v[28:31], a[236:239], v[60:63], v[28:31]
 s_waitcnt lgkmcnt(2)
 v_mfma_f32_16x16x32_bf16 v[16:19], a[240:243], v[64:67], v[16:19]
 s_waitcnt vmcnt(20)
 s_barrier
 ds_read_b128 v[48:51], v8 offset:0
 v_mfma_f32_16x16x32_bf16 v[20:23], a[244:247], v[64:67], v[20:23]
 ds_read_b128 v[52:55], v8 offset:8192
 v_mfma_f32_16x16x32_bf16 v[24:27], a[240:243], v[68:71], v[24:27]
 s_add_u32 m0, s61, 32768
 s_nop 0
 v_mfma_f32_16x16x32_bf16 v[28:31], a[244:247], v[68:71], v[28:31]
 buffer_load_dwordx4 v3, s[28:31], s53 offen offset:0 sc1 lds
 s_waitcnt lgkmcnt(2)
 v_mfma_f32_16x16x32_bf16 v[16:19], a[248:251], v[72:75], v[16:19]
 ds_read_b128 v[56:59], v8 offset:1024
 v_mfma_f32_16x16x32_bf16 v[20:23], a[252:255], v[72:75], v[20:23]
 ds_read_b128 v[60:63], v8 offset:9216
 v_mfma_f32_16x16x32_bf16 v[24:27], a[248:251], v[76:79], v[24:27]
 v_mfma_f32_16x16x32_bf16 v[28:31], a[252:255], v[76:79], v[28:31]
 s_sub_u32 s57, s57, 1
 s_cbranch_scc1 L_qk_end0
 s_waitcnt lgkmcnt(2)
 v_mfma_f32_16x16x32_bf16 v[32:35], a[0:3], v[48:51], 0
 ds_read_b128 v[64:67], v8 offset:2048
 v_mfma_f32_16x16x32_bf16 v[36:39], a[4:7], v[48:51], 0
 ds_read_b128 v[68:71], v8 offset:10240
 v_mfma_f32_16x16x32_bf16 v[40:43], a[0:3], v[52:55], 0
 buffer_load_dwordx4 v3, s[28:31], s53 offen offset:1024 sc1 lds
 v_mfma_f32_16x16x32_bf16 v[44:47], a[4:7], v[52:55], 0
 s_waitcnt lgkmcnt(2)
 v_mfma_f32_16x16x32_bf16 v[32:35], a[8:11], v[56:59], v[32:35]
 ds_read_b128 v[72:75], v8 offset:3072
 v_mfma_f32_16x16x32_bf16 v[36:39], a[12:15], v[56:59], v[36:39]
 ds_read_b128 v[76:79], v8 offset:11264
 v_mfma_f32_16x16x32_bf16 v[40:43], a[8:11], v[60:63], v[40:43]
 v_cvt_pk_bf16_f32 v80, v16, v17
 v_cvt_pk_bf16_f32 v81, v18, v19
 v_cvt_pk_bf16_f32 v82, v20, v21
 v_mfma_f32_16x16x32_bf16 v[44:47], a[12:15], v[60:63], v[44:47]
 v_cvt_pk_bf16_f32 v83, v22, v23
 v_pk_max_i16 v80, v80, s60
 s_waitcnt lgkmcnt(2)
 v_mfma_f32_16x16x32_bf16 v[32:35], a[16:19], v[64:67], v[32:35]
 ds_read_b128 v[48:51], v8 offset:4096
 v_mfma_f32_16x16x32_bf16 v[36:39], a[20:23], v[64:67], v[36:39]
 ds_read_b128 v[52:55], v8 offset:12288
 v_mfma_f32_16x16x32_bf16 v[40:43], a[16:19], v[68:71], v[40:43]
 buffer_load_dwordx4 v3, s[28:31], s53 offen offset:2048 sc1 lds
 v_mfma_f32_16x16x32_bf16 v[44:47], a[20:23], v[68:71], v[44:47]
 s_waitcnt lgkmcnt(2)
 v_mfma_f32_16x16x32_bf16 v[32:35], a[24:27], v[72:75], v[32:35]
 ds_read_b128 v[56:59], v8 offset:5120
 v_mfma_f32_16x16x32_bf16 v[36:39], a[28:31], v[72:75], v[36:39]
 ds_read_b128 v[60:63], v8 offset:13312
 v_mfma_f32_16x16x32_bf16 v[40:43], a[24:27], v[76:79], v[40:43]
 v_pk_max_i16 v81, v81, s60
 v_pk_max_i16 v82, v82, s60
 v_pk_max_i16 v83, v83, s60
 v_mfma_f32_16x16x32_bf16 v[44:47], a[28:31], v[76:79], v[44:47]
 buffer_store_dwordx4 v[80:83], v3, s[28:31], s54 offen sc1
 s_add_u32 s54, s54, s56
 s_waitcnt lgkmcnt(2)
 v_mfma_f32_16x16x32_bf16 v[32:35], a[32:35], v[48:51], v[32:35]
 ds_read_b128 v[64:67], v8 offset:6144
 v_mfma_f32_16x16x32_bf16 v[36:39], a[36:39], v[48:51], v[36:39]
 ds_read_b128 v[68:71], v8 offset:14336
 v_mfma_f32_16x16x32_bf16 v[40:43], a[32:35], v[52:55], v[40:43]
 buffer_load_dwordx4 v3, s[28:31], s53 offen offset:3072 sc1 lds
 v_mfma_f32_16x16x32_bf16 v[44:47], a[36:39], v[52:55], v[44:47]
 s_add_u32 s53, s53, 8192
 s_waitcnt lgkmcnt(2)
 v_mfma_f32_16x16x32_bf16 v[32:35], a[40:43], v[56:59], v[32:35]
 ds_read_b128 v[72:75], v8 offset:7168
 v_mfma_f32_16x16x32_bf16 v[36:39], a[44:47], v[56:59], v[36:39]
 ds_read_b128 v[76:79], v8 offset:15360
 v_mfma_f32_16x16x32_bf16 v[40:43], a[40:43], v[60:63], v[40:43]
 v_cvt_pk_bf16_f32 v84, v24, v25
 v_cvt_pk_bf16_f32 v85, v26, v27
 v_cvt_pk_bf16_f32 v86, v28, v29
 v_mfma_f32_16x16x32_bf16 v[44:47], a[44:47], v[60:63], v[44:47]
 v_cvt_pk_bf16_f32 v87, v30, v31
 v_pk_max_i16 v84, v84, s60
 s_waitcnt lgkmcnt(2)
 v_mfma_f32_16x16x32_bf16 v[32:35], a[48:51], v[64:67], v[32:35]
 s_waitcnt vmcnt(21)
 s_barrier
 ds_read_b128 v[48:51], v8 offset:16384
 v_mfma_f32_16x16x32_bf16 v[36:39], a[52:55], v[64:67], v[36:39]
 ds_read_b128 v[52:55], v8 offset:24576
 v_mfma_f32_16x16x32_bf16 v[40:43], a[48:51], v[68:71], v[40:43]
 s_add_u32 m0, s61, 49152
 s_nop 0
 v_mfma_f32_16x16x32_bf16 v[44:47], a[52:55], v[68:71], v[44:47]
 buffer_load_dwordx4 v3, s[28:31], s53 offen offset:0 sc1 lds
 s_waitcnt lgkmcnt(2)
 v_mfma_f32_16x16x32_bf16 v[32:35], a[56:59], v[72:75], v[32:35]
 ds_read_b128 v[56:59], v8 offset:17408
 v_mfma_f32_16x16x32_bf16 v[36:39], a[60:63], v[72:75], v[36:39]
 ds_read_b128 v[60:63], v8 offset:25600
 v_mfma_f32_16x16x32_bf16 v[40:43], a[56:59], v[76:79], v[40:43]
 v_pk_max_i16 v85, v85, s60
 v_pk_max_i16 v86, v86, s60
 v_pk_max_i16 v87, v87, s60
 v_mfma_f32_16x16x32_bf16 v[44:47], a[60:63], v[76:79], v[44:47]
 buffer_store_dwordx4 v[84:87], v3, s[28:31], s55 offen sc1
 s_add_u32 s55, s55, s56
 s_waitcnt lgkmcnt(2)
 v_mfma_f32_16x16x32_bf16 v[32:35], a[64:67], v[48:51], v[32:35]
 ds_read_b128 v[64:67], v8 offset:18432
 v_mfma_f32_16x16x32_bf16 v[36:39], a[68:71], v[48:51], v[36:39]
 ds_read_b128 v[68:71], v8 offset:26624
 v_mfma_f32_16x16x32_bf16 v[40:43], a[64:67], v[52:55], v[40:43]
 buffer_load_dwordx4 v3, s[28:31], s53 offen offset:1024 sc1 lds
 v_mfma_f32_16x16x32_bf16 v[44:47], a[68:71], v[52:55], v[44:47]
 s_waitcnt lgkmcnt(2)
 v_mfma_f32_16x16x32_bf16 v[32:35], a[72:75], v[56:59], v[32:35]
 ds_read_b128 v[72:75], v8 offset:19456
 v_mfma_f32_16x16x32_bf16 v[36:39], a[76:79], v[56:59], v[36:39]
 ds_read_b128 v[76:79], v8 offset:27648
 v_mfma_f32_16x16x32_bf16 v[40:43], a[72:75], v[60:63], v[40:43]
 v_mfma_f32_16x16x32_bf16 v[44:47], a[76:79], v[60:63], v[44:47]
 s_waitcnt lgkmcnt(2)
 v_mfma_f32_16x16x32_bf16 v[32:35], a[80:83], v[64:67], v[32:35]
 ds_read_b128 v[48:51], v8 offset:20480
 v_mfma_f32_16x16x32_bf16 v[36:39], a[84:87], v[64:67], v[36:39]
 ds_read_b128 v[52:55], v8 offset:28672
 v_mfma_f32_16x16x32_bf16 v[40:43], a[80:83], v[68:71], v[40:43]
 buffer_load_dwordx4 v3, s[28:31], s53 offen offset:2048 sc1 lds
 v_mfma_f32_16x16x32_bf16 v[44:47], a[84:87], v[68:71], v[44:47]
 s_waitcnt lgkmcnt(2)
 v_mfma_f32_16x16x32_bf16 v[32:35], a[88:91], v[72:75], v[32:35]
 ds_read_b128 v[56:59], v8 offset:21504
 v_mfma_f32_16x16x32_bf16 v[36:39], a[92:95], v[72:75], v[36:39]
 ds_read_b128 v[60:63], v8 offset:29696
 v_mfma_f32_16x16x32_bf16 v[40:43], a[88:91], v[76:79], v[40:43]
 v_mfma_f32_16x16x32_bf16 v[44:47], a[92:95], v[76:79], v[44:47]
 s_waitcnt lgkmcnt(2)
 v_mfma_f32_16x16x32_bf16 v[32:35], a[96:99], v[48:51], v[32:35]
 ds_read_b128 v[64:67], v8 offset:22528
 v_mfma_f32_16x16x32_bf16 v[36:39], a[100:103], v[48:51], v[36:39]
 ds_read_b128 v[68:71], v8 offset:30720
 v_mfma_f32_16x16x32_bf16 v[40:43], a[96:99], v[52:55], v[40:43]
 buffer_load_dwordx4 v3, s[28:31], s53 offen offset:3072 sc1 lds
 v_mfma_f32_16x16x32_bf16 v[44:47], a[100:103], v[52:55], v[44:47]
 s_add_u32 s53, s53, s58
 s_waitcnt lgkmcnt(2)
 v_mfma_f32_16x16x32_bf16 v[32:35], a[104:107], v[56:59], v[32:35]
 ds_read_b128 v[72:75], v8 offset:23552
 v_mfma_f32_16x16x32_bf16 v[36:39], a[108:111], v[56:59], v[36:39]
 ds_read_b128 v[76:79], v8 offset:31744
 v_mfma_f32_16x16x32_bf16 v[40:43], a[104:107], v[60:63], v[40:43]
 v_mfma_f32_16x16x32_bf16 v[44:47], a[108:111], v[60:63], v[44:47]
 s_waitcnt lgkmcnt(2)
 v_mfma_f32_16x16x32_bf16 v[32:35], a[112:115], v[64:67], v[32:35]
 s_waitcnt vmcnt(3)
 s_barrier
 ds_read_b128 v[48:51], v8 offset:32768
 v_mfma_f32_16x16x32_bf16 v[36:39], a[116:119], v[64:67], v[36:39]
 ds_read_b128 v[52:55], v8 offset:40960
 v_mfma_f32_16x16x32_bf16 v[40:43], a[112:115], v[68:71], v[40:43]
 s_add_u32 m0, s61, 65536
 s_nop 0
 v_mfma_f32_16x16x32_bf16 v[44:47], a[116:119], v[68:71], v[44:47]
 buffer_load_dwordx4 v3, s[28:31], s53 offen offset:0 sc1 lds
 s_waitcnt lgkmcnt(2)
 v_mfma_f32_16x16x32_bf16 v[32:35], a[120:123], v[72:75], v[32:35]
 ds_read_b128 v[56:59], v8 offset:33792
 v_mfma_f32_16x16x32_bf16 v[36:39], a[124:127], v[72:75], v[36:39]
 ds_read_b128 v[60:63], v8 offset:41984
 v_mfma_f32_16x16x32_bf16 v[40:43], a[120:123], v[76:79], v[40:43]
 v_mfma_f32_16x16x32_bf16 v[44:47], a[124:127], v[76:79], v[44:47]
 s_waitcnt lgkmcnt(2)
 v_mfma_f32_16x16x32_bf16 v[32:35], a[128:131], v[48:51], v[32:35]
 ds_read_b128 v[64:67], v8 offset:34816
 v_mfma_f32_16x16x32_bf16 v[36:39], a[132:135], v[48:51], v[36:39]
 ds_read_b128 v[68:71], v8 offset:43008
 v_mfma_f32_16x16x32_bf16 v[40:43], a[128:131], v[52:55], v[40:43]
 buffer_load_dwordx4 v3, s[28:31], s53 offen offset:1024 sc1 lds
 v_mfma_f32_16x16x32_bf16 v[44:47], a[132:135], v[52:55], v[44:47]
 s_waitcnt lgkmcnt(2)
 v_mfma_f32_16x16x32_bf16 v[32:35], a[136:139], v[56:59], v[32:35]
 ds_read_b128 v[72:75], v8 offset:35840
 v_mfma_f32_16x16x32_bf16 v[36:39], a[140:143], v[56:59], v[36:39]
 ds_read_b128 v[76:79], v8 offset:44032
 v_mfma_f32_16x16x32_bf16 v[40:43], a[136:139], v[60:63], v[40:43]
 s_add_u32 s64, s64, 2
 v_mov_b32 v1, s64
 v_mfma_f32_16x16x32_bf16 v[44:47], a[140:143], v[60:63], v[44:47]
 buffer_store_dword v1, v2, s[28:31], s59 offen sc1
 s_waitcnt lgkmcnt(2)
 v_mfma_f32_16x16x32_bf16 v[32:35], a[144:147], v[64:67], v[32:35]
 ds_read_b128 v[48:51], v8 offset:36864
 v_mfma_f32_16x16x32_bf16 v[36:39], a[148:151], v[64:67], v[36:39]
 ds_read_b128 v[52:55], v8 offset:45056
 v_mfma_f32_16x16x32_bf16 v[40:43], a[144:147], v[68:71], v[40:43]
 buffer_load_dwordx4 v3, s[28:31], s53 offen offset:2048 sc1 lds
 v_mfma_f32_16x16x32_bf16 v[44:47], a[148:151], v[68:71], v[44:47]
 s_waitcnt lgkmcnt(2)
 v_mfma_f32_16x16x32_bf16 v[32:35], a[152:155], v[72:75], v[32:35]
 ds_read_b128 v[56:59], v8 offset:37888
 v_mfma_f32_16x16x32_bf16 v[36:39], a[156:159], v[72:75], v[36:39]
 ds_read_b128 v[60:63], v8 offset:46080
 v_mfma_f32_16x16x32_bf16 v[40:43], a[152:155], v[76:79], v[40:43]
 v_mfma_f32_16x16x32_bf16 v[44:47], a[156:159], v[76:79], v[44:47]
 s_waitcnt lgkmcnt(2)
 v_mfma_f32_16x16x32_bf16 v[32:35], a[160:163], v[48:51], v[32:35]
 ds_read_b128 v[64:67], v8 offset:38912
 v_mfma_f32_16x16x32_bf16 v[36:39], a[164:167], v[48:51], v[36:39]
 ds_read_b128 v[68:71], v8 offset:47104
 v_mfma_f32_16x16x32_bf16 v[40:43], a[160:163], v[52:55], v[40:43]
 buffer_load_dwordx4 v3, s[28:31], s53 offen offset:3072 sc1 lds
 v_mfma_f32_16x16x32_bf16 v[44:47], a[164:167], v[52:55], v[44:47]
 s_add_u32 s53, s53, 8192
 s_waitcnt lgkmcnt(2)
 v_mfma_f32_16x16x32_bf16 v[32:35], a[168:171], v[56:59], v[32:35]
 ds_read_b128 v[72:75], v8 offset:39936
 v_mfma_f32_16x16x32_bf16 v[36:39], a[172:175], v[56:59], v[36:39]
 ds_read_b128 v[76:79], v8 offset:48128
 v_mfma_f32_16x16x32_bf16 v[40:43], a[168:171], v[60:63], v[40:43]
 v_mfma_f32_16x16x32_bf16 v[44:47], a[172:175], v[60:63], v[44:47]
 s_waitcnt lgkmcnt(2)
 v_mfma_f32_16x16x32_bf16 v[32:35], a[176:179], v[64:67], v[32:35]
 s_waitcnt vmcnt(23)
 s_barrier
 ds_read_b128 v[48:51], v8 offset:49152
 v_mfma_f32_16x16x32_bf16 v[36:39], a[180:183], v[64:67], v[36:39]
 ds_read_b128 v[52:55], v8 offset:57344
 v_mfma_f32_16x16x32_bf16 v[40:43], a[176:179], v[68:71], v[40:43]
 s_add_u32 m0, s61, 81920
 s_nop 0
 v_mfma_f32_16x16x32_bf16 v[44:47], a[180:183], v[68:71], v[44:47]
 buffer_load_dwordx4 v3, s[28:31], s53 offen offset:0 sc1 lds
 s_waitcnt lgkmcnt(2)
 v_mfma_f32_16x16x32_bf16 v[32:35], a[184:187], v[72:75], v[32:35]
 ds_read_b128 v[56:59], v8 offset:50176
 v_mfma_f32_16x16x32_bf16 v[36:39], a[188:191], v[72:75], v[36:39]
 ds_read_b128 v[60:63], v8 offset:58368
 v_mfma_f32_16x16x32_bf16 v[40:43], a[184:187], v[76:79], v[40:43]
 v_mfma_f32_16x16x32_bf16 v[44:47], a[188:191], v[76:79], v[44:47]
 s_waitcnt lgkmcnt(2)
 v_mfma_f32_16x16x32_bf16 v[32:35], a[192:195], v[48:51], v[32:35]
 ds_read_b128 v[64:67], v8 offset:51200
 v_mfma_f32_16x16x32_bf16 v[36:39], a[196:199], v[48:51], v[36:39]
 ds_read_b128 v[68:71], v8 offset:59392
 v_mfma_f32_16x16x32_bf16 v[40:43], a[192:195], v[52:55], v[40:43]
 buffer_load_dwordx4 v3, s[28:31], s53 offen offset:1024 sc1 lds
 v_mfma_f32_16x16x32_bf16 v[44:47], a[196:199], v[52:55], v[44:47]
 s_waitcnt lgkmcnt(2)
 v_mfma_f32_16x16x32_bf16 v[32:35], a[200:203], v[56:59], v[32:35]
 ds_read_b128 v[72:75], v8 offset:52224
 v_mfma_f32_16x16x32_bf16 v[36:39], a[204:207], v[56:59], v[36:39]
 ds_read_b128 v[76:79], v8 offset:60416
 v_mfma_f32_16x16x32_bf16 v[40:43], a[200:203], v[60:63], v[40:43]
 v_mfma_f32_16x16x32_bf16 v[44:47], a[204:207], v[60:63], v[44:47]
 s_waitcnt lgkmcnt(2)
 v_mfma_f32_16x16x32_bf16 v[32:35], a[208:211], v[64:67], v[32:35]
 ds_read_b128 v[48:51], v8 offset:53248
 v_mfma_f32_16x16x32_bf16 v[36:39], a[212:215], v[64:67], v[36:39]
 ds_read_b128 v[52:55], v8 offset:61440
 v_mfma_f32_16x16x32_bf16 v[40:43], a[208:211], v[68:71], v[40:43]
 buffer_load_dwordx4 v3, s[28:31], s53 offen offset:2048 sc1 lds
 v_mfma_f32_16x16x32_bf16 v[44:47], a[212:215], v[68:71], v[44:47]
 s_waitcnt lgkmcnt(2)
 v_mfma_f32_16x16x32_bf16 v[32:35], a[216:219], v[72:75], v[32:35]
 ds_read_b128 v[56:59], v8 offset:54272
 v_mfma_f32_16x16x32_bf16 v[36:39], a[220:223], v[72:75], v[36:39]
 ds_read_b128 v[60:63], v8 offset:62464
 v_mfma_f32_16x16x32_bf16 v[40:43], a[216:219], v[76:79], v[40:43]
 v_mfma_f32_16x16x32_bf16 v[44:47], a[220:223], v[76:79], v[44:47]
 s_waitcnt lgkmcnt(2)
 v_mfma_f32_16x16x32_bf16 v[32:35], a[224:227], v[48:51], v[32:35]
 ds_read_b128 v[64:67], v8 offset:55296
 v_mfma_f32_16x16x32_bf16 v[36:39], a[228:231], v[48:51], v[36:39]
 ds_read_b128 v[68:71], v8 offset:63488
 v_mfma_f32_16x16x32_bf16 v[40:43], a[224:227], v[52:55], v[40:43]
 buffer_load_dwordx4 v3, s[28:31], s53 offen offset:3072 sc1 lds
 v_mfma_f32_16x16x32_bf16 v[44:47], a[228:231], v[52:55], v[44:47]
 s_add_u32 s53, s53, 8192
 s_waitcnt lgkmcnt(2)
 v_mfma_f32_16x16x32_bf16 v[32:35], a[232:235], v[56:59], v[32:35]
 ds_read_b128 v[72:75], v8 offset:56320
 v_mfma_f32_16x16x32_bf16 v[36:39], a[236:239], v[56:59], v[36:39]
 ds_read_b128 v[76:79], v8 offset:64512
 v_mfma_f32_16x16x32_bf16 v[40:43], a[232:235], v[60:63], v[40:43]
 v_mfma_f32_16x16x32_bf16 v[44:47], a[236:239], v[60:63], v[44:47]
 s_waitcnt lgkmcnt(2)
 v_mfma_f32_16x16x32_bf16 v[32:35], a[240:243], v[64:67], v[32:35]
 s_waitcnt vmcnt(23)
 s_barrier
 ds_read_b128 v[48:51], v7 offset:0
 v_mfma_f32_16x16x32_bf16 v[36:39], a[244:247], v[64:67], v[36:39]
 ds_read_b128 v[52:55], v7 offset:8192
 v_mfma_f32_16x16x32_bf16 v[40:43], a[240:243], v[68:71], v[40:43]
 s_add_u32 m0, s61, 98304
 s_nop 0
 v_mfma_f32_16x16x32_bf16 v[44:47], a[244:247], v[68:71], v[44:47]
 buffer_load_dwordx4 v3, s[28:31], s53 offen offset:0 sc1 lds
 s_waitcnt lgkmcnt(2)
 v_mfma_f32_16x16x32_bf16 v[32:35], a[248:251], v[72:75], v[32:35]
 ds_read_b128 v[56:59], v7 offset:1024
 v_mfma_f32_16x16x32_bf16 v[36:39], a[252:255], v[72:75], v[36:39]
 ds_read_b128 v[60:63], v7 offset:9216
 v_mfma_f32_16x16x32_bf16 v[40:43], a[248:251], v[76:79], v[40:43]
 v_mfma_f32_16x16x32_bf16 v[44:47], a[252:255], v[76:79], v[44:47]
 s_sub_u32 s57, s57, 1
 s_cbranch_scc1 L_qk_end1
 v_mov_b32 v1, 0
gw_32:
 global_load_dword v9, v1, s[22:23] offset:4 sc1
 s_waitcnt vmcnt(0)
 v_readfirstlane_b32 s48, v9
 s_cmp_ge_u32 s48, 128
 s_cbranch_scc1 gwd_33
 s_sub_u32 s26, s26, 1
 s_cbranch_scc1 L_end
 s_sleep 2
 s_branch gw_32
gwd_33:
 s_waitcnt lgkmcnt(2)
 v_mfma_f32_16x16x32_bf16 v[16:19], a[0:3], v[48:51], 0
 ds_read_b128 v[64:67], v7 offset:2048
 v_mfma_f32_16x16x32_bf16 v[20:23], a[4:7], v[48:51], 0
 ds_read_b128 v[68:71], v7 offset:10240
 v_mfma_f32_16x16x32_bf16 v[24:27], a[0:3], v[52:55], 0
 buffer_load_dwordx4 v3, s[28:31], s53 offen offset:1024 sc1 lds
 v_mfma_f32_16x16x32_bf16 v[28:31], a[4:7], v[52:55], 0
 s_waitcnt lgkmcnt(2)
 v_mfma_f32_16x16x32_bf16 v[16:19], a[8:11], v[56:59], v[16:19]
 ds_read_b128 v[72:75], v7 offset:3072
 v_mfma_f32_16x16x32_bf16 v[20:23], a[12:15], v[56:59], v[20:23]
 ds_read_b128 v[76:79], v7 offset:11264
 v_mfma_f32_16x16x32_bf16 v[24:27], a[8:11], v[60:63], v[24:27]
 v_cvt_pk_bf16_f32 v80, v32, v33
 v_cvt_pk_bf16_f32 v81, v34, v35
 v_cvt_pk_bf16_f32 v82, v36, v37
 v_mfma_f32_16x16x32_bf16 v[28:31], a[12:15], v[60:63], v[28:31]
 v_cvt_pk_bf16_f32 v83, v38, v39
 v_pk_max_i16 v80, v80, s60
 s_waitcnt lgkmcnt(2)
 v_mfma_f32_16x16x32_bf16 v[16:19], a[16:19], v[64:67], v[16:19]
 ds_read_b128 v[48:51], v7 offset:4096
 v_mfma_f32_16x16x32_bf16 v[20:23], a[20:23], v[64:67], v[20:23]
 ds_read_b128 v[52:55], v7 offset:12288
 v_mfma_f32_16x16x32_bf16 v[24:27], a[16:19], v[68:71], v[24:27]
 buffer_load_dwordx4 v3, s[28:31], s53 offen offset:2048 sc1 lds
 v_mfma_f32_16x16x32_bf16 v[28:31], a[20:23], v[68:71], v[28:31]
 s_waitcnt lgkmcnt(2)
 v_mfma_f32_16x16x32_bf16 v[16:19], a[24:27], v[72:75], v[16:19]
 ds_read_b128 v[56:59], v7 offset:5120
 v_mfma_f32_16x16x32_bf16 v[20:23], a[28:31], v[72:75], v[20:23]
 ds_read_b128 v[60:63], v7 offset:13312
 v_mfma_f32_16x16x32_bf16 v[24:27], a[24:27], v[76:79], v[24:27]
 v_pk_max_i16 v81, v81, s60
 v_pk_max_i16 v82, v82, s60
 v_pk_max_i16 v83, v83, s60
 v_mfma_f32_16x16x32_bf16 v[28:31], a[28:31], v[76:79], v[28:31]
 buffer_store_dwordx4 v[80:83], v3, s[28:31], s54 offen sc1
 s_add_u32 s54, s54, s56
 s_waitcnt lgkmcnt(2)
 v_mfma_f32_16x16x32_bf16 v[16:19], a[32:35], v[48:51], v[16:19]
 ds_read_b128 v[64:67], v7 offset:6144
 v_mfma_f32_16x16x32_bf16 v[20:23], a[36:39], v[48:51], v[20:23]
 ds_read_b128 v[68:71], v7 offset:14336
 v_mfma_f32_16x16x32_bf16 v[24:27], a[32:35], v[52:55], v[24:27]
 buffer_load_dwordx4 v3, s[28:31], s53 offen offset:3072 sc1 lds
 v_mfma_f32_16x16x32_bf16 v[28:31], a[36:39], v[52:55], v[28:31]
 s_add_u32 s53, s53, 8192
 s_waitcnt lgkmcnt(2)
 v_mfma_f32_16x16x32_bf16 v[16:19], a[40:43], v[56:59], v[16:19]
 ds_read_b128 v[72:75], v7 offset:7168
 v_mfma_f32_16x16x32_bf16 v[20:23], a[44:47], v[56:59], v[20:23]
 ds_read_b128 v[76:79], v7 offset:15360
 v_mfma_f32_16x16x32_bf16 v[24:27], a[40:43], v[60:63], v[24:27]
 v_cvt_pk_bf16_f32 v84, v40, v41
 v_cvt_pk_bf16_f32 v85, v42, v43
 v_cvt_pk_bf16_f32 v86, v44, v45
 v_mfma_f32_16x16x32_bf16 v[28:31], a[44:47], v[60:63], v[28:31]
 v_cvt_pk_bf16_f32 v87, v46, v47
 v_pk_max_i16 v84, v84, s60
 s_waitcnt lgkmcnt(2)
 v_mfma_f32_16x16x32_bf16 v[16:19], a[48:51], v[64:67], v[16:19]
 s_waitcnt vmcnt(24)
 s_barrier
 ds_read_b128 v[48:51], v7 offset:16384
 v_mfma_f32_16x16x32_bf16 v[20:23], a[52:55], v[64:67], v[20:23]
 ds_read_b128 v[52:55], v7 offset:24576
 v_mfma_f32_16x16x32_bf16 v[24:27], a[48:51], v[68:71], v[24:27]
 s_add_u32 m0, s61, 114688
 s_nop 0
 v_mfma_f32_16x16x32_bf16 v[28:31], a[52:55], v[68:71], v[28:31]
 buffer_load_dwordx4 v3, s[28:31], s53 offen offset:0 sc1 lds
 s_waitcnt lgkmcnt(2)
 v_mfma_f32_16x16x32_bf16 v[16:19], a[56:59], v[72:75], v[16:19]
 ds_read_b128 v[56:59], v7 offset:17408
 v_mfma_f32_16x16x32_bf16 v[20:23], a[60:63], v[72:75], v[20:23]
 ds_read_b128 v[60:63], v7 offset:25600
 v_mfma_f32_16x16x32_bf16 v[24:27], a[56:59], v[76:79], v[24:27]
 v_pk_max_i16 v85, v85, s60
 v_pk_max_i16 v86, v86, s60
 v_pk_max_i16 v87, v87, s60
 v_mfma_f32_16x16x32_bf16 v[28:31], a[60:63], v[76:79], v[28:31]
 buffer_store_dwordx4 v[84:87], v3, s[28:31], s55 offen sc1
 s_add_u32 s55, s55, s56
 s_waitcnt lgkmcnt(2)
 v_mfma_f32_16x16x32_bf16 v[16:19], a[64:67], v[48:51], v[16:19]
 ds_read_b128 v[64:67], v7 offset:18432
 v_mfma_f32_16x16x32_bf16 v[20:23], a[68:71], v[48:51], v[20:23]
 ds_read_b128 v[68:71], v7 offset:26624
 v_mfma_f32_16x16x32_bf16 v[24:27], a[64:67], v[52:55], v[24:27]
 buffer_load_dwordx4 v3, s[28:31], s53 offen offset:1024 sc1 lds
 v_mfma_f32_16x16x32_bf16 v[28:31], a[68:71], v[52:55], v[28:31]
 s_waitcnt lgkmcnt(2)
 v_mfma_f32_16x16x32_bf16 v[16:19], a[72:75], v[56:59], v[16:19]
 ds_read_b128 v[72:75], v7 offset:19456
 v_mfma_f32_16x16x32_bf16 v[20:23], a[76:79], v[56:59], v[20:23]
 ds_read_b128 v[76:79], v7 offset:27648
 v_mfma_f32_16x16x32_bf16 v[24:27], a[72:75], v[60:63], v[24:27]
 v_mfma_f32_16x16x32_bf16 v[28:31], a[76:79], v[60:63], v[28:31]
 s_waitcnt lgkmcnt(2)
 v_mfma_f32_16x16x32_bf16 v[16:19], a[80:83], v[64:67], v[16:19]
 ds_read_b128 v[48:51], v7 offset:20480
 v_mfma_f32_16x16x32_bf16 v[20:23], a[84:87], v[64:67], v[20:23]
 ds_read_b128 v[52:55], v7 offset:28672
 v_mfma_f32_16x16x32_bf16 v[24:27], a[80:83], v[68:71], v[24:27]
 buffer_load_dwordx4 v3, s[28:31], s53 offen offset:2048 sc1 lds
 v_mfma_f32_16x16x32_bf16 v[28:31], a[84:87], v[68:71], v[28:31]
 s_waitcnt lgkmcnt(2)
 v_mfma_f32_16x16x32_bf16 v[16:19], a[88:91], v[72:75], v[16:19]
 ds_read_b128 v[56:59], v7 offset:21504
 v_mfma_f32_16x16x32_bf16 v[20:23], a[92:95], v[72:75], v[20:23]
 ds_read_b128 v[60:63], v7 offset:29696
 v_mfma_f32_16x16x32_bf16 v[24:27], a[88:91], v[76:79], v[24:27]
 v_mfma_f32_16x16x32_bf16 v[28:31], a[92:95], v[76:79], v[28:31]
 s_waitcnt lgkmcnt(2)
 v_mfma_f32_16x16x32_bf16 v[16:19], a[96:99], v[48:51], v[16:19]
 ds_read_b128 v[64:67], v7 offset:22528
 v_mfma_f32_16x16x32_bf16 v[20:23], a[100:103], v[48:51], v[20:23]
 ds_read_b128 v[68:71], v7 offset:30720
 v_mfma_f32_16x16x32_bf16 v[24:27], a[96:99], v[52:55], v[24:27]
 buffer_load_dwordx4 v3, s[28:31], s53 offen offset:3072 sc1 lds
 v_mfma_f32_16x16x32_bf16 v[28:31], a[100:103], v[52:55], v[28:31]
 s_add_u32 s53, s53, s58
 s_waitcnt lgkmcnt(2)
 v_mfma_f32_16x16x32_bf16 v[16:19], a[104:107], v[56:59], v[16:19]
 ds_read_b128 v[72:75], v7 offset:23552
 v_mfma_f32_16x16x32_bf16 v[20:23], a[108:111], v[56:59], v[20:23]
 ds_read_b128 v[76:79], v7 offset:31744
 v_mfma_f32_16x16x32_bf16 v[24:27], a[104:107], v[60:63], v[24:27]
 v_mfma_f32_16x16x32_bf16 v[28:31], a[108:111], v[60:63], v[28:31]
 s_waitcnt lgkmcnt(2)
 v_mfma_f32_16x16x32_bf16 v[16:19], a[112:115], v[64:67], v[16:19]
 s_waitcnt vmcnt(24)
 s_barrier
 ds_read_b128 v[48:51], v7 offset:32768
 v_mfma_f32_16x16x32_bf16 v[20:23], a[116:119], v[64:67], v[20:23]
 ds_read_b128 v[52:55], v7 offset:40960
 v_mfma_f32_16x16x32_bf16 v[24:27], a[112:115], v[68:71], v[24:27]
 s_mov_b32 m0, s61
 s_nop 0
 v_mfma_f32_16x16x32_bf16 v[28:31], a[116:119], v[68:71], v[28:31]
 buffer_load_dwordx4 v3, s[28:31], s53 offen offset:0 sc1 lds
 s_waitcnt lgkmcnt(2)
 v_mfma_f32_16x16x32_bf16 v[16:19], a[120:123], v[72:75], v[16:19]
 ds_read_b128 v[56:59], v7 offset:33792
 v_mfma_f32_16x16x32_bf16 v[20:23], a[124:127], v[72:75], v[20:23]
 ds_read_b128 v[60:63], v7 offset:41984
 v_mfma_f32_16x16x32_bf16 v[24:27], a[120:123], v[76:79], v[24:27]
 v_mfma_f32_16x16x32_bf16 v[28:31], a[124:127], v[76:79], v[28:31]
 s_waitcnt lgkmcnt(2)
 v_mfma_f32_16x16x32_bf16 v[16:19], a[128:131], v[48:51], v[16:19]
 ds_read_b128 v[64:67], v7 offset:34816
 v_mfma_f32_16x16x32_bf16 v[20:23], a[132:135], v[48:51], v[20:23]
 ds_read_b128 v[68:71], v7 offset:43008
 v_mfma_f32_16x16x32_bf16 v[24:27], a[128:131], v[52:55], v[24:27]
 buffer_load_dwordx4 v3, s[28:31], s53 offen offset:1024 sc1 lds
 v_mfma_f32_16x16x32_bf16 v[28:31], a[132:135], v[52:55], v[28:31]
 s_waitcnt lgkmcnt(2)
 v_mfma_f32_16x16x32_bf16 v[16:19], a[136:139], v[56:59], v[16:19]
 ds_read_b128 v[72:75], v7 offset:35840
 v_mfma_f32_16x16x32_bf16 v[20:23], a[140:143], v[56:59], v[20:23]
 ds_read_b128 v[76:79], v7 offset:44032
 v_mfma_f32_16x16x32_bf16 v[24:27], a[136:139], v[60:63], v[24:27]
 v_mfma_f32_16x16x32_bf16 v[28:31], a[140:143], v[60:63], v[28:31]
 s_waitcnt lgkmcnt(2)
 v_mfma_f32_16x16x32_bf16 v[16:19], a[144:147], v[64:67], v[16:19]
 ds_read_b128 v[48:51], v7 offset:36864
 v_mfma_f32_16x16x32_bf16 v[20:23], a[148:151], v[64:67], v[20:23]
 ds_read_b128 v[52:55], v7 offset:45056
 v_mfma_f32_16x16x32_bf16 v[24:27], a[144:147], v[68:71], v[24:27]
 buffer_load_dwordx4 v3, s[28:31], s53 offen offset:2048 sc1 lds
 v_mfma_f32_16x16x32_bf16 v[28:31], a[148:151], v[68:71], v[28:31]
 s_waitcnt lgkmcnt(2)
 v_mfma_f32_16x16x32_bf16 v[16:19], a[152:155], v[72:75], v[16:19]
 ds_read_b128 v[56:59], v7 offset:37888
 v_mfma_f32_16x16x32_bf16 v[20:23], a[156:159], v[72:75], v[20:23]
 ds_read_b128 v[60:63], v7 offset:46080
 v_mfma_f32_16x16x32_bf16 v[24:27], a[152:155], v[76:79], v[24:27]
 v_mfma_f32_16x16x32_bf16 v[28:31], a[156:159], v[76:79], v[28:31]
 s_waitcnt lgkmcnt(2)
 v_mfma_f32_16x16x32_bf16 v[16:19], a[160:163], v[48:51], v[16:19]
 ds_read_b128 v[64:67], v7 offset:38912
 v_mfma_f32_16x16x32_bf16 v[20:23], a[164:167], v[48:51], v[20:23]
 ds_read_b128 v[68:71], v7 offset:47104
 v_mfma_f32_16x16x32_bf16 v[24:27], a[160:163], v[52:55], v[24:27]
 buffer_load_dwordx4 v3, s[28:31], s53 offen offset:3072 sc1 lds
 v_mfma_f32_16x16x32_bf16 v[28:31], a[164:167], v[52:55], v[28:31]
 s_add_u32 s53, s53, 8192
 s_waitcnt lgkmcnt(2)
 v_mfma_f32_16x16x32_bf16 v[16:19], a[168:171], v[56:59], v[16:19]
 ds_read_b128 v[72:75], v7 offset:39936
 v_mfma_f32_16x16x32_bf16 v[20:23], a[172:175], v[56:59], v[20:23]
 ds_read_b128 v[76:79], v7 offset:48128
 v_mfma_f32_16x16x32_bf16 v[24:27], a[168:171], v[60:63], v[24:27]
 v_mfma_f32_16x16x32_bf16 v[28:31], a[172:175], v[60:63], v[28:31]
 s_waitcnt lgkmcnt(2)
 v_mfma_f32_16x16x32_bf16 v[16:19], a[176:179], v[64:67], v[16:19]
 s_waitcnt vmcnt(23)
 s_barrier
 ds_read_b128 v[48:51], v7 offset:49152
 v_mfma_f32_16x16x32_bf16 v[20:23], a[180:183], v[64:67], v[20:23]
 ds_read_b128 v[52:55], v7 offset:57344
 v_mfma_f32_16x16x32_bf16 v[24:27], a[176:179], v[68:71], v[24:27]
 s_add_u32 m0, s61, 16384
 s_nop 0
 v_mfma_f32_16x16x32_bf16 v[28:31], a[180:183], v[68:71], v[28:31]
 buffer_load_dwordx4 v3, s[28:31], s53 offen offset:0 sc1 lds
 s_waitcnt lgkmcnt(2)
 v_mfma_f32_16x16x32_bf16 v[16:19], a[184:187], v[72:75], v[16:19]
 ds_read_b128 v[56:59], v7 offset:50176
 v_mfma_f32_16x16x32_bf16 v[20:23], a[188:191], v[72:75], v[20:23]
 ds_read_b128 v[60:63], v7 offset:58368
 v_mfma_f32_16x16x32_bf16 v[24:27], a[184:187], v[76:79], v[24:27]
 v_mfma_f32_16x16x32_bf16 v[28:31], a[188:191], v[76:79], v[28:31]
 s_waitcnt lgkmcnt(2)
 v_mfma_f32_16x16x32_bf16 v[16:19], a[192:195], v[48:51], v[16:19]
 ds_read_b128 v[64:67], v7 offset:51200
 v_mfma_f32_16x16x32_bf16 v[20:23], a[196:199], v[48:51], v[20:23]
 ds_read_b128 v[68:71], v7 offset:59392
 v_mfma_f32_16x16x32_bf16 v[24:27], a[192:195], v[52:55], v[24:27]
 buffer_load_dwordx4 v3, s[28:31], s53 offen offset:1024 sc1 lds
 v_mfma_f32_16x16x32_bf16 v[28:31], a[196:199], v[52:55], v[28:31]
 s_waitcnt lgkmcnt(2)
 v_mfma_f32_16x16x32_bf16 v[16:19], a[200:203], v[56:59], v[16:19]
 ds_read_b128 v[72:75], v7 offset:52224
 v_mfma_f32_16x16x32_bf16 v[20:23], a[204:207], v[56:59], v[20:23]
 ds_read_b128 v[76:79], v7 offset:60416
 v_mfma_f32_16x16x32_bf16 v[24:27], a[200:203], v[60:63], v[24:27]
 v_mfma_f32_16x16x32_bf16 v[28:31], a[204:207], v[60:63], v[28:31]
 s_waitcnt lgkmcnt(2)
 v_mfma_f32_16x16x32_bf16 v[16:19], a[208:211], v[64:67], v[16:19]
 ds_read_b128 v[48:51], v7 offset:53248
 v_mfma_f32_16x16x32_bf16 v[20:23], a[212:215], v[64:67], v[20:23]
 ds_read_b128 v[52:55], v7 offset:61440
 v_mfma_f32_16x16x32_bf16 v[24:27], a[208:211], v[68:71], v[24:27]
 buffer_load_dwordx4 v3, s[28:31], s53 offen offset:2048 sc1 lds
 v_mfma_f32_16x16x32_bf16 v[28:31], a[212:215], v[68:71], v[28:31]
 s_waitcnt lgkmcnt(2)
 v_mfma_f32_16x16x32_bf16 v[16:19], a[216:219], v[72:75], v[16:19]
 ds_read_b128 v[56:59], v7 offset:54272
 v_mfma_f32_16x16x32_bf16 v[20:23], a[220:223], v[72:75], v[20:23]
 ds_read_b128 v[60:63], v7 offset:62464
 v_mfma_f32_16x16x32_bf16 v[24:27], a[216:219], v[76:79], v[24:27]
 v_mfma_f32_16x16x32_bf16 v[28:31], a[220:223], v[76:79], v[28:31]
 s_waitcnt lgkmcnt(2)
 v_mfma_f32_16x16x32_bf16 v[16:19], a[224:227], v[48:51], v[16:19]
 ds_read_b128 v[64:67], v7 offset:55296
 v_mfma_f32_16x16x32_bf16 v[20:23], a[228:231], v[48:51], v[20:23]
 ds_read_b128 v[68:71], v7 offset:63488
 v_mfma_f32_16x16x32_bf16 v[24:27], a[224:227], v[52:55], v[24:27]
 buffer_load_dwordx4 v3, s[28:31], s53 offen offset:3072 sc1 lds
 v_mfma_f32_16x16x32_bf16 v[28:31], a[228:231], v[52:55], v[28:31]
 s_add_u32 s53, s53, 8192
 s_waitcnt lgkmcnt(2)
 v_mfma_f32_16x16x32_bf16 v[16:19], a[232:235], v[56:59], v[16:19]
 ds_read_b128 v[72:75], v7 offset:56320
 v_mfma_f32_16x16x32_bf16 v[20:23], a[236:239], v[56:59], v[20:23]
 ds_read_b128 v[76:79], v7 offset:64512
 v_mfma_f32_16x16x32_bf16 v[24:27], a[232:235], v[60:63], v[24:27]
 v_mfma_f32_16x16x32_bf16 v[28:31], a[236:239], v[60:63], v[28:31]
 s_waitcnt lgkmcnt(2)
 v_mfma_f32_16x16x32_bf16 v[16:19], a[240:243], v[64:67], v[16:19]
 s_waitcnt vmcnt(22)
 s_barrier
 ds_read_b128 v[48:51], v8 offset:0
 v_mfma_f32_16x16x32_bf16 v[20:23], a[244:247], v[64:67], v[20:23]
 ds_read_b128 v[52:55], v8 offset:8192
 v_mfma_f32_16x16x32_bf16 v[24:27], a[240:243], v[68:71], v[24:27]
 s_add_u32 m0, s61, 32768
 s_nop 0
 v_mfma_f32_16x16x32_bf16 v[28:31], a[244:247], v[68:71], v[28:31]
 buffer_load_dwordx4 v3, s[28:31], s53 offen offset:0 sc1 lds
 s_waitcnt lgkmcnt(2)
 v_mfma_f32_16x16x32_bf16 v[16:19], a[248:251], v[72:75], v[16:19]
 ds_read_b128 v[56:59], v8 offset:1024
 v_mfma_f32_16x16x32_bf16 v[20:23], a[252:255], v[72:75], v[20:23]
 ds_read_b128 v[60:63], v8 offset:9216
 v_mfma_f32_16x16x32_bf16 v[24:27], a[248:251], v[76:79], v[24:27]
 v_mfma_f32_16x16x32_bf16 v[28:31], a[252:255], v[76:79], v[28:31]
 s_sub_u32 s57, s57, 1
 s_cbranch_scc1 L_qk_end0
L_qk_top:
 s_waitcnt lgkmcnt(2)
 v_mfma_f32_16x16x32_bf16 v[32:35], a[0:3], v[48:51], 0
 ds_read_b128 v[64:67], v8 offset:2048
 v_mfma_f32_16x16x32_bf16 v[36:39], a[4:7], v[48:51], 0
 ds_read_b128 v[68:71], v8 offset:10240
 v_mfma_f32_16x16x32_bf16 v[40:43], a[0:3], v[52:55], 0
 buffer_load_dwordx4 v3, s[28:31], s53 offen offset:1024 sc1 lds
 v_mfma_f32_16x16x32_bf16 v[44:47], a[4:7], v[52:55], 0
 s_waitcnt lgkmcnt(2)
 v_mfma_f32_16x16x32_bf16 v[32:35], a[8:11], v[56:59], v[32:35]
 ds_read_b128 v[72:75], v8 offset:3072
 v_mfma_f32_16x16x32_bf16 v[36:39], a[12:15], v[56:59], v[36:39]
 ds_read_b128 v[76:79], v8 offset:11264
 v_mfma_f32_16x16x32_bf16 v[40:43], a[8:11], v[60:63], v[40:43]
 v_cvt_pk_bf16_f32 v80, v16, v17
 v_cvt_pk_bf16_f32 v81, v18, v19
 v_cvt_pk_bf16_f32 v82, v20, v21
 v_mfma_f32_16x16x32_bf16 v[44:47], a[12:15], v[60:63], v[44:47]
 v_cvt_pk_bf16_f32 v83, v22, v23
 v_pk_max_i16 v80, v80, s60
 s_waitcnt lgkmcnt(2)
 v_mfma_f32_16x16x32_bf16 v[32:35], a[16:19], v[64:67], v[32:35]
 ds_read_b128 v[48:51], v8 offset:4096
 v_mfma_f32_16x16x32_bf16 v[36:39], a[20:23], v[64:67], v[36:39]
 ds_read_b128 v[52:55], v8 offset:12288
 v_mfma_f32_16x16x32_bf16 v[40:43], a[16:19], v[68:71], v[40:43]
 buffer_load_dwordx4 v3, s[28:31], s53 offen offset:2048 sc1 lds
 v_mfma_f32_16x16x32_bf16 v[44:47], a[20:23], v[68:71], v[44:47]
 s_waitcnt lgkmcnt(2)
 v_mfma_f32_16x16x32_bf16 v[32:35], a[24:27], v[72:75], v[32:35]
 ds_read_b128 v[56:59], v8 offset:5120
 v_mfma_f32_16x16x32_bf16 v[36:39], a[28:31], v[72:75], v[36:39]
 ds_read_b128 v[60:63], v8 offset:13312
 v_mfma_f32_16x16x32_bf16 v[40:43], a[24:27], v[76:79], v[40:43]
 v_pk_max_i16 v81, v81, s60
 v_pk_max_i16 v82, v82, s60
 v_pk_max_i16 v83, v83, s60
 v_mfma_f32_16x16x32_bf16 v[44:47], a[28:31], v[76:79], v[44:47]
 buffer_store_dwordx4 v[80:83], v3, s[28:31], s54 offen sc1
 s_add_u32 s54, s54, s56
 s_waitcnt lgkmcnt(2)
 v_mfma_f32_16x16x32_bf16 v[32:35], a[32:35], v[48:51], v[32:35]
 ds_read_b128 v[64:67], v8 offset:6144
 v_mfma_f32_16x16x32_bf16 v[36:39], a[36:39], v[48:51], v[36:39]
 ds_read_b128 v[68:71], v8 offset:14336
 v_mfma_f32_16x16x32_bf16 v[40:43], a[32:35], v[52:55], v[40:43]
 buffer_load_dwordx4 v3, s[28:31], s53 offen offset:3072 sc1 lds
 v_mfma_f32_16x16x32_bf16 v[44:47], a[36:39], v[52:55], v[44:47]
 s_add_u32 s53, s53, 8192
 s_waitcnt lgkmcnt(2)
 v_mfma_f32_16x16x32_bf16 v[32:35], a[40:43], v[56:59], v[32:35]
 ds_read_b128 v[72:75], v8 offset:7168
 v_mfma_f32_16x16x32_bf16 v[36:39], a[44:47], v[56:59], v[36:39]
 ds_read_b128 v[76:79], v8 offset:15360
 v_mfma_f32_16x16x32_bf16 v[40:43], a[40:43], v[60:63], v[40:43]
 v_cvt_pk_bf16_f32 v84, v24, v25
 v_cvt_pk_bf16_f32 v85, v26, v27
 v_cvt_pk_bf16_f32 v86, v28, v29
 v_mfma_f32_16x16x32_bf16 v[44:47], a[44:47], v[60:63], v[44:47]
 v_cvt_pk_bf16_f32 v87, v30, v31
 v_pk_max_i16 v84, v84, s60
 s_waitcnt lgkmcnt(2)
 v_mfma_f32_16x16x32_bf16 v[32:35], a[48:51], v[64:67], v[32:35]
 s_waitcnt vmcnt(23)
 s_barrier
 ds_read_b128 v[48:51], v8 offset:16384
 v_mfma_f32_16x16x32_bf16 v[36:39], a[52:55], v[64:67], v[36:39]
 ds_read_b128 v[52:55], v8 offset:24576
 v_mfma_f32_16x16x32_bf16 v[40:43], a[48:51], v[68:71], v[40:43]
 s_add_u32 m0, s61, 49152
 s_nop 0
 v_mfma_f32_16x16x32_bf16 v[44:47], a[52:55], v[68:71], v[44:47]
 buffer_load_dwordx4 v3, s[28:31], s53 offen offset:0 sc1 lds
 s_waitcnt lgkmcnt(2)
 v_mfma_f32_16x16x32_bf16 v[32:35], a[56:59], v[72:75], v[32:35]
 ds_read_b128 v[56:59], v8 offset:17408
 v_mfma_f32_16x16x32_bf16 v[36:39], a[60:63], v[72:75], v[36:39]
 ds_read_b128 v[60:63], v8 offset:25600
 v_mfma_f32_16x16x32_bf16 v[40:43], a[56:59], v[76:79], v[40:43]
 v_pk_max_i16 v85, v85, s60
 v_pk_max_i16 v86, v86, s60
 v_pk_max_i16 v87, v87, s60
 v_mfma_f32_16x16x32_bf16 v[44:47], a[60:63], v[76:79], v[44:47]
 buffer_store_dwordx4 v[84:87], v3, s[28:31], s55 offen sc1
 s_add_u32 s55, s55, s56
 s_waitcnt lgkmcnt(2)
 v_mfma_f32_16x16x32_bf16 v[32:35], a[64:67], v[48:51], v[32:35]
 ds_read_b128 v[64:67], v8 offset:18432
 v_mfma_f32_16x16x32_bf16 v[36:39], a[68:71], v[48:51], v[36:39]
 ds_read_b128 v[68:71], v8 offset:26624
 v_mfma_f32_16x16x32_bf16 v[40:43], a[64:67], v[52:55], v[40:43]
 buffer_load_dwordx4 v3, s[28:31], s53 offen offset:1024 sc1 lds
 v_mfma_f32_16x16x32_bf16 v[44:47], a[68:71], v[52:55], v[44:47]
 s_waitcnt lgkmcnt(2)
 v_mfma_f32_16x16x32_bf16 v[32:35], a[72:75], v[56:59], v[32:35]
 ds_read_b128 v[72:75], v8 offset:19456
 v_mfma_f32_16x16x32_bf16 v[36:39], a[76:79], v[56:59], v[36:39]
 ds_read_b128 v[76:79], v8 offset:27648
 v_mfma_f32_16x16x32_bf16 v[40:43], a[72:75], v[60:63], v[40:43]
 v_mfma_f32_16x16x32_bf16 v[44:47], a[76:79], v[60:63], v[44:47]
 s_waitcnt lgkmcnt(2)
 v_mfma_f32_16x16x32_bf16 v[32:35], a[80:83], v[64:67], v[32:35]
 ds_read_b128 v[48:51], v8 offset:20480
 v_mfma_f32_16x16x32_bf16 v[36:39], a[84:87], v[64:67], v[36:39]
 ds_read_b128 v[52:55], v8 offset:28672
 v_mfma_f32_16x16x32_bf16 v[40:43], a[80:83], v[68:71], v[40:43]
 buffer_load_dwordx4 v3, s[28:31], s53 offen offset:2048 sc1 lds
 v_mfma_f32_16x16x32_bf16 v[44:47], a[84:87], v[68:71], v[44:47]
 s_waitcnt lgkmcnt(2)
 v_mfma_f32_16x16x32_bf16 v[32:35], a[88:91], v[72:75], v[32:35]
 ds_read_b128 v[56:59], v8 offset:21504
 v_mfma_f32_16x16x32_bf16 v[36:39], a[92:95], v[72:75], v[36:39]
 ds_read_b128 v[60:63], v8 offset:29696
 v_mfma_f32_16x16x32_bf16 v[40:43], a[88:91], v[76:79], v[40:43]
 v_mfma_f32_16x16x32_bf16 v[44:47], a[92:95], v[76:79], v[44:47]
 s_waitcnt lgkmcnt(2)
 v_mfma_f32_16x16x32_bf16 v[32:35], a[96:99], v[48:51], v[32:35]
 ds_read_b128 v[64:67], v8 offset:22528
 v_mfma_f32_16x16x32_bf16 v[36:39], a[100:103], v[48:51], v[36:39]
 ds_read_b128 v[68:71], v8 offset:30720
 v_mfma_f32_16x16x32_bf16 v[40:43], a[96:99], v[52:55], v[40:43]
 buffer_load_dwordx4 v3, s[28:31], s53 offen offset:3072 sc1 lds
 v_mfma_f32_16x16x32_bf16 v[44:47], a[100:103], v[52:55], v[44:47]
 s_add_u32 s53, s53, s58
 s_waitcnt lgkmcnt(2)
 v_mfma_f32_16x16x32_bf16 v[32:35], a[104:107], v[56:59], v[32:35]
 ds_read_b128 v[72:75], v8 offset:23552
 v_mfma_f32_16x16x32_bf16 v[36:39], a[108:111], v[56:59], v[36:39]
 ds_read_b128 v[76:79], v8 offset:31744
 v_mfma_f32_16x16x32_bf16 v[40:43], a[104:107], v[60:63], v[40:43]
 v_mfma_f32_16x16x32_bf16 v[44:47], a[108:111], v[60:63], v[44:47]
 s_waitcnt lgkmcnt(2)
 v_mfma_f32_16x16x32_bf16 v[32:35], a[112:115], v[64:67], v[32:35]
 s_waitcnt vmcnt(23)
 s_barrier
 ds_read_b128 v[48:51], v8 offset:32768
 v_mfma_f32_16x16x32_bf16 v[36:39], a[116:119], v[64:67], v[36:39]
 ds_read_b128 v[52:55], v8 offset:40960
 v_mfma_f32_16x16x32_bf16 v[40:43], a[112:115], v[68:71], v[40:43]
 s_add_u32 m0, s61, 65536
 s_nop 0
 v_mfma_f32_16x16x32_bf16 v[44:47], a[116:119], v[68:71], v[44:47]
 buffer_load_dwordx4 v3, s[28:31], s53 offen offset:0 sc1 lds
 s_waitcnt lgkmcnt(2)
 v_mfma_f32_16x16x32_bf16 v[32:35], a[120:123], v[72:75], v[32:35]
 ds_read_b128 v[56:59], v8 offset:33792
 v_mfma_f32_16x16x32_bf16 v[36:39], a[124:127], v[72:75], v[36:39]
 ds_read_b128 v[60:63], v8 offset:41984
 v_mfma_f32_16x16x32_bf16 v[40:43], a[120:123], v[76:79], v[40:43]
 v_mfma_f32_16x16x32_bf16 v[44:47], a[124:127], v[76:79], v[44:47]
 s_waitcnt lgkmcnt(2)
 v_mfma_f32_16x16x32_bf16 v[32:35], a[128:131], v[48:51], v[32:35]
 ds_read_b128 v[64:67], v8 offset:34816
 v_mfma_f32_16x16x32_bf16 v[36:39], a[132:135], v[48:51], v[36:39]
 ds_read_b128 v[68:71], v8 offset:43008
 v_mfma_f32_16x16x32_bf16 v[40:43], a[128:131], v[52:55], v[40:43]
 buffer_load_dwordx4 v3, s[28:31], s53 offen offset:1024 sc1 lds
 v_mfma_f32_16x16x32_bf16 v[44:47], a[132:135], v[52:55], v[44:47]
 s_waitcnt lgkmcnt(2)
 v_mfma_f32_16x16x32_bf16 v[32:35], a[136:139], v[56:59], v[32:35]
 ds_read_b128 v[72:75], v8 offset:35840
 v_mfma_f32_16x16x32_bf16 v[36:39], a[140:143], v[56:59], v[36:39]
 ds_read_b128 v[76:79], v8 offset:44032
 v_mfma_f32_16x16x32_bf16 v[40:43], a[136:139], v[60:63], v[40:43]
 v_mfma_f32_16x16x32_bf16 v[44:47], a[140:143], v[60:63], v[44:47]
 s_waitcnt lgkmcnt(2)
 v_mfma_f32_16x16x32_bf16 v[32:35], a[144:147], v[64:67], v[32:35]
 ds_read_b128 v[48:51], v8 offset:36864
 v_mfma_f32_16x16x32_bf16 v[36:39], a[148:151], v[64:67], v[36:39]
 ds_read_b128 v[52:55], v8 offset:45056
 v_mfma_f32_16x16x32_bf16 v[40:43], a[144:147], v[68:71], v[40:43]
 buffer_load_dwordx4 v3, s[28:31], s53 offen offset:2048 sc1 lds
 v_mfma_f32_16x16x32_bf16 v[44:47], a[148:151], v[68:71], v[44:47]
 s_waitcnt lgkmcnt(2)
 v_mfma_f32_16x16x32_bf16 v[32:35], a[152:155], v[72:75], v[32:35]
 ds_read_b128 v[56:59], v8 offset:37888
 v_mfma_f32_16x16x32_bf16 v[36:39], a[156:159], v[72:75], v[36:39]
 ds_read_b128 v[60:63], v8 offset:46080
 v_mfma_f32_16x16x32_bf16 v[40:43], a[152:155], v[76:79], v[40:43]
 v_mfma_f32_16x16x32_bf16 v[44:47], a[156:159], v[76:79], v[44:47]
 s_waitcnt lgkmcnt(2)
 v_mfma_f32_16x16x32_bf16 v[32:35], a[160:163], v[48:51], v[32:35]
 ds_read_b128 v[64:67], v8 offset:38912
 v_mfma_f32_16x16x32_bf16 v[36:39], a[164:167], v[48:51], v[36:39]
 ds_read_b128 v[68:71], v8 offset:47104
 v_mfma_f32_16x16x32_bf16 v[40:43], a[160:163], v[52:55], v[40:43]
 buffer_load_dwordx4 v3, s[28:31], s53 offen offset:3072 sc1 lds
 v_mfma_f32_16x16x32_bf16 v[44:47], a[164:167], v[52:55], v[44:47]
 s_add_u32 s53, s53, 8192
 s_waitcnt lgkmcnt(2)
 v_mfma_f32_16x16x32_bf16 v[32:35], a[168:171], v[56:59], v[32:35]
 ds_read_b128 v[72:75], v8 offset:39936
 v_mfma_f32_16x16x32_bf16 v[36:39], a[172:175], v[56:59], v[36:39]
 ds_read_b128 v[76:79], v8 offset:48128
 v_mfma_f32_16x16x32_bf16 v[40:43], a[168:171], v[60:63], v[40:43]
 v_mfma_f32_16x16x32_bf16 v[44:47], a[172:175], v[60:63], v[44:47]
 s_waitcnt lgkmcnt(2)
 v_mfma_f32_16x16x32_bf16 v[32:35], a[176:179], v[64:67], v[32:35]
 s_waitcnt vmcnt(22)
 s_barrier
 ds_read_b128 v[48:51], v8 offset:49152
 v_mfma_f32_16x16x32_bf16 v[36:39], a[180:183], v[64:67], v[36:39]
 ds_read_b128 v[52:55], v8 offset:57344
 v_mfma_f32_16x16x32_bf16 v[40:43], a[176:179], v[68:71], v[40:43]
 s_add_u32 m0, s61, 81920
 s_nop 0
 v_mfma_f32_16x16x32_bf16 v[44:47], a[180:183], v[68:71], v[44:47]
 buffer_load_dwordx4 v3, s[28:31], s53 offen offset:0 sc1 lds
 s_waitcnt lgkmcnt(2)
 v_mfma_f32_16x16x32_bf16 v[32:35], a[184:187], v[72:75], v[32:35]
 ds_read_b128 v[56:59], v8 offset:50176
 v_mfma_f32_16x16x32_bf16 v[36:39], a[188:191], v[72:75], v[36:39]
 ds_read_b128 v[60:63], v8 offset:58368
 v_mfma_f32_16x16x32_bf16 v[40:43], a[184:187], v[76:79], v[40:43]
 v_mfma_f32_16x16x32_bf16 v[44:47], a[188:191], v[76:79], v[44:47]
 s_waitcnt lgkmcnt(2)
 v_mfma_f32_16x16x32_bf16 v[32:35], a[192:195], v[48:51], v[32:35]
 ds_read_b128 v[64:67], v8 offset:51200
 v_mfma_f32_16x16x32_bf16 v[36:39], a[196:199], v[48:51], v[36:39]
 ds_read_b128 v[68:71], v8 offset:59392
 v_mfma_f32_16x16x32_bf16 v[40:43], a[192:195], v[52:55], v[40:43]
 buffer_load_dwordx4 v3, s[28:31], s53 offen offset:1024 sc1 lds
 v_mfma_f32_16x16x32_bf16 v[44:47], a[196:199], v[52:55], v[44:47]
 s_waitcnt lgkmcnt(2)
 v_mfma_f32_16x16x32_bf16 v[32:35], a[200:203], v[56:59], v[32:35]
 ds_read_b128 v[72:75], v8 offset:52224
 v_mfma_f32_16x16x32_bf16 v[36:39], a[204:207], v[56:59], v[36:39]
 ds_read_b128 v[76:79], v8 offset:60416
 v_mfma_f32_16x16x32_bf16 v[40:43], a[200:203], v[60:63], v[40:43]
 s_add_u32 s64, s64, 2
 v_mov_b32 v1, s64
 v_mfma_f32_16x16x32_bf16 v[44:47], a[204:207], v[60:63], v[44:47]
 buffer_store_dword v1, v2, s[28:31], s59 offen sc1
 s_waitcnt lgkmcnt(2)
 v_mfma_f32_16x16x32_bf16 v[32:35], a[208:211], v[64:67], v[32:35]
 ds_read_b128 v[48:51], v8 offset:53248
 v_mfma_f32_16x16x32_bf16 v[36:39], a[212:215], v[64:67], v[36:39]
 ds_read_b128 v[52:55], v8 offset:61440
 v_mfma_f32_16x16x32_bf16 v[40:43], a[208:211], v[68:71], v[40:43]
 buffer_load_dwordx4 v3, s[28:31], s53 offen offset:2048 sc1 lds
 v_mfma_f32_16x16x32_bf16 v[44:47], a[212:215], v[68:71], v[44:47]
 s_waitcnt lgkmcnt(2)
 v_mfma_f32_16x16x32_bf16 v[32:35], a[216:219], v[72:75], v[32:35]
 ds_read_b128 v[56:59], v8 offset:54272
 v_mfma_f32_16x16x32_bf16 v[36:39], a[220:223], v[72:75], v[36:39]
 ds_read_b128 v[60:63], v8 offset:62464
 v_mfma_f32_16x16x32_bf16 v[40:43], a[216:219], v[76:79], v[40:43]
 v_mfma_f32_16x16x32_bf16 v[44:47], a[220:223], v[76:79], v[44:47]
 s_waitcnt lgkmcnt(2)
 v_mfma_f32_16x16x32_bf16 v[32:35], a[224:227], v[48:51], v[32:35]
 ds_read_b128 v[64:67], v8 offset:55296
 v_mfma_f32_16x16x32_bf16 v[36:39], a[228:231], v[48:51], v[36:39]
 ds_read_b128 v[68:71], v8 offset:63488
 v_mfma_f32_16x16x32_bf16 v[40:43], a[224:227], v[52:55], v[40:43]
 buffer_load_dwordx4 v3, s[28:31], s53 offen offset:3072 sc1 lds
 v_mfma_f32_16x16x32_bf16 v[44:47], a[228:231], v[52:55], v[44:47]
 s_add_u32 s53, s53, 8192
 s_waitcnt lgkmcnt(2)
 v_mfma_f32_16x16x32_bf16 v[32:35], a[232:235], v[56:59], v[32:35]
 ds_read_b128 v[72:75], v8 offset:56320
 v_mfma_f32_16x16x32_bf16 v[36:39], a[236:239], v[56:59], v[36:39]
 ds_read_b128 v[76:79], v8 offset:64512
 v_mfma_f32_16x16x32_bf16 v[40:43], a[232:235], v[60:63], v[40:43]
 v_mfma_f32_16x16x32_bf16 v[44:47], a[236:239], v[60:63], v[44:47]
 s_waitcnt lgkmcnt(2)
 v_mfma_f32_16x16x32_bf16 v[32:35], a[240:243], v[64:67], v[32:35]
 s_waitcnt vmcnt(23)
 s_barrier
 ds_read_b128 v[48:51], v7 offset:0
 v_mfma_f32_16x16x32_bf16 v[36:39], a[244:247], v[64:67], v[36:39]
 ds_read_b128 v[52:55], v7 offset:8192
 v_mfma_f32_16x16x32_bf16 v[40:43], a[240:243], v[68:71], v[40:43]
 s_add_u32 m0, s61, 98304
 s_nop 0
 v_mfma_f32_16x16x32_bf16 v[44:47], a[244:247], v[68:71], v[44:47]
 buffer_load_dwordx4 v3, s[28:31], s53 offen offset:0 sc1 lds
 s_waitcnt lgkmcnt(2)
 v_mfma_f32_16x16x32_bf16 v[32:35], a[248:251], v[72:75], v[32:35]
 ds_read_b128 v[56:59], v7 offset:1024
 v_mfma_f32_16x16x32_bf16 v[36:39], a[252:255], v[72:75], v[36:39]
 ds_read_b128 v[60:63], v7 offset:9216
 v_mfma_f32_16x16x32_bf16 v[40:43], a[248:251], v[76:79], v[40:43]
 v_mfma_f32_16x16x32_bf16 v[44:47], a[252:255], v[76:79], v[44:47]
 s_sub_u32 s57, s57, 1
 s_cbranch_scc1 L_qk_end1
 s_waitcnt lgkmcnt(2)
 v_mfma_f32_16x16x32_bf16 v[16:19], a[0:3], v[48:51], 0
 ds_read_b128 v[64:67], v7 offset:2048
 v_mfma_f32_16x16x32_bf16 v[20:23], a[4:7], v[48:51], 0
 ds_read_b128 v[68:71], v7 offset:10240
 v_mfma_f32_16x16x32_bf16 v[24:27], a[0:3], v[52:55], 0
 buffer_load_dwordx4 v3, s[28:31], s53 offen offset:1024 sc1 lds
 v_mfma_f32_16x16x32_bf16 v[28:31], a[4:7], v[52:55], 0
 s_waitcnt lgkmcnt(2)
 v_mfma_f32_16x16x32_bf16 v[16:19], a[8:11], v[56:59], v[16:19]
 ds_read_b128 v[72:75], v7 offset:3072
 v_mfma_f32_16x16x32_bf16 v[20:23], a[12:15], v[56:59], v[20:23]
 ds_read_b128 v[76:79], v7 offset:11264
 v_mfma_f32_16x16x32_bf16 v[24:27], a[8:11], v[60:63], v[24:27]
 v_cvt_pk_bf16_f32 v80, v32, v33
 v_cvt_pk_bf16_f32 v81, v34, v35
 v_cvt_pk_bf16_f32 v82, v36, v37
 v_mfma_f32_16x16x32_bf16 v[28:31], a[12:15], v[60:63], v[28:31]
 v_cvt_pk_bf16_f32 v83, v38, v39
 v_pk_max_i16 v80, v80, s60
 s_waitcnt lgkmcnt(2)
 v_mfma_f32_16x16x32_bf16 v[16:19], a[16:19], v[64:67], v[16:19]
 ds_read_b128 v[48:51], v7 offset:4096
 v_mfma_f32_16x16x32_bf16 v[20:23], a[20:23], v[64:67], v[20:23]
 ds_read_b128 v[52:55], v7 offset:12288
 v_mfma_f32_16x16x32_bf16 v[24:27], a[16:19], v[68:71], v[24:27]
 buffer_load_dwordx4 v3, s[28:31], s53 offen offset:2048 sc1 lds
 v_mfma_f32_16x16x32_bf16 v[28:31], a[20:23], v[68:71], v[28:31]
 s_waitcnt lgkmcnt(2)
 v_mfma_f32_16x16x32_bf16 v[16:19], a[24:27], v[72:75], v[16:19]
 ds_read_b128 v[56:59], v7 offset:5120
 v_mfma_f32_16x16x32_bf16 v[20:23], a[28:31], v[72:75], v[20:23]
 ds_read_b128 v[60:63], v7 offset:13312
 v_mfma_f32_16x16x32_bf16 v[24:27], a[24:27], v[76:79], v[24:27]
 v_pk_max_i16 v81, v81, s60
 v_pk_max_i16 v82, v82, s60
 v_pk_max_i16 v83, v83, s60
 v_mfma_f32_16x16x32_bf16 v[28:31], a[28:31], v[76:79], v[28:31]
 buffer_store_dwordx4 v[80:83], v3, s[28:31], s54 offen sc1
 s_add_u32 s54, s54, s56
 s_waitcnt lgkmcnt(2)
 v_mfma_f32_16x16x32_bf16 v[16:19], a[32:35], v[48:51], v[16:19]
 ds_read_b128 v[64:67], v7 offset:6144
 v_mfma_f32_16x16x32_bf16 v[20:23], a[36:39], v[48:51], v[20:23]
 ds_read_b128 v[68:71], v7 offset:14336
 v_mfma_f32_16x16x32_bf16 v[24:27], a[32:35], v[52:55], v[24:27]
 buffer_load_dwordx4 v3, s[28:31], s53 offen offset:3072 sc1 lds
 v_mfma_f32_16x16x32_bf16 v[28:31], a[36:39], v[52:55], v[28:31]
 s_add_u32 s53, s53, 8192
 s_waitcnt lgkmcnt(2)
 v_mfma_f32_16x16x32_bf16 v[16:19], a[40:43], v[56:59], v[16:19]
 ds_read_b128 v[72:75], v7 offset:7168
 v_mfma_f32_16x16x32_bf16 v[20:23], a[44:47], v[56:59], v[20:23]
 ds_read_b128 v[76:79], v7 offset:15360
 v_mfma_f32_16x16x32_bf16 v[24:27], a[40:43], v[60:63], v[24:27]
 v_cvt_pk_bf16_f32 v84, v40, v41
 v_cvt_pk_bf16_f32 v85, v42, v43
 v_cvt_pk_bf16_f32 v86, v44, v45
 v_mfma_f32_16x16x32_bf16 v[28:31], a[44:47], v[60:63], v[28:31]
 v_cvt_pk_bf16_f32 v87, v46, v47
 v_pk_max_i16 v84, v84, s60
 s_waitcnt lgkmcnt(2)
 v_mfma_f32_16x16x32_bf16 v[16:19], a[48:51], v[64:67], v[16:19]
 s_waitcnt vmcnt(24)
 s_barrier
 ds_read_b128 v[48:51], v7 offset:16384
 v_mfma_f32_16x16x32_bf16 v[20:23], a[52:55], v[64:67], v[20:23]
 ds_read_b128 v[52:55], v7 offset:24576
 v_mfma_f32_16x16x32_bf16 v[24:27], a[48:51], v[68:71], v[24:27]
 s_add_u32 m0, s61, 114688
 s_nop 0
 v_mfma_f32_16x16x32_bf16 v[28:31], a[52:55], v[68:71], v[28:31]
 buffer_load_dwordx4 v3, s[28:31], s53 offen offset:0 sc1 lds
 s_waitcnt lgkmcnt(2)
 v_mfma_f32_16x16x32_bf16 v[16:19], a[56:59], v[72:75], v[16:19]
 ds_read_b128 v[56:59], v7 offset:17408
 v_mfma_f32_16x16x32_bf16 v[20:23], a[60:63], v[72:75], v[20:23]
 ds_read_b128 v[60:63], v7 offset:25600
 v_mfma_f32_16x16x32_bf16 v[24:27], a[56:59], v[76:79], v[24:27]
 v_pk_max_i16 v85, v85, s60
 v_pk_max_i16 v86, v86, s60
 v_pk_max_i16 v87, v87, s60
 v_mfma_f32_16x16x32_bf16 v[28:31], a[60:63], v[76:79], v[28:31]
 buffer_store_dwordx4 v[84:87], v3, s[28:31], s55 offen sc1
 s_add_u32 s55, s55, s56
 s_waitcnt lgkmcnt(2)
 v_mfma_f32_16x16x32_bf16 v[16:19], a[64:67], v[48:51], v[16:19]
 ds_read_b128 v[64:67], v7 offset:18432
 v_mfma_f32_16x16x32_bf16 v[20:23], a[68:71], v[48:51], v[20:23]
 ds_read_b128 v[68:71], v7 offset:26624
 v_mfma_f32_16x16x32_bf16 v[24:27], a[64:67], v[52:55], v[24:27]
 buffer_load_dwordx4 v3, s[28:31], s53 offen offset:1024 sc1 lds
 v_mfma_f32_16x16x32_bf16 v[28:31], a[68:71], v[52:55], v[28:31]
 s_waitcnt lgkmcnt(2)
 v_mfma_f32_16x16x32_bf16 v[16:19], a[72:75], v[56:59], v[16:19]
 ds_read_b128 v[72:75], v7 offset:19456
 v_mfma_f32_16x16x32_bf16 v[20:23], a[76:79], v[56:59], v[20:23]
 ds_read_b128 v[76:79], v7 offset:27648
 v_mfma_f32_16x16x32_bf16 v[24:27], a[72:75], v[60:63], v[24:27]
 v_mfma_f32_16x16x32_bf16 v[28:31], a[76:79], v[60:63], v[28:31]
 s_waitcnt lgkmcnt(2)
 v_mfma_f32_16x16x32_bf16 v[16:19], a[80:83], v[64:67], v[16:19]
 ds_read_b128 v[48:51], v7 offset:20480
 v_mfma_f32_16x16x32_bf16 v[20:23], a[84:87], v[64:67], v[20:23]
 ds_read_b128 v[52:55], v7 offset:28672
 v_mfma_f32_16x16x32_bf16 v[24:27], a[80:83], v[68:71], v[24:27]
 buffer_load_dwordx4 v3, s[28:31], s53 offen offset:2048 sc1 lds
 v_mfma_f32_16x16x32_bf16 v[28:31], a[84:87], v[68:71], v[28:31]
 s_waitcnt lgkmcnt(2)
 v_mfma_f32_16x16x32_bf16 v[16:19], a[88:91], v[72:75], v[16:19]
 ds_read_b128 v[56:59], v7 offset:21504
 v_mfma_f32_16x16x32_bf16 v[20:23], a[92:95], v[72:75], v[20:23]
 ds_read_b128 v[60:63], v7 offset:29696
 v_mfma_f32_16x16x32_bf16 v[24:27], a[88:91], v[76:79], v[24:27]
 v_mfma_f32_16x16x32_bf16 v[28:31], a[92:95], v[76:79], v[28:31]
 s_waitcnt lgkmcnt(2)
 v_mfma_f32_16x16x32_bf16 v[16:19], a[96:99], v[48:51], v[16:19]
 ds_read_b128 v[64:67], v7 offset:22528
 v_mfma_f32_16x16x32_bf16 v[20:23], a[100:103], v[48:51], v[20:23]
 ds_read_b128 v[68:71], v7 offset:30720
 v_mfma_f32_16x16x32_bf16 v[24:27], a[96:99], v[52:55], v[24:27]
 buffer_load_dwordx4 v3, s[28:31], s53 offen offset:3072 sc1 lds
 v_mfma_f32_16x16x32_bf16 v[28:31], a[100:103], v[52:55], v[28:31]
 s_add_u32 s53, s53, s58
 s_waitcnt lgkmcnt(2)
 v_mfma_f32_16x16x32_bf16 v[16:19], a[104:107], v[56:59], v[16:19]
 ds_read_b128 v[72:75], v7 offset:23552
 v_mfma_f32_16x16x32_bf16 v[20:23], a[108:111], v[56:59], v[20:23]
 ds_read_b128 v[76:79], v7 offset:31744
 v_mfma_f32_16x16x32_bf16 v[24:27], a[104:107], v[60:63], v[24:27]
 v_mfma_f32_16x16x32_bf16 v[28:31], a[108:111], v[60:63], v[28:31]
 s_waitcnt lgkmcnt(2)
 v_mfma_f32_16x16x32_bf16 v[16:19], a[112:115], v[64:67], v[16:19]
 s_waitcnt vmcnt(24)
 s_barrier
 ds_read_b128 v[48:51], v7 offset:32768
 v_mfma_f32_16x16x32_bf16 v[20:23], a[116:119], v[64:67], v[20:23]
 ds_read_b128 v[52:55], v7 offset:40960
 v_mfma_f32_16x16x32_bf16 v[24:27], a[112:115], v[68:71], v[24:27]
 s_mov_b32 m0, s61
 s_nop 0
 v_mfma_f32_16x16x32_bf16 v[28:31], a[116:119], v[68:71], v[28:31]
 buffer_load_dwordx4 v3, s[28:31], s53 offen offset:0 sc1 lds
 s_waitcnt lgkmcnt(2)
 v_mfma_f32_16x16x32_bf16 v[16:19], a[120:123], v[72:75], v[16:19]
 ds_read_b128 v[56:59], v7 offset:33792
 v_mfma_f32_16x16x32_bf16 v[20:23], a[124:127], v[72:75], v[20:23]
 ds_read_b128 v[60:63], v7 offset:41984
 v_mfma_f32_16x16x32_bf16 v[24:27], a[120:123], v[76:79], v[24:27]
 v_mfma_f32_16x16x32_bf16 v[28:31], a[124:127], v[76:79], v[28:31]
 s_waitcnt lgkmcnt(2)
 v_mfma_f32_16x16x32_bf16 v[16:19], a[128:131], v[48:51], v[16:19]
 ds_read_b128 v[64:67], v7 offset:34816
 v_mfma_f32_16x16x32_bf16 v[20:23], a[132:135], v[48:51], v[20:23]
 ds_read_b128 v[68:71], v7 offset:43008
 v_mfma_f32_16x16x32_bf16 v[24:27], a[128:131], v[52:55], v[24:27]
 buffer_load_dwordx4 v3, s[28:31], s53 offen offset:1024 sc1 lds
 v_mfma_f32_16x16x32_bf16 v[28:31], a[132:135], v[52:55], v[28:31]
 s_waitcnt lgkmcnt(2)
 v_mfma_f32_16x16x32_bf16 v[16:19], a[136:139], v[56:59], v[16:19]
 ds_read_b128 v[72:75], v7 offset:35840
 v_mfma_f32_16x16x32_bf16 v[20:23], a[140:143], v[56:59], v[20:23]
 ds_read_b128 v[76:79], v7 offset:44032
 v_mfma_f32_16x16x32_bf16 v[24:27], a[136:139], v[60:63], v[24:27]
 v_mfma_f32_16x16x32_bf16 v[28:31], a[140:143], v[60:63], v[28:31]
 s_waitcnt lgkmcnt(2)
 v_mfma_f32_16x16x32_bf16 v[16:19], a[144:147], v[64:67], v[16:19]
 ds_read_b128 v[48:51], v7 offset:36864
 v_mfma_f32_16x16x32_bf16 v[20:23], a[148:151], v[64:67], v[20:23]
 ds_read_b128 v[52:55], v7 offset:45056
 v_mfma_f32_16x16x32_bf16 v[24:27], a[144:147], v[68:71], v[24:27]
 buffer_load_dwordx4 v3, s[28:31], s53 offen offset:2048 sc1 lds
 v_mfma_f32_16x16x32_bf16 v[28:31], a[148:151], v[68:71], v[28:31]
 s_waitcnt lgkmcnt(2)
 v_mfma_f32_16x16x32_bf16 v[16:19], a[152:155], v[72:75], v[16:19]
 ds_read_b128 v[56:59], v7 offset:37888
 v_mfma_f32_16x16x32_bf16 v[20:23], a[156:159], v[72:75], v[20:23]
 ds_read_b128 v[60:63], v7 offset:46080
 v_mfma_f32_16x16x32_bf16 v[24:27], a[152:155], v[76:79], v[24:27]
 v_mfma_f32_16x16x32_bf16 v[28:31], a[156:159], v[76:79], v[28:31]
 s_waitcnt lgkmcnt(2)
 v_mfma_f32_16x16x32_bf16 v[16:19], a[160:163], v[48:51], v[16:19]
 ds_read_b128 v[64:67], v7 offset:38912
 v_mfma_f32_16x16x32_bf16 v[20:23], a[164:167], v[48:51], v[20:23]
 ds_read_b128 v[68:71], v7 offset:47104
 v_mfma_f32_16x16x32_bf16 v[24:27], a[160:163], v[52:55], v[24:27]
 buffer_load_dwordx4 v3, s[28:31], s53 offen offset:3072 sc1 lds
 v_mfma_f32_16x16x32_bf16 v[28:31], a[164:167], v[52:55], v[28:31]
 s_add_u32 s53, s53, 8192
 s_waitcnt lgkmcnt(2)
 v_mfma_f32_16x16x32_bf16 v[16:19], a[168:171], v[56:59], v[16:19]
 ds_read_b128 v[72:75], v7 offset:39936
 v_mfma_f32_16x16x32_bf16 v[20:23], a[172:175], v[56:59], v[20:23]
 ds_read_b128 v[76:79], v7 offset:48128
 v_mfma_f32_16x16x32_bf16 v[24:27], a[168:171], v[60:63], v[24:27]
 v_mfma_f32_16x16x32_bf16 v[28:31], a[172:175], v[60:63], v[28:31]
 s_waitcnt lgkmcnt(2)
 v_mfma_f32_16x16x32_bf16 v[16:19], a[176:179], v[64:67], v[16:19]
 s_waitcnt vmcnt(23)
 s_barrier
 ds_read_b128 v[48:51], v7 offset:49152
 v_mfma_f32_16x16x32_bf16 v[20:23], a[180:183], v[64:67], v[20:23]
 ds_read_b128 v[52:55], v7 offset:57344
 v_mfma_f32_16x16x32_bf16 v[24:27], a[176:179], v[68:71], v[24:27]
 s_add_u32 m0, s61, 16384
 s_nop 0
 v_mfma_f32_16x16x32_bf16 v[28:31], a[180:183], v[68:71], v[28:31]
 buffer_load_dwordx4 v3, s[28:31], s53 offen offset:0 sc1 lds
 s_waitcnt lgkmcnt(2)
 v_mfma_f32_16x16x32_bf16 v[16:19], a[184:187], v[72:75], v[16:19]
 ds_read_b128 v[56:59], v7 offset:50176
 v_mfma_f32_16x16x32_bf16 v[20:23], a[188:191], v[72:75], v[20:23]
 ds_read_b128 v[60:63], v7 offset:58368
 v_mfma_f32_16x16x32_bf16 v[24:27], a[184:187], v[76:79], v[24:27]
 v_mfma_f32_16x16x32_bf16 v[28:31], a[188:191], v[76:79], v[28:31]
 s_waitcnt lgkmcnt(2)
 v_mfma_f32_16x16x32_bf16 v[16:19], a[192:195], v[48:51], v[16:19]
 ds_read_b128 v[64:67], v7 offset:51200
 v_mfma_f32_16x16x32_bf16 v[20:23], a[196:199], v[48:51], v[20:23]
 ds_read_b128 v[68:71], v7 offset:59392
 v_mfma_f32_16x16x32_bf16 v[24:27], a[192:195], v[52:55], v[24:27]
 buffer_load_dwordx4 v3, s[28:31], s53 offen offset:1024 sc1 lds
 v_mfma_f32_16x16x32_bf16 v[28:31], a[196:199], v[52:55], v[28:31]
 s_waitcnt lgkmcnt(2)
 v_mfma_f32_16x16x32_bf16 v[16:19], a[200:203], v[56:59], v[16:19]
 ds_read_b128 v[72:75], v7 offset:52224
 v_mfma_f32_16x16x32_bf16 v[20:23], a[204:207], v[56:59], v[20:23]
 ds_read_b128 v[76:79], v7 offset:60416
 v_mfma_f32_16x16x32_bf16 v[24:27], a[200:203], v[60:63], v[24:27]
 s_add_u32 s64, s64, 2
 v_mov_b32 v1, s64
 v_mfma_f32_16x16x32_bf16 v[28:31], a[204:207], v[60:63], v[28:31]
 buffer_store_dword v1, v2, s[28:31], s59 offen sc1
 s_waitcnt lgkmcnt(2)
 v_mfma_f32_16x16x32_bf16 v[16:19], a[208:211], v[64:67], v[16:19]
 ds_read_b128 v[48:51], v7 offset:53248
 v_mfma_f32_16x16x32_bf16 v[20:23], a[212:215], v[64:67], v[20:23]
 ds_read_b128 v[52:55], v7 offset:61440
 v_mfma_f32_16x16x32_bf16 v[24:27], a[208:211], v[68:71], v[24:27]
 buffer_load_dwordx4 v3, s[28:31], s53 offen offset:2048 sc1 lds
 v_mfma_f32_16x16x32_bf16 v[28:31], a[212:215], v[68:71], v[28:31]
 s_waitcnt lgkmcnt(2)
 v_mfma_f32_16x16x32_bf16 v[16:19], a[216:219], v[72:75], v[16:19]
 ds_read_b128 v[56:59], v7 offset:54272
 v_mfma_f32_16x16x32_bf16 v[20:23], a[220:223], v[72:75], v[20:23]
 ds_read_b128 v[60:63], v7 offset:62464
 v_mfma_f32_16x16x32_bf16 v[24:27], a[216:219], v[76:79], v[24:27]
 v_mfma_f32_16x16x32_bf16 v[28:31], a[220:223], v[76:79], v[28:31]
 s_waitcnt lgkmcnt(2)
 v_mfma_f32_16x16x32_bf16 v[16:19], a[224:227], v[48:51], v[16:19]
 ds_read_b128 v[64:67], v7 offset:55296
 v_mfma_f32_16x16x32_bf16 v[20:23], a[228:231], v[48:51], v[20:23]
 ds_read_b128 v[68:71], v7 offset:63488
 v_mfma_f32_16x16x32_bf16 v[24:27], a[224:227], v[52:55], v[24:27]
 buffer_load_dwordx4 v3, s[28:31], s53 offen offset:3072 sc1 lds
 v_mfma_f32_16x16x32_bf16 v[28:31], a[228:231], v[52:55], v[28:31]
 s_add_u32 s53, s53, 8192
 s_waitcnt lgkmcnt(2)
 v_mfma_f32_16x16x32_bf16 v[16:19], a[232:235], v[56:59], v[16:19]
 ds_read_b128 v[72:75], v7 offset:56320
 v_mfma_f32_16x16x32_bf16 v[20:23], a[236:239], v[56:59], v[20:23]
 ds_read_b128 v[76:79], v7 offset:64512
 v_mfma_f32_16x16x32_bf16 v[24:27], a[232:235], v[60:63], v[24:27]
 v_mfma_f32_16x16x32_bf16 v[28:31], a[236:239], v[60:63], v[28:31]
 s_waitcnt lgkmcnt(2)
 v_mfma_f32_16x16x32_bf16 v[16:19], a[240:243], v[64:67], v[16:19]
 s_waitcnt vmcnt(24)
 s_barrier
 ds_read_b128 v[48:51], v8 offset:0
 v_mfma_f32_16x16x32_bf16 v[20:23], a[244:247], v[64:67], v[20:23]
 ds_read_b128 v[52:55], v8 offset:8192
 v_mfma_f32_16x16x32_bf16 v[24:27], a[240:243], v[68:71], v[24:27]
 s_add_u32 m0, s61, 32768
 s_nop 0
 v_mfma_f32_16x16x32_bf16 v[28:31], a[244:247], v[68:71], v[28:31]
 buffer_load_dwordx4 v3, s[28:31], s53 offen offset:0 sc1 lds
 s_waitcnt lgkmcnt(2)
 v_mfma_f32_16x16x32_bf16 v[16:19], a[248:251], v[72:75], v[16:19]
 ds_read_b128 v[56:59], v8 offset:1024
 v_mfma_f32_16x16x32_bf16 v[20:23], a[252:255], v[72:75], v[20:23]
 ds_read_b128 v[60:63], v8 offset:9216
 v_mfma_f32_16x16x32_bf16 v[24:27], a[248:251], v[76:79], v[24:27]
 v_mfma_f32_16x16x32_bf16 v[28:31], a[252:255], v[76:79], v[28:31]
 s_sub_u32 s57, s57, 1
 s_cbranch_scc1 L_qk_end0
 s_branch L_qk_top
L_qk_end0:
 s_nop 7
 v_cvt_pk_bf16_f32 v80, v16, v17
 v_cvt_pk_bf16_f32 v81, v18, v19
 v_cvt_pk_bf16_f32 v82, v20, v21
 v_cvt_pk_bf16_f32 v83, v22, v23
 v_pk_max_i16 v80, v80, s60
 v_pk_max_i16 v81, v81, s60
 v_pk_max_i16 v82, v82, s60
 v_pk_max_i16 v83, v83, s60
 buffer_store_dwordx4 v[80:83], v3, s[28:31], s54 offen sc1
 s_add_u32 s54, s54, s56
 v_cvt_pk_bf16_f32 v84, v24, v25
 v_cvt_pk_bf16_f32 v85, v26, v27
 v_cvt_pk_bf16_f32 v86, v28, v29
 v_cvt_pk_bf16_f32 v87, v30, v31
 v_pk_max_i16 v84, v84, s60
 v_pk_max_i16 v85, v85, s60
 v_pk_max_i16 v86, v86, s60
 v_pk_max_i16 v87, v87, s60
 buffer_store_dwordx4 v[84:87], v3, s[28:31], s55 offen sc1
 s_add_u32 s55, s55, s56
 s_branch L_qk_done
L_qk_end1:
 s_nop 7
 v_cvt_pk_bf16_f32 v80, v32, v33
 v_cvt_pk_bf16_f32 v81, v34, v35
 v_cvt_pk_bf16_f32 v82, v36, v37
 v_cvt_pk_bf16_f32 v83, v38, v39
 v_pk_max_i16 v80, v80, s60
 v_pk_max_i16 v81, v81, s60
 v_pk_max_i16 v82, v82, s60
 v_pk_max_i16 v83, v83, s60
 buffer_store_dwordx4 v[80:83], v3, s[28:31], s54 offen sc1
 s_add_u32 s54, s54, s56
 v_cvt_pk_bf16_f32 v84, v40, v41
 v_cvt_pk_bf16_f32 v85, v42, v43
 v_cvt_pk_bf16_f32 v86, v44, v45
 v_cvt_pk_bf16_f32 v87, v46, v47
 v_pk_max_i16 v84, v84, s60
 v_pk_max_i16 v85, v85, s60
 v_pk_max_i16 v86, v86, s60
 v_pk_max_i16 v87, v87, s60
 buffer_store_dwordx4 v[84:87], v3, s[28:31], s55 offen sc1
 s_add_u32 s55, s55, s56
L_qk_done:
 s_waitcnt vmcnt(0) lgkmcnt(0)
 s_barrier
 v_mov_b32 v1, 64
 buffer_store_dword v1, v2, s[28:31], s59 offen sc1
 s_branch L_ffn1
L_projv:
 s_lshl_b32 s48, s40, 11
 s_add_u32 s54, s54, s48
 s_add_u32 s55, s54, 1024
 s_lshl_b32 s61, s40, 12
 s_mov_b32 m0, s61
 s_nop 0
 buffer_load_dwordx4 v3, s[28:31], s53 offen offset:0 sc1 lds
 buffer_load_dwordx4 v3, s[28:31], s53 offen offset:1024 sc1 lds
 buffer_load_dwordx4 v3, s[28:31], s53 offen offset:2048 sc1 lds
 buffer_load_dwordx4 v3, s[28:31], s53 offen offset:3072 sc1 lds
 s_add_u32 s53, s53, 8192
 s_add_u32 m0, s61, 16384
 s_nop 0
 buffer_load_dwordx4 v3, s[28:31], s53 offen offset:0 sc1 lds
 buffer_load_dwordx4 v3, s[28:31], s53 offen offset:1024 sc1 lds
 buffer_load_dwordx4 v3, s[28:31], s53 offen offset:2048 sc1 lds
 buffer_load_dwordx4 v3, s[28:31], s53 offen offset:3072 sc1 lds
 s_add_u32 s53, s53, 8192
 s_add_u32 m0, s61, 32768
 s_nop 0
 buffer_load_dwordx4 v3, s[28:31], s53 offen offset:0 sc1 lds
 buffer_load_dwordx4 v3, s[28:31], s53 offen offset:1024 sc1 lds
 buffer_load_dwordx4 v3, s[28:31], s53 offen offset:2048 sc1 lds
 buffer_load_dwordx4 v3, s[28:31], s53 offen offset:3072 sc1 lds
 s_add_u32 s53, s53, 8192
 s_add_u32 m0, s61, 49152
 s_nop 0
 buffer_load_dwordx4 v3, s[28:31], s53 offen offset:0 sc1 lds
 buffer_load_dwordx4 v3, s[28:31], s53 offen offset:1024 sc1 lds
 buffer_load_dwordx4 v3, s[28:31], s53 offen offset:2048 sc1 lds
 buffer_load_dwordx4 v3, s[28:31], s53 offen offset:3072 sc1 lds
 s_add_u32 s53, s53, s58
 s_add_u32 m0, s61, 65536
 s_nop 0
 buffer_load_dwordx4 v3, s[28:31], s53 offen offset:0 sc1 lds
 buffer_load_dwordx4 v3, s[28:31], s53 offen offset:1024 sc1 lds
 buffer_load_dwordx4 v3, s[28:31], s53 offen offset:2048 sc1 lds
 buffer_load_dwordx4 v3, s[28:31], s53 offen offset:3072 sc1 lds
 s_add_u32 s53, s53, 8192
 s_add_u32 m0, s61, 81920
 s_nop 0
 buffer_load_dwordx4 v3, s[28:31], s53 offen offset:0 sc1 lds
 buffer_load_dwordx4 v3, s[28:31], s53 offen offset:1024 sc1 lds
 buffer_load_dwordx4 v3, s[28:31], s53 offen offset:2048 sc1 lds
 buffer_load_dwordx4 v3, s[28:31], s53 offen offset:3072 sc1 lds
 s_add_u32 s53, s53, 8192
 s_add_u32 m0, s61, 98304
 s_nop 0
 buffer_load_dwordx4 v3, s[28:31], s53 offen offset:0 sc1 lds
 buffer_load_dwordx4 v3, s[28:31], s53 offen offset:1024 sc1 lds
 buffer_load_dwordx4 v3, s[28:31], s53 offen offset:2048 sc1 lds
 buffer_load_dwordx4 v3, s[28:31], s53 offen offset:3072 sc1 lds
 s_add_u32 s53, s53, 8192
 s_waitcnt vmcnt(24)
 s_barrier
 ds_read_b128 v[48:51], v7 offset:0
 ds_read_b128 v[52:55], v7 offset:8192
 ds_read_b128 v[56:59], v7 offset:1024
 ds_read_b128 v[60:63], v7 offset:9216
 s_waitcnt lgkmcnt(2)
 v_mfma_f32_16x16x32_bf16 v[16:19], v[48:51], a[0:3], 0
 ds_read_b128 v[64:67], v7 offset:2048
 v_mfma_f32_16x16x32_bf16 v[20:23], v[52:55], a[0:3], 0
 ds_read_b128 v[68:71], v7 offset:10240
 v_mfma_f32_16x16x32_bf16 v[24:27], v[48:51], a[4:7], 0
 v_mfma_f32_16x16x32_bf16 v[28:31], v[52:55], a[4:7], 0
 s_waitcnt lgkmcnt(2)
 v_mfma_f32_16x16x32_bf16 v[16:19], v[56:59], a[8:11], v[16:19]
 ds_read_b128 v[72:75], v7 offset:3072
 v_mfma_f32_16x16x32_bf16 v[20:23], v[60:63], a[8:11], v[20:23]
 ds_read_b128 v[76:79], v7 offset:11264
 v_mfma_f32_16x16x32_bf16 v[24:27], v[56:59], a[12:15], v[24:27]
 v_mfma_f32_16x16x32_bf16 v[28:31], v[60:63], a[12:15], v[28:31]
 s_waitcnt lgkmcnt(2)
 v_mfma_f32_16x16x32_bf16 v[16:19], v[64:67], a[16:19], v[16:19]
 ds_read_b128 v[48:51], v7 offset:4096
 v_mfma_f32_16x16x32_bf16 v[20:23], v[68:71], a[16:19], v[20:23]
 ds_read_b128 v[52:55], v7 offset:12288
 v_mfma_f32_16x16x32_bf16 v[24:27], v[64:67], a[20:23], v[24:27]
 v_mfma_f32_16x16x32_bf16 v[28:31], v[68:71], a[20:23], v[28:31]
 s_waitcnt lgkmcnt(2)
 v_mfma_f32_16x16x32_bf16 v[16:19], v[72:75], a[24:27], v[16:19]
 ds_read_b128 v[56:59], v7 offset:5120
 v_mfma_f32_16x16x32_bf16 v[20:23], v[76:79], a[24:27], v[20:23]
 ds_read_b128 v[60:63], v7 offset:13312
 v_mfma_f32_16x16x32_bf16 v[24:27], v[72:75], a[28:31], v[24:27]
 v_mfma_f32_16x16x32_bf16 v[28:31], v[76:79], a[28:31], v[28:31]
 s_waitcnt lgkmcnt(2)
 v_mfma_f32_16x16x32_bf16 v[16:19], v[48:51], a[32:35], v[16:19]
 ds_read_b128 v[64:67], v7 offset:6144
 v_mfma_f32_16x16x32_bf16 v[20:23], v[52:55], a[32:35], v[20:23]
 ds_read_b128 v[68:71], v7 offset:14336
 v_mfma_f32_16x16x32_bf16 v[24:27], v[48:51], a[36:39], v[24:27]
 v_mfma_f32_16x16x32_bf16 v[28:31], v[52:55], a[36:39], v[28:31]
 s_waitcnt lgkmcnt(2)
 v_mfma_f32_16x16x32_bf16 v[16:19], v[56:59], a[40:43], v[16:19]
 ds_read_b128 v[72:75], v7 offset:7168
 v_mfma_f32_16x16x32_bf16 v[20:23], v[60:63], a[40:43], v[20:23]
 ds_read_b128 v[76:79], v7 offset:15360
 v_mfma_f32_16x16x32_bf16 v[24:27], v[56:59], a[44:47], v[24:27]
 v_mfma_f32_16x16x32_bf16 v[28:31], v[60:63], a[44:47], v[28:31]
 s_waitcnt lgkmcnt(2)
 v_mfma_f32_16x16x32_bf16 v[16:19], v[64:67], a[48:51], v[16:19]
 s_waitcnt vmcnt(20)
 s_barrier
 ds_read_b128 v[48:51], v7 offset:16384
 v_mfma_f32_16x16x32_bf16 v[20:23], v[68:71], a[48:51], v[20:23]
 ds_read_b128 v[52:55], v7 offset:24576
 v_mfma_f32_16x16x32_bf16 v[24:27], v[64:67], a[52:55], v[24:27]
 s_add_u32 m0, s61, 114688
 s_nop 0
 v_mfma_f32_16x16x32_bf16 v[28:31], v[68:71], a[52:55], v[28:31]
 buffer_load_dwordx4 v3, s[28:31], s53 offen offset:0 sc1 lds
 s_waitcnt lgkmcnt(2)
 v_mfma_f32_16x16x32_bf16 v[16:19], v[72:75], a[56:59], v[16:19]
 ds_read_b128 v[56:59], v7 offset:17408
 v_mfma_f32_16x16x32_bf16 v[20:23], v[76:79], a[56:59], v[20:23]
 ds_read_b128 v[60:63], v7 offset:25600
 v_mfma_f32_16x16x32_bf16 v[24:27], v[72:75], a[60:63], v[24:27]
 v_mfma_f32_16x16x32_bf16 v[28:31], v[76:79], a[60:63], v[28:31]
 s_waitcnt lgkmcnt(2)
 v_mfma_f32_16x16x32_bf16 v[16:19], v[48:51], a[64:67], v[16:19]
 ds_read_b128 v[64:67], v7 offset:18432
 v_mfma_f32_16x16x32_bf16 v[20:23], v[52:55], a[64:67], v[20:23]
 ds_read_b128 v[68:71], v7 offset:26624
 v_mfma_f32_16x16x32_bf16 v[24:27], v[48:51], a[68:71], v[24:27]
 buffer_load_dwordx4 v3, s[28:31], s53 offen offset:1024 sc1 lds
 v_mfma_f32_16x16x32_bf16 v[28:31], v[52:55], a[68:71], v[28:31]
 s_waitcnt lgkmcnt(2)
 v_mfma_f32_16x16x32_bf16 v[16:19], v[56:59], a[72:75], v[16:19]
 ds_read_b128 v[72:75], v7 offset:19456
 v_mfma_f32_16x16x32_bf16 v[20:23], v[60:63], a[72:75], v[20:23]
 ds_read_b128 v[76:79], v7 offset:27648
 v_mfma_f32_16x16x32_bf16 v[24:27], v[56:59], a[76:79], v[24:27]
 v_mfma_f32_16x16x32_bf16 v[28:31], v[60:63], a[76:79], v[28:31]
 s_waitcnt lgkmcnt(2)
 v_mfma_f32_16x16x32_bf16 v[16:19], v[64:67], a[80:83], v[16:19]
 ds_read_b128 v[48:51], v7 offset:20480
 v_mfma_f32_16x16x32_bf16 v[20:23], v[68:71], a[80:83], v[20:23]
 ds_read_b128 v[52:55], v7 offset:28672
 v_mfma_f32_16x16x32_bf16 v[24:27], v[64:67], a[84:87], v[24:27]
 buffer_load_dwordx4 v3, s[28:31], s53 offen offset:2048 sc1 lds
 v_mfma_f32_16x16x32_bf16 v[28:31], v[68:71], a[84:87], v[28:31]
 s_waitcnt lgkmcnt(2)
 v_mfma_f32_16x16x32_bf16 v[16:19], v[72:75], a[88:91], v[16:19]
 ds_read_b128 v[56:59], v7 offset:21504
 v_mfma_f32_16x16x32_bf16 v[20:23], v[76:79], a[88:91], v[20:23]
 ds_read_b128 v[60:63], v7 offset:29696
 v_mfma_f32_16x16x32_bf16 v[24:27], v[72:75], a[92:95], v[24:27]
 v_mfma_f32_16x16x32_bf16 v[28:31], v[76:79], a[92:95], v[28:31]
 s_waitcnt lgkmcnt(2)
 v_mfma_f32_16x16x32_bf16 v[16:19], v[48:51], a[96:99], v[16:19]
 ds_read_b128 v[64:67], v7 offset:22528
 v_mfma_f32_16x16x32_bf16 v[20:23], v[52:55], a[96:99], v[20:23]
 ds_read_b128 v[68:71], v7 offset:30720
 v_mfma_f32_16x16x32_bf16 v[24:27], v[48:51], a[100:103], v[24:27]
 buffer_load_dwordx4 v3, s[28:31], s53 offen offset:3072 sc1 lds
 v_mfma_f32_16x16x32_bf16 v[28:31], v[52:55], a[100:103], v[28:31]
 s_add_u32 s53, s53, s58
 s_waitcnt lgkmcnt(2)
 v_mfma_f32_16x16x32_bf16 v[16:19], v[56:59], a[104:107], v[16:19]
 ds_read_b128 v[72:75], v7 offset:23552
 v_mfma_f32_16x16x32_bf16 v[20:23], v[60:63], a[104:107], v[20:23]
 ds_read_b128 v[76:79], v7 offset:31744
 v_mfma_f32_16x16x32_bf16 v[24:27], v[56:59], a[108:111], v[24:27]
 v_mfma_f32_16x16x32_bf16 v[28:31], v[60:63], a[108:111], v[28:31]
 s_waitcnt lgkmcnt(2)
 v_mfma_f32_16x16x32_bf16 v[16:19], v[64:67], a[112:115], v[16:19]
 s_waitcnt vmcnt(20)
 s_barrier
 ds_read_b128 v[48:51], v7 offset:32768
 v_mfma_f32_16x16x32_bf16 v[20:23], v[68:71], a[112:115], v[20:23]
 ds_read_b128 v[52:55], v7 offset:40960
 v_mfma_f32_16x16x32_bf16 v[24:27], v[64:67], a[116:119], v[24:27]
 s_mov_b32 m0, s61
 s_nop 0
 v_mfma_f32_16x16x32_bf16 v[28:31], v[68:71], a[116:119], v[28:31]
 buffer_load_dwordx4 v3, s[28:31], s53 offen offset:0 sc1 lds
 s_waitcnt lgkmcnt(2)
 v_mfma_f32_16x16x32_bf16 v[16:19], v[72:75], a[120:123], v[16:19]
 ds_read_b128 v[56:59], v7 offset:33792
 v_mfma_f32_16x16x32_bf16 v[20:23], v[76:79], a[120:123], v[20:23]
 ds_read_b128 v[60:63], v7 offset:41984
 v_mfma_f32_16x16x32_bf16 v[24:27], v[72:75], a[124:127], v[24:27]
 v_mfma_f32_16x16x32_bf16 v[28:31], v[76:79], a[124:127], v[28:31]
 s_waitcnt lgkmcnt(2)
 v_mfma_f32_16x16x32_bf16 v[16:19], v[48:51], a[128:131], v[16:19]
 ds_read_b128 v[64:67], v7 offset:34816
 v_mfma_f32_16x16x32_bf16 v[20:23], v[52:55], a[128:131], v[20:23]
 ds_read_b128 v[68:71], v7 offset:43008
 v_mfma_f32_16x16x32_bf16 v[24:27], v[48:51], a[132:135], v[24:27]
 buffer_load_dwordx4 v3, s[28:31], s53 offen offset:1024 sc1 lds
 v_mfma_f32_16x16x32_bf16 v[28:31], v[52:55], a[132:135], v[28:31]
 s_waitcnt lgkmcnt(2)
 v_mfma_f32_16x16x32_bf16 v[16:19], v[56:59], a[136:139], v[16:19]
 ds_read_b128 v[72:75], v7 offset:35840
 v_mfma_f32_16x16x32_bf16 v[20:23], v[60:63], a[136:139], v[20:23]
 ds_read_b128 v[76:79], v7 offset:44032
 v_mfma_f32_16x16x32_bf16 v[24:27], v[56:59], a[140:143], v[24:27]
 v_mfma_f32_16x16x32_bf16 v[28:31], v[60:63], a[140:143], v[28:31]
 s_waitcnt lgkmcnt(2)
 v_mfma_f32_16x16x32_bf16 v[16:19], v[64:67], a[144:147], v[16:19]
 ds_read_b128 v[48:51], v7 offset:36864
 v_mfma_f32_16x16x32_bf16 v[20:23], v[68:71], a[144:147], v[20:23]
 ds_read_b128 v[52:55], v7 offset:45056
 v_mfma_f32_16x16x32_bf16 v[24:27], v[64:67], a[148:151], v[24:27]
 buffer_load_dwordx4 v3, s[28:31], s53 offen offset:2048 sc1 lds
 v_mfma_f32_16x16x32_bf16 v[28:31], v[68:71], a[148:151], v[28:31]
 s_waitcnt lgkmcnt(2)
 v_mfma_f32_16x16x32_bf16 v[16:19], v[72:75], a[152:155], v[16:19]
 ds_read_b128 v[56:59], v7 offset:37888
 v_mfma_f32_16x16x32_bf16 v[20:23], v[76:79], a[152:155], v[20:23]
 ds_read_b128 v[60:63], v7 offset:46080
 v_mfma_f32_16x16x32_bf16 v[24:27], v[72:75], a[156:159], v[24:27]
 v_mfma_f32_16x16x32_bf16 v[28:31], v[76:79], a[156:159], v[28:31]
 s_waitcnt lgkmcnt(2)
 v_mfma_f32_16x16x32_bf16 v[16:19], v[48:51], a[160:163], v[16:19]
 ds_read_b128 v[64:67], v7 offset:38912
 v_mfma_f32_16x16x32_bf16 v[20:23], v[52:55], a[160:163], v[20:23]
 ds_read_b128 v[68:71], v7 offset:47104
 v_mfma_f32_16x16x32_bf16 v[24:27], v[48:51], a[164:167], v[24:27]
 buffer_load_dwordx4 v3, s[28:31], s53 offen offset:3072 sc1 lds
 v_mfma_f32_16x16x32_bf16 v[28:31], v[52:55], a[164:167], v[28:31]
 s_add_u32 s53, s53, 8192
 s_waitcnt lgkmcnt(2)
 v_mfma_f32_16x16x32_bf16 v[16:19], v[56:59], a[168:171], v[16:19]
 ds_read_b128 v[72:75], v7 offset:39936
 v_mfma_f32_16x16x32_bf16 v[20:23], v[60:63], a[168:171], v[20:23]
 ds_read_b128 v[76:79], v7 offset:48128
 v_mfma_f32_16x16x32_bf16 v[24:27], v[56:59], a[172:175], v[24:27]
 v_mfma_f32_16x16x32_bf16 v[28:31], v[60:63], a[172:175], v[28:31]
 s_waitcnt lgkmcnt(2)
 v_mfma_f32_16x16x32_bf16 v[16:19], v[64:67], a[176:179], v[16:19]
 s_waitcnt vmcnt(20)
 s_barrier
 ds_read_b128 v[48:51], v7 offset:49152
 v_mfma_f32_16x16x32_bf16 v[20:23], v[68:71], a[176:179], v[20:23]
 ds_read_b128 v[52:55], v7 offset:57344
 v_mfma_f32_16x16x32_bf16 v[24:27], v[64:67], a[180:183], v[24:27]
 s_add_u32 m0, s61, 16384
 s_nop 0
 v_mfma_f32_16x16x32_bf16 v[28:31], v[68:71], a[180:183], v[28:31]
 buffer_load_dwordx4 v3, s[28:31], s53 offen offset:0 sc1 lds
 s_waitcnt lgkmcnt(2)
 v_mfma_f32_16x16x32_bf16 v[16:19], v[72:75], a[184:187], v[16:19]
 ds_read_b128 v[56:59], v7 offset:50176
 v_mfma_f32_16x16x32_bf16 v[20:23], v[76:79], a[184:187], v[20:23]
 ds_read_b128 v[60:63], v7 offset:58368
 v_mfma_f32_16x16x32_bf16 v[24:27], v[72:75], a[188:191], v[24:27]
 v_mfma_f32_16x16x32_bf16 v[28:31], v[76:79], a[188:191], v[28:31]
 s_waitcnt lgkmcnt(2)
 v_mfma_f32_16x16x32_bf16 v[16:19], v[48:51], a[192:195], v[16:19]
 ds_read_b128 v[64:67], v7 offset:51200
 v_mfma_f32_16x16x32_bf16 v[20:23], v[52:55], a[192:195], v[20:23]
 ds_read_b128 v[68:71], v7 offset:59392
 v_mfma_f32_16x16x32_bf16 v[24:27], v[48:51], a[196:199], v[24:27]
 buffer_load_dwordx4 v3, s[28:31], s53 offen offset:1024 sc1 lds
 v_mfma_f32_16x16x32_bf16 v[28:31], v[52:55], a[196:199], v[28:31]
 s_waitcnt lgkmcnt(2)
 v_mfma_f32_16x16x32_bf16 v[16:19], v[56:59], a[200:203], v[16:19]
 ds_read_b128 v[72:75], v7 offset:52224
 v_mfma_f32_16x16x32_bf16 v[20:23], v[60:63], a[200:203], v[20:23]
 ds_read_b128 v[76:79], v7 offset:60416
 v_mfma_f32_16x16x32_bf16 v[24:27], v[56:59], a[204:207], v[24:27]
 v_mfma_f32_16x16x32_bf16 v[28:31], v[60:63], a[204:207], v[28:31]
 s_waitcnt lgkmcnt(2)
 v_mfma_f32_16x16x32_bf16 v[16:19], v[64:67], a[208:211], v[16:19]
 ds_read_b128 v[48:51], v7 offset:53248
 v_mfma_f32_16x16x32_bf16 v[20:23], v[68:71], a[208:211], v[20:23]
 ds_read_b128 v[52:55], v7 offset:61440
 v_mfma_f32_16x16x32_bf16 v[24:27], v[64:67], a[212:215], v[24:27]
 buffer_load_dwordx4 v3, s[28:31], s53 offen offset:2048 sc1 lds
 v_mfma_f32_16x16x32_bf16 v[28:31], v[68:71], a[212:215], v[28:31]
 s_waitcnt lgkmcnt(2)
 v_mfma_f32_16x16x32_bf16 v[16:19], v[72:75], a[216:219], v[16:19]
 ds_read_b128 v[56:59], v7 offset:54272
 v_mfma_f32_16x16x32_bf16 v[20:23], v[76:79], a[216:219], v[20:23]
 ds_read_b128 v[60:63], v7 offset:62464
 v_mfma_f32_16x16x32_bf16 v[24:27], v[72:75], a[220:223], v[24:27]
 v_mfma_f32_16x16x32_bf16 v[28:31], v[76:79], a[220:223], v[28:31]
 s_waitcnt lgkmcnt(2)
 v_mfma_f32_16x16x32_bf16 v[16:19], v[48:51], a[224:227], v[16:19]
 ds_read_b128 v[64:67], v7 offset:55296
 v_mfma_f32_16x16x32_bf16 v[20:23], v[52:55], a[224:227], v[20:23]
 ds_read_b128 v[68:71], v7 offset:63488
 v_mfma_f32_16x16x32_bf16 v[24:27], v[48:51], a[228:231], v[24:27]
 buffer_load_dwordx4 v3, s[28:31], s53 offen offset:3072 sc1 lds
 v_mfma_f32_16x16x32_bf16 v[28:31], v[52:55], a[228:231], v[28:31]
 s_add_u32 s53, s53, 8192
 s_waitcnt lgkmcnt(2)
 v_mfma_f32_16x16x32_bf16 v[16:19], v[56:59], a[232:235], v[16:19]
 ds_read_b128 v[72:75], v7 offset:56320
 v_mfma_f32_16x16x32_bf16 v[20:23], v[60:63], a[232:235], v[20:23]
 ds_read_b128 v[76:79], v7 offset:64512
 v_mfma_f32_16x16x32_bf16 v[24:27], v[56:59], a[236:239], v[24:27]
 v_mfma_f32_16x16x32_bf16 v[28:31], v[60:63], a[236:239], v[28:31]
 s_waitcnt lgkmcnt(2)
 v_mfma_f32_16x16x32_bf16 v[16:19], v[64:67], a[240:243], v[16:19]
 s_waitcnt vmcnt(20)
 s_barrier
 ds_read_b128 v[48:51], v8 offset:0
 v_mfma_f32_16x16x32_bf16 v[20:23], v[68:71], a[240:243], v[20:23]
 ds_read_b128 v[52:55], v8 offset:8192
 v_mfma_f32_16x16x32_bf16 v[24:27], v[64:67], a[244:247], v[24:27]
 s_add_u32 m0, s61, 32768
 s_nop 0
 v_mfma_f32_16x16x32_bf16 v[28:31], v[68:71], a[244:247], v[28:31]
 buffer_load_dwordx4 v3, s[28:31], s53 offen offset:0 sc1 lds
 s_waitcnt lgkmcnt(2)
 v_mfma_f32_16x16x32_bf16 v[16:19], v[72:75], a[248:251], v[16:19]
 ds_read_b128 v[56:59], v8 offset:1024
 v_mfma_f32_16x16x32_bf16 v[20:23], v[76:79], a[248:251], v[20:23]
 ds_read_b128 v[60:63], v8 offset:9216
 v_mfma_f32_16x16x32_bf16 v[24:27], v[72:75], a[252:255], v[24:27]
 v_mfma_f32_16x16x32_bf16 v[28:31], v[76:79], a[252:255], v[28:31]
 s_sub_u32 s57, s57, 1
 s_cbranch_scc1 L_v_end0
 s_waitcnt lgkmcnt(2)
 v_mfma_f32_16x16x32_bf16 v[32:35], v[48:51], a[0:3], 0
 ds_read_b128 v[64:67], v8 offset:2048
 v_mfma_f32_16x16x32_bf16 v[36:39], v[52:55], a[0:3], 0
 ds_read_b128 v[68:71], v8 offset:10240
 v_mfma_f32_16x16x32_bf16 v[40:43], v[48:51], a[4:7], 0
 buffer_load_dwordx4 v3, s[28:31], s53 offen offset:1024 sc1 lds
 v_mfma_f32_16x16x32_bf16 v[44:47], v[52:55], a[4:7], 0
 s_waitcnt lgkmcnt(2)
 v_mfma_f32_16x16x32_bf16 v[32:35], v[56:59], a[8:11], v[32:35]
 ds_read_b128 v[72:75], v8 offset:3072
 v_mfma_f32_16x16x32_bf16 v[36:39], v[60:63], a[8:11], v[36:39]
 ds_read_b128 v[76:79], v8 offset:11264
 v_mfma_f32_16x16x32_bf16 v[40:43], v[56:59], a[12:15], v[40:43]
 v_cvt_pk_bf16_f32 v80, v16, v17
 v_cvt_pk_bf16_f32 v81, v18, v19
 v_mfma_f32_16x16x32_bf16 v[44:47], v[60:63], a[12:15], v[44:47]
 v_cvt_pk_bf16_f32 v82, v20, v21
 s_waitcnt lgkmcnt(2)
 v_mfma_f32_16x16x32_bf16 v[32:35], v[64:67], a[16:19], v[32:35]
 ds_read_b128 v[48:51], v8 offset:4096
 v_mfma_f32_16x16x32_bf16 v[36:39], v[68:71], a[16:19], v[36:39]
 ds_read_b128 v[52:55], v8 offset:12288
 v_mfma_f32_16x16x32_bf16 v[40:43], v[64:67], a[20:23], v[40:43]
 buffer_load_dwordx4 v3, s[28:31], s53 offen offset:2048 sc1 lds
 v_mfma_f32_16x16x32_bf16 v[44:47], v[68:71], a[20:23], v[44:47]
 s_waitcnt lgkmcnt(2)
 v_mfma_f32_16x16x32_bf16 v[32:35], v[72:75], a[24:27], v[32:35]
 ds_read_b128 v[56:59], v8 offset:5120
 v_mfma_f32_16x16x32_bf16 v[36:39], v[76:79], a[24:27], v[36:39]
 ds_read_b128 v[60:63], v8 offset:13312
 v_mfma_f32_16x16x32_bf16 v[40:43], v[72:75], a[28:31], v[40:43]
 v_cvt_pk_bf16_f32 v83, v22, v23
 buffer_store_dwordx4 v[80:83], v3, s[28:31], s54 offen sc1
 v_mfma_f32_16x16x32_bf16 v[44:47], v[76:79], a[28:31], v[44:47]
 s_add_u32 s54, s54, s56
 s_waitcnt lgkmcnt(2)
 v_mfma_f32_16x16x32_bf16 v[32:35], v[48:51], a[32:35], v[32:35]
 ds_read_b128 v[64:67], v8 offset:6144
 v_mfma_f32_16x16x32_bf16 v[36:39], v[52:55], a[32:35], v[36:39]
 ds_read_b128 v[68:71], v8 offset:14336
 v_mfma_f32_16x16x32_bf16 v[40:43], v[48:51], a[36:39], v[40:43]
 buffer_load_dwordx4 v3, s[28:31], s53 offen offset:3072 sc1 lds
 v_mfma_f32_16x16x32_bf16 v[44:47], v[52:55], a[36:39], v[44:47]
 s_add_u32 s53, s53, 8192
 s_waitcnt lgkmcnt(2)
 v_mfma_f32_16x16x32_bf16 v[32:35], v[56:59], a[40:43], v[32:35]
 ds_read_b128 v[72:75], v8 offset:7168
 v_mfma_f32_16x16x32_bf16 v[36:39], v[60:63], a[40:43], v[36:39]
 ds_read_b128 v[76:79], v8 offset:15360
 v_mfma_f32_16x16x32_bf16 v[40:43], v[56:59], a[44:47], v[40:43]
 v_cvt_pk_bf16_f32 v84, v24, v25
 v_cvt_pk_bf16_f32 v85, v26, v27
 v_mfma_f32_16x16x32_bf16 v[44:47], v[60:63], a[44:47], v[44:47]
 v_cvt_pk_bf16_f32 v86, v28, v29
 s_waitcnt lgkmcnt(2)
 v_mfma_f32_16x16x32_bf16 v[32:35], v[64:67], a[48:51], v[32:35]
 s_waitcnt vmcnt(21)
 s_barrier
 ds_read_b128 v[48:51], v8 offset:16384
 v_mfma_f32_16x16x32_bf16 v[36:39], v[68:71], a[48:51], v[36:39]
 ds_read_b128 v[52:55], v8 offset:24576
 v_mfma_f32_16x16x32_bf16 v[40:43], v[64:67], a[52:55], v[40:43]
 s_add_u32 m0, s61, 49152
 s_nop 0
 v_mfma_f32_16x16x32_bf16 v[44:47], v[68:71], a[52:55], v[44:47]
 buffer_load_dwordx4 v3, s[28:31], s53 offen offset:0 sc1 lds
 s_waitcnt lgkmcnt(2)
 v_mfma_f32_16x16x32_bf16 v[32:35], v[72:75], a[56:59], v[32:35]
 ds_read_b128 v[56:59], v8 offset:17408
 v_mfma_f32_16x16x32_bf16 v[36:39], v[76:79], a[56:59], v[36:39]
 ds_read_b128 v[60:63], v8 offset:25600
 v_mfma_f32_16x16x32_bf16 v[40:43], v[72:75], a[60:63], v[40:43]
 v_cvt_pk_bf16_f32 v87, v30, v31
 buffer_store_dwordx4 v[84:87], v3, s[28:31], s55 offen sc1
 v_mfma_f32_16x16x32_bf16 v[44:47], v[76:79], a[60:63], v[44:47]
 s_add_u32 s55, s55, s56
 s_waitcnt lgkmcnt(2)
 v_mfma_f32_16x16x32_bf16 v[32:35], v[48:51], a[64:67], v[32:35]
 ds_read_b128 v[64:67], v8 offset:18432
 v_mfma_f32_16x16x32_bf16 v[36:39], v[52:55], a[64:67], v[36:39]
 ds_read_b128 v[68:71], v8 offset:26624
 v_mfma_f32_16x16x32_bf16 v[40:43], v[48:51], a[68:71], v[40:43]
 buffer_load_dwordx4 v3, s[28:31], s53 offen offset:1024 sc1 lds
 v_mfma_f32_16x16x32_bf16 v[44:47], v[52:55], a[68:71], v[44:47]
 s_waitcnt lgkmcnt(2)
 v_mfma_f32_16x16x32_bf16 v[32:35], v[56:59], a[72:75], v[32:35]
 ds_read_b128 v[72:75], v8 offset:19456
 v_mfma_f32_16x16x32_bf16 v[36:39], v[60:63], a[72:75], v[36:39]
 ds_read_b128 v[76:79], v8 offset:27648
 v_mfma_f32_16x16x32_bf16 v[40:43], v[56:59], a[76:79], v[40:43]
 v_mfma_f32_16x16x32_bf16 v[44:47], v[60:63], a[76:79], v[44:47]
 s_waitcnt lgkmcnt(2)
 v_mfma_f32_16x16x32_bf16 v[32:35], v[64:67], a[80:83], v[32:35]
 ds_read_b128 v[48:51], v8 offset:20480
 v_mfma_f32_16x16x32_bf16 v[36:39], v[68:71], a[80:83], v[36:39]
 ds_read_b128 v[52:55], v8 offset:28672
 v_mfma_f32_16x16x32_bf16 v[40:43], v[64:67], a[84:87], v[40:43]
 buffer_load_dwordx4 v3, s[28:31], s53 offen offset:2048 sc1 lds
 v_mfma_f32_16x16x32_bf16 v[44:47], v[68:71], a[84:87], v[44:47]
 s_waitcnt lgkmcnt(2)
 v_mfma_f32_16x16x32_bf16 v[32:35], v[72:75], a[88:91], v[32:35]
 ds_read_b128 v[56:59], v8 offset:21504
 v_mfma_f32_16x16x32_bf16 v[36:39], v[76:79], a[88:91], v[36:39]
 ds_read_b128 v[60:63], v8 offset:29696
 v_mfma_f32_16x16x32_bf16 v[40:43], v[72:75], a[92:95], v[40:43]
 v_mfma_f32_16x16x32_bf16 v[44:47], v[76:79], a[92:95], v[44:47]
 s_waitcnt lgkmcnt(2)
 v_mfma_f32_16x16x32_bf16 v[32:35], v[48:51], a[96:99], v[32:35]
 ds_read_b128 v[64:67], v8 offset:22528
 v_mfma_f32_16x16x32_bf16 v[36:39], v[52:55], a[96:99], v[36:39]
 ds_read_b128 v[68:71], v8 offset:30720
 v_mfma_f32_16x16x32_bf16 v[40:43], v[48:51], a[100:103], v[40:43]
 buffer_load_dwordx4 v3, s[28:31], s53 offen offset:3072 sc1 lds
 v_mfma_f32_16x16x32_bf16 v[44:47], v[52:55], a[100:103], v[44:47]
 s_add_u32 s53, s53, s58
 s_waitcnt lgkmcnt(2)
 v_mfma_f32_16x16x32_bf16 v[32:35], v[56:59], a[104:107], v[32:35]
 ds_read_b128 v[72:75], v8 offset:23552
 v_mfma_f32_16x16x32_bf16 v[36:39], v[60:63], a[104:107], v[36:39]
 ds_read_b128 v[76:79], v8 offset:31744
 v_mfma_f32_16x16x32_bf16 v[40:43], v[56:59], a[108:111], v[40:43]
 v_mfma_f32_16x16x32_bf16 v[44:47], v[60:63], a[108:111], v[44:47]
 s_waitcnt lgkmcnt(2)
 v_mfma_f32_16x16x32_bf16 v[32:35], v[64:67], a[112:115], v[32:35]
 s_waitcnt vmcnt(3)
 s_barrier
 ds_read_b128 v[48:51], v8 offset:32768
 v_mfma_f32_16x16x32_bf16 v[36:39], v[68:71], a[112:115], v[36:39]
 ds_read_b128 v[52:55], v8 offset:40960
 v_mfma_f32_16x16x32_bf16 v[40:43], v[64:67], a[116:119], v[40:43]
 s_add_u32 m0, s61, 65536
 s_nop 0
 v_mfma_f32_16x16x32_bf16 v[44:47], v[68:71], a[116:119], v[44:47]
 buffer_load_dwordx4 v3, s[28:31], s53 offen offset:0 sc1 lds
 s_waitcnt lgkmcnt(2)
 v_mfma_f32_16x16x32_bf16 v[32:35], v[72:75], a[120:123], v[32:35]
 ds_read_b128 v[56:59], v8 offset:33792
 v_mfma_f32_16x16x32_bf16 v[36:39], v[76:79], a[120:123], v[36:39]
 ds_read_b128 v[60:63], v8 offset:41984
 v_mfma_f32_16x16x32_bf16 v[40:43], v[72:75], a[124:127], v[40:43]
 v_mfma_f32_16x16x32_bf16 v[44:47], v[76:79], a[124:127], v[44:47]
 s_waitcnt lgkmcnt(2)
 v_mfma_f32_16x16x32_bf16 v[32:35], v[48:51], a[128:131], v[32:35]
 ds_read_b128 v[64:67], v8 offset:34816
 v_mfma_f32_16x16x32_bf16 v[36:39], v[52:55], a[128:131], v[36:39]
 ds_read_b128 v[68:71], v8 offset:43008
 v_mfma_f32_16x16x32_bf16 v[40:43], v[48:51], a[132:135], v[40:43]
 buffer_load_dwordx4 v3, s[28:31], s53 offen offset:1024 sc1 lds
 v_mfma_f32_16x16x32_bf16 v[44:47], v[52:55], a[132:135], v[44:47]
 s_waitcnt lgkmcnt(2)
 v_mfma_f32_16x16x32_bf16 v[32:35], v[56:59], a[136:139], v[32:35]
 ds_read_b128 v[72:75], v8 offset:35840
 v_mfma_f32_16x16x32_bf16 v[36:39], v[60:63], a[136:139], v[36:39]
 ds_read_b128 v[76:79], v8 offset:44032
 v_mfma_f32_16x16x32_bf16 v[40:43], v[56:59], a[140:143], v[40:43]
 s_add_u32 s64, s64, 2
 v_mov_b32 v1, s64
 v_mfma_f32_16x16x32_bf16 v[44:47], v[60:63], a[140:143], v[44:47]
 buffer_store_dword v1, v2, s[28:31], s59 offen sc1
 s_waitcnt lgkmcnt(2)
 v_mfma_f32_16x16x32_bf16 v[32:35], v[64:67], a[144:147], v[32:35]
 ds_read_b128 v[48:51], v8 offset:36864
 v_mfma_f32_16x16x32_bf16 v[36:39], v[68:71], a[144:147], v[36:39]
 ds_read_b128 v[52:55], v8 offset:45056
 v_mfma_f32_16x16x32_bf16 v[40:43], v[64:67], a[148:151], v[40:43]
 buffer_load_dwordx4 v3, s[28:31], s53 offen offset:2048 sc1 lds
 v_mfma_f32_16x16x32_bf16 v[44:47], v[68:71], a[148:151], v[44:47]
 s_waitcnt lgkmcnt(2)
 v_mfma_f32_16x16x32_bf16 v[32:35], v[72:75], a[152:155], v[32:35]
 ds_read_b128 v[56:59], v8 offset:37888
 v_mfma_f32_16x16x32_bf16 v[36:39], v[76:79], a[152:155], v[36:39]
 ds_read_b128 v[60:63], v8 offset:46080
 v_mfma_f32_16x16x32_bf16 v[40:43], v[72:75], a[156:159], v[40:43]
 v_mfma_f32_16x16x32_bf16 v[44:47], v[76:79], a[156:159], v[44:47]
 s_waitcnt lgkmcnt(2)
 v_mfma_f32_16x16x32_bf16 v[32:35], v[48:51], a[160:163], v[32:35]
 ds_read_b128 v[64:67], v8 offset:38912
 v_mfma_f32_16x16x32_bf16 v[36:39], v[52:55], a[160:163], v[36:39]
 ds_read_b128 v[68:71], v8 offset:47104
 v_mfma_f32_16x16x32_bf16 v[40:43], v[48:51], a[164:167], v[40:43]
 buffer_load_dwordx4 v3, s[28:31], s53 offen offset:3072 sc1 lds
 v_mfma_f32_16x16x32_bf16 v[44:47], v[52:55], a[164:167], v[44:47]
 s_add_u32 s53, s53, 8192
 s_waitcnt lgkmcnt(2)
 v_mfma_f32_16x16x32_bf16 v[32:35], v[56:59], a[168:171], v[32:35]
 ds_read_b128 v[72:75], v8 offset:39936
 v_mfma_f32_16x16x32_bf16 v[36:39], v[60:63], a[168:171], v[36:39]
 ds_read_b128 v[76:79], v8 offset:48128
 v_mfma_f32_16x16x32_bf16 v[40:43], v[56:59], a[172:175], v[40:43]
 v_mfma_f32_16x16x32_bf16 v[44:47], v[60:63], a[172:175], v[44:47]
 s_waitcnt lgkmcnt(2)
 v_mfma_f32_16x16x32_bf16 v[32:35], v[64:67], a[176:179], v[32:35]
 s_waitcnt vmcnt(23)
 s_barrier
 ds_read_b128 v[48:51], v8 offset:49152
 v_mfma_f32_16x16x32_bf16 v[36:39], v[68:71], a[176:179], v[36:39]
 ds_read_b128 v[52:55], v8 offset:57344
 v_mfma_f32_16x16x32_bf16 v[40:43], v[64:67], a[180:183], v[40:43]
 s_add_u32 m0, s61, 81920
 s_nop 0
 v_mfma_f32_16x16x32_bf16 v[44:47], v[68:71], a[180:183], v[44:47]
 buffer_load_dwordx4 v3, s[28:31], s53 offen offset:0 sc1 lds
 s_waitcnt lgkmcnt(2)
 v_mfma_f32_16x16x32_bf16 v[32:35], v[72:75], a[184:187], v[32:35]
 ds_read_b128 v[56:59], v8 offset:50176
 v_mfma_f32_16x16x32_bf16 v[36:39], v[76:79], a[184:187], v[36:39]
 ds_read_b128 v[60:63], v8 offset:58368
 v_mfma_f32_16x16x32_bf16 v[40:43], v[72:75], a[188:191], v[40:43]
 v_mfma_f32_16x16x32_bf16 v[44:47], v[76:79], a[188:191], v[44:47]
 s_waitcnt lgkmcnt(2)
 v_mfma_f32_16x16x32_bf16 v[32:35], v[48:51], a[192:195], v[32:35]
 ds_read_b128 v[64:67], v8 offset:51200
 v_mfma_f32_16x16x32_bf16 v[36:39], v[52:55], a[192:195], v[36:39]
 ds_read_b128 v[68:71], v8 offset:59392
 v_mfma_f32_16x16x32_bf16 v[40:43], v[48:51], a[196:199], v[40:43]
 buffer_load_dwordx4 v3, s[28:31], s53 offen offset:1024 sc1 lds
 v_mfma_f32_16x16x32_bf16 v[44:47], v[52:55], a[196:199], v[44:47]
 s_waitcnt lgkmcnt(2)
 v_mfma_f32_16x16x32_bf16 v[32:35], v[56:59], a[200:203], v[32:35]
 ds_read_b128 v[72:75], v8 offset:52224
 v_mfma_f32_16x16x32_bf16 v[36:39], v[60:63], a[200:203], v[36:39]
 ds_read_b128 v[76:79], v8 offset:60416
 v_mfma_f32_16x16x32_bf16 v[40:43], v[56:59], a[204:207], v[40:43]
 v_mfma_f32_16x16x32_bf16 v[44:47], v[60:63], a[204:207], v[44:47]
 s_waitcnt lgkmcnt(2)
 v_mfma_f32_16x16x32_bf16 v[32:35], v[64:67], a[208:211], v[32:35]
 ds_read_b128 v[48:51], v8 offset:53248
 v_mfma_f32_16x16x32_bf16 v[36:39], v[68:71], a[208:211], v[36:39]
 ds_read_b128 v[52:55], v8 offset:61440
 v_mfma_f32_16x16x32_bf16 v[40:43], v[64:67], a[212:215], v[40:43]
 buffer_load_dwordx4 v3, s[28:31], s53 offen offset:2048 sc1 lds
 v_mfma_f32_16x16x32_bf16 v[44:47], v[68:71], a[212:215], v[44:47]
 s_waitcnt lgkmcnt(2)
 v_mfma_f32_16x16x32_bf16 v[32:35], v[72:75], a[216:219], v[32:35]
 ds_read_b128 v[56:59], v8 offset:54272
 v_mfma_f32_16x16x32_bf16 v[36:39], v[76:79], a[216:219], v[36:39]
 ds_read_b128 v[60:63], v8 offset:62464
 v_mfma_f32_16x16x32_bf16 v[40:43], v[72:75], a[220:223], v[40:43]
 v_mfma_f32_16x16x32_bf16 v[44:47], v[76:79], a[220:223], v[44:47]
 s_waitcnt lgkmcnt(2)
 v_mfma_f32_16x16x32_bf16 v[32:35], v[48:51], a[224:227], v[32:35]
 ds_read_b128 v[64:67], v8 offset:55296
 v_mfma_f32_16x16x32_bf16 v[36:39], v[52:55], a[224:227], v[36:39]
 ds_read_b128 v[68:71], v8 offset:63488
 v_mfma_f32_16x16x32_bf16 v[40:43], v[48:51], a[228:231], v[40:43]
 buffer_load_dwordx4 v3, s[28:31], s53 offen offset:3072 sc1 lds
 v_mfma_f32_16x16x32_bf16 v[44:47], v[52:55], a[228:231], v[44:47]
 s_add_u32 s53, s53, 8192
 s_waitcnt lgkmcnt(2)
 v_mfma_f32_16x16x32_bf16 v[32:35], v[56:59], a[232:235], v[32:35]
 ds_read_b128 v[72:75], v8 offset:56320
 v_mfma_f32_16x16x32_bf16 v[36:39], v[60:63], a[232:235], v[36:39]
 ds_read_b128 v[76:79], v8 offset:64512
 v_mfma_f32_16x16x32_bf16 v[40:43], v[56:59], a[236:239], v[40:43]
 v_mfma_f32_16x16x32_bf16 v[44:47], v[60:63], a[236:239], v[44:47]
 s_waitcnt lgkmcnt(2)
 v_mfma_f32_16x16x32_bf16 v[32:35], v[64:67], a[240:243], v[32:35]
 s_waitcnt vmcnt(23)
 s_barrier
 ds_read_b128 v[48:51], v7 offset:0
 v_mfma_f32_16x16x32_bf16 v[36:39], v[68:71], a[240:243], v[36:39]
 ds_read_b128 v[52:55], v7 offset:8192
 v_mfma_f32_16x16x32_bf16 v[40:43], v[64:67], a[244:247], v[40:43]
 s_add_u32 m0, s61, 98304
 s_nop 0
 v_mfma_f32_16x16x32_bf16 v[44:47], v[68:71], a[244:247], v[44:47]
 buffer_load_dwordx4 v3, s[28:31], s53 offen offset:0 sc1 lds
 s_waitcnt lgkmcnt(2)
 v_mfma_f32_16x16x32_bf16 v[32:35], v[72:75], a[248:251], v[32:35]
 ds_read_b128 v[56:59], v7 offset:1024
 v_mfma_f32_16x16x32_bf16 v[36:39], v[76:79], a[248:251], v[36:39]
 ds_read_b128 v[60:63], v7 offset:9216
 v_mfma_f32_16x16x32_bf16 v[40:43], v[72:75], a[252:255], v[40:43]
 v_mfma_f32_16x16x32_bf16 v[44:47], v[76:79], a[252:255], v[44:47]
 s_sub_u32 s57, s57, 1
 s_cbranch_scc1 L_v_end1
 v_mov_b32 v1, 0
gw_34:
 global_load_dword v9, v1, s[22:23] offset:4 sc1
 s_waitcnt vmcnt(0)
 v_readfirstlane_b32 s48, v9
 s_cmp_ge_u32 s48, 128
 s_cbranch_scc1 gwd_35
 s_sub_u32 s26, s26, 1
 s_cbranch_scc1 L_end
 s_sleep 2
 s_branch gw_34
gwd_35:
 s_waitcnt lgkmcnt(2)
 v_mfma_f32_16x16x32_bf16 v[16:19], v[48:51], a[0:3], 0
 ds_read_b128 v[64:67], v7 offset:2048
 v_mfma_f32_16x16x32_bf16 v[20:23], v[52:55], a[0:3], 0
 ds_read_b128 v[68:71], v7 offset:10240
 v_mfma_f32_16x16x32_bf16 v[24:27], v[48:51], a[4:7], 0
 buffer_load_dwordx4 v3, s[28:31], s53 offen offset:1024 sc1 lds
 v_mfma_f32_16x16x32_bf16 v[28:31], v[52:55], a[4:7], 0
 s_waitcnt lgkmcnt(2)
 v_mfma_f32_16x16x32_bf16 v[16:19], v[56:59], a[8:11], v[16:19]
 ds_read_b128 v[72:75], v7 offset:3072
 v_mfma_f32_16x16x32_bf16 v[20:23], v[60:63], a[8:11], v[20:23]
 ds_read_b128 v[76:79], v7 offset:11264
 v_mfma_f32_16x16x32_bf16 v[24:27], v[56:59], a[12:15], v[24:27]
 v_cvt_pk_bf16_f32 v80, v32, v33
 v_cvt_pk_bf16_f32 v81, v34, v35
 v_mfma_f32_16x16x32_bf16 v[28:31], v[60:63], a[12:15], v[28:31]
 v_cvt_pk_bf16_f32 v82, v36, v37
 s_waitcnt lgkmcnt(2)
 v_mfma_f32_16x16x32_bf16 v[16:19], v[64:67], a[16:19], v[16:19]
 ds_read_b128 v[48:51], v7 offset:4096
 v_mfma_f32_16x16x32_bf16 v[20:23], v[68:71], a[16:19], v[20:23]
 ds_read_b128 v[52:55], v7 offset:12288
 v_mfma_f32_16x16x32_bf16 v[24:27], v[64:67], a[20:23], v[24:27]
 buffer_load_dwordx4 v3, s[28:31], s53 offen offset:2048 sc1 lds
 v_mfma_f32_16x16x32_bf16 v[28:31], v[68:71], a[20:23], v[28:31]
 s_waitcnt lgkmcnt(2)
 v_mfma_f32_16x16x32_bf16 v[16:19], v[72:75], a[24:27], v[16:19]
 ds_read_b128 v[56:59], v7 offset:5120
 v_mfma_f32_16x16x32_bf16 v[20:23], v[76:79], a[24:27], v[20:23]
 ds_read_b128 v[60:63], v7 offset:13312
 v_mfma_f32_16x16x32_bf16 v[24:27], v[72:75], a[28:31], v[24:27]
 v_cvt_pk_bf16_f32 v83, v38, v39
 buffer_store_dwordx4 v[80:83], v3, s[28:31], s54 offen sc1
 v_mfma_f32_16x16x32_bf16 v[28:31], v[76:79], a[28:31], v[28:31]
 s_add_u32 s54, s54, s56
 s_waitcnt lgkmcnt(2)
 v_mfma_f32_16x16x32_bf16 v[16:19], v[48:51], a[32:35], v[16:19]
 ds_read_b128 v[64:67], v7 offset:6144
 v_mfma_f32_16x16x32_bf16 v[20:23], v[52:55], a[32:35], v[20:23]
 ds_read_b128 v[68:71], v7 offset:14336
 v_mfma_f32_16x16x32_bf16 v[24:27], v[48:51], a[36:39], v[24:27]
 buffer_load_dwordx4 v3, s[28:31], s53 offen offset:3072 sc1 lds
 v_mfma_f32_16x16x32_bf16 v[28:31], v[52:55], a[36:39], v[28:31]
 s_add_u32 s53, s53, 8192
 s_waitcnt lgkmcnt(2)
 v_mfma_f32_16x16x32_bf16 v[16:19], v[56:59], a[40:43], v[16:19]
 ds_read_b128 v[72:75], v7 offset:7168
 v_mfma_f32_16x16x32_bf16 v[20:23], v[60:63], a[40:43], v[20:23]
 ds_read_b128 v[76:79], v7 offset:15360
 v_mfma_f32_16x16x32_bf16 v[24:27], v[56:59], a[44:47], v[24:27]
 v_cvt_pk_bf16_f32 v84, v40, v41
 v_cvt_pk_bf16_f32 v85, v42, v43
 v_mfma_f32_16x16x32_bf16 v[28:31], v[60:63], a[44:47], v[28:31]
 v_cvt_pk_bf16_f32 v86, v44, v45
 s_waitcnt lgkmcnt(2)
 v_mfma_f32_16x16x32_bf16 v[16:19], v[64:67], a[48:51], v[16:19]
 s_waitcnt vmcnt(24)
 s_barrier
 ds_read_b128 v[48:51], v7 offset:16384
 v_mfma_f32_16x16x32_bf16 v[20:23], v[68:71], a[48:51], v[20:23]
 ds_read_b128 v[52:55], v7 offset:24576
 v_mfma_f32_16x16x32_bf16 v[24:27], v[64:67], a[52:55], v[24:27]
 s_add_u32 m0, s61, 114688
 s_nop 0
 v_mfma_f32_16x16x32_bf16 v[28:31], v[68:71], a[52:55], v[28:31]
 buffer_load_dwordx4 v3, s[28:31], s53 offen offset:0 sc1 lds
 s_waitcnt lgkmcnt(2)
 v_mfma_f32_16x16x32_bf16 v[16:19], v[72:75], a[56:59], v[16:19]
 ds_read_b128 v[56:59], v7 offset:17408
 v_mfma_f32_16x16x32_bf16 v[20:23], v[76:79], a[56:59], v[20:23]
 ds_read_b128 v[60:63], v7 offset:25600
 v_mfma_f32_16x16x32_bf16 v[24:27], v[72:75], a[60:63], v[24:27]
 v_cvt_pk_bf16_f32 v87, v46, v47
 buffer_store_dwordx4 v[84:87], v3, s[28:31], s55 offen sc1
 v_mfma_f32_16x16x32_bf16 v[28:31], v[76:79], a[60:63], v[28:31]
 s_add_u32 s55, s55, s56
 s_waitcnt lgkmcnt(2)
 v_mfma_f32_16x16x32_bf16 v[16:19], v[48:51], a[64:67], v[16:19]
 ds_read_b128 v[64:67], v7 offset:18432
 v_mfma_f32_16x16x32_bf16 v[20:23], v[52:55], a[64:67], v[20:23]
 ds_read_b128 v[68:71], v7 offset:26624
 v_mfma_f32_16x16x32_bf16 v[24:27], v[48:51], a[68:71], v[24:27]
 buffer_load_dwordx4 v3, s[28:31], s53 offen offset:1024 sc1 lds
 v_mfma_f32_16x16x32_bf16 v[28:31], v[52:55], a[68:71], v[28:31]
 s_waitcnt lgkmcnt(2)
 v_mfma_f32_16x16x32_bf16 v[16:19], v[56:59], a[72:75], v[16:19]
 ds_read_b128 v[72:75], v7 offset:19456
 v_mfma_f32_16x16x32_bf16 v[20:23], v[60:63], a[72:75], v[20:23]
 ds_read_b128 v[76:79], v7 offset:27648
 v_mfma_f32_16x16x32_bf16 v[24:27], v[56:59], a[76:79], v[24:27]
 v_mfma_f32_16x16x32_bf16 v[28:31], v[60:63], a[76:79], v[28:31]
 s_waitcnt lgkmcnt(2)
 v_mfma_f32_16x16x32_bf16 v[16:19], v[64:67], a[80:83], v[16:19]
 ds_read_b128 v[48:51], v7 offset:20480
 v_mfma_f32_16x16x32_bf16 v[20:23], v[68:71], a[80:83], v[20:23]
 ds_read_b128 v[52:55], v7 offset:28672
 v_mfma_f32_16x16x32_bf16 v[24:27], v[64:67], a[84:87], v[24:27]
 buffer_load_dwordx4 v3, s[28:31], s53 offen offset:2048 sc1 lds
 v_mfma_f32_16x16x32_bf16 v[28:31], v[68:71], a[84:87], v[28:31]
 s_waitcnt lgkmcnt(2)
 v_mfma_f32_16x16x32_bf16 v[16:19], v[72:75], a[88:91], v[16:19]
 ds_read_b128 v[56:59], v7 offset:21504
 v_mfma_f32_16x16x32_bf16 v[20:23], v[76:79], a[88:91], v[20:23]
 ds_read_b128 v[60:63], v7 offset:29696
 v_mfma_f32_16x16x32_bf16 v[24:27], v[72:75], a[92:95], v[24:27]
 v_mfma_f32_16x16x32_bf16 v[28:31], v[76:79], a[92:95], v[28:31]
 s_waitcnt lgkmcnt(2)
 v_mfma_f32_16x16x32_bf16 v[16:19], v[48:51], a[96:99], v[16:19]
 ds_read_b128 v[64:67], v7 offset:22528
 v_mfma_f32_16x16x32_bf16 v[20:23], v[52:55], a[96:99], v[20:23]
 ds_read_b128 v[68:71], v7 offset:30720
 v_mfma_f32_16x16x32_bf16 v[24:27], v[48:51], a[100:103], v[24:27]
 buffer_load_dwordx4 v3, s[28:31], s53 offen offset:3072 sc1 lds
 v_mfma_f32_16x16x32_bf16 v[28:31], v[52:55], a[100:103], v[28:31]
 s_add_u32 s53, s53, s58
 s_waitcnt lgkmcnt(2)
 v_mfma_f32_16x16x32_bf16 v[16:19], v[56:59], a[104:107], v[16:19]
 ds_read_b128 v[72:75], v7 offset:23552
 v_mfma_f32_16x16x32_bf16 v[20:23], v[60:63], a[104:107], v[20:23]
 ds_read_b128 v[76:79], v7 offset:31744
 v_mfma_f32_16x16x32_bf16 v[24:27], v[56:59], a[108:111], v[24:27]
 v_mfma_f32_16x16x32_bf16 v[28:31], v[60:63], a[108:111], v[28:31]
 s_waitcnt lgkmcnt(2)
 v_mfma_f32_16x16x32_bf16 v[16:19], v[64:67], a[112:115], v[16:19]
 s_waitcnt vmcnt(24)
 s_barrier
 ds_read_b128 v[48:51], v7 offset:32768
 v_mfma_f32_16x16x32_bf16 v[20:23], v[68:71], a[112:115], v[20:23]
 ds_read_b128 v[52:55], v7 offset:40960
 v_mfma_f32_16x16x32_bf16 v[24:27], v[64:67], a[116:119], v[24:27]
 s_mov_b32 m0, s61
 s_nop 0
 v_mfma_f32_16x16x32_bf16 v[28:31], v[68:71], a[116:119], v[28:31]
 buffer_load_dwordx4 v3, s[28:31], s53 offen offset:0 sc1 lds
 s_waitcnt lgkmcnt(2)
 v_mfma_f32_16x16x32_bf16 v[16:19], v[72:75], a[120:123], v[16:19]
 ds_read_b128 v[56:59], v7 offset:33792
 v_mfma_f32_16x16x32_bf16 v[20:23], v[76:79], a[120:123], v[20:23]
 ds_read_b128 v[60:63], v7 offset:41984
 v_mfma_f32_16x16x32_bf16 v[24:27], v[72:75], a[124:127], v[24:27]
 v_mfma_f32_16x16x32_bf16 v[28:31], v[76:79], a[124:127], v[28:31]
 s_waitcnt lgkmcnt(2)
 v_mfma_f32_16x16x32_bf16 v[16:19], v[48:51], a[128:131], v[16:19]
 ds_read_b128 v[64:67], v7 offset:34816
 v_mfma_f32_16x16x32_bf16 v[20:23], v[52:55], a[128:131], v[20:23]
 ds_read_b128 v[68:71], v7 offset:43008
 v_mfma_f32_16x16x32_bf16 v[24:27], v[48:51], a[132:135], v[24:27]
 buffer_load_dwordx4 v3, s[28:31], s53 offen offset:1024 sc1 lds
 v_mfma_f32_16x16x32_bf16 v[28:31], v[52:55], a[132:135], v[28:31]
 s_waitcnt lgkmcnt(2)
 v_mfma_f32_16x16x32_bf16 v[16:19], v[56:59], a[136:139], v[16:19]
 ds_read_b128 v[72:75], v7 offset:35840
 v_mfma_f32_16x16x32_bf16 v[20:23], v[60:63], a[136:139], v[20:23]
 ds_read_b128 v[76:79], v7 offset:44032
 v_mfma_f32_16x16x32_bf16 v[24:27], v[56:59], a[140:143], v[24:27]
 v_mfma_f32_16x16x32_bf16 v[28:31], v[60:63], a[140:143], v[28:31]
 s_waitcnt lgkmcnt(2)
 v_mfma_f32_16x16x32_bf16 v[16:19], v[64:67], a[144:147], v[16:19]
 ds_read_b128 v[48:51], v7 offset:36864
 v_mfma_f32_16x16x32_bf16 v[20:23], v[68:71], a[144:147], v[20:23]
 ds_read_b128 v[52:55], v7 offset:45056
 v_mfma_f32_16x16x32_bf16 v[24:27], v[64:67], a[148:151], v[24:27]
 buffer_load_dwordx4 v3, s[28:31], s53 offen offset:2048 sc1 lds
 v_mfma_f32_16x16x32_bf16 v[28:31], v[68:71], a[148:151], v[28:31]
 s_waitcnt lgkmcnt(2)
 v_mfma_f32_16x16x32_bf16 v[16:19], v[72:75], a[152:155], v[16:19]
 ds_read_b128 v[56:59], v7 offset:37888
 v_mfma_f32_16x16x32_bf16 v[20:23], v[76:79], a[152:155], v[20:23]
 ds_read_b128 v[60:63], v7 offset:46080
 v_mfma_f32_16x16x32_bf16 v[24:27], v[72:75], a[156:159], v[24:27]
 v_mfma_f32_16x16x32_bf16 v[28:31], v[76:79], a[156:159], v[28:31]
 s_waitcnt lgkmcnt(2)
 v_mfma_f32_16x16x32_bf16 v[16:19], v[48:51], a[160:163], v[16:19]
 ds_read_b128 v[64:67], v7 offset:38912
 v_mfma_f32_16x16x32_bf16 v[20:23], v[52:55], a[160:163], v[20:23]
 ds_read_b128 v[68:71], v7 offset:47104
 v_mfma_f32_16x16x32_bf16 v[24:27], v[48:51], a[164:167], v[24:27]
 buffer_load_dwordx4 v3, s[28:31], s53 offen offset:3072 sc1 lds
 v_mfma_f32_16x16x32_bf16 v[28:31], v[52:55], a[164:167], v[28:31]
 s_add_u32 s53, s53, 8192
 s_waitcnt lgkmcnt(2)
 v_mfma_f32_16x16x32_bf16 v[16:19], v[56:59], a[168:171], v[16:19]
 ds_read_b128 v[72:75], v7 offset:39936
 v_mfma_f32_16x16x32_bf16 v[20:23], v[60:63], a[168:171], v[20:23]
 ds_read_b128 v[76:79], v7 offset:48128
 v_mfma_f32_16x16x32_bf16 v[24:27], v[56:59], a[172:175], v[24:27]
 v_mfma_f32_16x16x32_bf16 v[28:31], v[60:63], a[172:175], v[28:31]
 s_waitcnt lgkmcnt(2)
 v_mfma_f32_16x16x32_bf16 v[16:19], v[64:67], a[176:179], v[16:19]
 s_waitcnt vmcnt(23)
 s_barrier
 ds_read_b128 v[48:51], v7 offset:49152
 v_mfma_f32_16x16x32_bf16 v[20:23], v[68:71], a[176:179], v[20:23]
 ds_read_b128 v[52:55], v7 offset:57344
 v_mfma_f32_16x16x32_bf16 v[24:27], v[64:67], a[180:183], v[24:27]
 s_add_u32 m0, s61, 16384
 s_nop 0
 v_mfma_f32_16x16x32_bf16 v[28:31], v[68:71], a[180:183], v[28:31]
 buffer_load_dwordx4 v3, s[28:31], s53 offen offset:0 sc1 lds
 s_waitcnt lgkmcnt(2)
 v_mfma_f32_16x16x32_bf16 v[16:19], v[72:75], a[184:187], v[16:19]
 ds_read_b128 v[56:59], v7 offset:50176
 v_mfma_f32_16x16x32_bf16 v[20:23], v[76:79], a[184:187], v[20:23]
 ds_read_b128 v[60:63], v7 offset:58368
 v_mfma_f32_16x16x32_bf16 v[24:27], v[72:75], a[188:191], v[24:27]
 v_mfma_f32_16x16x32_bf16 v[28:31], v[76:79], a[188:191], v[28:31]
 s_waitcnt lgkmcnt(2)
 v_mfma_f32_16x16x32_bf16 v[16:19], v[48:51], a[192:195], v[16:19]
 ds_read_b128 v[64:67], v7 offset:51200
 v_mfma_f32_16x16x32_bf16 v[20:23], v[52:55], a[192:195], v[20:23]
 ds_read_b128 v[68:71], v7 offset:59392
 v_mfma_f32_16x16x32_bf16 v[24:27], v[48:51], a[196:199], v[24:27]
 buffer_load_dwordx4 v3, s[28:31], s53 offen offset:1024 sc1 lds
 v_mfma_f32_16x16x32_bf16 v[28:31], v[52:55], a[196:199], v[28:31]
 s_waitcnt lgkmcnt(2)
 v_mfma_f32_16x16x32_bf16 v[16:19], v[56:59], a[200:203], v[16:19]
 ds_read_b128 v[72:75], v7 offset:52224
 v_mfma_f32_16x16x32_bf16 v[20:23], v[60:63], a[200:203], v[20:23]
 ds_read_b128 v[76:79], v7 offset:60416
 v_mfma_f32_16x16x32_bf16 v[24:27], v[56:59], a[204:207], v[24:27]
 v_mfma_f32_16x16x32_bf16 v[28:31], v[60:63], a[204:207], v[28:31]
 s_waitcnt lgkmcnt(2)
 v_mfma_f32_16x16x32_bf16 v[16:19], v[64:67], a[208:211], v[16:19]
 ds_read_b128 v[48:51], v7 offset:53248
 v_mfma_f32_16x16x32_bf16 v[20:23], v[68:71], a[208:211], v[20:23]
 ds_read_b128 v[52:55], v7 offset:61440
 v_mfma_f32_16x16x32_bf16 v[24:27], v[64:67], a[212:215], v[24:27]
 buffer_load_dwordx4 v3, s[28:31], s53 offen offset:2048 sc1 lds
 v_mfma_f32_16x16x32_bf16 v[28:31], v[68:71], a[212:215], v[28:31]
 s_waitcnt lgkmcnt(2)
 v_mfma_f32_16x16x32_bf16 v[16:19], v[72:75], a[216:219], v[16:19]
 ds_read_b128 v[56:59], v7 offset:54272
 v_mfma_f32_16x16x32_bf16 v[20:23], v[76:79], a[216:219], v[20:23]
 ds_read_b128 v[60:63], v7 offset:62464
 v_mfma_f32_16x16x32_bf16 v[24:27], v[72:75], a[220:223], v[24:27]
 v_mfma_f32_16x16x32_bf16 v[28:31], v[76:79], a[220:223], v[28:31]
 s_waitcnt lgkmcnt(2)
 v_mfma_f32_16x16x32_bf16 v[16:19], v[48:51], a[224:227], v[16:19]
 ds_read_b128 v[64:67], v7 offset:55296
 v_mfma_f32_16x16x32_bf16 v[20:23], v[52:55], a[224:227], v[20:23]
 ds_read_b128 v[68:71], v7 offset:63488
 v_mfma_f32_16x16x32_bf16 v[24:27], v[48:51], a[228:231], v[24:27]
 buffer_load_dwordx4 v3, s[28:31], s53 offen offset:3072 sc1 lds
 v_mfma_f32_16x16x32_bf16 v[28:31], v[52:55], a[228:231], v[28:31]
 s_add_u32 s53, s53, 8192
 s_waitcnt lgkmcnt(2)
 v_mfma_f32_16x16x32_bf16 v[16:19], v[56:59], a[232:235], v[16:19]
 ds_read_b128 v[72:75], v7 offset:56320
 v_mfma_f32_16x16x32_bf16 v[20:23], v[60:63], a[232:235], v[20:23]
 ds_read_b128 v[76:79], v7 offset:64512
 v_mfma_f32_16x16x32_bf16 v[24:27], v[56:59], a[236:239], v[24:27]
 v_mfma_f32_16x16x32_bf16 v[28:31], v[60:63], a[236:239], v[28:31]
 s_waitcnt lgkmcnt(2)
 v_mfma_f32_16x16x32_bf16 v[16:19], v[64:67], a[240:243], v[16:19]
 s_waitcnt vmcnt(22)
 s_barrier
 ds_read_b128 v[48:51], v8 offset:0
 v_mfma_f32_16x16x32_bf16 v[20:23], v[68:71], a[240:243], v[20:23]
 ds_read_b128 v[52:55], v8 offset:8192
 v_mfma_f32_16x16x32_bf16 v[24:27], v[64:67], a[244:247], v[24:27]
 s_add_u32 m0, s61, 32768
 s_nop 0
 v_mfma_f32_16x16x32_bf16 v[28:31], v[68:71], a[244:247], v[28:31]
 buffer_load_dwordx4 v3, s[28:31], s53 offen offset:0 sc1 lds
 s_waitcnt lgkmcnt(2)
 v_mfma_f32_16x16x32_bf16 v[16:19], v[72:75], a[248:251], v[16:19]
 ds_read_b128 v[56:59], v8 offset:1024
 v_mfma_f32_16x16x32_bf16 v[20:23], v[76:79], a[248:251], v[20:23]
 ds_read_b128 v[60:63], v8 offset:9216
 v_mfma_f32_16x16x32_bf16 v[24:27], v[72:75], a[252:255], v[24:27]
 v_mfma_f32_16x16x32_bf16 v[28:31], v[76:79], a[252:255], v[28:31]
 s_sub_u32 s57, s57, 1
 s_cbranch_scc1 L_v_end0
L_v_top:
 s_waitcnt lgkmcnt(2)
 v_mfma_f32_16x16x32_bf16 v[32:35], v[48:51], a[0:3], 0
 ds_read_b128 v[64:67], v8 offset:2048
 v_mfma_f32_16x16x32_bf16 v[36:39], v[52:55], a[0:3], 0
 ds_read_b128 v[68:71], v8 offset:10240
 v_mfma_f32_16x16x32_bf16 v[40:43], v[48:51], a[4:7], 0
 buffer_load_dwordx4 v3, s[28:31], s53 offen offset:1024 sc1 lds
 v_mfma_f32_16x16x32_bf16 v[44:47], v[52:55], a[4:7], 0
 s_waitcnt lgkmcnt(2)
 v_mfma_f32_16x16x32_bf16 v[32:35], v[56:59], a[8:11], v[32:35]
 ds_read_b128 v[72:75], v8 offset:3072
 v_mfma_f32_16x16x32_bf16 v[36:39], v[60:63], a[8:11], v[36:39]
 ds_read_b128 v[76:79], v8 offset:11264
 v_mfma_f32_16x16x32_bf16 v[40:43], v[56:59], a[12:15], v[40:43]
 v_cvt_pk_bf16_f32 v80, v16, v17
 v_cvt_pk_bf16_f32 v81, v18, v19
 v_mfma_f32_16x16x32_bf16 v[44:47], v[60:63], a[12:15], v[44:47]
 v_cvt_pk_bf16_f32 v82, v20, v21
 s_waitcnt lgkmcnt(2)
 v_mfma_f32_16x16x32_bf16 v[32:35], v[64:67], a[16:19], v[32:35]
 ds_read_b128 v[48:51], v8 offset:4096
 v_mfma_f32_16x16x32_bf16 v[36:39], v[68:71], a[16:19], v[36:39]
 ds_read_b128 v[52:55], v8 offset:12288
 v_mfma_f32_16x16x32_bf16 v[40:43], v[64:67], a[20:23], v[40:43]
 buffer_load_dwordx4 v3, s[28:31], s53 offen offset:2048 sc1 lds
 v_mfma_f32_16x16x32_bf16 v[44:47], v[68:71], a[20:23], v[44:47]
 s_waitcnt lgkmcnt(2)
 v_mfma_f32_16x16x32_bf16 v[32:35], v[72:75], a[24:27], v[32:35]
 ds_read_b128 v[56:59], v8 offset:5120
 v_mfma_f32_16x16x32_bf16 v[36:39], v[76:79], a[24:27], v[36:39]
 ds_read_b128 v[60:63], v8 offset:13312
 v_mfma_f32_16x16x32_bf16 v[40:43], v[72:75], a[28:31], v[40:43]
 v_cvt_pk_bf16_f32 v83, v22, v23
 buffer_store_dwordx4 v[80:83], v3, s[28:31], s54 offen sc1
 v_mfma_f32_16x16x32_bf16 v[44:47], v[76:79], a[28:31], v[44:47]
 s_add_u32 s54, s54, s56
 s_waitcnt lgkmcnt(2)
 v_mfma_f32_16x16x32_bf16 v[32:35], v[48:51], a[32:35], v[32:35]
 ds_read_b128 v[64:67], v8 offset:6144
 v_mfma_f32_16x16x32_bf16 v[36:39], v[52:55], a[32:35], v[36:39]
 ds_read_b128 v[68:71], v8 offset:14336
 v_mfma_f32_16x16x32_bf16 v[40:43], v[48:51], a[36:39], v[40:43]
 buffer_load_dwordx4 v3, s[28:31], s53 offen offset:3072 sc1 lds
 v_mfma_f32_16x16x32_bf16 v[44:47], v[52:55], a[36:39], v[44:47]
 s_add_u32 s53, s53, 8192
 s_waitcnt lgkmcnt(2)
 v_mfma_f32_16x16x32_bf16 v[32:35], v[56:59], a[40:43], v[32:35]
 ds_read_b128 v[72:75], v8 offset:7168
 v_mfma_f32_16x16x32_bf16 v[36:39], v[60:63], a[40:43], v[36:39]
 ds_read_b128 v[76:79], v8 offset:15360
 v_mfma_f32_16x16x32_bf16 v[40:43], v[56:59], a[44:47], v[40:43]
 v_cvt_pk_bf16_f32 v84, v24, v25
 v_cvt_pk_bf16_f32 v85, v26, v27
 v_mfma_f32_16x16x32_bf16 v[44:47], v[60:63], a[44:47], v[44:47]
 v_cvt_pk_bf16_f32 v86, v28, v29
 s_waitcnt lgkmcnt(2)
 v_mfma_f32_16x16x32_bf16 v[32:35], v[64:67], a[48:51], v[32:35]
 s_waitcnt vmcnt(23)
 s_barrier
 ds_read_b128 v[48:51], v8 offset:16384
 v_mfma_f32_16x16x32_bf16 v[36:39], v[68:71], a[48:51], v[36:39]
 ds_read_b128 v[52:55], v8 offset:24576
 v_mfma_f32_16x16x32_bf16 v[40:43], v[64:67], a[52:55], v[40:43]
 s_add_u32 m0, s61, 49152
 s_nop 0
 v_mfma_f32_16x16x32_bf16 v[44:47], v[68:71], a[52:55], v[44:47]
 buffer_load_dwordx4 v3, s[28:31], s53 offen offset:0 sc1 lds
 s_waitcnt lgkmcnt(2)
 v_mfma_f32_16x16x32_bf16 v[32:35], v[72:75], a[56:59], v[32:35]
 ds_read_b128 v[56:59], v8 offset:17408
 v_mfma_f32_16x16x32_bf16 v[36:39], v[76:79], a[56:59], v[36:39]
 ds_read_b128 v[60:63], v8 offset:25600
 v_mfma_f32_16x16x32_bf16 v[40:43], v[72:75], a[60:63], v[40:43]
 v_cvt_pk_bf16_f32 v87, v30, v31
 buffer_store_dwordx4 v[84:87], v3, s[28:31], s55 offen sc1
 v_mfma_f32_16x16x32_bf16 v[44:47], v[76:79], a[60:63], v[44:47]
 s_add_u32 s55, s55, s56
 s_waitcnt lgkmcnt(2)
 v_mfma_f32_16x16x32_bf16 v[32:35], v[48:51], a[64:67], v[32:35]
 ds_read_b128 v[64:67], v8 offset:18432
 v_mfma_f32_16x16x32_bf16 v[36:39], v[52:55], a[64:67], v[36:39]
 ds_read_b128 v[68:71], v8 offset:26624
 v_mfma_f32_16x16x32_bf16 v[40:43], v[48:51], a[68:71], v[40:43]
 buffer_load_dwordx4 v3, s[28:31], s53 offen offset:1024 sc1 lds
 v_mfma_f32_16x16x32_bf16 v[44:47], v[52:55], a[68:71], v[44:47]
 s_waitcnt lgkmcnt(2)
 v_mfma_f32_16x16x32_bf16 v[32:35], v[56:59], a[72:75], v[32:35]
 ds_read_b128 v[72:75], v8 offset:19456
 v_mfma_f32_16x16x32_bf16 v[36:39], v[60:63], a[72:75], v[36:39]
 ds_read_b128 v[76:79], v8 offset:27648
 v_mfma_f32_16x16x32_bf16 v[40:43], v[56:59], a[76:79], v[40:43]
 v_mfma_f32_16x16x32_bf16 v[44:47], v[60:63], a[76:79], v[44:47]
 s_waitcnt lgkmcnt(2)
 v_mfma_f32_16x16x32_bf16 v[32:35], v[64:67], a[80:83], v[32:35]
 ds_read_b128 v[48:51], v8 offset:20480
 v_mfma_f32_16x16x32_bf16 v[36:39], v[68:71], a[80:83], v[36:39]
 ds_read_b128 v[52:55], v8 offset:28672
 v_mfma_f32_16x16x32_bf16 v[40:43], v[64:67], a[84:87], v[40:43]
 buffer_load_dwordx4 v3, s[28:31], s53 offen offset:2048 sc1 lds
 v_mfma_f32_16x16x32_bf16 v[44:47], v[68:71], a[84:87], v[44:47]
 s_waitcnt lgkmcnt(2)
 v_mfma_f32_16x16x32_bf16 v[32:35], v[72:75], a[88:91], v[32:35]
 ds_read_b128 v[56:59], v8 offset:21504
 v_mfma_f32_16x16x32_bf16 v[36:39], v[76:79], a[88:91], v[36:39]
 ds_read_b128 v[60:63], v8 offset:29696
 v_mfma_f32_16x16x32_bf16 v[40:43], v[72:75], a[92:95], v[40:43]
 v_mfma_f32_16x16x32_bf16 v[44:47], v[76:79], a[92:95], v[44:47]
 s_waitcnt lgkmcnt(2)
 v_mfma_f32_16x16x32_bf16 v[32:35], v[48:51], a[96:99], v[32:35]
 ds_read_b128 v[64:67], v8 offset:22528
 v_mfma_f32_16x16x32_bf16 v[36:39], v[52:55], a[96:99], v[36:39]
 ds_read_b128 v[68:71], v8 offset:30720
 v_mfma_f32_16x16x32_bf16 v[40:43], v[48:51], a[100:103], v[40:43]
 buffer_load_dwordx4 v3, s[28:31], s53 offen offset:3072 sc1 lds
 v_mfma_f32_16x16x32_bf16 v[44:47], v[52:55], a[100:103], v[44:47]
 s_add_u32 s53, s53, s58
 s_waitcnt lgkmcnt(2)
 v_mfma_f32_16x16x32_bf16 v[32:35], v[56:59], a[104:107], v[32:35]
 ds_read_b128 v[72:75], v8 offset:23552
 v_mfma_f32_16x16x32_bf16 v[36:39], v[60:63], a[104:107], v[36:39]
 ds_read_b128 v[76:79], v8 offset:31744
 v_mfma_f32_16x16x32_bf16 v[40:43], v[56:59], a[108:111], v[40:43]
 v_mfma_f32_16x16x32_bf16 v[44:47], v[60:63], a[108:111], v[44:47]
 s_waitcnt lgkmcnt(2)
 v_mfma_f32_16x16x32_bf16 v[32:35], v[64:67], a[112:115], v[32:35]
 s_waitcnt vmcnt(23)
 s_barrier
 ds_read_b128 v[48:51], v8 offset:32768
 v_mfma_f32_16x16x32_bf16 v[36:39], v[68:71], a[112:115], v[36:39]
 ds_read_b128 v[52:55], v8 offset:40960
 v_mfma_f32_16x16x32_bf16 v[40:43], v[64:67], a[116:119], v[40:43]
 s_add_u32 m0, s61, 65536
 s_nop 0
 v_mfma_f32_16x16x32_bf16 v[44:47], v[68:71], a[116:119], v[44:47]
 buffer_load_dwordx4 v3, s[28:31], s53 offen offset:0 sc1 lds
 s_waitcnt lgkmcnt(2)
 v_mfma_f32_16x16x32_bf16 v[32:35], v[72:75], a[120:123], v[32:35]
 ds_read_b128 v[56:59], v8 offset:33792
 v_mfma_f32_16x16x32_bf16 v[36:39], v[76:79], a[120:123], v[36:39]
 ds_read_b128 v[60:63], v8 offset:41984
 v_mfma_f32_16x16x32_bf16 v[40:43], v[72:75], a[124:127], v[40:43]
 v_mfma_f32_16x16x32_bf16 v[44:47], v[76:79], a[124:127], v[44:47]
 s_waitcnt lgkmcnt(2)
 v_mfma_f32_16x16x32_bf16 v[32:35], v[48:51], a[128:131], v[32:35]
 ds_read_b128 v[64:67], v8 offset:34816
 v_mfma_f32_16x16x32_bf16 v[36:39], v[52:55], a[128:131], v[36:39]
 ds_read_b128 v[68:71], v8 offset:43008
 v_mfma_f32_16x16x32_bf16 v[40:43], v[48:51], a[132:135], v[40:43]
 buffer_load_dwordx4 v3, s[28:31], s53 offen offset:1024 sc1 lds
 v_mfma_f32_16x16x32_bf16 v[44:47], v[52:55], a[132:135], v[44:47]
 s_waitcnt lgkmcnt(2)
 v_mfma_f32_16x16x32_bf16 v[32:35], v[56:59], a[136:139], v[32:35]
 ds_read_b128 v[72:75], v8 offset:35840
 v_mfma_f32_16x16x32_bf16 v[36:39], v[60:63], a[136:139], v[36:39]
 ds_read_b128 v[76:79], v8 offset:44032
 v_mfma_f32_16x16x32_bf16 v[40:43], v[56:59], a[140:143], v[40:43]
 v_mfma_f32_16x16x32_bf16 v[44:47], v[60:63], a[140:143], v[44:47]
 s_waitcnt lgkmcnt(2)
 v_mfma_f32_16x16x32_bf16 v[32:35], v[64:67], a[144:147], v[32:35]
 ds_read_b128 v[48:51], v8 offset:36864
 v_mfma_f32_16x16x32_bf16 v[36:39], v[68:71], a[144:147], v[36:39]
 ds_read_b128 v[52:55], v8 offset:45056
 v_mfma_f32_16x16x32_bf16 v[40:43], v[64:67], a[148:151], v[40:43]
 buffer_load_dwordx4 v3, s[28:31], s53 offen offset:2048 sc1 lds
 v_mfma_f32_16x16x32_bf16 v[44:47], v[68:71], a[148:151], v[44:47]
 s_waitcnt lgkmcnt(2)
 v_mfma_f32_16x16x32_bf16 v[32:35], v[72:75], a[152:155], v[32:35]
 ds_read_b128 v[56:59], v8 offset:37888
 v_mfma_f32_16x16x32_bf16 v[36:39], v[76:79], a[152:155], v[36:39]
 ds_read_b128 v[60:63], v8 offset:46080
 v_mfma_f32_16x16x32_bf16 v[40:43], v[72:75], a[156:159], v[40:43]
 v_mfma_f32_16x16x32_bf16 v[44:47], v[76:79], a[156:159], v[44:47]
 s_waitcnt lgkmcnt(2)
 v_mfma_f32_16x16x32_bf16 v[32:35], v[48:51], a[160:163], v[32:35]
 ds_read_b128 v[64:67], v8 offset:38912
 v_mfma_f32_16x16x32_bf16 v[36:39], v[52:55], a[160:163], v[36:39]
 ds_read_b128 v[68:71], v8 offset:47104
 v_mfma_f32_16x16x32_bf16 v[40:43], v[48:51], a[164:167], v[40:43]
 buffer_load_dwordx4 v3, s[28:31], s53 offen offset:3072 sc1 lds
 v_mfma_f32_16x16x32_bf16 v[44:47], v[52:55], a[164:167], v[44:47]
 s_add_u32 s53, s53, 8192
 s_waitcnt lgkmcnt(2)
 v_mfma_f32_16x16x32_bf16 v[32:35], v[56:59], a[168:171], v[32:35]
 ds_read_b128 v[72:75], v8 offset:39936
 v_mfma_f32_16x16x32_bf16 v[36:39], v[60:63], a[168:171], v[36:39]
 ds_read_b128 v[76:79], v8 offset:48128
 v_mfma_f32_16x16x32_bf16 v[40:43], v[56:59], a[172:175], v[40:43]
 v_mfma_f32_16x16x32_bf16 v[44:47], v[60:63], a[172:175], v[44:47]
 s_waitcnt lgkmcnt(2)
 v_mfma_f32_16x16x32_bf16 v[32:35], v[64:67], a[176:179], v[32:35]
 s_waitcnt vmcnt(22)
 s_barrier
 ds_read_b128 v[48:51], v8 offset:49152
 v_mfma_f32_16x16x32_bf16 v[36:39], v[68:71], a[176:179], v[36:39]
 ds_read_b128 v[52:55], v8 offset:57344
 v_mfma_f32_16x16x32_bf16 v[40:43], v[64:67], a[180:183], v[40:43]
 s_add_u32 m0, s61, 81920
 s_nop 0
 v_mfma_f32_16x16x32_bf16 v[44:47], v[68:71], a[180:183], v[44:47]
 buffer_load_dwordx4 v3, s[28:31], s53 offen offset:0 sc1 lds
 s_waitcnt lgkmcnt(2)
 v_mfma_f32_16x16x32_bf16 v[32:35], v[72:75], a[184:187], v[32:35]
 ds_read_b128 v[56:59], v8 offset:50176
 v_mfma_f32_16x16x32_bf16 v[36:39], v[76:79], a[184:187], v[36:39]
 ds_read_b128 v[60:63], v8 offset:58368
 v_mfma_f32_16x16x32_bf16 v[40:43], v[72:75], a[188:191], v[40:43]
 v_mfma_f32_16x16x32_bf16 v[44:47], v[76:79], a[188:191], v[44:47]
 s_waitcnt lgkmcnt(2)
 v_mfma_f32_16x16x32_bf16 v[32:35], v[48:51], a[192:195], v[32:35]
 ds_read_b128 v[64:67], v8 offset:51200
 v_mfma_f32_16x16x32_bf16 v[36:39], v[52:55], a[192:195], v[36:39]
 ds_read_b128 v[68:71], v8 offset:59392
 v_mfma_f32_16x16x32_bf16 v[40:43], v[48:51], a[196:199], v[40:43]
 buffer_load_dwordx4 v3, s[28:31], s53 offen offset:1024 sc1 lds
 v_mfma_f32_16x16x32_bf16 v[44:47], v[52:55], a[196:199], v[44:47]
 s_waitcnt lgkmcnt(2)
 v_mfma_f32_16x16x32_bf16 v[32:35], v[56:59], a[200:203], v[32:35]
 ds_read_b128 v[72:75], v8 offset:52224
 v_mfma_f32_16x16x32_bf16 v[36:39], v[60:63], a[200:203], v[36:39]
 ds_read_b128 v[76:79], v8 offset:60416
 v_mfma_f32_16x16x32_bf16 v[40:43], v[56:59], a[204:207], v[40:43]
 s_add_u32 s64, s64, 2
 v_mov_b32 v1, s64
 v_mfma_f32_16x16x32_bf16 v[44:47], v[60:63], a[204:207], v[44:47]
 buffer_store_dword v1, v2, s[28:31], s59 offen sc1
 s_waitcnt lgkmcnt(2)
 v_mfma_f32_16x16x32_bf16 v[32:35], v[64:67], a[208:211], v[32:35]
 ds_read_b128 v[48:51], v8 offset:53248
 v_mfma_f32_16x16x32_bf16 v[36:39], v[68:71], a[208:211], v[36:39]
 ds_read_b128 v[52:55], v8 offset:61440
 v_mfma_f32_16x16x32_bf16 v[40:43], v[64:67], a[212:215], v[40:43]
 buffer_load_dwordx4 v3, s[28:31], s53 offen offset:2048 sc1 lds
 v_mfma_f32_16x16x32_bf16 v[44:47], v[68:71], a[212:215], v[44:47]
 s_waitcnt lgkmcnt(2)
 v_mfma_f32_16x16x32_bf16 v[32:35], v[72:75], a[216:219], v[32:35]
 ds_read_b128 v[56:59], v8 offset:54272
 v_mfma_f32_16x16x32_bf16 v[36:39], v[76:79], a[216:219], v[36:39]
 ds_read_b128 v[60:63], v8 offset:62464
 v_mfma_f32_16x16x32_bf16 v[40:43], v[72:75], a[220:223], v[40:43]
 v_mfma_f32_16x16x32_bf16 v[44:47], v[76:79], a[220:223], v[44:47]
 s_waitcnt lgkmcnt(2)
 v_mfma_f32_16x16x32_bf16 v[32:35], v[48:51], a[224:227], v[32:35]
 ds_read_b128 v[64:67], v8 offset:55296
 v_mfma_f32_16x16x32_bf16 v[36:39], v[52:55], a[224:227], v[36:39]
 ds_read_b128 v[68:71], v8 offset:63488
 v_mfma_f32_16x16x32_bf16 v[40:43], v[48:51], a[228:231], v[40:43]
 buffer_load_dwordx4 v3, s[28:31], s53 offen offset:3072 sc1 lds
 v_mfma_f32_16x16x32_bf16 v[44:47], v[52:55], a[228:231], v[44:47]
 s_add_u32 s53, s53, 8192
 s_waitcnt lgkmcnt(2)
 v_mfma_f32_16x16x32_bf16 v[32:35], v[56:59], a[232:235], v[32:35]
 ds_read_b128 v[72:75], v8 offset:56320
 v_mfma_f32_16x16x32_bf16 v[36:39], v[60:63], a[232:235], v[36:39]
 ds_read_b128 v[76:79], v8 offset:64512
 v_mfma_f32_16x16x32_bf16 v[40:43], v[56:59], a[236:239], v[40:43]
 v_mfma_f32_16x16x32_bf16 v[44:47], v[60:63], a[236:239], v[44:47]
 s_waitcnt lgkmcnt(2)
 v_mfma_f32_16x16x32_bf16 v[32:35], v[64:67], a[240:243], v[32:35]
 s_waitcnt vmcnt(23)
 s_barrier
 ds_read_b128 v[48:51], v7 offset:0
 v_mfma_f32_16x16x32_bf16 v[36:39], v[68:71], a[240:243], v[36:39]
 ds_read_b128 v[52:55], v7 offset:8192
 v_mfma_f32_16x16x32_bf16 v[40:43], v[64:67], a[244:247], v[40:43]
 s_add_u32 m0, s61, 98304
 s_nop 0
 v_mfma_f32_16x16x32_bf16 v[44:47], v[68:71], a[244:247], v[44:47]
 buffer_load_dwordx4 v3, s[28:31], s53 offen offset:0 sc1 lds
 s_waitcnt lgkmcnt(2)
 v_mfma_f32_16x16x32_bf16 v[32:35], v[72:75], a[248:251], v[32:35]
 ds_read_b128 v[56:59], v7 offset:1024
 v_mfma_f32_16x16x32_bf16 v[36:39], v[76:79], a[248:251], v[36:39]
 ds_read_b128 v[60:63], v7 offset:9216
 v_mfma_f32_16x16x32_bf16 v[40:43], v[72:75], a[252:255], v[40:43]
 v_mfma_f32_16x16x32_bf16 v[44:47], v[76:79], a[252:255], v[44:47]
 s_sub_u32 s57, s57, 1
 s_cbranch_scc1 L_v_end1
 s_waitcnt lgkmcnt(2)
 v_mfma_f32_16x16x32_bf16 v[16:19], v[48:51], a[0:3], 0
 ds_read_b128 v[64:67], v7 offset:2048
 v_mfma_f32_16x16x32_bf16 v[20:23], v[52:55], a[0:3], 0
 ds_read_b128 v[68:71], v7 offset:10240
 v_mfma_f32_16x16x32_bf16 v[24:27], v[48:51], a[4:7], 0
 buffer_load_dwordx4 v3, s[28:31], s53 offen offset:1024 sc1 lds
 v_mfma_f32_16x16x32_bf16 v[28:31], v[52:55], a[4:7], 0
 s_waitcnt lgkmcnt(2)
 v_mfma_f32_16x16x32_bf16 v[16:19], v[56:59], a[8:11], v[16:19]
 ds_read_b128 v[72:75], v7 offset:3072
 v_mfma_f32_16x16x32_bf16 v[20:23], v[60:63], a[8:11], v[20:23]
 ds_read_b128 v[76:79], v7 offset:11264
 v_mfma_f32_16x16x32_bf16 v[24:27], v[56:59], a[12:15], v[24:27]
 v_cvt_pk_bf16_f32 v80, v32, v33
 v_cvt_pk_bf16_f32 v81, v34, v35
 v_mfma_f32_16x16x32_bf16 v[28:31], v[60:63], a[12:15], v[28:31]
 v_cvt_pk_bf16_f32 v82, v36, v37
 s_waitcnt lgkmcnt(2)
 v_mfma_f32_16x16x32_bf16 v[16:19], v[64:67], a[16:19], v[16:19]
 ds_read_b128 v[48:51], v7 offset:4096
 v_mfma_f32_16x16x32_bf16 v[20:23], v[68:71], a[16:19], v[20:23]
 ds_read_b128 v[52:55], v7 offset:12288
 v_mfma_f32_16x16x32_bf16 v[24:27], v[64:67], a[20:23], v[24:27]
 buffer_load_dwordx4 v3, s[28:31], s53 offen offset:2048 sc1 lds
 v_mfma_f32_16x16x32_bf16 v[28:31], v[68:71], a[20:23], v[28:31]
 s_waitcnt lgkmcnt(2)
 v_mfma_f32_16x16x32_bf16 v[16:19], v[72:75], a[24:27], v[16:19]
 ds_read_b128 v[56:59], v7 offset:5120
 v_mfma_f32_16x16x32_bf16 v[20:23], v[76:79], a[24:27], v[20:23]
 ds_read_b128 v[60:63], v7 offset:13312
 v_mfma_f32_16x16x32_bf16 v[24:27], v[72:75], a[28:31], v[24:27]
 v_cvt_pk_bf16_f32 v83, v38, v39
 buffer_store_dwordx4 v[80:83], v3, s[28:31], s54 offen sc1
 v_mfma_f32_16x16x32_bf16 v[28:31], v[76:79], a[28:31], v[28:31]
 s_add_u32 s54, s54, s56
 s_waitcnt lgkmcnt(2)
 v_mfma_f32_16x16x32_bf16 v[16:19], v[48:51], a[32:35], v[16:19]
 ds_read_b128 v[64:67], v7 offset:6144
 v_mfma_f32_16x16x32_bf16 v[20:23], v[52:55], a[32:35], v[20:23]
 ds_read_b128 v[68:71], v7 offset:14336
 v_mfma_f32_16x16x32_bf16 v[24:27], v[48:51], a[36:39], v[24:27]
 buffer_load_dwordx4 v3, s[28:31], s53 offen offset:3072 sc1 lds
 v_mfma_f32_16x16x32_bf16 v[28:31], v[52:55], a[36:39], v[28:31]
 s_add_u32 s53, s53, 8192
 s_waitcnt lgkmcnt(2)
 v_mfma_f32_16x16x32_bf16 v[16:19], v[56:59], a[40:43], v[16:19]
 ds_read_b128 v[72:75], v7 offset:7168
 v_mfma_f32_16x16x32_bf16 v[20:23], v[60:63], a[40:43], v[20:23]
 ds_read_b128 v[76:79], v7 offset:15360
 v_mfma_f32_16x16x32_bf16 v[24:27], v[56:59], a[44:47], v[24:27]
 v_cvt_pk_bf16_f32 v84, v40, v41
 v_cvt_pk_bf16_f32 v85, v42, v43
 v_mfma_f32_16x16x32_bf16 v[28:31], v[60:63], a[44:47], v[28:31]
 v_cvt_pk_bf16_f32 v86, v44, v45
 s_waitcnt lgkmcnt(2)
 v_mfma_f32_16x16x32_bf16 v[16:19], v[64:67], a[48:51], v[16:19]
 s_waitcnt vmcnt(24)
 s_barrier
 ds_read_b128 v[48:51], v7 offset:16384
 v_mfma_f32_16x16x32_bf16 v[20:23], v[68:71], a[48:51], v[20:23]
 ds_read_b128 v[52:55], v7 offset:24576
 v_mfma_f32_16x16x32_bf16 v[24:27], v[64:67], a[52:55], v[24:27]
 s_add_u32 m0, s61, 114688
 s_nop 0
 v_mfma_f32_16x16x32_bf16 v[28:31], v[68:71], a[52:55], v[28:31]
 buffer_load_dwordx4 v3, s[28:31], s53 offen offset:0 sc1 lds
 s_waitcnt lgkmcnt(2)
 v_mfma_f32_16x16x32_bf16 v[16:19], v[72:75], a[56:59], v[16:19]
 ds_read_b128 v[56:59], v7 offset:17408
 v_mfma_f32_16x16x32_bf16 v[20:23], v[76:79], a[56:59], v[20:23]
 ds_read_b128 v[60:63], v7 offset:25600
 v_mfma_f32_16x16x32_bf16 v[24:27], v[72:75], a[60:63], v[24:27]
 v_cvt_pk_bf16_f32 v87, v46, v47
 buffer_store_dwordx4 v[84:87], v3, s[28:31], s55 offen sc1
 v_mfma_f32_16x16x32_bf16 v[28:31], v[76:79], a[60:63], v[28:31]
 s_add_u32 s55, s55, s56
 s_waitcnt lgkmcnt(2)
 v_mfma_f32_16x16x32_bf16 v[16:19], v[48:51], a[64:67], v[16:19]
 ds_read_b128 v[64:67], v7 offset:18432
 v_mfma_f32_16x16x32_bf16 v[20:23], v[52:55], a[64:67], v[20:23]
 ds_read_b128 v[68:71], v7 offset:26624
 v_mfma_f32_16x16x32_bf16 v[24:27], v[48:51], a[68:71], v[24:27]
 buffer_load_dwordx4 v3, s[28:31], s53 offen offset:1024 sc1 lds
 v_mfma_f32_16x16x32_bf16 v[28:31], v[52:55], a[68:71], v[28:31]
 s_waitcnt lgkmcnt(2)
 v_mfma_f32_16x16x32_bf16 v[16:19], v[56:59], a[72:75], v[16:19]
 ds_read_b128 v[72:75], v7 offset:19456
 v_mfma_f32_16x16x32_bf16 v[20:23], v[60:63], a[72:75], v[20:23]
 ds_read_b128 v[76:79], v7 offset:27648
 v_mfma_f32_16x16x32_bf16 v[24:27], v[56:59], a[76:79], v[24:27]
 v_mfma_f32_16x16x32_bf16 v[28:31], v[60:63], a[76:79], v[28:31]
 s_waitcnt lgkmcnt(2)
 v_mfma_f32_16x16x32_bf16 v[16:19], v[64:67], a[80:83], v[16:19]
 ds_read_b128 v[48:51], v7 offset:20480
 v_mfma_f32_16x16x32_bf16 v[20:23], v[68:71], a[80:83], v[20:23]
 ds_read_b128 v[52:55], v7 offset:28672
 v_mfma_f32_16x16x32_bf16 v[24:27], v[64:67], a[84:87], v[24:27]
 buffer_load_dwordx4 v3, s[28:31], s53 offen offset:2048 sc1 lds
 v_mfma_f32_16x16x32_bf16 v[28:31], v[68:71], a[84:87], v[28:31]
 s_waitcnt lgkmcnt(2)
 v_mfma_f32_16x16x32_bf16 v[16:19], v[72:75], a[88:91], v[16:19]
 ds_read_b128 v[56:59], v7 offset:21504
 v_mfma_f32_16x16x32_bf16 v[20:23], v[76:79], a[88:91], v[20:23]
 ds_read_b128 v[60:63], v7 offset:29696
 v_mfma_f32_16x16x32_bf16 v[24:27], v[72:75], a[92:95], v[24:27]
 v_mfma_f32_16x16x32_bf16 v[28:31], v[76:79], a[92:95], v[28:31]
 s_waitcnt lgkmcnt(2)
 v_mfma_f32_16x16x32_bf16 v[16:19], v[48:51], a[96:99], v[16:19]
 ds_read_b128 v[64:67], v7 offset:22528
 v_mfma_f32_16x16x32_bf16 v[20:23], v[52:55], a[96:99], v[20:23]
 ds_read_b128 v[68:71], v7 offset:30720
 v_mfma_f32_16x16x32_bf16 v[24:27], v[48:51], a[100:103], v[24:27]
 buffer_load_dwordx4 v3, s[28:31], s53 offen offset:3072 sc1 lds
 v_mfma_f32_16x16x32_bf16 v[28:31], v[52:55], a[100:103], v[28:31]
 s_add_u32 s53, s53, s58
 s_waitcnt lgkmcnt(2)
 v_mfma_f32_16x16x32_bf16 v[16:19], v[56:59], a[104:107], v[16:19]
 ds_read_b128 v[72:75], v7 offset:23552
 v_mfma_f32_16x16x32_bf16 v[20:23], v[60:63], a[104:107], v[20:23]
 ds_read_b128 v[76:79], v7 offset:31744
 v_mfma_f32_16x16x32_bf16 v[24:27], v[56:59], a[108:111], v[24:27]
 v_mfma_f32_16x16x32_bf16 v[28:31], v[60:63], a[108:111], v[28:31]
 s_waitcnt lgkmcnt(2)
 v_mfma_f32_16x16x32_bf16 v[16:19], v[64:67], a[112:115], v[16:19]
 s_waitcnt vmcnt(24)
 s_barrier
 ds_read_b128 v[48:51], v7 offset:32768
 v_mfma_f32_16x16x32_bf16 v[20:23], v[68:71], a[112:115], v[20:23]
 ds_read_b128 v[52:55], v7 offset:40960
 v_mfma_f32_16x16x32_bf16 v[24:27], v[64:67], a[116:119], v[24:27]
 s_mov_b32 m0, s61
 s_nop 0
 v_mfma_f32_16x16x32_bf16 v[28:31], v[68:71], a[116:119], v[28:31]
 buffer_load_dwordx4 v3, s[28:31], s53 offen offset:0 sc1 lds
 s_waitcnt lgkmcnt(2)
 v_mfma_f32_16x16x32_bf16 v[16:19], v[72:75], a[120:123], v[16:19]
 ds_read_b128 v[56:59], v7 offset:33792
 v_mfma_f32_16x16x32_bf16 v[20:23], v[76:79], a[120:123], v[20:23]
 ds_read_b128 v[60:63], v7 offset:41984
 v_mfma_f32_16x16x32_bf16 v[24:27], v[72:75], a[124:127], v[24:27]
 v_mfma_f32_16x16x32_bf16 v[28:31], v[76:79], a[124:127], v[28:31]
 s_waitcnt lgkmcnt(2)
 v_mfma_f32_16x16x32_bf16 v[16:19], v[48:51], a[128:131], v[16:19]
 ds_read_b128 v[64:67], v7 offset:34816
 v_mfma_f32_16x16x32_bf16 v[20:23], v[52:55], a[128:131], v[20:23]
 ds_read_b128 v[68:71], v7 offset:43008
 v_mfma_f32_16x16x32_bf16 v[24:27], v[48:51], a[132:135], v[24:27]
 buffer_load_dwordx4 v3, s[28:31], s53 offen offset:1024 sc1 lds
 v_mfma_f32_16x16x32_bf16 v[28:31], v[52:55], a[132:135], v[28:31]
 s_waitcnt lgkmcnt(2)
 v_mfma_f32_16x16x32_bf16 v[16:19], v[56:59], a[136:139], v[16:19]
 ds_read_b128 v[72:75], v7 offset:35840
 v_mfma_f32_16x16x32_bf16 v[20:23], v[60:63], a[136:139], v[20:23]
 ds_read_b128 v[76:79], v7 offset:44032
 v_mfma_f32_16x16x32_bf16 v[24:27], v[56:59], a[140:143], v[24:27]
 v_mfma_f32_16x16x32_bf16 v[28:31], v[60:63], a[140:143], v[28:31]
 s_waitcnt lgkmcnt(2)
 v_mfma_f32_16x16x32_bf16 v[16:19], v[64:67], a[144:147], v[16:19]
 ds_read_b128 v[48:51], v7 offset:36864
 v_mfma_f32_16x16x32_bf16 v[20:23], v[68:71], a[144:147], v[20:23]
 ds_read_b128 v[52:55], v7 offset:45056
 v_mfma_f32_16x16x32_bf16 v[24:27], v[64:67], a[148:151], v[24:27]
 buffer_load_dwordx4 v3, s[28:31], s53 offen offset:2048 sc1 lds
 v_mfma_f32_16x16x32_bf16 v[28:31], v[68:71], a[148:151], v[28:31]
 s_waitcnt lgkmcnt(2)
 v_mfma_f32_16x16x32_bf16 v[16:19], v[72:75], a[152:155], v[16:19]
 ds_read_b128 v[56:59], v7 offset:37888
 v_mfma_f32_16x16x32_bf16 v[20:23], v[76:79], a[152:155], v[20:23]
 ds_read_b128 v[60:63], v7 offset:46080
 v_mfma_f32_16x16x32_bf16 v[24:27], v[72:75], a[156:159], v[24:27]
 v_mfma_f32_16x16x32_bf16 v[28:31], v[76:79], a[156:159], v[28:31]
 s_waitcnt lgkmcnt(2)
 v_mfma_f32_16x16x32_bf16 v[16:19], v[48:51], a[160:163], v[16:19]
 ds_read_b128 v[64:67], v7 offset:38912
 v_mfma_f32_16x16x32_bf16 v[20:23], v[52:55], a[160:163], v[20:23]
 ds_read_b128 v[68:71], v7 offset:47104
 v_mfma_f32_16x16x32_bf16 v[24:27], v[48:51], a[164:167], v[24:27]
 buffer_load_dwordx4 v3, s[28:31], s53 offen offset:3072 sc1 lds
 v_mfma_f32_16x16x32_bf16 v[28:31], v[52:55], a[164:167], v[28:31]
 s_add_u32 s53, s53, 8192
 s_waitcnt lgkmcnt(2)
 v_mfma_f32_16x16x32_bf16 v[16:19], v[56:59], a[168:171], v[16:19]
 ds_read_b128 v[72:75], v7 offset:39936
 v_mfma_f32_16x16x32_bf16 v[20:23], v[60:63], a[168:171], v[20:23]
 ds_read_b128 v[76:79], v7 offset:48128
 v_mfma_f32_16x16x32_bf16 v[24:27], v[56:59], a[172:175], v[24:27]
 v_mfma_f32_16x16x32_bf16 v[28:31], v[60:63], a[172:175], v[28:31]
 s_waitcnt lgkmcnt(2)
 v_mfma_f32_16x16x32_bf16 v[16:19], v[64:67], a[176:179], v[16:19]
 s_waitcnt vmcnt(23)
 s_barrier
 ds_read_b128 v[48:51], v7 offset:49152
 v_mfma_f32_16x16x32_bf16 v[20:23], v[68:71], a[176:179], v[20:23]
 ds_read_b128 v[52:55], v7 offset:57344
 v_mfma_f32_16x16x32_bf16 v[24:27], v[64:67], a[180:183], v[24:27]
 s_add_u32 m0, s61, 16384
 s_nop 0
 v_mfma_f32_16x16x32_bf16 v[28:31], v[68:71], a[180:183], v[28:31]
 buffer_load_dwordx4 v3, s[28:31], s53 offen offset:0 sc1 lds
 s_waitcnt lgkmcnt(2)
 v_mfma_f32_16x16x32_bf16 v[16:19], v[72:75], a[184:187], v[16:19]
 ds_read_b128 v[56:59], v7 offset:50176
 v_mfma_f32_16x16x32_bf16 v[20:23], v[76:79], a[184:187], v[20:23]
 ds_read_b128 v[60:63], v7 offset:58368
 v_mfma_f32_16x16x32_bf16 v[24:27], v[72:75], a[188:191], v[24:27]
 v_mfma_f32_16x16x32_bf16 v[28:31], v[76:79], a[188:191], v[28:31]
 s_waitcnt lgkmcnt(2)
 v_mfma_f32_16x16x32_bf16 v[16:19], v[48:51], a[192:195], v[16:19]
 ds_read_b128 v[64:67], v7 offset:51200
 v_mfma_f32_16x16x32_bf16 v[20:23], v[52:55], a[192:195], v[20:23]
 ds_read_b128 v[68:71], v7 offset:59392
 v_mfma_f32_16x16x32_bf16 v[24:27], v[48:51], a[196:199], v[24:27]
 buffer_load_dwordx4 v3, s[28:31], s53 offen offset:1024 sc1 lds
 v_mfma_f32_16x16x32_bf16 v[28:31], v[52:55], a[196:199], v[28:31]
 s_waitcnt lgkmcnt(2)
 v_mfma_f32_16x16x32_bf16 v[16:19], v[56:59], a[200:203], v[16:19]
 ds_read_b128 v[72:75], v7 offset:52224
 v_mfma_f32_16x16x32_bf16 v[20:23], v[60:63], a[200:203], v[20:23]
 ds_read_b128 v[76:79], v7 offset:60416
 v_mfma_f32_16x16x32_bf16 v[24:27], v[56:59], a[204:207], v[24:27]
 s_add_u32 s64, s64, 2
 v_mov_b32 v1, s64
 v_mfma_f32_16x16x32_bf16 v[28:31], v[60:63], a[204:207], v[28:31]
 buffer_store_dword v1, v2, s[28:31], s59 offen sc1
 s_waitcnt lgkmcnt(2)
 v_mfma_f32_16x16x32_bf16 v[16:19], v[64:67], a[208:211], v[16:19]
 ds_read_b128 v[48:51], v7 offset:53248
 v_mfma_f32_16x16x32_bf16 v[20:23], v[68:71], a[208:211], v[20:23]
 ds_read_b128 v[52:55], v7 offset:61440
 v_mfma_f32_16x16x32_bf16 v[24:27], v[64:67], a[212:215], v[24:27]
 buffer_load_dwordx4 v3, s[28:31], s53 offen offset:2048 sc1 lds
 v_mfma_f32_16x16x32_bf16 v[28:31], v[68:71], a[212:215], v[28:31]
 s_waitcnt lgkmcnt(2)
 v_mfma_f32_16x16x32_bf16 v[16:19], v[72:75], a[216:219], v[16:19]
 ds_read_b128 v[56:59], v7 offset:54272
 v_mfma_f32_16x16x32_bf16 v[20:23], v[76:79], a[216:219], v[20:23]
 ds_read_b128 v[60:63], v7 offset:62464
 v_mfma_f32_16x16x32_bf16 v[24:27], v[72:75], a[220:223], v[24:27]
 v_mfma_f32_16x16x32_bf16 v[28:31], v[76:79], a[220:223], v[28:31]
 s_waitcnt lgkmcnt(2)
 v_mfma_f32_16x16x32_bf16 v[16:19], v[48:51], a[224:227], v[16:19]
 ds_read_b128 v[64:67], v7 offset:55296
 v_mfma_f32_16x16x32_bf16 v[20:23], v[52:55], a[224:227], v[20:23]
 ds_read_b128 v[68:71], v7 offset:63488
 v_mfma_f32_16x16x32_bf16 v[24:27], v[48:51], a[228:231], v[24:27]
 buffer_load_dwordx4 v3, s[28:31], s53 offen offset:3072 sc1 lds
 v_mfma_f32_16x16x32_bf16 v[28:31], v[52:55], a[228:231], v[28:31]
 s_add_u32 s53, s53, 8192
 s_waitcnt lgkmcnt(2)
 v_mfma_f32_16x16x32_bf16 v[16:19], v[56:59], a[232:235], v[16:19]
 ds_read_b128 v[72:75], v7 offset:56320
 v_mfma_f32_16x16x32_bf16 v[20:23], v[60:63], a[232:235], v[20:23]
 ds_read_b128 v[76:79], v7 offset:64512
 v_mfma_f32_16x16x32_bf16 v[24:27], v[56:59], a[236:239], v[24:27]
 v_mfma_f32_16x16x32_bf16 v[28:31], v[60:63], a[236:239], v[28:31]
 s_waitcnt lgkmcnt(2)
 v_mfma_f32_16x16x32_bf16 v[16:19], v[64:67], a[240:243], v[16:19]
 s_waitcnt vmcnt(24)
 s_barrier
 ds_read_b128 v[48:51], v8 offset:0
 v_mfma_f32_16x16x32_bf16 v[20:23], v[68:71], a[240:243], v[20:23]
 ds_read_b128 v[52:55], v8 offset:8192
 v_mfma_f32_16x16x32_bf16 v[24:27], v[64:67], a[244:247], v[24:27]
 s_add_u32 m0, s61, 32768
 s_nop 0
 v_mfma_f32_16x16x32_bf16 v[28:31], v[68:71], a[244:247], v[28:31]
 buffer_load_dwordx4 v3, s[28:31], s53 offen offset:0 sc1 lds
 s_waitcnt lgkmcnt(2)
 v_mfma_f32_16x16x32_bf16 v[16:19], v[72:75], a[248:251], v[16:19]
 ds_read_b128 v[56:59], v8 offset:1024
 v_mfma_f32_16x16x32_bf16 v[20:23], v[76:79], a[248:251], v[20:23]
 ds_read_b128 v[60:63], v8 offset:9216
 v_mfma_f32_16x16x32_bf16 v[24:27], v[72:75], a[252:255], v[24:27]
 v_mfma_f32_16x16x32_bf16 v[28:31], v[76:79], a[252:255], v[28:31]
 s_sub_u32 s57, s57, 1
 s_cbranch_scc1 L_v_end0
 s_branch L_v_top
L_v_end0:
 s_nop 7
 v_cvt_pk_bf16_f32 v80, v16, v17
 v_cvt_pk_bf16_f32 v81, v18, v19
 v_cvt_pk_bf16_f32 v82, v20, v21
 v_cvt_pk_bf16_f32 v83, v22, v23
 buffer_store_dwordx4 v[80:83], v3, s[28:31], s54 offen sc1
 s_add_u32 s54, s54, s56
 v_cvt_pk_bf16_f32 v84, v24, v25
 v_cvt_pk_bf16_f32 v85, v26, v27
 v_cvt_pk_bf16_f32 v86, v28, v29
 v_cvt_pk_bf16_f32 v87, v30, v31
 buffer_store_dwordx4 v[84:87], v3, s[28:31], s55 offen sc1
 s_add_u32 s55, s55, s56
 s_branch L_v_done
L_v_end1:
 s_nop 7
 v_cvt_pk_bf16_f32 v80, v32, v33
 v_cvt_pk_bf16_f32 v81, v34, v35
 v_cvt_pk_bf16_f32 v82, v36, v37
 v_cvt_pk_bf16_f32 v83, v38, v39
 buffer_store_dwordx4 v[80:83], v3, s[28:31], s54 offen sc1
 s_add_u32 s54, s54, s56
 v_cvt_pk_bf16_f32 v84, v40, v41
 v_cvt_pk_bf16_f32 v85, v42, v43
 v_cvt_pk_bf16_f32 v86, v44, v45
 v_cvt_pk_bf16_f32 v87, v46, v47
 buffer_store_dwordx4 v[84:87], v3, s[28:31], s55 offen sc1
 s_add_u32 s55, s55, s56
L_v_done:
 s_waitcnt vmcnt(0) lgkmcnt(0)
 s_barrier
 v_mov_b32 v1, 64
 buffer_store_dword v1, v2, s[28:31], s59 offen sc1
L_ffn1:
 s_cmp_ge_u32 s50, 168
 s_cbranch_scc1 L_final
 s_mul_i32 s63, s50, 171
 s_lshr_b32 s63, s63, 10
 s_mul_i32 s48, s63, 6
 s_sub_u32 s64, s50, s48
 s_cmp_lt_u32 s64, 4
 s_cselect_b32 s57, 10, 9
 s_mov_b32 s32, s16
 s_and_b32 s33, s17, 0xffff
 s_mov_b32 s34, 0x700000
 s_mov_b32 s35, 0x20000
 s_lshl_b32 s48, s63, 8
 s_lshl_b32 s49, s40, 6
 s_add_u32 s49, s49, s48
 v_bfe_u32 v16, v0, 3, 2
 v_bfe_u32 v17, v0, 1, 2
 v_lshl_add_u32 v16, v16, 3, v17
 v_mul_u32_u24 v16, 7168, v16
 v_and_b32 v17, 1, v0
 v_lshl_add_u32 v16, v17, 4, v16
 v_lshrrev_b32 v17, 5, v0
 v_lshl_add_u32 v16, v17, 5, v16
 v_add_u32 v6, s49, v16
 s_add_u32 m0, s45, 16384
 s_mov_b32 s47, 0x0
 buffer_load_dwordx4 v6, s[32:35], s47 offen lds
 s_add_u32 m0, s45, 17408
 s_mov_b32 s47, 0x7000
 buffer_load_dwordx4 v6, s[32:35], s47 offen lds
 s_add_u32 m0, s45, 18432
 s_mov_b32 s47, 0x38000
 buffer_load_dwordx4 v6, s[32:35], s47 offen lds
 s_add_u32 m0, s45, 19456
 s_mov_b32 s47, 0x3f000
 buffer_load_dwordx4 v6, s[32:35], s47 offen lds
 s_add_u32 m0, s45, 20480
 s_mov_b32 s47, 0x70000
 buffer_load_dwordx4 v6, s[32:35], s47 offen lds
 s_add_u32 m0, s45, 21504
 s_mov_b32 s47, 0x77000
 buffer_load_dwordx4 v6, s[32:35], s47 offen lds
 s_add_u32 m0, s45, 22528
 s_mov_b32 s47, 0xa8000
 buffer_load_dwordx4 v6, s[32:35], s47 offen lds
 s_add_u32 m0, s45, 23552
 s_mov_b32 s47, 0xaf000
 buffer_load_dwordx4 v6, s[32:35], s47 offen lds
 s_add_u32 m0, s45, 24576
 s_mov_b32 s47, 0xe0000
 buffer_load_dwordx4 v6, s[32:35], s47 offen lds
 s_add_u32 m0, s45, 25600
 s_mov_b32 s47, 0xe7000
 buffer_load_dwordx4 v6, s[32:35], s47 offen lds
 s_add_u32 m0, s45, 26624
 s_mov_b32 s47, 0x118000
 buffer_load_dwordx4 v6, s[32:35], s47 offen lds
 s_add_u32 m0, s45, 27648
 s_mov_b32 s47, 0x11f000
 buffer_load_dwordx4 v6, s[32:35], s47 offen lds
 s_add_u32 m0, s45, 28672
 s_mov_b32 s47, 0x150000
 buffer_load_dwordx4 v6, s[32:35], s47 offen lds
 s_add_u32 m0, s45, 29696
 s_mov_b32 s47, 0x157000
 buffer_load_dwordx4 v6, s[32:35], s47 offen lds
 s_add_u32 m0, s45, 30720
 s_mov_b32 s47, 0x188000
 buffer_load_dwordx4 v6, s[32:35], s47 offen lds
 s_add_u32 m0, s45, 31744
 s_mov_b32 s47, 0x18f000
 buffer_load_dwordx4 v6, s[32:35], s47 offen lds
 s_mov_b32 m0, s46
 s_mov_b32 s47, 0x1c0000
 buffer_load_dwordx4 v6, s[32:35], s47 offen lds
 s_add_u32 m0, s46, 1024
 s_mov_b32 s47, 0x1c7000
 buffer_load_dwordx4 v6, s[32:35], s47 offen lds
 s_add_u32 m0, s46, 2048
 s_mov_b32 s47, 0x1f8000
 buffer_load_dwordx4 v6, s[32:35], s47 offen lds
 s_add_u32 m0, s46, 3072
 s_mov_b32 s47, 0x1ff000
 buffer_load_dwordx4 v6, s[32:35], s47 offen lds
 s_add_u32 m0, s46, 4096
 s_mov_b32 s47, 0x230000
 buffer_load_dwordx4 v6, s[32:35], s47 offen lds
 s_add_u32 m0, s46, 5120
 s_mov_b32 s47, 0x237000
 buffer_load_dwordx4 v6, s[32:35], s47 offen lds
 s_add_u32 m0, s46, 6144
 s_mov_b32 s47, 0x268000
 buffer_load_dwordx4 v6, s[32:35], s47 offen lds
 s_add_u32 m0, s46, 7168
 s_mov_b32 s47, 0x26f000
 buffer_load_dwordx4 v6, s[32:35], s47 offen lds
 s_mov_b32 m0, s45
 s_mov_b32 s47, 0x2a0000
 buffer_load_dwordx4 v6, s[32:35], s47 offen lds
 s_add_u32 m0, s45, 1024
 s_mov_b32 s47, 0x2a7000
 buffer_load_dwordx4 v6, s[32:35], s47 offen lds
 s_add_u32 m0, s45, 2048
 s_mov_b32 s47, 0x2d8000
 buffer_load_dwordx4 v6, s[32:35], s47 offen lds
 s_add_u32 m0, s45, 3072
 s_mov_b32 s47, 0x2df000
 buffer_load_dwordx4 v6, s[32:35], s47 offen lds
 s_add_u32 m0, s45, 4096
 s_mov_b32 s47, 0x310000
 buffer_load_dwordx4 v6, s[32:35], s47 offen lds
 s_add_u32 m0, s45, 5120
 s_mov_b32 s47, 0x317000
 buffer_load_dwordx4 v6, s[32:35], s47 offen lds
 s_add_u32 m0, s45, 6144
 s_mov_b32 s47, 0x348000
 buffer_load_dwordx4 v6, s[32:35], s47 offen lds
 s_add_u32 m0, s45, 7168
 s_mov_b32 s47, 0x34f000
 buffer_load_dwordx4 v6, s[32:35], s47 offen lds
 s_add_u32 m0, s45, 8192
 s_mov_b32 s47, 0x380000
 buffer_load_dwordx4 v6, s[32:35], s47 offen lds
 s_add_u32 m0, s45, 9216
 s_mov_b32 s47, 0x387000
 buffer_load_dwordx4 v6, s[32:35], s47 offen lds
 s_add_u32 m0, s45, 10240
 s_mov_b32 s47, 0x3b8000
 buffer_load_dwordx4 v6, s[32:35], s47 offen lds
 s_add_u32 m0, s45, 11264
 s_mov_b32 s47, 0x3bf000
 buffer_load_dwordx4 v6, s[32:35], s47 offen lds
 s_add_u32 m0, s45, 12288
 s_mov_b32 s47, 0x3f0000
 buffer_load_dwordx4 v6, s[32:35], s47 offen lds
 s_add_u32 m0, s45, 13312
 s_mov_b32 s47, 0x3f7000
 buffer_load_dwordx4 v6, s[32:35], s47 offen lds
 s_add_u32 m0, s45, 14336
 s_mov_b32 s47, 0x428000
 buffer_load_dwordx4 v6, s[32:35], s47 offen lds
 s_add_u32 m0, s45, 15360
 s_mov_b32 s47, 0x42f000
 buffer_load_dwordx4 v6, s[32:35], s47 offen lds
 s_waitcnt vmcnt(39)
 ds_read_b64_tr_b16 a[0:1], v4 offset:16384
 ds_read_b64_tr_b16 a[4:5], v4 offset:16896
 s_waitcnt vmcnt(38)
 ds_read_b64_tr_b16 a[2:3], v4 offset:17408
 ds_read_b64_tr_b16 a[6:7], v4 offset:17920
 s_waitcnt vmcnt(37)
 ds_read_b64_tr_b16 a[8:9], v4 offset:18432
 ds_read_b64_tr_b16 a[12:13], v4 offset:18944
 s_waitcnt vmcnt(36)
 ds_read_b64_tr_b16 a[10:11], v4 offset:19456
 ds_read_b64_tr_b16 a[14:15], v4 offset:19968
 s_waitcnt lgkmcnt(6)
 s_add_u32 m0, s45, 16384
 s_mov_b32 s47, 0x460000
 buffer_load_dwordx4 v6, s[32:35], s47 offen lds
 s_waitcnt vmcnt(36)
 ds_read_b64_tr_b16 a[16:17], v4 offset:20480
 ds_read_b64_tr_b16 a[20:21], v4 offset:20992
 s_waitcnt lgkmcnt(6)
 s_add_u32 m0, s45, 17408
 s_mov_b32 s47, 0x467000
 buffer_load_dwordx4 v6, s[32:35], s47 offen lds
 s_waitcnt vmcnt(36)
 ds_read_b64_tr_b16 a[18:19], v4 offset:21504
 ds_read_b64_tr_b16 a[22:23], v4 offset:22016
 s_waitcnt lgkmcnt(6)
 s_add_u32 m0, s45, 18432
 s_mov_b32 s47, 0x498000
 buffer_load_dwordx4 v6, s[32:35], s47 offen lds
 s_waitcnt vmcnt(36)
 ds_read_b64_tr_b16 a[24:25], v4 offset:22528
 ds_read_b64_tr_b16 a[28:29], v4 offset:23040
 s_waitcnt lgkmcnt(6)
 s_add_u32 m0, s45, 19456
 s_mov_b32 s47, 0x49f000
 buffer_load_dwordx4 v6, s[32:35], s47 offen lds
 s_waitcnt vmcnt(36)
 ds_read_b64_tr_b16 a[26:27], v4 offset:23552
 ds_read_b64_tr_b16 a[30:31], v4 offset:24064
 s_waitcnt lgkmcnt(6)
 s_add_u32 m0, s45, 20480
 s_mov_b32 s47, 0x4d0000
 buffer_load_dwordx4 v6, s[32:35], s47 offen lds
 s_waitcnt vmcnt(36)
 ds_read_b64_tr_b16 a[32:33], v4 offset:24576
 ds_read_b64_tr_b16 a[36:37], v4 offset:25088
 s_waitcnt lgkmcnt(6)
 s_add_u32 m0, s45, 21504
 s_mov_b32 s47, 0x4d7000
 buffer_load_dwordx4 v6, s[32:35], s47 offen lds
 s_waitcnt vmcnt(36)
 ds_read_b64_tr_b16 a[34:35], v4 offset:25600
 ds_read_b64_tr_b16 a[38:39], v4 offset:26112
 s_waitcnt lgkmcnt(6)
 s_add_u32 m0, s45, 22528
 s_mov_b32 s47, 0x508000
 buffer_load_dwordx4 v6, s[32:35], s47 offen lds
 s_waitcnt vmcnt(36)
 ds_read_b64_tr_b16 a[40:41], v4 offset:26624
 ds_read_b64_tr_b16 a[44:45], v4 offset:27136
 s_waitcnt lgkmcnt(6)
 s_add_u32 m0, s45, 23552
 s_mov_b32 s47, 0x50f000
 buffer_load_dwordx4 v6, s[32:35], s47 offen lds
 s_waitcnt vmcnt(36)
 ds_read_b64_tr_b16 a[42:43], v4 offset:27648
 ds_read_b64_tr_b16 a[46:47], v4 offset:28160
 s_waitcnt lgkmcnt(6)
 s_add_u32 m0, s45, 24576
 s_mov_b32 s47, 0x540000
 buffer_load_dwordx4 v6, s[32:35], s47 offen lds
 s_waitcnt vmcnt(36)
 ds_read_b64_tr_b16 a[48:49], v4 offset:28672
 ds_read_b64_tr_b16 a[52:53], v4 offset:29184
 s_waitcnt lgkmcnt(6)
 s_add_u32 m0, s45, 25600
 s_mov_b32 s47, 0x547000
 buffer_load_dwordx4 v6, s[32:35], s47 offen lds
 s_waitcnt vmcnt(36)
 ds_read_b64_tr_b16 a[50:51], v4 offset:29696
 ds_read_b64_tr_b16 a[54:55], v4 offset:30208
 s_waitcnt lgkmcnt(6)
 s_add_u32 m0, s45, 26624
 s_mov_b32 s47, 0x578000
 buffer_load_dwordx4 v6, s[32:35], s47 offen lds
 s_waitcnt vmcnt(36)
 ds_read_b64_tr_b16 a[56:57], v4 offset:30720
 ds_read_b64_tr_b16 a[60:61], v4 offset:31232
 s_waitcnt lgkmcnt(6)
 s_add_u32 m0, s45, 27648
 s_mov_b32 s47, 0x57f000
 buffer_load_dwordx4 v6, s[32:35], s47 offen lds
 s_waitcnt vmcnt(36)
 ds_read_b64_tr_b16 a[58:59], v4 offset:31744
 ds_read_b64_tr_b16 a[62:63], v4 offset:32256
 s_waitcnt lgkmcnt(6)
 s_add_u32 m0, s45, 28672
 s_mov_b32 s47, 0x5b0000
 buffer_load_dwordx4 v6, s[32:35], s47 offen lds
 s_waitcnt vmcnt(36)
 ds_read_b64_tr_b16 a[64:65], v5 offset:0
 ds_read_b64_tr_b16 a[68:69], v5 offset:512
 s_waitcnt lgkmcnt(6)
 s_add_u32 m0, s45, 29696
 s_mov_b32 s47, 0x5b7000
 buffer_load_dwordx4 v6, s[32:35], s47 offen lds
 s_waitcnt vmcnt(36)
 ds_read_b64_tr_b16 a[66:67], v5 offset:1024
 ds_read_b64_tr_b16 a[70:71], v5 offset:1536
 s_waitcnt lgkmcnt(6)
 s_add_u32 m0, s45, 30720
 s_mov_b32 s47, 0x5e8000
 buffer_load_dwordx4 v6, s[32:35], s47 offen lds
 s_waitcnt vmcnt(36)
 ds_read_b64_tr_b16 a[72:73], v5 offset:2048
 ds_read_b64_tr_b16 a[76:77], v5 offset:2560
 s_waitcnt lgkmcnt(6)
 s_add_u32 m0, s45, 31744
 s_mov_b32 s47, 0x5ef000
 buffer_load_dwordx4 v6, s[32:35], s47 offen lds
 s_waitcnt vmcnt(36)
 ds_read_b64_tr_b16 a[74:75], v5 offset:3072
 ds_read_b64_tr_b16 a[78:79], v5 offset:3584
 s_waitcnt lgkmcnt(6)
 s_mov_b32 m0, s46
 s_mov_b32 s47, 0x620000
 buffer_load_dwordx4 v6, s[32:35], s47 offen lds
 s_waitcnt vmcnt(36)
 ds_read_b64_tr_b16 a[80:81], v5 offset:4096
 ds_read_b64_tr_b16 a[84:85], v5 offset:4608
 s_waitcnt lgkmcnt(6)
 s_add_u32 m0, s46, 1024
 s_mov_b32 s47, 0x627000
 buffer_load_dwordx4 v6, s[32:35], s47 offen lds
 s_waitcnt vmcnt(36)
 ds_read_b64_tr_b16 a[82:83], v5 offset:5120
 ds_read_b64_tr_b16 a[86:87], v5 offset:5632
 s_waitcnt lgkmcnt(6)
 s_add_u32 m0, s46, 2048
 s_mov_b32 s47, 0x658000
 buffer_load_dwordx4 v6, s[32:35], s47 offen lds
 s_waitcnt vmcnt(36)
 ds_read_b64_tr_b16 a[88:89], v5 offset:6144
 ds_read_b64_tr_b16 a[92:93], v5 offset:6656
 s_waitcnt lgkmcnt(6)
 s_add_u32 m0, s46, 3072
 s_mov_b32 s47, 0x65f000
 buffer_load_dwordx4 v6, s[32:35], s47 offen lds
 s_waitcnt vmcnt(36)
 ds_read_b64_tr_b16 a[90:91], v5 offset:7168
 ds_read_b64_tr_b16 a[94:95], v5 offset:7680
 s_waitcnt lgkmcnt(6)
 s_add_u32 m0, s46, 4096
 s_mov_b32 s47, 0x690000
 buffer_load_dwordx4 v6, s[32:35], s47 offen lds
 s_waitcnt vmcnt(36)
 ds_read_b64_tr_b16 a[96:97], v4 offset:0
 ds_read_b64_tr_b16 a[100:101], v4 offset:512
 s_waitcnt lgkmcnt(6)
 s_add_u32 m0, s46, 5120
 s_mov_b32 s47, 0x697000
 buffer_load_dwordx4 v6, s[32:35], s47 offen lds
 s_waitcnt vmcnt(36)
 ds_read_b64_tr_b16 a[98:99], v4 offset:1024
 ds_read_b64_tr_b16 a[102:103], v4 offset:1536
 s_waitcnt lgkmcnt(6)
 s_add_u32 m0, s46, 6144
 s_mov_b32 s47, 0x6c8000
 buffer_load_dwordx4 v6, s[32:35], s47 offen lds
 s_waitcnt vmcnt(36)
 ds_read_b64_tr_b16 a[104:105], v4 offset:2048
 ds_read_b64_tr_b16 a[108:109], v4 offset:2560
 s_waitcnt lgkmcnt(6)
 s_add_u32 m0, s46, 7168
 s_mov_b32 s47, 0x6cf000
 buffer_load_dwordx4 v6, s[32:35], s47 offen lds
 s_waitcnt vmcnt(36)
 ds_read_b64_tr_b16 a[106:107], v4 offset:3072
 ds_read_b64_tr_b16 a[110:111], v4 offset:3584
 s_waitcnt vmcnt(35)
 ds_read_b64_tr_b16 a[112:113], v4 offset:4096
 ds_read_b64_tr_b16 a[116:117], v4 offset:4608
 s_waitcnt vmcnt(34)
 ds_read_b64_tr_b16 a[114:115], v4 offset:5120
 ds_read_b64_tr_b16 a[118:119], v4 offset:5632
 s_waitcnt vmcnt(33)
 ds_read_b64_tr_b16 a[120:121], v4 offset:6144
 ds_read_b64_tr_b16 a[124:125], v4 offset:6656
 s_waitcnt vmcnt(32)
 ds_read_b64_tr_b16 a[122:123], v4 offset:7168
 ds_read_b64_tr_b16 a[126:127], v4 offset:7680
 s_waitcnt vmcnt(31)
 ds_read_b64_tr_b16 a[128:129], v4 offset:8192
 ds_read_b64_tr_b16 a[132:133], v4 offset:8704
 s_waitcnt vmcnt(30)
 ds_read_b64_tr_b16 a[130:131], v4 offset:9216
 ds_read_b64_tr_b16 a[134:135], v4 offset:9728
 s_waitcnt vmcnt(29)
 ds_read_b64_tr_b16 a[136:137], v4 offset:10240
 ds_read_b64_tr_b16 a[140:141], v4 offset:10752
 s_waitcnt vmcnt(28)
 ds_read_b64_tr_b16 a[138:139], v4 offset:11264
 ds_read_b64_tr_b16 a[142:143], v4 offset:11776
 s_waitcnt vmcnt(27)
 ds_read_b64_tr_b16 a[144:145], v4 offset:12288
 ds_read_b64_tr_b16 a[148:149], v4 offset:12800
 s_waitcnt vmcnt(26)
 ds_read_b64_tr_b16 a[146:147], v4 offset:13312
 ds_read_b64_tr_b16 a[150:151], v4 offset:13824
 s_waitcnt vmcnt(25)
 ds_read_b64_tr_b16 a[152:153], v4 offset:14336
 ds_read_b64_tr_b16 a[156:157], v4 offset:14848
 s_waitcnt vmcnt(24)
 ds_read_b64_tr_b16 a[154:155], v4 offset:15360
 ds_read_b64_tr_b16 a[158:159], v4 offset:15872
 s_waitcnt vmcnt(23)
 ds_read_b64_tr_b16 a[160:161], v4 offset:16384
 ds_read_b64_tr_b16 a[164:165], v4 offset:16896
 s_waitcnt vmcnt(22)
 ds_read_b64_tr_b16 a[162:163], v4 offset:17408
 ds_read_b64_tr_b16 a[166:167], v4 offset:17920
 s_waitcnt vmcnt(21)
 ds_read_b64_tr_b16 a[168:169], v4 offset:18432
 ds_read_b64_tr_b16 a[172:173], v4 offset:18944
 s_waitcnt vmcnt(20)
 ds_read_b64_tr_b16 a[170:171], v4 offset:19456
 ds_read_b64_tr_b16 a[174:175], v4 offset:19968
 s_waitcnt vmcnt(19)
 ds_read_b64_tr_b16 a[176:177], v4 offset:20480
 ds_read_b64_tr_b16 a[180:181], v4 offset:20992
 s_waitcnt vmcnt(18)
 ds_read_b64_tr_b16 a[178:179], v4 offset:21504
 ds_read_b64_tr_b16 a[182:183], v4 offset:22016
 s_waitcnt vmcnt(17)
 ds_read_b64_tr_b16 a[184:185], v4 offset:22528
 ds_read_b64_tr_b16 a[188:189], v4 offset:23040
 s_waitcnt vmcnt(16)
 ds_read_b64_tr_b16 a[186:187], v4 offset:23552
 ds_read_b64_tr_b16 a[190:191], v4 offset:24064
 s_waitcnt vmcnt(15)
 ds_read_b64_tr_b16 a[192:193], v4 offset:24576
 ds_read_b64_tr_b16 a[196:197], v4 offset:25088
 s_waitcnt vmcnt(14)
 ds_read_b64_tr_b16 a[194:195], v4 offset:25600
 ds_read_b64_tr_b16 a[198:199], v4 offset:26112
 s_waitcnt vmcnt(13)
 ds_read_b64_tr_b16 a[200:201], v4 offset:26624
 ds_read_b64_tr_b16 a[204:205], v4 offset:27136
 s_waitcnt vmcnt(12)
 ds_read_b64_tr_b16 a[202:203], v4 offset:27648
 ds_read_b64_tr_b16 a[206:207], v4 offset:28160
 s_waitcnt vmcnt(11)
 ds_read_b64_tr_b16 a[208:209], v4 offset:28672
 ds_read_b64_tr_b16 a[212:213], v4 offset:29184
 s_waitcnt vmcnt(10)
 ds_read_b64_tr_b16 a[210:211], v4 offset:29696
 ds_read_b64_tr_b16 a[214:215], v4 offset:30208
 s_waitcnt vmcnt(9)
 ds_read_b64_tr_b16 a[216:217], v4 offset:30720
 ds_read_b64_tr_b16 a[220:221], v4 offset:31232
 s_waitcnt vmcnt(8)
 ds_read_b64_tr_b16 a[218:219], v4 offset:31744
 ds_read_b64_tr_b16 a[222:223], v4 offset:32256
 s_waitcnt vmcnt(7)
 ds_read_b64_tr_b16 a[224:225], v5 offset:0
 ds_read_b64_tr_b16 a[228:229], v5 offset:512
 s_waitcnt vmcnt(6)
 ds_read_b64_tr_b16 a[226:227], v5 offset:1024
 ds_read_b64_tr_b16 a[230:231], v5 offset:1536
 s_waitcnt vmcnt(5)
 ds_read_b64_tr_b16 a[232:233], v5 offset:2048
 ds_read_b64_tr_b16 a[236:237], v5 offset:2560
 s_waitcnt vmcnt(4)
 ds_read_b64_tr_b16 a[234:235], v5 offset:3072
 ds_read_b64_tr_b16 a[238:239], v5 offset:3584
 s_waitcnt vmcnt(3)
 ds_read_b64_tr_b16 a[240:241], v5 offset:4096
 ds_read_b64_tr_b16 a[244:245], v5 offset:4608
 s_waitcnt vmcnt(2)
 ds_read_b64_tr_b16 a[242:243], v5 offset:5120
 ds_read_b64_tr_b16 a[246:247], v5 offset:5632
 s_waitcnt vmcnt(1)
 ds_read_b64_tr_b16 a[248:249], v5 offset:6144
 ds_read_b64_tr_b16 a[252:253], v5 offset:6656
 s_waitcnt vmcnt(0)
 ds_read_b64_tr_b16 a[250:251], v5 offset:7168
 ds_read_b64_tr_b16 a[254:255], v5 offset:7680
 s_waitcnt lgkmcnt(0)
 s_mul_i32 s54, s64, 229376
 s_lshl_b32 s48, s63, 13
 s_add_u32 s54, s54, s48
 s_lshl_b32 s48, s40, 11
 s_add_u32 s54, s54, s48
 s_add_u32 s54, s54, 0x4000000
 s_add_u32 s55, s54, 1024
 s_mov_b32 s56, 1376256
 s_lshl_b32 s53, s64, 16
 s_lshr_b32 s48, s40, 1
 s_lshl_b32 s48, s48, 15
 s_add_u32 s53, s53, s48
 s_and_b32 s48, s40, 1
 s_lshl_b32 s48, s48, 12
 s_add_u32 s53, s53, s48
 s_add_u32 s53, s53, 0xc00000
 s_mov_b32 s58, 368640
 s_mov_b32 s60, 0
 s_barrier
 s_lshl_b32 s61, s40, 12
 s_mov_b32 m0, s61
 s_nop 0
 buffer_load_dwordx4 v3, s[28:31], s53 offen offset:0 sc1 lds
 buffer_load_dwordx4 v3, s[28:31], s53 offen offset:1024 sc1 lds
 buffer_load_dwordx4 v3, s[28:31], s53 offen offset:2048 sc1 lds
 buffer_load_dwordx4 v3, s[28:31], s53 offen offset:3072 sc1 lds
 s_add_u32 s53, s53, 8192
 s_add_u32 m0, s61, 16384
 s_nop 0
 buffer_load_dwordx4 v3, s[28:31], s53 offen offset:0 sc1 lds
 buffer_load_dwordx4 v3, s[28:31], s53 offen offset:1024 sc1 lds
 buffer_load_dwordx4 v3, s[28:31], s53 offen offset:2048 sc1 lds
 buffer_load_dwordx4 v3, s[28:31], s53 offen offset:3072 sc1 lds
 s_add_u32 s53, s53, 8192
 s_add_u32 m0, s61, 32768
 s_nop 0
 buffer_load_dwordx4 v3, s[28:31], s53 offen offset:0 sc1 lds
 buffer_load_dwordx4 v3, s[28:31], s53 offen offset:1024 sc1 lds
 buffer_load_dwordx4 v3, s[28:31], s53 offen offset:2048 sc1 lds
 buffer_load_dwordx4 v3, s[28:31], s53 offen offset:3072 sc1 lds
 s_add_u32 s53, s53, 8192
 s_add_u32 m0, s61, 49152
 s_nop 0
 buffer_load_dwordx4 v3, s[28:31], s53 offen offset:0 sc1 lds
 buffer_load_dwordx4 v3, s[28:31], s53 offen offset:1024 sc1 lds
 buffer_load_dwordx4 v3, s[28:31], s53 offen offset:2048 sc1 lds
 buffer_load_dwordx4 v3, s[28:31], s53 offen offset:3072 sc1 lds
 s_add_u32 s53, s53, s58
 s_add_u32 m0, s61, 65536
 s_nop 0
 buffer_load_dwordx4 v3, s[28:31], s53 offen offset:0 sc1 lds
 buffer_load_dwordx4 v3, s[28:31], s53 offen offset:1024 sc1 lds
 buffer_load_dwordx4 v3, s[28:31], s53 offen offset:2048 sc1 lds
 buffer_load_dwordx4 v3, s[28:31], s53 offen offset:3072 sc1 lds
 s_add_u32 s53, s53, 8192
 s_add_u32 m0, s61, 81920
 s_nop 0
 buffer_load_dwordx4 v3, s[28:31], s53 offen offset:0 sc1 lds
 buffer_load_dwordx4 v3, s[28:31], s53 offen offset:1024 sc1 lds
 buffer_load_dwordx4 v3, s[28:31], s53 offen offset:2048 sc1 lds
 buffer_load_dwordx4 v3, s[28:31], s53 offen offset:3072 sc1 lds
 s_add_u32 s53, s53, 8192
 s_add_u32 m0, s61, 98304
 s_nop 0
 buffer_load_dwordx4 v3, s[28:31], s53 offen offset:0 sc1 lds
 buffer_load_dwordx4 v3, s[28:31], s53 offen offset:1024 sc1 lds
 buffer_load_dwordx4 v3, s[28:31], s53 offen offset:2048 sc1 lds
 buffer_load_dwordx4 v3, s[28:31], s53 offen offset:3072 sc1 lds
 s_add_u32 s53, s53, 8192
 s_waitcnt vmcnt(24)
 s_barrier
 ds_read_b128 v[48:51], v7 offset:0
 ds_read_b128 v[52:55], v7 offset:8192
 ds_read_b128 v[56:59], v7 offset:1024
 ds_read_b128 v[60:63], v7 offset:9216
 s_waitcnt lgkmcnt(2)
 v_mfma_f32_16x16x32_bf16 v[16:19], a[0:3], v[48:51], 0
 ds_read_b128 v[64:67], v7 offset:2048
 v_mfma_f32_16x16x32_bf16 v[20:23], a[4:7], v[48:51], 0
 ds_read_b128 v[68:71], v7 offset:10240
 v_mfma_f32_16x16x32_bf16 v[24:27], a[0:3], v[52:55], 0
 v_mfma_f32_16x16x32_bf16 v[28:31], a[4:7], v[52:55], 0
 s_waitcnt lgkmcnt(2)
 v_mfma_f32_16x16x32_bf16 v[16:19], a[8:11], v[56:59], v[16:19]
 ds_read_b128 v[72:75], v7 offset:3072
 v_mfma_f32_16x16x32_bf16 v[20:23], a[12:15], v[56:59], v[20:23]
 ds_read_b128 v[76:79], v7 offset:11264
 v_mfma_f32_16x16x32_bf16 v[24:27], a[8:11], v[60:63], v[24:27]
 v_mfma_f32_16x16x32_bf16 v[28:31], a[12:15], v[60:63], v[28:31]
 s_waitcnt lgkmcnt(2)
 v_mfma_f32_16x16x32_bf16 v[16:19], a[16:19], v[64:67], v[16:19]
 ds_read_b128 v[48:51], v7 offset:4096
 v_mfma_f32_16x16x32_bf16 v[20:23], a[20:23], v[64:67], v[20:23]
 ds_read_b128 v[52:55], v7 offset:12288
 v_mfma_f32_16x16x32_bf16 v[24:27], a[16:19], v[68:71], v[24:27]
 v_mfma_f32_16x16x32_bf16 v[28:31], a[20:23], v[68:71], v[28:31]
 s_waitcnt lgkmcnt(2)
 v_mfma_f32_16x16x32_bf16 v[16:19], a[24:27], v[72:75], v[16:19]
 ds_read_b128 v[56:59], v7 offset:5120
 v_mfma_f32_16x16x32_bf16 v[20:23], a[28:31], v[72:75], v[20:23]
 ds_read_b128 v[60:63], v7 offset:13312
 v_mfma_f32_16x16x32_bf16 v[24:27], a[24:27], v[76:79], v[24:27]
 v_mfma_f32_16x16x32_bf16 v[28:31], a[28:31], v[76:79], v[28:31]
 s_waitcnt lgkmcnt(2)
 v_mfma_f32_16x16x32_bf16 v[16:19], a[32:35], v[48:51], v[16:19]
 ds_read_b128 v[64:67], v7 offset:6144
 v_mfma_f32_16x16x32_bf16 v[20:23], a[36:39], v[48:51], v[20:23]
 ds_read_b128 v[68:71], v7 offset:14336
 v_mfma_f32_16x16x32_bf16 v[24:27], a[32:35], v[52:55], v[24:27]
 v_mfma_f32_16x16x32_bf16 v[28:31], a[36:39], v[52:55], v[28:31]
 s_waitcnt lgkmcnt(2)
 v_mfma_f32_16x16x32_bf16 v[16:19], a[40:43], v[56:59], v[16:19]
 ds_read_b128 v[72:75], v7 offset:7168
 v_mfma_f32_16x16x32_bf16 v[20:23], a[44:47], v[56:59], v[20:23]
 ds_read_b128 v[76:79], v7 offset:15360
 v_mfma_f32_16x16x32_bf16 v[24:27], a[40:43], v[60:63], v[24:27]
 v_mfma_f32_16x16x32_bf16 v[28:31], a[44:47], v[60:63], v[28:31]
 s_waitcnt lgkmcnt(2)
 v_mfma_f32_16x16x32_bf16 v[16:19], a[48:51], v[64:67], v[16:19]
 s_waitcnt vmcnt(20)
 s_barrier
 ds_read_b128 v[48:51], v7 offset:16384
 v_mfma_f32_16x16x32_bf16 v[20:23], a[52:55], v[64:67], v[20:23]
 ds_read_b128 v[52:55], v7 offset:24576
 v_mfma_f32_16x16x32_bf16 v[24:27], a[48:51], v[68:71], v[24:27]
 s_add_u32 m0, s61, 114688
 s_nop 0
 v_mfma_f32_16x16x32_bf16 v[28:31], a[52:55], v[68:71], v[28:31]
 buffer_load_dwordx4 v3, s[28:31], s53 offen offset:0 sc1 lds
 s_waitcnt lgkmcnt(2)
 v_mfma_f32_16x16x32_bf16 v[16:19], a[56:59], v[72:75], v[16:19]
 ds_read_b128 v[56:59], v7 offset:17408
 v_mfma_f32_16x16x32_bf16 v[20:23], a[60:63], v[72:75], v[20:23]
 ds_read_b128 v[60:63], v7 offset:25600
 v_mfma_f32_16x16x32_bf16 v[24:27], a[56:59], v[76:79], v[24:27]
 v_mfma_f32_16x16x32_bf16 v[28:31], a[60:63], v[76:79], v[28:31]
 s_waitcnt lgkmcnt(2)
 v_mfma_f32_16x16x32_bf16 v[16:19], a[64:67], v[48:51], v[16:19]
 ds_read_b128 v[64:67], v7 offset:18432
 v_mfma_f32_16x16x32_bf16 v[20:23], a[68:71], v[48:51], v[20:23]
 ds_read_b128 v[68:71], v7 offset:26624
 v_mfma_f32_16x16x32_bf16 v[24:27], a[64:67], v[52:55], v[24:27]
 buffer_load_dwordx4 v3, s[28:31], s53 offen offset:1024 sc1 lds
 v_mfma_f32_16x16x32_bf16 v[28:31], a[68:71], v[52:55], v[28:31]
 s_waitcnt lgkmcnt(2)
 v_mfma_f32_16x16x32_bf16 v[16:19], a[72:75], v[56:59], v[16:19]
 ds_read_b128 v[72:75], v7 offset:19456
 v_mfma_f32_16x16x32_bf16 v[20:23], a[76:79], v[56:59], v[20:23]
 ds_read_b128 v[76:79], v7 offset:27648
 v_mfma_f32_16x16x32_bf16 v[24:27], a[72:75], v[60:63], v[24:27]
 v_mfma_f32_16x16x32_bf16 v[28:31], a[76:79], v[60:63], v[28:31]
 s_waitcnt lgkmcnt(2)
 v_mfma_f32_16x16x32_bf16 v[16:19], a[80:83], v[64:67], v[16:19]
 ds_read_b128 v[48:51], v7 offset:20480
 v_mfma_f32_16x16x32_bf16 v[20:23], a[84:87], v[64:67], v[20:23]
 ds_read_b128 v[52:55], v7 offset:28672
 v_mfma_f32_16x16x32_bf16 v[24:27], a[80:83], v[68:71], v[24:27]
 buffer_load_dwordx4 v3, s[28:31], s53 offen offset:2048 sc1 lds
 v_mfma_f32_16x16x32_bf16 v[28:31], a[84:87], v[68:71], v[28:31]
 s_waitcnt lgkmcnt(2)
 v_mfma_f32_16x16x32_bf16 v[16:19], a[88:91], v[72:75], v[16:19]
 ds_read_b128 v[56:59], v7 offset:21504
 v_mfma_f32_16x16x32_bf16 v[20:23], a[92:95], v[72:75], v[20:23]
 ds_read_b128 v[60:63], v7 offset:29696
 v_mfma_f32_16x16x32_bf16 v[24:27], a[88:91], v[76:79], v[24:27]
 v_mfma_f32_16x16x32_bf16 v[28:31], a[92:95], v[76:79], v[28:31]
 s_waitcnt lgkmcnt(2)
 v_mfma_f32_16x16x32_bf16 v[16:19], a[96:99], v[48:51], v[16:19]
 ds_read_b128 v[64:67], v7 offset:22528
 v_mfma_f32_16x16x32_bf16 v[20:23], a[100:103], v[48:51], v[20:23]
 ds_read_b128 v[68:71], v7 offset:30720
 v_mfma_f32_16x16x32_bf16 v[24:27], a[96:99], v[52:55], v[24:27]
 buffer_load_dwordx4 v3, s[28:31], s53 offen offset:3072 sc1 lds
 v_mfma_f32_16x16x32_bf16 v[28:31], a[100:103], v[52:55], v[28:31]
 s_add_u32 s53, s53, s58
 s_waitcnt lgkmcnt(2)
 v_mfma_f32_16x16x32_bf16 v[16:19], a[104:107], v[56:59], v[16:19]
 ds_read_b128 v[72:75], v7 offset:23552
 v_mfma_f32_16x16x32_bf16 v[20:23], a[108:111], v[56:59], v[20:23]
 ds_read_b128 v[76:79], v7 offset:31744
 v_mfma_f32_16x16x32_bf16 v[24:27], a[104:107], v[60:63], v[24:27]
 v_mfma_f32_16x16x32_bf16 v[28:31], a[108:111], v[60:63], v[28:31]
 s_waitcnt lgkmcnt(2)
 v_mfma_f32_16x16x32_bf16 v[16:19], a[112:115], v[64:67], v[16:19]
 s_waitcnt vmcnt(20)
 s_barrier
 ds_read_b128 v[48:51], v7 offset:32768
 v_mfma_f32_16x16x32_bf16 v[20:23], a[116:119], v[64:67], v[20:23]
 ds_read_b128 v[52:55], v7 offset:40960
 v_mfma_f32_16x16x32_bf16 v[24:27], a[112:115], v[68:71], v[24:27]
 s_mov_b32 m0, s61
 s_nop 0
 v_mfma_f32_16x16x32_bf16 v[28:31], a[116:119], v[68:71], v[28:31]
 buffer_load_dwordx4 v3, s[28:31], s53 offen offset:0 sc1 lds
 s_waitcnt lgkmcnt(2)
 v_mfma_f32_16x16x32_bf16 v[16:19], a[120:123], v[72:75], v[16:19]
 ds_read_b128 v[56:59], v7 offset:33792
 v_mfma_f32_16x16x32_bf16 v[20:23], a[124:127], v[72:75], v[20:23]
 ds_read_b128 v[60:63], v7 offset:41984
 v_mfma_f32_16x16x32_bf16 v[24:27], a[120:123], v[76:79], v[24:27]
 v_mfma_f32_16x16x32_bf16 v[28:31], a[124:127], v[76:79], v[28:31]
 s_waitcnt lgkmcnt(2)
 v_mfma_f32_16x16x32_bf16 v[16:19], a[128:131], v[48:51], v[16:19]
 ds_read_b128 v[64:67], v7 offset:34816
 v_mfma_f32_16x16x32_bf16 v[20:23], a[132:135], v[48:51], v[20:23]
 ds_read_b128 v[68:71], v7 offset:43008
 v_mfma_f32_16x16x32_bf16 v[24:27], a[128:131], v[52:55], v[24:27]
 buffer_load_dwordx4 v3, s[28:31], s53 offen offset:1024 sc1 lds
 v_mfma_f32_16x16x32_bf16 v[28:31], a[132:135], v[52:55], v[28:31]
 s_waitcnt lgkmcnt(2)
 v_mfma_f32_16x16x32_bf16 v[16:19], a[136:139], v[56:59], v[16:19]
 ds_read_b128 v[72:75], v7 offset:35840
 v_mfma_f32_16x16x32_bf16 v[20:23], a[140:143], v[56:59], v[20:23]
 ds_read_b128 v[76:79], v7 offset:44032
 v_mfma_f32_16x16x32_bf16 v[24:27], a[136:139], v[60:63], v[24:27]
 v_mfma_f32_16x16x32_bf16 v[28:31], a[140:143], v[60:63], v[28:31]
 s_waitcnt lgkmcnt(2)
 v_mfma_f32_16x16x32_bf16 v[16:19], a[144:147], v[64:67], v[16:19]
 ds_read_b128 v[48:51], v7 offset:36864
 v_mfma_f32_16x16x32_bf16 v[20:23], a[148:151], v[64:67], v[20:23]
 ds_read_b128 v[52:55], v7 offset:45056
 v_mfma_f32_16x16x32_bf16 v[24:27], a[144:147], v[68:71], v[24:27]
 buffer_load_dwordx4 v3, s[28:31], s53 offen offset:2048 sc1 lds
 v_mfma_f32_16x16x32_bf16 v[28:31], a[148:151], v[68:71], v[28:31]
 s_waitcnt lgkmcnt(2)
 v_mfma_f32_16x16x32_bf16 v[16:19], a[152:155], v[72:75], v[16:19]
 ds_read_b128 v[56:59], v7 offset:37888
 v_mfma_f32_16x16x32_bf16 v[20:23], a[156:159], v[72:75], v[20:23]
 ds_read_b128 v[60:63], v7 offset:46080
 v_mfma_f32_16x16x32_bf16 v[24:27], a[152:155], v[76:79], v[24:27]
 v_mfma_f32_16x16x32_bf16 v[28:31], a[156:159], v[76:79], v[28:31]
 s_waitcnt lgkmcnt(2)
 v_mfma_f32_16x16x32_bf16 v[16:19], a[160:163], v[48:51], v[16:19]
 ds_read_b128 v[64:67], v7 offset:38912
 v_mfma_f32_16x16x32_bf16 v[20:23], a[164:167], v[48:51], v[20:23]
 ds_read_b128 v[68:71], v7 offset:47104
 v_mfma_f32_16x16x32_bf16 v[24:27], a[160:163], v[52:55], v[24:27]
 buffer_load_dwordx4 v3, s[28:31], s53 offen offset:3072 sc1 lds
 v_mfma_f32_16x16x32_bf16 v[28:31], a[164:167], v[52:55], v[28:31]
 s_add_u32 s53, s53, 8192
 s_waitcnt lgkmcnt(2)
 v_mfma_f32_16x16x32_bf16 v[16:19], a[168:171], v[56:59], v[16:19]
 ds_read_b128 v[72:75], v7 offset:39936
 v_mfma_f32_16x16x32_bf16 v[20:23], a[172:175], v[56:59], v[20:23]
 ds_read_b128 v[76:79], v7 offset:48128
 v_mfma_f32_16x16x32_bf16 v[24:27], a[168:171], v[60:63], v[24:27]
 v_mfma_f32_16x16x32_bf16 v[28:31], a[172:175], v[60:63], v[28:31]
 s_waitcnt lgkmcnt(2)
 v_mfma_f32_16x16x32_bf16 v[16:19], a[176:179], v[64:67], v[16:19]
 s_waitcnt vmcnt(20)
 s_barrier
 ds_read_b128 v[48:51], v7 offset:49152
 v_mfma_f32_16x16x32_bf16 v[20:23], a[180:183], v[64:67], v[20:23]
 ds_read_b128 v[52:55], v7 offset:57344
 v_mfma_f32_16x16x32_bf16 v[24:27], a[176:179], v[68:71], v[24:27]
 s_add_u32 m0, s61, 16384
 s_nop 0
 v_mfma_f32_16x16x32_bf16 v[28:31], a[180:183], v[68:71], v[28:31]
 buffer_load_dwordx4 v3, s[28:31], s53 offen offset:0 sc1 lds
 s_waitcnt lgkmcnt(2)
 v_mfma_f32_16x16x32_bf16 v[16:19], a[184:187], v[72:75], v[16:19]
 ds_read_b128 v[56:59], v7 offset:50176
 v_mfma_f32_16x16x32_bf16 v[20:23], a[188:191], v[72:75], v[20:23]
 ds_read_b128 v[60:63], v7 offset:58368
 v_mfma_f32_16x16x32_bf16 v[24:27], a[184:187], v[76:79], v[24:27]
 v_mfma_f32_16x16x32_bf16 v[28:31], a[188:191], v[76:79], v[28:31]
 s_waitcnt lgkmcnt(2)
 v_mfma_f32_16x16x32_bf16 v[16:19], a[192:195], v[48:51], v[16:19]
 ds_read_b128 v[64:67], v7 offset:51200
 v_mfma_f32_16x16x32_bf16 v[20:23], a[196:199], v[48:51], v[20:23]
 ds_read_b128 v[68:71], v7 offset:59392
 v_mfma_f32_16x16x32_bf16 v[24:27], a[192:195], v[52:55], v[24:27]
 buffer_load_dwordx4 v3, s[28:31], s53 offen offset:1024 sc1 lds
 v_mfma_f32_16x16x32_bf16 v[28:31], a[196:199], v[52:55], v[28:31]
 s_waitcnt lgkmcnt(2)
 v_mfma_f32_16x16x32_bf16 v[16:19], a[200:203], v[56:59], v[16:19]
 ds_read_b128 v[72:75], v7 offset:52224
 v_mfma_f32_16x16x32_bf16 v[20:23], a[204:207], v[56:59], v[20:23]
 ds_read_b128 v[76:79], v7 offset:60416
 v_mfma_f32_16x16x32_bf16 v[24:27], a[200:203], v[60:63], v[24:27]
 v_mfma_f32_16x16x32_bf16 v[28:31], a[204:207], v[60:63], v[28:31]
 s_waitcnt lgkmcnt(2)
 v_mfma_f32_16x16x32_bf16 v[16:19], a[208:211], v[64:67], v[16:19]
 ds_read_b128 v[48:51], v7 offset:53248
 v_mfma_f32_16x16x32_bf16 v[20:23], a[212:215], v[64:67], v[20:23]
 ds_read_b128 v[52:55], v7 offset:61440
 v_mfma_f32_16x16x32_bf16 v[24:27], a[208:211], v[68:71], v[24:27]
 buffer_load_dwordx4 v3, s[28:31], s53 offen offset:2048 sc1 lds
 v_mfma_f32_16x16x32_bf16 v[28:31], a[212:215], v[68:71], v[28:31]
 s_waitcnt lgkmcnt(2)
 v_mfma_f32_16x16x32_bf16 v[16:19], a[216:219], v[72:75], v[16:19]
 ds_read_b128 v[56:59], v7 offset:54272
 v_mfma_f32_16x16x32_bf16 v[20:23], a[220:223], v[72:75], v[20:23]
 ds_read_b128 v[60:63], v7 offset:62464
 v_mfma_f32_16x16x32_bf16 v[24:27], a[216:219], v[76:79], v[24:27]
 v_mfma_f32_16x16x32_bf16 v[28:31], a[220:223], v[76:79], v[28:31]
 s_waitcnt lgkmcnt(2)
 v_mfma_f32_16x16x32_bf16 v[16:19], a[224:227], v[48:51], v[16:19]
 ds_read_b128 v[64:67], v7 offset:55296
 v_mfma_f32_16x16x32_bf16 v[20:23], a[228:231], v[48:51], v[20:23]
 ds_read_b128 v[68:71], v7 offset:63488
 v_mfma_f32_16x16x32_bf16 v[24:27], a[224:227], v[52:55], v[24:27]
 buffer_load_dwordx4 v3, s[28:31], s53 offen offset:3072 sc1 lds
 v_mfma_f32_16x16x32_bf16 v[28:31], a[228:231], v[52:55], v[28:31]
 s_add_u32 s53, s53, 8192
 s_waitcnt lgkmcnt(2)
 v_mfma_f32_16x16x32_bf16 v[16:19], a[232:235], v[56:59], v[16:19]
 ds_read_b128 v[72:75], v7 offset:56320
 v_mfma_f32_16x16x32_bf16 v[20:23], a[236:239], v[56:59], v[20:23]
 ds_read_b128 v[76:79], v7 offset:64512
 v_mfma_f32_16x16x32_bf16 v[24:27], a[232:235], v[60:63], v[24:27]
 v_mfma_f32_16x16x32_bf16 v[28:31], a[236:239], v[60:63], v[28:31]
 s_waitcnt lgkmcnt(2)
 v_mfma_f32_16x16x32_bf16 v[16:19], a[240:243], v[64:67], v[16:19]
 s_waitcnt vmcnt(20)
 s_barrier
 ds_read_b128 v[48:51], v8 offset:0
 v_mfma_f32_16x16x32_bf16 v[20:23], a[244:247], v[64:67], v[20:23]
 ds_read_b128 v[52:55], v8 offset:8192
 v_mfma_f32_16x16x32_bf16 v[24:27], a[240:243], v[68:71], v[24:27]
 s_add_u32 m0, s61, 32768
 s_nop 0
 v_mfma_f32_16x16x32_bf16 v[28:31], a[244:247], v[68:71], v[28:31]
 buffer_load_dwordx4 v3, s[28:31], s53 offen offset:0 sc1 lds
 s_waitcnt lgkmcnt(2)
 v_mfma_f32_16x16x32_bf16 v[16:19], a[248:251], v[72:75], v[16:19]
 ds_read_b128 v[56:59], v8 offset:1024
 v_mfma_f32_16x16x32_bf16 v[20:23], a[252:255], v[72:75], v[20:23]
 ds_read_b128 v[60:63], v8 offset:9216
 v_mfma_f32_16x16x32_bf16 v[24:27], a[248:251], v[76:79], v[24:27]
 v_mfma_f32_16x16x32_bf16 v[28:31], a[252:255], v[76:79], v[28:31]
 s_sub_u32 s57, s57, 1
 s_cbranch_scc1 L_h_end0
L_h_top:
 s_waitcnt lgkmcnt(2)
 v_mfma_f32_16x16x32_bf16 v[32:35], a[0:3], v[48:51], 0
 ds_read_b128 v[64:67], v8 offset:2048
 v_mfma_f32_16x16x32_bf16 v[36:39], a[4:7], v[48:51], 0
 ds_read_b128 v[68:71], v8 offset:10240
 v_mfma_f32_16x16x32_bf16 v[40:43], a[0:3], v[52:55], 0
 buffer_load_dwordx4 v3, s[28:31], s53 offen offset:1024 sc1 lds
 v_mfma_f32_16x16x32_bf16 v[44:47], a[4:7], v[52:55], 0
 s_waitcnt lgkmcnt(2)
 v_mfma_f32_16x16x32_bf16 v[32:35], a[8:11], v[56:59], v[32:35]
 ds_read_b128 v[72:75], v8 offset:3072
 v_mfma_f32_16x16x32_bf16 v[36:39], a[12:15], v[56:59], v[36:39]
 ds_read_b128 v[76:79], v8 offset:11264
 v_mfma_f32_16x16x32_bf16 v[40:43], a[8:11], v[60:63], v[40:43]
 v_cvt_pk_bf16_f32 v80, v16, v17
 v_cvt_pk_bf16_f32 v81, v18, v19
 v_cvt_pk_bf16_f32 v82, v20, v21
 v_mfma_f32_16x16x32_bf16 v[44:47], a[12:15], v[60:63], v[44:47]
 v_cvt_pk_bf16_f32 v83, v22, v23
 v_pk_max_i16 v80, v80, s60
 s_waitcnt lgkmcnt(2)
 v_mfma_f32_16x16x32_bf16 v[32:35], a[16:19], v[64:67], v[32:35]
 ds_read_b128 v[48:51], v8 offset:4096
 v_mfma_f32_16x16x32_bf16 v[36:39], a[20:23], v[64:67], v[36:39]
 ds_read_b128 v[52:55], v8 offset:12288
 v_mfma_f32_16x16x32_bf16 v[40:43], a[16:19], v[68:71], v[40:43]
 buffer_load_dwordx4 v3, s[28:31], s53 offen offset:2048 sc1 lds
 v_mfma_f32_16x16x32_bf16 v[44:47], a[20:23], v[68:71], v[44:47]
 s_waitcnt lgkmcnt(2)
 v_mfma_f32_16x16x32_bf16 v[32:35], a[24:27], v[72:75], v[32:35]
 ds_read_b128 v[56:59], v8 offset:5120
 v_mfma_f32_16x16x32_bf16 v[36:39], a[28:31], v[72:75], v[36:39]
 ds_read_b128 v[60:63], v8 offset:13312
 v_mfma_f32_16x16x32_bf16 v[40:43], a[24:27], v[76:79], v[40:43]
 v_pk_max_i16 v81, v81, s60
 v_pk_max_i16 v82, v82, s60
 v_pk_max_i16 v83, v83, s60
 v_mfma_f32_16x16x32_bf16 v[44:47], a[28:31], v[76:79], v[44:47]
 buffer_store_dwordx4 v[80:83], v3, s[28:31], s54 offen sc1
 s_add_u32 s54, s54, s56
 s_waitcnt lgkmcnt(2)
 v_mfma_f32_16x16x32_bf16 v[32:35], a[32:35], v[48:51], v[32:35]
 ds_read_b128 v[64:67], v8 offset:6144
 v_mfma_f32_16x16x32_bf16 v[36:39], a[36:39], v[48:51], v[36:39]
 ds_read_b128 v[68:71], v8 offset:14336
 v_mfma_f32_16x16x32_bf16 v[40:43], a[32:35], v[52:55], v[40:43]
 buffer_load_dwordx4 v3, s[28:31], s53 offen offset:3072 sc1 lds
 v_mfma_f32_16x16x32_bf16 v[44:47], a[36:39], v[52:55], v[44:47]
 s_add_u32 s53, s53, 8192
 s_waitcnt lgkmcnt(2)
 v_mfma_f32_16x16x32_bf16 v[32:35], a[40:43], v[56:59], v[32:35]
 ds_read_b128 v[72:75], v8 offset:7168
 v_mfma_f32_16x16x32_bf16 v[36:39], a[44:47], v[56:59], v[36:39]
 ds_read_b128 v[76:79], v8 offset:15360
 v_mfma_f32_16x16x32_bf16 v[40:43], a[40:43], v[60:63], v[40:43]
 v_cvt_pk_bf16_f32 v84, v24, v25
 v_cvt_pk_bf16_f32 v85, v26, v27
 v_cvt_pk_bf16_f32 v86, v28, v29
 v_mfma_f32_16x16x32_bf16 v[44:47], a[44:47], v[60:63], v[44:47]
 v_cvt_pk_bf16_f32 v87, v30, v31
 v_pk_max_i16 v84, v84, s60
 s_waitcnt lgkmcnt(2)
 v_mfma_f32_16x16x32_bf16 v[32:35], a[48:51], v[64:67], v[32:35]
 s_waitcnt vmcnt(21)
 s_barrier
 ds_read_b128 v[48:51], v8 offset:16384
 v_mfma_f32_16x16x32_bf16 v[36:39], a[52:55], v[64:67], v[36:39]
 ds_read_b128 v[52:55], v8 offset:24576
 v_mfma_f32_16x16x32_bf16 v[40:43], a[48:51], v[68:71], v[40:43]
 s_add_u32 m0, s61, 49152
 s_nop 0
 v_mfma_f32_16x16x32_bf16 v[44:47], a[52:55], v[68:71], v[44:47]
 buffer_load_dwordx4 v3, s[28:31], s53 offen offset:0 sc1 lds
 s_waitcnt lgkmcnt(2)
 v_mfma_f32_16x16x32_bf16 v[32:35], a[56:59], v[72:75], v[32:35]
 ds_read_b128 v[56:59], v8 offset:17408
 v_mfma_f32_16x16x32_bf16 v[36:39], a[60:63], v[72:75], v[36:39]
 ds_read_b128 v[60:63], v8 offset:25600
 v_mfma_f32_16x16x32_bf16 v[40:43], a[56:59], v[76:79], v[40:43]
 v_pk_max_i16 v85, v85, s60
 v_pk_max_i16 v86, v86, s60
 v_pk_max_i16 v87, v87, s60
 v_mfma_f32_16x16x32_bf16 v[44:47], a[60:63], v[76:79], v[44:47]
 buffer_store_dwordx4 v[84:87], v3, s[28:31], s55 offen sc1
 s_add_u32 s55, s55, s56
 s_waitcnt lgkmcnt(2)
 v_mfma_f32_16x16x32_bf16 v[32:35], a[64:67], v[48:51], v[32:35]
 ds_read_b128 v[64:67], v8 offset:18432
 v_mfma_f32_16x16x32_bf16 v[36:39], a[68:71], v[48:51], v[36:39]
 ds_read_b128 v[68:71], v8 offset:26624
 v_mfma_f32_16x16x32_bf16 v[40:43], a[64:67], v[52:55], v[40:43]
 buffer_load_dwordx4 v3, s[28:31], s53 offen offset:1024 sc1 lds
 v_mfma_f32_16x16x32_bf16 v[44:47], a[68:71], v[52:55], v[44:47]
 s_waitcnt lgkmcnt(2)
 v_mfma_f32_16x16x32_bf16 v[32:35], a[72:75], v[56:59], v[32:35]
 ds_read_b128 v[72:75], v8 offset:19456
 v_mfma_f32_16x16x32_bf16 v[36:39], a[76:79], v[56:59], v[36:39]
 ds_read_b128 v[76:79], v8 offset:27648
 v_mfma_f32_16x16x32_bf16 v[40:43], a[72:75], v[60:63], v[40:43]
 v_mfma_f32_16x16x32_bf16 v[44:47], a[76:79], v[60:63], v[44:47]
 s_waitcnt lgkmcnt(2)
 v_mfma_f32_16x16x32_bf16 v[32:35], a[80:83], v[64:67], v[32:35]
 ds_read_b128 v[48:51], v8 offset:20480
 v_mfma_f32_16x16x32_bf16 v[36:39], a[84:87], v[64:67], v[36:39]
 ds_read_b128 v[52:55], v8 offset:28672
 v_mfma_f32_16x16x32_bf16 v[40:43], a[80:83], v[68:71], v[40:43]
 buffer_load_dwordx4 v3, s[28:31], s53 offen offset:2048 sc1 lds
 v_mfma_f32_16x16x32_bf16 v[44:47], a[84:87], v[68:71], v[44:47]
 s_waitcnt lgkmcnt(2)
 v_mfma_f32_16x16x32_bf16 v[32:35], a[88:91], v[72:75], v[32:35]
 ds_read_b128 v[56:59], v8 offset:21504
 v_mfma_f32_16x16x32_bf16 v[36:39], a[92:95], v[72:75], v[36:39]
 ds_read_b128 v[60:63], v8 offset:29696
 v_mfma_f32_16x16x32_bf16 v[40:43], a[88:91], v[76:79], v[40:43]
 v_mfma_f32_16x16x32_bf16 v[44:47], a[92:95], v[76:79], v[44:47]
 s_waitcnt lgkmcnt(2)
 v_mfma_f32_16x16x32_bf16 v[32:35], a[96:99], v[48:51], v[32:35]
 ds_read_b128 v[64:67], v8 offset:22528
 v_mfma_f32_16x16x32_bf16 v[36:39], a[100:103], v[48:51], v[36:39]
 ds_read_b128 v[68:71], v8 offset:30720
 v_mfma_f32_16x16x32_bf16 v[40:43], a[96:99], v[52:55], v[40:43]
 buffer_load_dwordx4 v3, s[28:31], s53 offen offset:3072 sc1 lds
 v_mfma_f32_16x16x32_bf16 v[44:47], a[100:103], v[52:55], v[44:47]
 s_add_u32 s53, s53, s58
 s_waitcnt lgkmcnt(2)
 v_mfma_f32_16x16x32_bf16 v[32:35], a[104:107], v[56:59], v[32:35]
 ds_read_b128 v[72:75], v8 offset:23552
 v_mfma_f32_16x16x32_bf16 v[36:39], a[108:111], v[56:59], v[36:39]
 ds_read_b128 v[76:79], v8 offset:31744
 v_mfma_f32_16x16x32_bf16 v[40:43], a[104:107], v[60:63], v[40:43]
 v_mfma_f32_16x16x32_bf16 v[44:47], a[108:111], v[60:63], v[44:47]
 s_waitcnt lgkmcnt(2)
 v_mfma_f32_16x16x32_bf16 v[32:35], a[112:115], v[64:67], v[32:35]
 s_waitcnt vmcnt(22)
 s_barrier
 ds_read_b128 v[48:51], v8 offset:32768
 v_mfma_f32_16x16x32_bf16 v[36:39], a[116:119], v[64:67], v[36:39]
 ds_read_b128 v[52:55], v8 offset:40960
 v_mfma_f32_16x16x32_bf16 v[40:43], a[112:115], v[68:71], v[40:43]
 s_add_u32 m0, s61, 65536
 s_nop 0
 v_mfma_f32_16x16x32_bf16 v[44:47], a[116:119], v[68:71], v[44:47]
 buffer_load_dwordx4 v3, s[28:31], s53 offen offset:0 sc1 lds
 s_waitcnt lgkmcnt(2)
 v_mfma_f32_16x16x32_bf16 v[32:35], a[120:123], v[72:75], v[32:35]
 ds_read_b128 v[56:59], v8 offset:33792
 v_mfma_f32_16x16x32_bf16 v[36:39], a[124:127], v[72:75], v[36:39]
 ds_read_b128 v[60:63], v8 offset:41984
 v_mfma_f32_16x16x32_bf16 v[40:43], a[120:123], v[76:79], v[40:43]
 v_mfma_f32_16x16x32_bf16 v[44:47], a[124:127], v[76:79], v[44:47]
 s_waitcnt lgkmcnt(2)
 v_mfma_f32_16x16x32_bf16 v[32:35], a[128:131], v[48:51], v[32:35]
 ds_read_b128 v[64:67], v8 offset:34816
 v_mfma_f32_16x16x32_bf16 v[36:39], a[132:135], v[48:51], v[36:39]
 ds_read_b128 v[68:71], v8 offset:43008
 v_mfma_f32_16x16x32_bf16 v[40:43], a[128:131], v[52:55], v[40:43]
 buffer_load_dwordx4 v3, s[28:31], s53 offen offset:1024 sc1 lds
 v_mfma_f32_16x16x32_bf16 v[44:47], a[132:135], v[52:55], v[44:47]
 s_waitcnt lgkmcnt(2)
 v_mfma_f32_16x16x32_bf16 v[32:35], a[136:139], v[56:59], v[32:35]
 ds_read_b128 v[72:75], v8 offset:35840
 v_mfma_f32_16x16x32_bf16 v[36:39], a[140:143], v[56:59], v[36:39]
 ds_read_b128 v[76:79], v8 offset:44032
 v_mfma_f32_16x16x32_bf16 v[40:43], a[136:139], v[60:63], v[40:43]
 v_mfma_f32_16x16x32_bf16 v[44:47], a[140:143], v[60:63], v[44:47]
 s_waitcnt lgkmcnt(2)
 v_mfma_f32_16x16x32_bf16 v[32:35], a[144:147], v[64:67], v[32:35]
 ds_read_b128 v[48:51], v8 offset:36864
 v_mfma_f32_16x16x32_bf16 v[36:39], a[148:151], v[64:67], v[36:39]
 ds_read_b128 v[52:55], v8 offset:45056
 v_mfma_f32_16x16x32_bf16 v[40:43], a[144:147], v[68:71], v[40:43]
 buffer_load_dwordx4 v3, s[28:31], s53 offen offset:2048 sc1 lds
 v_mfma_f32_16x16x32_bf16 v[44:47], a[148:151], v[68:71], v[44:47]
 s_waitcnt lgkmcnt(2)
 v_mfma_f32_16x16x32_bf16 v[32:35], a[152:155], v[72:75], v[32:35]
 ds_read_b128 v[56:59], v8 offset:37888
 v_mfma_f32_16x16x32_bf16 v[36:39], a[156:159], v[72:75], v[36:39]
 ds_read_b128 v[60:63], v8 offset:46080
 v_mfma_f32_16x16x32_bf16 v[40:43], a[152:155], v[76:79], v[40:43]
 v_mfma_f32_16x16x32_bf16 v[44:47], a[156:159], v[76:79], v[44:47]
 s_waitcnt lgkmcnt(2)
 v_mfma_f32_16x16x32_bf16 v[32:35], a[160:163], v[48:51], v[32:35]
 ds_read_b128 v[64:67], v8 offset:38912
 v_mfma_f32_16x16x32_bf16 v[36:39], a[164:167], v[48:51], v[36:39]
 ds_read_b128 v[68:71], v8 offset:47104
 v_mfma_f32_16x16x32_bf16 v[40:43], a[160:163], v[52:55], v[40:43]
 buffer_load_dwordx4 v3, s[28:31], s53 offen offset:3072 sc1 lds
 v_mfma_f32_16x16x32_bf16 v[44:47], a[164:167], v[52:55], v[44:47]
 s_add_u32 s53, s53, 8192
 s_waitcnt lgkmcnt(2)
 v_mfma_f32_16x16x32_bf16 v[32:35], a[168:171], v[56:59], v[32:35]
 ds_read_b128 v[72:75], v8 offset:39936
 v_mfma_f32_16x16x32_bf16 v[36:39], a[172:175], v[56:59], v[36:39]
 ds_read_b128 v[76:79], v8 offset:48128
 v_mfma_f32_16x16x32_bf16 v[40:43], a[168:171], v[60:63], v[40:43]
 v_mfma_f32_16x16x32_bf16 v[44:47], a[172:175], v[60:63], v[44:47]
 s_waitcnt lgkmcnt(2)
 v_mfma_f32_16x16x32_bf16 v[32:35], a[176:179], v[64:67], v[32:35]
 s_waitcnt vmcnt(22)
 s_barrier
 ds_read_b128 v[48:51], v8 offset:49152
 v_mfma_f32_16x16x32_bf16 v[36:39], a[180:183], v[64:67], v[36:39]
 ds_read_b128 v[52:55], v8 offset:57344
 v_mfma_f32_16x16x32_bf16 v[40:43], a[176:179], v[68:71], v[40:43]
 s_add_u32 m0, s61, 81920
 s_nop 0
 v_mfma_f32_16x16x32_bf16 v[44:47], a[180:183], v[68:71], v[44:47]
 buffer_load_dwordx4 v3, s[28:31], s53 offen offset:0 sc1 lds
 s_waitcnt lgkmcnt(2)
 v_mfma_f32_16x16x32_bf16 v[32:35], a[184:187], v[72:75], v[32:35]
 ds_read_b128 v[56:59], v8 offset:50176
 v_mfma_f32_16x16x32_bf16 v[36:39], a[188:191], v[72:75], v[36:39]
 ds_read_b128 v[60:63], v8 offset:58368
 v_mfma_f32_16x16x32_bf16 v[40:43], a[184:187], v[76:79], v[40:43]
 v_mfma_f32_16x16x32_bf16 v[44:47], a[188:191], v[76:79], v[44:47]
 s_waitcnt lgkmcnt(2)
 v_mfma_f32_16x16x32_bf16 v[32:35], a[192:195], v[48:51], v[32:35]
 ds_read_b128 v[64:67], v8 offset:51200
 v_mfma_f32_16x16x32_bf16 v[36:39], a[196:199], v[48:51], v[36:39]
 ds_read_b128 v[68:71], v8 offset:59392
 v_mfma_f32_16x16x32_bf16 v[40:43], a[192:195], v[52:55], v[40:43]
 buffer_load_dwordx4 v3, s[28:31], s53 offen offset:1024 sc1 lds
 v_mfma_f32_16x16x32_bf16 v[44:47], a[196:199], v[52:55], v[44:47]
 s_waitcnt lgkmcnt(2)
 v_mfma_f32_16x16x32_bf16 v[32:35], a[200:203], v[56:59], v[32:35]
 ds_read_b128 v[72:75], v8 offset:52224
 v_mfma_f32_16x16x32_bf16 v[36:39], a[204:207], v[56:59], v[36:39]
 ds_read_b128 v[76:79], v8 offset:60416
 v_mfma_f32_16x16x32_bf16 v[40:43], a[200:203], v[60:63], v[40:43]
 v_mfma_f32_16x16x32_bf16 v[44:47], a[204:207], v[60:63], v[44:47]
 s_waitcnt lgkmcnt(2)
 v_mfma_f32_16x16x32_bf16 v[32:35], a[208:211], v[64:67], v[32:35]
 ds_read_b128 v[48:51], v8 offset:53248
 v_mfma_f32_16x16x32_bf16 v[36:39], a[212:215], v[64:67], v[36:39]
 ds_read_b128 v[52:55], v8 offset:61440
 v_mfma_f32_16x16x32_bf16 v[40:43], a[208:211], v[68:71], v[40:43]
 buffer_load_dwordx4 v3, s[28:31], s53 offen offset:2048 sc1 lds
 v_mfma_f32_16x16x32_bf16 v[44:47], a[212:215], v[68:71], v[44:47]
 s_waitcnt lgkmcnt(2)
 v_mfma_f32_16x16x32_bf16 v[32:35], a[216:219], v[72:75], v[32:35]
 ds_read_b128 v[56:59], v8 offset:54272
 v_mfma_f32_16x16x32_bf16 v[36:39], a[220:223], v[72:75], v[36:39]
 ds_read_b128 v[60:63], v8 offset:62464
 v_mfma_f32_16x16x32_bf16 v[40:43], a[216:219], v[76:79], v[40:43]
 v_mfma_f32_16x16x32_bf16 v[44:47], a[220:223], v[76:79], v[44:47]
 s_waitcnt lgkmcnt(2)
 v_mfma_f32_16x16x32_bf16 v[32:35], a[224:227], v[48:51], v[32:35]
 ds_read_b128 v[64:67], v8 offset:55296
 v_mfma_f32_16x16x32_bf16 v[36:39], a[228:231], v[48:51], v[36:39]
 ds_read_b128 v[68:71], v8 offset:63488
 v_mfma_f32_16x16x32_bf16 v[40:43], a[224:227], v[52:55], v[40:43]
 buffer_load_dwordx4 v3, s[28:31], s53 offen offset:3072 sc1 lds
 v_mfma_f32_16x16x32_bf16 v[44:47], a[228:231], v[52:55], v[44:47]
 s_add_u32 s53, s53, 8192
 s_waitcnt lgkmcnt(2)
 v_mfma_f32_16x16x32_bf16 v[32:35], a[232:235], v[56:59], v[32:35]
 ds_read_b128 v[72:75], v8 offset:56320
 v_mfma_f32_16x16x32_bf16 v[36:39], a[236:239], v[56:59], v[36:39]
 ds_read_b128 v[76:79], v8 offset:64512
 v_mfma_f32_16x16x32_bf16 v[40:43], a[232:235], v[60:63], v[40:43]
 v_mfma_f32_16x16x32_bf16 v[44:47], a[236:239], v[60:63], v[44:47]
 s_waitcnt lgkmcnt(2)
 v_mfma_f32_16x16x32_bf16 v[32:35], a[240:243], v[64:67], v[32:35]
 s_waitcnt vmcnt(22)
 s_barrier
 ds_read_b128 v[48:51], v7 offset:0
 v_mfma_f32_16x16x32_bf16 v[36:39], a[244:247], v[64:67], v[36:39]
 ds_read_b128 v[52:55], v7 offset:8192
 v_mfma_f32_16x16x32_bf16 v[40:43], a[240:243], v[68:71], v[40:43]
 s_add_u32 m0, s61, 98304
 s_nop 0
 v_mfma_f32_16x16x32_bf16 v[44:47], a[244:247], v[68:71], v[44:47]
 buffer_load_dwordx4 v3, s[28:31], s53 offen offset:0 sc1 lds
 s_waitcnt lgkmcnt(2)
 v_mfma_f32_16x16x32_bf16 v[32:35], a[248:251], v[72:75], v[32:35]
 ds_read_b128 v[56:59], v7 offset:1024
 v_mfma_f32_16x16x32_bf16 v[36:39], a[252:255], v[72:75], v[36:39]
 ds_read_b128 v[60:63], v7 offset:9216
 v_mfma_f32_16x16x32_bf16 v[40:43], a[248:251], v[76:79], v[40:43]
 v_mfma_f32_16x16x32_bf16 v[44:47], a[252:255], v[76:79], v[44:47]
 s_sub_u32 s57, s57, 1
 s_cbranch_scc1 L_h_end1
 s_waitcnt lgkmcnt(2)
 v_mfma_f32_16x16x32_bf16 v[16:19], a[0:3], v[48:51], 0
 ds_read_b128 v[64:67], v7 offset:2048
 v_mfma_f32_16x16x32_bf16 v[20:23], a[4:7], v[48:51], 0
 ds_read_b128 v[68:71], v7 offset:10240
 v_mfma_f32_16x16x32_bf16 v[24:27], a[0:3], v[52:55], 0
 buffer_load_dwordx4 v3, s[28:31], s53 offen offset:1024 sc1 lds
 v_mfma_f32_16x16x32_bf16 v[28:31], a[4:7], v[52:55], 0
 s_waitcnt lgkmcnt(2)
 v_mfma_f32_16x16x32_bf16 v[16:19], a[8:11], v[56:59], v[16:19]
 ds_read_b128 v[72:75], v7 offset:3072
 v_mfma_f32_16x16x32_bf16 v[20:23], a[12:15], v[56:59], v[20:23]
 ds_read_b128 v[76:79], v7 offset:11264
 v_mfma_f32_16x16x32_bf16 v[24:27], a[8:11], v[60:63], v[24:27]
 v_cvt_pk_bf16_f32 v80, v32, v33
 v_cvt_pk_bf16_f32 v81, v34, v35
 v_cvt_pk_bf16_f32 v82, v36, v37
 v_mfma_f32_16x16x32_bf16 v[28:31], a[12:15], v[60:63], v[28:31]
 v_cvt_pk_bf16_f32 v83, v38, v39
 v_pk_max_i16 v80, v80, s60
 s_waitcnt lgkmcnt(2)
 v_mfma_f32_16x16x32_bf16 v[16:19], a[16:19], v[64:67], v[16:19]
 ds_read_b128 v[48:51], v7 offset:4096
 v_mfma_f32_16x16x32_bf16 v[20:23], a[20:23], v[64:67], v[20:23]
 ds_read_b128 v[52:55], v7 offset:12288
 v_mfma_f32_16x16x32_bf16 v[24:27], a[16:19], v[68:71], v[24:27]
 buffer_load_dwordx4 v3, s[28:31], s53 offen offset:2048 sc1 lds
 v_mfma_f32_16x16x32_bf16 v[28:31], a[20:23], v[68:71], v[28:31]
 s_waitcnt lgkmcnt(2)
 v_mfma_f32_16x16x32_bf16 v[16:19], a[24:27], v[72:75], v[16:19]
 ds_read_b128 v[56:59], v7 offset:5120
 v_mfma_f32_16x16x32_bf16 v[20:23], a[28:31], v[72:75], v[20:23]
 ds_read_b128 v[60:63], v7 offset:13312
 v_mfma_f32_16x16x32_bf16 v[24:27], a[24:27], v[76:79], v[24:27]
 v_pk_max_i16 v81, v81, s60
 v_pk_max_i16 v82, v82, s60
 v_pk_max_i16 v83, v83, s60
 v_mfma_f32_16x16x32_bf16 v[28:31], a[28:31], v[76:79], v[28:31]
 buffer_store_dwordx4 v[80:83], v3, s[28:31], s54 offen sc1
 s_add_u32 s54, s54, s56
 s_waitcnt lgkmcnt(2)
 v_mfma_f32_16x16x32_bf16 v[16:19], a[32:35], v[48:51], v[16:19]
 ds_read_b128 v[64:67], v7 offset:6144
 v_mfma_f32_16x16x32_bf16 v[20:23], a[36:39], v[48:51], v[20:23]
 ds_read_b128 v[68:71], v7 offset:14336
 v_mfma_f32_16x16x32_bf16 v[24:27], a[32:35], v[52:55], v[24:27]
 buffer_load_dwordx4 v3, s[28:31], s53 offen offset:3072 sc1 lds
 v_mfma_f32_16x16x32_bf16 v[28:31], a[36:39], v[52:55], v[28:31]
 s_add_u32 s53, s53, 8192
 s_waitcnt lgkmcnt(2)
 v_mfma_f32_16x16x32_bf16 v[16:19], a[40:43], v[56:59], v[16:19]
 ds_read_b128 v[72:75], v7 offset:7168
 v_mfma_f32_16x16x32_bf16 v[20:23], a[44:47], v[56:59], v[20:23]
 ds_read_b128 v[76:79], v7 offset:15360
 v_mfma_f32_16x16x32_bf16 v[24:27], a[40:43], v[60:63], v[24:27]
 v_cvt_pk_bf16_f32 v84, v40, v41
 v_cvt_pk_bf16_f32 v85, v42, v43
 v_cvt_pk_bf16_f32 v86, v44, v45
 v_mfma_f32_16x16x32_bf16 v[28:31], a[44:47], v[60:63], v[28:31]
 v_cvt_pk_bf16_f32 v87, v46, v47
 v_pk_max_i16 v84, v84, s60
 s_waitcnt lgkmcnt(2)
 v_mfma_f32_16x16x32_bf16 v[16:19], a[48:51], v[64:67], v[16:19]
 s_waitcnt vmcnt(23)
 s_barrier
 ds_read_b128 v[48:51], v7 offset:16384
 v_mfma_f32_16x16x32_bf16 v[20:23], a[52:55], v[64:67], v[20:23]
 ds_read_b128 v[52:55], v7 offset:24576
 v_mfma_f32_16x16x32_bf16 v[24:27], a[48:51], v[68:71], v[24:27]
 s_add_u32 m0, s61, 114688
 s_nop 0
 v_mfma_f32_16x16x32_bf16 v[28:31], a[52:55], v[68:71], v[28:31]
 buffer_load_dwordx4 v3, s[28:31], s53 offen offset:0 sc1 lds
 s_waitcnt lgkmcnt(2)
 v_mfma_f32_16x16x32_bf16 v[16:19], a[56:59], v[72:75], v[16:19]
 ds_read_b128 v[56:59], v7 offset:17408
 v_mfma_f32_16x16x32_bf16 v[20:23], a[60:63], v[72:75], v[20:23]
 ds_read_b128 v[60:63], v7 offset:25600
 v_mfma_f32_16x16x32_bf16 v[24:27], a[56:59], v[76:79], v[24:27]
 v_pk_max_i16 v85, v85, s60
 v_pk_max_i16 v86, v86, s60
 v_pk_max_i16 v87, v87, s60
 v_mfma_f32_16x16x32_bf16 v[28:31], a[60:63], v[76:79], v[28:31]
 buffer_store_dwordx4 v[84:87], v3, s[28:31], s55 offen sc1
 s_add_u32 s55, s55, s56
 s_waitcnt lgkmcnt(2)
 v_mfma_f32_16x16x32_bf16 v[16:19], a[64:67], v[48:51], v[16:19]
 ds_read_b128 v[64:67], v7 offset:18432
 v_mfma_f32_16x16x32_bf16 v[20:23], a[68:71], v[48:51], v[20:23]
 ds_read_b128 v[68:71], v7 offset:26624
 v_mfma_f32_16x16x32_bf16 v[24:27], a[64:67], v[52:55], v[24:27]
 buffer_load_dwordx4 v3, s[28:31], s53 offen offset:1024 sc1 lds
 v_mfma_f32_16x16x32_bf16 v[28:31], a[68:71], v[52:55], v[28:31]
 s_waitcnt lgkmcnt(2)
 v_mfma_f32_16x16x32_bf16 v[16:19], a[72:75], v[56:59], v[16:19]
 ds_read_b128 v[72:75], v7 offset:19456
 v_mfma_f32_16x16x32_bf16 v[20:23], a[76:79], v[56:59], v[20:23]
 ds_read_b128 v[76:79], v7 offset:27648
 v_mfma_f32_16x16x32_bf16 v[24:27], a[72:75], v[60:63], v[24:27]
 v_mfma_f32_16x16x32_bf16 v[28:31], a[76:79], v[60:63], v[28:31]
 s_waitcnt lgkmcnt(2)
 v_mfma_f32_16x16x32_bf16 v[16:19], a[80:83], v[64:67], v[16:19]
 ds_read_b128 v[48:51], v7 offset:20480
 v_mfma_f32_16x16x32_bf16 v[20:23], a[84:87], v[64:67], v[20:23]
 ds_read_b128 v[52:55], v7 offset:28672
 v_mfma_f32_16x16x32_bf16 v[24:27], a[80:83], v[68:71], v[24:27]
 buffer_load_dwordx4 v3, s[28:31], s53 offen offset:2048 sc1 lds
 v_mfma_f32_16x16x32_bf16 v[28:31], a[84:87], v[68:71], v[28:31]
 s_waitcnt lgkmcnt(2)
 v_mfma_f32_16x16x32_bf16 v[16:19], a[88:91], v[72:75], v[16:19]
 ds_read_b128 v[56:59], v7 offset:21504
 v_mfma_f32_16x16x32_bf16 v[20:23], a[92:95], v[72:75], v[20:23]
 ds_read_b128 v[60:63], v7 offset:29696
 v_mfma_f32_16x16x32_bf16 v[24:27], a[88:91], v[76:79], v[24:27]
 v_mfma_f32_16x16x32_bf16 v[28:31], a[92:95], v[76:79], v[28:31]
 s_waitcnt lgkmcnt(2)
 v_mfma_f32_16x16x32_bf16 v[16:19], a[96:99], v[48:51], v[16:19]
 ds_read_b128 v[64:67], v7 offset:22528
 v_mfma_f32_16x16x32_bf16 v[20:23], a[100:103], v[48:51], v[20:23]
 ds_read_b128 v[68:71], v7 offset:30720
 v_mfma_f32_16x16x32_bf16 v[24:27], a[96:99], v[52:55], v[24:27]
 buffer_load_dwordx4 v3, s[28:31], s53 offen offset:3072 sc1 lds
 v_mfma_f32_16x16x32_bf16 v[28:31], a[100:103], v[52:55], v[28:31]
 s_add_u32 s53, s53, s58
 s_waitcnt lgkmcnt(2)
 v_mfma_f32_16x16x32_bf16 v[16:19], a[104:107], v[56:59], v[16:19]
 ds_read_b128 v[72:75], v7 offset:23552
 v_mfma_f32_16x16x32_bf16 v[20:23], a[108:111], v[56:59], v[20:23]
 ds_read_b128 v[76:79], v7 offset:31744
 v_mfma_f32_16x16x32_bf16 v[24:27], a[104:107], v[60:63], v[24:27]
 v_mfma_f32_16x16x32_bf16 v[28:31], a[108:111], v[60:63], v[28:31]
 s_waitcnt lgkmcnt(2)
 v_mfma_f32_16x16x32_bf16 v[16:19], a[112:115], v[64:67], v[16:19]
 s_waitcnt vmcnt(23)
 s_barrier
 ds_read_b128 v[48:51], v7 offset:32768
 v_mfma_f32_16x16x32_bf16 v[20:23], a[116:119], v[64:67], v[20:23]
 ds_read_b128 v[52:55], v7 offset:40960
 v_mfma_f32_16x16x32_bf16 v[24:27], a[112:115], v[68:71], v[24:27]
 s_mov_b32 m0, s61
 s_nop 0
 v_mfma_f32_16x16x32_bf16 v[28:31], a[116:119], v[68:71], v[28:31]
 buffer_load_dwordx4 v3, s[28:31], s53 offen offset:0 sc1 lds
 s_waitcnt lgkmcnt(2)
 v_mfma_f32_16x16x32_bf16 v[16:19], a[120:123], v[72:75], v[16:19]
 ds_read_b128 v[56:59], v7 offset:33792
 v_mfma_f32_16x16x32_bf16 v[20:23], a[124:127], v[72:75], v[20:23]
 ds_read_b128 v[60:63], v7 offset:41984
 v_mfma_f32_16x16x32_bf16 v[24:27], a[120:123], v[76:79], v[24:27]
 v_mfma_f32_16x16x32_bf16 v[28:31], a[124:127], v[76:79], v[28:31]
 s_waitcnt lgkmcnt(2)
 v_mfma_f32_16x16x32_bf16 v[16:19], a[128:131], v[48:51], v[16:19]
 ds_read_b128 v[64:67], v7 offset:34816
 v_mfma_f32_16x16x32_bf16 v[20:23], a[132:135], v[48:51], v[20:23]
 ds_read_b128 v[68:71], v7 offset:43008
 v_mfma_f32_16x16x32_bf16 v[24:27], a[128:131], v[52:55], v[24:27]
 buffer_load_dwordx4 v3, s[28:31], s53 offen offset:1024 sc1 lds
 v_mfma_f32_16x16x32_bf16 v[28:31], a[132:135], v[52:55], v[28:31]
 s_waitcnt lgkmcnt(2)
 v_mfma_f32_16x16x32_bf16 v[16:19], a[136:139], v[56:59], v[16:19]
 ds_read_b128 v[72:75], v7 offset:35840
 v_mfma_f32_16x16x32_bf16 v[20:23], a[140:143], v[56:59], v[20:23]
 ds_read_b128 v[76:79], v7 offset:44032
 v_mfma_f32_16x16x32_bf16 v[24:27], a[136:139], v[60:63], v[24:27]
 v_mfma_f32_16x16x32_bf16 v[28:31], a[140:143], v[60:63], v[28:31]
 s_waitcnt lgkmcnt(2)
 v_mfma_f32_16x16x32_bf16 v[16:19], a[144:147], v[64:67], v[16:19]
 ds_read_b128 v[48:51], v7 offset:36864
 v_mfma_f32_16x16x32_bf16 v[20:23], a[148:151], v[64:67], v[20:23]
 ds_read_b128 v[52:55], v7 offset:45056
 v_mfma_f32_16x16x32_bf16 v[24:27], a[144:147], v[68:71], v[24:27]
 buffer_load_dwordx4 v3, s[28:31], s53 offen offset:2048 sc1 lds
 v_mfma_f32_16x16x32_bf16 v[28:31], a[148:151], v[68:71], v[28:31]
 s_waitcnt lgkmcnt(2)
 v_mfma_f32_16x16x32_bf16 v[16:19], a[152:155], v[72:75], v[16:19]
 ds_read_b128 v[56:59], v7 offset:37888
 v_mfma_f32_16x16x32_bf16 v[20:23], a[156:159], v[72:75], v[20:23]
 ds_read_b128 v[60:63], v7 offset:46080
 v_mfma_f32_16x16x32_bf16 v[24:27], a[152:155], v[76:79], v[24:27]
 v_mfma_f32_16x16x32_bf16 v[28:31], a[156:159], v[76:79], v[28:31]
 s_waitcnt lgkmcnt(2)
 v_mfma_f32_16x16x32_bf16 v[16:19], a[160:163], v[48:51], v[16:19]
 ds_read_b128 v[64:67], v7 offset:38912
 v_mfma_f32_16x16x32_bf16 v[20:23], a[164:167], v[48:51], v[20:23]
 ds_read_b128 v[68:71], v7 offset:47104
 v_mfma_f32_16x16x32_bf16 v[24:27], a[160:163], v[52:55], v[24:27]
 buffer_load_dwordx4 v3, s[28:31], s53 offen offset:3072 sc1 lds
 v_mfma_f32_16x16x32_bf16 v[28:31], a[164:167], v[52:55], v[28:31]
 s_add_u32 s53, s53, 8192
 s_waitcnt lgkmcnt(2)
 v_mfma_f32_16x16x32_bf16 v[16:19], a[168:171], v[56:59], v[16:19]
 ds_read_b128 v[72:75], v7 offset:39936
 v_mfma_f32_16x16x32_bf16 v[20:23], a[172:175], v[56:59], v[20:23]
 ds_read_b128 v[76:79], v7 offset:48128
 v_mfma_f32_16x16x32_bf16 v[24:27], a[168:171], v[60:63], v[24:27]
 v_mfma_f32_16x16x32_bf16 v[28:31], a[172:175], v[60:63], v[28:31]
 s_waitcnt lgkmcnt(2)
 v_mfma_f32_16x16x32_bf16 v[16:19], a[176:179], v[64:67], v[16:19]
 s_waitcnt vmcnt(22)
 s_barrier
 ds_read_b128 v[48:51], v7 offset:49152
 v_mfma_f32_16x16x32_bf16 v[20:23], a[180:183], v[64:67], v[20:23]
 ds_read_b128 v[52:55], v7 offset:57344
 v_mfma_f32_16x16x32_bf16 v[24:27], a[176:179], v[68:71], v[24:27]
 s_add_u32 m0, s61, 16384
 s_nop 0
 v_mfma_f32_16x16x32_bf16 v[28:31], a[180:183], v[68:71], v[28:31]
 buffer_load_dwordx4 v3, s[28:31], s53 offen offset:0 sc1 lds
 s_waitcnt lgkmcnt(2)
 v_mfma_f32_16x16x32_bf16 v[16:19], a[184:187], v[72:75], v[16:19]
 ds_read_b128 v[56:59], v7 offset:50176
 v_mfma_f32_16x16x32_bf16 v[20:23], a[188:191], v[72:75], v[20:23]
 ds_read_b128 v[60:63], v7 offset:58368
 v_mfma_f32_16x16x32_bf16 v[24:27], a[184:187], v[76:79], v[24:27]
 v_mfma_f32_16x16x32_bf16 v[28:31], a[188:191], v[76:79], v[28:31]
 s_waitcnt lgkmcnt(2)
 v_mfma_f32_16x16x32_bf16 v[16:19], a[192:195], v[48:51], v[16:19]
 ds_read_b128 v[64:67], v7 offset:51200
 v_mfma_f32_16x16x32_bf16 v[20:23], a[196:199], v[48:51], v[20:23]
 ds_read_b128 v[68:71], v7 offset:59392
 v_mfma_f32_16x16x32_bf16 v[24:27], a[192:195], v[52:55], v[24:27]
 buffer_load_dwordx4 v3, s[28:31], s53 offen offset:1024 sc1 lds
 v_mfma_f32_16x16x32_bf16 v[28:31], a[196:199], v[52:55], v[28:31]
 s_waitcnt lgkmcnt(2)
 v_mfma_f32_16x16x32_bf16 v[16:19], a[200:203], v[56:59], v[16:19]
 ds_read_b128 v[72:75], v7 offset:52224
 v_mfma_f32_16x16x32_bf16 v[20:23], a[204:207], v[56:59], v[20:23]
 ds_read_b128 v[76:79], v7 offset:60416
 v_mfma_f32_16x16x32_bf16 v[24:27], a[200:203], v[60:63], v[24:27]
 v_mfma_f32_16x16x32_bf16 v[28:31], a[204:207], v[60:63], v[28:31]
 s_waitcnt lgkmcnt(2)
 v_mfma_f32_16x16x32_bf16 v[16:19], a[208:211], v[64:67], v[16:19]
 ds_read_b128 v[48:51], v7 offset:53248
 v_mfma_f32_16x16x32_bf16 v[20:23], a[212:215], v[64:67], v[20:23]
 ds_read_b128 v[52:55], v7 offset:61440
 v_mfma_f32_16x16x32_bf16 v[24:27], a[208:211], v[68:71], v[24:27]
 buffer_load_dwordx4 v3, s[28:31], s53 offen offset:2048 sc1 lds
 v_mfma_f32_16x16x32_bf16 v[28:31], a[212:215], v[68:71], v[28:31]
 s_waitcnt lgkmcnt(2)
 v_mfma_f32_16x16x32_bf16 v[16:19], a[216:219], v[72:75], v[16:19]
 ds_read_b128 v[56:59], v7 offset:54272
 v_mfma_f32_16x16x32_bf16 v[20:23], a[220:223], v[72:75], v[20:23]
 ds_read_b128 v[60:63], v7 offset:62464
 v_mfma_f32_16x16x32_bf16 v[24:27], a[216:219], v[76:79], v[24:27]
 v_mfma_f32_16x16x32_bf16 v[28:31], a[220:223], v[76:79], v[28:31]
 s_waitcnt lgkmcnt(2)
 v_mfma_f32_16x16x32_bf16 v[16:19], a[224:227], v[48:51], v[16:19]
 ds_read_b128 v[64:67], v7 offset:55296
 v_mfma_f32_16x16x32_bf16 v[20:23], a[228:231], v[48:51], v[20:23]
 ds_read_b128 v[68:71], v7 offset:63488
 v_mfma_f32_16x16x32_bf16 v[24:27], a[224:227], v[52:55], v[24:27]
 buffer_load_dwordx4 v3, s[28:31], s53 offen offset:3072 sc1 lds
 v_mfma_f32_16x16x32_bf16 v[28:31], a[228:231], v[52:55], v[28:31]
 s_add_u32 s53, s53, 8192
 s_waitcnt lgkmcnt(2)
 v_mfma_f32_16x16x32_bf16 v[16:19], a[232:235], v[56:59], v[16:19]
 ds_read_b128 v[72:75], v7 offset:56320
 v_mfma_f32_16x16x32_bf16 v[20:23], a[236:239], v[56:59], v[20:23]
 ds_read_b128 v[76:79], v7 offset:64512
 v_mfma_f32_16x16x32_bf16 v[24:27], a[232:235], v[60:63], v[24:27]
 v_mfma_f32_16x16x32_bf16 v[28:31], a[236:239], v[60:63], v[28:31]
 s_waitcnt lgkmcnt(2)
 v_mfma_f32_16x16x32_bf16 v[16:19], a[240:243], v[64:67], v[16:19]
 s_waitcnt vmcnt(22)
 s_barrier
 ds_read_b128 v[48:51], v8 offset:0
 v_mfma_f32_16x16x32_bf16 v[20:23], a[244:247], v[64:67], v[20:23]
 ds_read_b128 v[52:55], v8 offset:8192
 v_mfma_f32_16x16x32_bf16 v[24:27], a[240:243], v[68:71], v[24:27]
 s_add_u32 m0, s61, 32768
 s_nop 0
 v_mfma_f32_16x16x32_bf16 v[28:31], a[244:247], v[68:71], v[28:31]
 buffer_load_dwordx4 v3, s[28:31], s53 offen offset:0 sc1 lds
 s_waitcnt lgkmcnt(2)
 v_mfma_f32_16x16x32_bf16 v[16:19], a[248:251], v[72:75], v[16:19]
 ds_read_b128 v[56:59], v8 offset:1024
 v_mfma_f32_16x16x32_bf16 v[20:23], a[252:255], v[72:75], v[20:23]
 ds_read_b128 v[60:63], v8 offset:9216
 v_mfma_f32_16x16x32_bf16 v[24:27], a[248:251], v[76:79], v[24:27]
 v_mfma_f32_16x16x32_bf16 v[28:31], a[252:255], v[76:79], v[28:31]
 s_sub_u32 s57, s57, 1
 s_cbranch_scc1 L_h_end0
 s_branch L_h_top
L_h_end0:
 s_nop 7
 v_cvt_pk_bf16_f32 v80, v16, v17
 v_cvt_pk_bf16_f32 v81, v18, v19
 v_cvt_pk_bf16_f32 v82, v20, v21
 v_cvt_pk_bf16_f32 v83, v22, v23
 v_pk_max_i16 v80, v80, s60
 v_pk_max_i16 v81, v81, s60
 v_pk_max_i16 v82, v82, s60
 v_pk_max_i16 v83, v83, s60
 buffer_store_dwordx4 v[80:83], v3, s[28:31], s54 offen sc1
 s_add_u32 s54, s54, s56
 v_cvt_pk_bf16_f32 v84, v24, v25
 v_cvt_pk_bf16_f32 v85, v26, v27
 v_cvt_pk_bf16_f32 v86, v28, v29
 v_cvt_pk_bf16_f32 v87, v30, v31
 v_pk_max_i16 v84, v84, s60
 v_pk_max_i16 v85, v85, s60
 v_pk_max_i16 v86, v86, s60
 v_pk_max_i16 v87, v87, s60
 buffer_store_dwordx4 v[84:87], v3, s[28:31], s55 offen sc1
 s_add_u32 s55, s55, s56
 s_branch L_h_done
L_h_end1:
 s_nop 7
 v_cvt_pk_bf16_f32 v80, v32, v33
 v_cvt_pk_bf16_f32 v81, v34, v35
 v_cvt_pk_bf16_f32 v82, v36, v37
 v_cvt_pk_bf16_f32 v83, v38, v39
 v_pk_max_i16 v80, v80, s60
 v_pk_max_i16 v81, v81, s60
 v_pk_max_i16 v82, v82, s60
 v_pk_max_i16 v83, v83, s60
 buffer_store_dwordx4 v[80:83], v3, s[28:31], s54 offen sc1
 s_add_u32 s54, s54, s56
 v_cvt_pk_bf16_f32 v84, v40, v41
 v_cvt_pk_bf16_f32 v85, v42, v43
 v_cvt_pk_bf16_f32 v86, v44, v45
 v_cvt_pk_bf16_f32 v87, v46, v47
 v_pk_max_i16 v84, v84, s60
 v_pk_max_i16 v85, v85, s60
 v_pk_max_i16 v86, v86, s60
 v_pk_max_i16 v87, v87, s60
 buffer_store_dwordx4 v[84:87], v3, s[28:31], s55 offen sc1
 s_add_u32 s55, s55, s56
L_h_done:
 s_waitcnt vmcnt(0) lgkmcnt(0)
 s_barrier
L_final:
 s_waitcnt vmcnt(0)
 s_barrier
 s_cmp_lg_u32 s40, 0
 s_cbranch_scc1 arr_36
 s_mov_b64 exec, 1
 v_mov_b32 v16, 0
 v_mov_b32 v17, 1
 global_atomic_add v16, v17, s[22:23] offset:128 sc1
 s_mov_b64 exec, -1
arr_36:
 s_mov_b32 s32, s18
 s_and_b32 s33, s19, 0xffff
 s_mov_b32 s34, 0x700000
 s_mov_b32 s35, 0x20000
 s_mov_b32 s36, s14
 s_and_b32 s37, s15, 0xffff
 s_mov_b32 s38, 0x800000
 s_mov_b32 s39, 0x20000
 s_lshl_b32 s48, s52, 6
 s_mul_i32 s49, s40, 1835008
 s_add_u32 s49, s49, s48
 v_bfe_u32 v16, v0, 3, 2
 v_bfe_u32 v17, v0, 1, 2
 v_lshl_add_u32 v16, v16, 2, v17
 v_mul_u32_u24 v16, 2048, v16
 v_and_b32 v17, 1, v0
 v_lshl_add_u32 v16, v17, 4, v16
 v_lshrrev_b32 v17, 5, v0
 v_lshl_add_u32 v16, v17, 5, v16
 v_add_u32 v6, s49, v16
 s_lshl_b32 s49, s40, 21
 s_add_u32 s49, s49, s48
 v_bfe_u32 v16, v0, 3, 2
 v_bfe_u32 v17, v0, 1, 2
 v_lshl_add_u32 v16, v16, 2, v17
 v_mul_u32_u24 v16, 2048, v16
 v_and_b32 v17, 1, v0
 v_lshl_add_u32 v16, v17, 4, v16
 v_lshrrev_b32 v17, 5, v0
 v_lshl_add_u32 v16, v17, 5, v16
 v_add_u32 v7, s49, v16
 v_lshlrev_b32 v4, 3, v0
 v_add_u32 v4, s45, v4
 s_mov_b32 m0, s45
 s_mov_b32 s47, 0x0
 buffer_load_dwordx4 v6, s[32:35], s47 offen lds
 s_add_u32 m0, s45, 1024
 s_mov_b32 s47, 0x8000
 buffer_load_dwordx4 v6, s[32:35], s47 offen lds
 s_add_u32 m0, s45, 2048
 s_mov_b32 s47, 0x10000
 buffer_load_dwordx4 v6, s[32:35], s47 offen lds
 s_add_u32 m0, s45, 3072
 s_mov_b32 s47, 0x18000
 buffer_load_dwordx4 v6, s[32:35], s47 offen lds
 s_add_u32 m0, s45, 4096
 s_mov_b32 s47, 0x20000
 buffer_load_dwordx4 v6, s[32:35], s47 offen lds
 s_add_u32 m0, s45, 5120
 s_mov_b32 s47, 0x28000
 buffer_load_dwordx4 v6, s[32:35], s47 offen lds
 s_add_u32 m0, s45, 6144
 s_mov_b32 s47, 0x30000
 buffer_load_dwordx4 v6, s[32:35], s47 offen lds
 s_add_u32 m0, s45, 7168
 s_mov_b32 s47, 0x38000
 buffer_load_dwordx4 v6, s[32:35], s47 offen lds
 s_add_u32 m0, s45, 8192
 s_mov_b32 s47, 0x40000
 buffer_load_dwordx4 v6, s[32:35], s47 offen lds
 s_add_u32 m0, s45, 9216
 s_mov_b32 s47, 0x48000
 buffer_load_dwordx4 v6, s[32:35], s47 offen lds
 s_add_u32 m0, s45, 10240
 s_mov_b32 s47, 0x50000
 buffer_load_dwordx4 v6, s[32:35], s47 offen lds
 s_add_u32 m0, s45, 11264
 s_mov_b32 s47, 0x58000
 buffer_load_dwordx4 v6, s[32:35], s47 offen lds
 s_add_u32 m0, s45, 12288
 s_mov_b32 s47, 0x60000
 buffer_load_dwordx4 v6, s[32:35], s47 offen lds
 s_add_u32 m0, s45, 13312
 s_mov_b32 s47, 0x68000
 buffer_load_dwordx4 v6, s[32:35], s47 offen lds
 s_add_u32 m0, s45, 14336
 s_mov_b32 s47, 0x70000
 buffer_load_dwordx4 v6, s[32:35], s47 offen lds
 s_add_u32 m0, s45, 15360
 s_mov_b32 s47, 0x78000
 buffer_load_dwordx4 v6, s[32:35], s47 offen lds
 s_add_u32 m0, s45, 16384
 s_mov_b32 s47, 0x80000
 buffer_load_dwordx4 v6, s[32:35], s47 offen lds
 s_add_u32 m0, s45, 17408
 s_mov_b32 s47, 0x88000
 buffer_load_dwordx4 v6, s[32:35], s47 offen lds
 s_add_u32 m0, s45, 18432
 s_mov_b32 s47, 0x90000
 buffer_load_dwordx4 v6, s[32:35], s47 offen lds
 s_add_u32 m0, s45, 19456
 s_mov_b32 s47, 0x98000
 buffer_load_dwordx4 v6, s[32:35], s47 offen lds
 s_add_u32 m0, s45, 20480
 s_mov_b32 s47, 0xa0000
 buffer_load_dwordx4 v6, s[32:35], s47 offen lds
 s_add_u32 m0, s45, 21504
 s_mov_b32 s47, 0xa8000
 buffer_load_dwordx4 v6, s[32:35], s47 offen lds
 s_add_u32 m0, s45, 22528
 s_mov_b32 s47, 0xb0000
 buffer_load_dwordx4 v6, s[32:35], s47 offen lds
 s_add_u32 m0, s45, 23552
 s_mov_b32 s47, 0xb8000
 buffer_load_dwordx4 v6, s[32:35], s47 offen lds
 s_add_u32 m0, s45, 24576
 s_mov_b32 s47, 0x0
 buffer_load_dwordx4 v7, s[36:39], s47 offen lds
 s_add_u32 m0, s45, 25600
 s_mov_b32 s47, 0x8000
 buffer_load_dwordx4 v7, s[36:39], s47 offen lds
 s_add_u32 m0, s45, 26624
 s_mov_b32 s47, 0x10000
 buffer_load_dwordx4 v7, s[36:39], s47 offen lds
 s_add_u32 m0, s45, 27648
 s_mov_b32 s47, 0x18000
 buffer_load_dwordx4 v7, s[36:39], s47 offen lds
 s_add_u32 m0, s45, 28672
 s_mov_b32 s47, 0x20000
 buffer_load_dwordx4 v7, s[36:39], s47 offen lds
 s_add_u32 m0, s45, 29696
 s_mov_b32 s47, 0x28000
 buffer_load_dwordx4 v7, s[36:39], s47 offen lds
 s_add_u32 m0, s45, 30720
 s_mov_b32 s47, 0x30000
 buffer_load_dwordx4 v7, s[36:39], s47 offen lds
 s_add_u32 m0, s45, 31744
 s_mov_b32 s47, 0x38000
 buffer_load_dwordx4 v7, s[36:39], s47 offen lds
 s_mov_b32 m0, s46
 s_mov_b32 s47, 0x40000
 buffer_load_dwordx4 v7, s[36:39], s47 offen lds
 s_add_u32 m0, s46, 1024
 s_mov_b32 s47, 0x48000
 buffer_load_dwordx4 v7, s[36:39], s47 offen lds
 s_add_u32 m0, s46, 2048
 s_mov_b32 s47, 0x50000
 buffer_load_dwordx4 v7, s[36:39], s47 offen lds
 s_add_u32 m0, s46, 3072
 s_mov_b32 s47, 0x58000
 buffer_load_dwordx4 v7, s[36:39], s47 offen lds
 s_add_u32 m0, s46, 4096
 s_mov_b32 s47, 0x60000
 buffer_load_dwordx4 v7, s[36:39], s47 offen lds
 s_add_u32 m0, s46, 5120
 s_mov_b32 s47, 0x68000
 buffer_load_dwordx4 v7, s[36:39], s47 offen lds
 s_add_u32 m0, s46, 6144
 s_mov_b32 s47, 0x70000
 buffer_load_dwordx4 v7, s[36:39], s47 offen lds
 s_add_u32 m0, s46, 7168
 s_mov_b32 s47, 0x78000
 buffer_load_dwordx4 v7, s[36:39], s47 offen lds
 s_waitcnt vmcnt(39)
 ds_read_b64_tr_b16 v[160:161], v4 offset:0
 ds_read_b64_tr_b16 v[164:165], v4 offset:512
 s_waitcnt vmcnt(38)
 ds_read_b64_tr_b16 v[162:163], v4 offset:1024
 ds_read_b64_tr_b16 v[166:167], v4 offset:1536
 s_waitcnt vmcnt(37)
 ds_read_b64_tr_b16 v[168:169], v4 offset:2048
 ds_read_b64_tr_b16 v[172:173], v4 offset:2560
 s_waitcnt vmcnt(36)
 ds_read_b64_tr_b16 v[170:171], v4 offset:3072
 ds_read_b64_tr_b16 v[174:175], v4 offset:3584
 s_waitcnt lgkmcnt(6)
 s_mov_b32 m0, s45
 s_mov_b32 s47, 0x80000
 buffer_load_dwordx4 v7, s[36:39], s47 offen lds
 s_waitcnt vmcnt(36)
 ds_read_b64_tr_b16 v[176:177], v4 offset:4096
 ds_read_b64_tr_b16 v[180:181], v4 offset:4608
 s_waitcnt lgkmcnt(6)
 s_add_u32 m0, s45, 1024
 s_mov_b32 s47, 0x88000
 buffer_load_dwordx4 v7, s[36:39], s47 offen lds
 s_waitcnt vmcnt(36)
 ds_read_b64_tr_b16 v[178:179], v4 offset:5120
 ds_read_b64_tr_b16 v[182:183], v4 offset:5632
 s_waitcnt lgkmcnt(6)
 s_add_u32 m0, s45, 2048
 s_mov_b32 s47, 0x90000
 buffer_load_dwordx4 v7, s[36:39], s47 offen lds
 s_waitcnt vmcnt(36)
 ds_read_b64_tr_b16 v[184:185], v4 offset:6144
 ds_read_b64_tr_b16 v[188:189], v4 offset:6656
 s_waitcnt lgkmcnt(6)
 s_add_u32 m0, s45, 3072
 s_mov_b32 s47, 0x98000
 buffer_load_dwordx4 v7, s[36:39], s47 offen lds
 s_waitcnt vmcnt(36)
 ds_read_b64_tr_b16 v[186:187], v4 offset:7168
 ds_read_b64_tr_b16 v[190:191], v4 offset:7680
 s_waitcnt lgkmcnt(6)
 s_add_u32 m0, s45, 4096
 s_mov_b32 s47, 0xa0000
 buffer_load_dwordx4 v7, s[36:39], s47 offen lds
 s_waitcnt vmcnt(36)
 ds_read_b64_tr_b16 v[192:193], v4 offset:8192
 ds_read_b64_tr_b16 v[196:197], v4 offset:8704
 s_waitcnt lgkmcnt(6)
 s_add_u32 m0, s45, 5120
 s_mov_b32 s47, 0xa8000
 buffer_load_dwordx4 v7, s[36:39], s47 offen lds
 s_waitcnt vmcnt(36)
 ds_read_b64_tr_b16 v[194:195], v4 offset:9216
 ds_read_b64_tr_b16 v[198:199], v4 offset:9728
 s_waitcnt lgkmcnt(6)
 s_add_u32 m0, s45, 6144
 s_mov_b32 s47, 0xb0000
 buffer_load_dwordx4 v7, s[36:39], s47 offen lds
 s_waitcnt vmcnt(36)
 ds_read_b64_tr_b16 v[200:201], v4 offset:10240
 ds_read_b64_tr_b16 v[204:205], v4 offset:10752
 s_waitcnt lgkmcnt(6)
 s_add_u32 m0, s45, 7168
 s_mov_b32 s47, 0xb8000
 buffer_load_dwordx4 v7, s[36:39], s47 offen lds
 s_waitcnt vmcnt(36)
 ds_read_b64_tr_b16 v[202:203], v4 offset:11264
 ds_read_b64_tr_b16 v[206:207], v4 offset:11776
 s_waitcnt lgkmcnt(6)
 s_add_u32 m0, s45, 8192
 s_mov_b32 s47, 0xc0000
 buffer_load_dwordx4 v7, s[36:39], s47 offen lds
 s_waitcnt vmcnt(36)
 ds_read_b64_tr_b16 v[208:209], v4 offset:12288
 ds_read_b64_tr_b16 v[212:213], v4 offset:12800
 s_waitcnt lgkmcnt(6)
 s_add_u32 m0, s45, 9216
 s_mov_b32 s47, 0xc8000
 buffer_load_dwordx4 v7, s[36:39], s47 offen lds
 s_waitcnt vmcnt(36)
 ds_read_b64_tr_b16 v[210:211], v4 offset:13312
 ds_read_b64_tr_b16 v[214:215], v4 offset:13824
 s_waitcnt lgkmcnt(6)
 s_add_u32 m0, s45, 10240
 s_mov_b32 s47, 0xd0000
 buffer_load_dwordx4 v7, s[36:39], s47 offen lds
 s_waitcnt vmcnt(36)
 ds_read_b64_tr_b16 v[216:217], v4 offset:14336
 ds_read_b64_tr_b16 v[220:221], v4 offset:14848
 s_waitcnt lgkmcnt(6)
 s_add_u32 m0, s45, 11264
 s_mov_b32 s47, 0xd8000
 buffer_load_dwordx4 v7, s[36:39], s47 offen lds
 s_waitcnt vmcnt(36)
 ds_read_b64_tr_b16 v[218:219], v4 offset:15360
 ds_read_b64_tr_b16 v[222:223], v4 offset:15872
 s_waitcnt lgkmcnt(6)
 s_add_u32 m0, s45, 12288
 s_mov_b32 s47, 0xe0000
 buffer_load_dwordx4 v7, s[36:39], s47 offen lds
 s_waitcnt vmcnt(36)
 ds_read_b64_tr_b16 v[224:225], v4 offset:16384
 ds_read_b64_tr_b16 v[228:229], v4 offset:16896
 s_waitcnt lgkmcnt(6)
 s_add_u32 m0, s45, 13312
 s_mov_b32 s47, 0xe8000
 buffer_load_dwordx4 v7, s[36:39], s47 offen lds
 s_waitcnt vmcnt(36)
 ds_read_b64_tr_b16 v[226:227], v4 offset:17408
 ds_read_b64_tr_b16 v[230:231], v4 offset:17920
 s_waitcnt lgkmcnt(6)
 s_add_u32 m0, s45, 14336
 s_mov_b32 s47, 0xf0000
 buffer_load_dwordx4 v7, s[36:39], s47 offen lds
 s_waitcnt vmcnt(36)
 ds_read_b64_tr_b16 v[232:233], v4 offset:18432
 ds_read_b64_tr_b16 v[236:237], v4 offset:18944
 s_waitcnt lgkmcnt(6)
 s_add_u32 m0, s45, 15360
 s_mov_b32 s47, 0xf8000
 buffer_load_dwordx4 v7, s[36:39], s47 offen lds
 s_waitcnt vmcnt(36)
 ds_read_b64_tr_b16 v[234:235], v4 offset:19456
 ds_read_b64_tr_b16 v[238:239], v4 offset:19968
 s_waitcnt lgkmcnt(6)
 s_add_u32 m0, s45, 16384
 s_mov_b32 s47, 0x100000
 buffer_load_dwordx4 v7, s[36:39], s47 offen lds
 s_waitcnt vmcnt(36)
 ds_read_b64_tr_b16 v[240:241], v4 offset:20480
 ds_read_b64_tr_b16 v[244:245], v4 offset:20992
 s_waitcnt lgkmcnt(6)
 s_add_u32 m0, s45, 17408
 s_mov_b32 s47, 0x108000
 buffer_load_dwordx4 v7, s[36:39], s47 offen lds
 s_waitcnt vmcnt(36)
 ds_read_b64_tr_b16 v[242:243], v4 offset:21504
 ds_read_b64_tr_b16 v[246:247], v4 offset:22016
 s_waitcnt lgkmcnt(6)
 s_add_u32 m0, s45, 18432
 s_mov_b32 s47, 0x110000
 buffer_load_dwordx4 v7, s[36:39], s47 offen lds
 s_waitcnt vmcnt(36)
 ds_read_b64_tr_b16 v[248:249], v4 offset:22528
 ds_read_b64_tr_b16 v[252:253], v4 offset:23040
 s_waitcnt lgkmcnt(6)
 s_add_u32 m0, s45, 19456
 s_mov_b32 s47, 0x118000
 buffer_load_dwordx4 v7, s[36:39], s47 offen lds
 s_waitcnt vmcnt(36)
 ds_read_b64_tr_b16 v[250:251], v4 offset:23552
 ds_read_b64_tr_b16 v[254:255], v4 offset:24064
 s_waitcnt lgkmcnt(6)
 s_add_u32 m0, s45, 20480
 s_mov_b32 s47, 0x120000
 buffer_load_dwordx4 v7, s[36:39], s47 offen lds
 s_waitcnt vmcnt(36)
 ds_read_b64_tr_b16 a[0:1], v4 offset:24576
 ds_read_b64_tr_b16 a[4:5], v4 offset:25088
 s_waitcnt lgkmcnt(6)
 s_add_u32 m0, s45, 21504
 s_mov_b32 s47, 0x128000
 buffer_load_dwordx4 v7, s[36:39], s47 offen lds
 s_waitcnt vmcnt(36)
 ds_read_b64_tr_b16 a[2:3], v4 offset:25600
 ds_read_b64_tr_b16 a[6:7], v4 offset:26112
 s_waitcnt lgkmcnt(6)
 s_add_u32 m0, s45, 22528
 s_mov_b32 s47, 0x130000
 buffer_load_dwordx4 v7, s[36:39], s47 offen lds
 s_waitcnt vmcnt(36)
 ds_read_b64_tr_b16 a[8:9], v4 offset:26624
 ds_read_b64_tr_b16 a[12:13], v4 offset:27136
 s_waitcnt lgkmcnt(6)
 s_add_u32 m0, s45, 23552
 s_mov_b32 s47, 0x138000
 buffer_load_dwordx4 v7, s[36:39], s47 offen lds
 s_waitcnt vmcnt(36)
 ds_read_b64_tr_b16 a[10:11], v4 offset:27648
 ds_read_b64_tr_b16 a[14:15], v4 offset:28160
 s_waitcnt lgkmcnt(6)
 s_add_u32 m0, s45, 24576
 s_mov_b32 s47, 0x140000
 buffer_load_dwordx4 v7, s[36:39], s47 offen lds
 s_waitcnt vmcnt(36)
 ds_read_b64_tr_b16 a[16:17], v4 offset:28672
 ds_read_b64_tr_b16 a[20:21], v4 offset:29184
 s_waitcnt lgkmcnt(6)
 s_add_u32 m0, s45, 25600
 s_mov_b32 s47, 0x148000
 buffer_load_dwordx4 v7, s[36:39], s47 offen lds
 s_waitcnt vmcnt(36)
 ds_read_b64_tr_b16 a[18:19], v4 offset:29696
 ds_read_b64_tr_b16 a[22:23], v4 offset:30208
 s_waitcnt lgkmcnt(6)
 s_add_u32 m0, s45, 26624
 s_mov_b32 s47, 0x150000
 buffer_load_dwordx4 v7, s[36:39], s47 offen lds
 s_waitcnt vmcnt(36)
 ds_read_b64_tr_b16 a[24:25], v4 offset:30720
 ds_read_b64_tr_b16 a[28:29], v4 offset:31232
 s_waitcnt lgkmcnt(6)
 s_add_u32 m0, s45, 27648
 s_mov_b32 s47, 0x158000
 buffer_load_dwordx4 v7, s[36:39], s47 offen lds
 s_waitcnt vmcnt(36)
 ds_read_b64_tr_b16 a[26:27], v4 offset:31744
 ds_read_b64_tr_b16 a[30:31], v4 offset:32256
 s_waitcnt lgkmcnt(6)
 s_add_u32 m0, s45, 28672
 s_mov_b32 s47, 0x160000
 buffer_load_dwordx4 v7, s[36:39], s47 offen lds
 s_waitcnt vmcnt(36)
 ds_read_b64_tr_b16 a[32:33], v5 offset:0
 ds_read_b64_tr_b16 a[36:37], v5 offset:512
 s_waitcnt lgkmcnt(6)
 s_add_u32 m0, s45, 29696
 s_mov_b32 s47, 0x168000
 buffer_load_dwordx4 v7, s[36:39], s47 offen lds
 s_waitcnt vmcnt(36)
 ds_read_b64_tr_b16 a[34:35], v5 offset:1024
 ds_read_b64_tr_b16 a[38:39], v5 offset:1536
 s_waitcnt lgkmcnt(6)
 s_add_u32 m0, s45, 30720
 s_mov_b32 s47, 0x170000
 buffer_load_dwordx4 v7, s[36:39], s47 offen lds
 s_waitcnt vmcnt(36)
 ds_read_b64_tr_b16 a[40:41], v5 offset:2048
 ds_read_b64_tr_b16 a[44:45], v5 offset:2560
 s_waitcnt lgkmcnt(6)
 s_add_u32 m0, s45, 31744
 s_mov_b32 s47, 0x178000
 buffer_load_dwordx4 v7, s[36:39], s47 offen lds
 s_waitcnt vmcnt(36)
 ds_read_b64_tr_b16 a[42:43], v5 offset:3072
 ds_read_b64_tr_b16 a[46:47], v5 offset:3584
 s_waitcnt lgkmcnt(6)
 s_mov_b32 m0, s46
 s_mov_b32 s47, 0x180000
 buffer_load_dwordx4 v7, s[36:39], s47 offen lds
 s_waitcnt vmcnt(36)
 ds_read_b64_tr_b16 a[48:49], v5 offset:4096
 ds_read_b64_tr_b16 a[52:53], v5 offset:4608
 s_waitcnt lgkmcnt(6)
 s_add_u32 m0, s46, 1024
 s_mov_b32 s47, 0x188000
 buffer_load_dwordx4 v7, s[36:39], s47 offen lds
 s_waitcnt vmcnt(36)
 ds_read_b64_tr_b16 a[50:51], v5 offset:5120
 ds_read_b64_tr_b16 a[54:55], v5 offset:5632
 s_waitcnt lgkmcnt(6)
 s_add_u32 m0, s46, 2048
 s_mov_b32 s47, 0x190000
 buffer_load_dwordx4 v7, s[36:39], s47 offen lds
 s_waitcnt vmcnt(36)
 ds_read_b64_tr_b16 a[56:57], v5 offset:6144
 ds_read_b64_tr_b16 a[60:61], v5 offset:6656
 s_waitcnt lgkmcnt(6)
 s_add_u32 m0, s46, 3072
 s_mov_b32 s47, 0x198000
 buffer_load_dwordx4 v7, s[36:39], s47 offen lds
 s_waitcnt vmcnt(36)
 ds_read_b64_tr_b16 a[58:59], v5 offset:7168
 ds_read_b64_tr_b16 a[62:63], v5 offset:7680
 s_waitcnt lgkmcnt(6)
 s_add_u32 m0, s46, 4096
 s_mov_b32 s47, 0x1a0000
 buffer_load_dwordx4 v7, s[36:39], s47 offen lds
 s_waitcnt vmcnt(36)
 ds_read_b64_tr_b16 a[64:65], v4 offset:0
 ds_read_b64_tr_b16 a[68:69], v4 offset:512
 s_waitcnt lgkmcnt(6)
 s_add_u32 m0, s46, 5120
 s_mov_b32 s47, 0x1a8000
 buffer_load_dwordx4 v7, s[36:39], s47 offen lds
 s_waitcnt vmcnt(36)
 ds_read_b64_tr_b16 a[66:67], v4 offset:1024
 ds_read_b64_tr_b16 a[70:71], v4 offset:1536
 s_waitcnt lgkmcnt(6)
 s_add_u32 m0, s46, 6144
 s_mov_b32 s47, 0x1b0000
 buffer_load_dwordx4 v7, s[36:39], s47 offen lds
 s_waitcnt vmcnt(36)
 ds_read_b64_tr_b16 a[72:73], v4 offset:2048
 ds_read_b64_tr_b16 a[76:77], v4 offset:2560
 s_waitcnt lgkmcnt(6)
 s_add_u32 m0, s46, 7168
 s_mov_b32 s47, 0x1b8000
 buffer_load_dwordx4 v7, s[36:39], s47 offen lds
 s_waitcnt vmcnt(36)
 ds_read_b64_tr_b16 a[74:75], v4 offset:3072
 ds_read_b64_tr_b16 a[78:79], v4 offset:3584
 s_waitcnt lgkmcnt(6)
 s_mov_b32 m0, s45
 s_mov_b32 s47, 0x1c0000
 buffer_load_dwordx4 v7, s[36:39], s47 offen lds
 s_waitcnt vmcnt(36)
 ds_read_b64_tr_b16 a[80:81], v4 offset:4096
 ds_read_b64_tr_b16 a[84:85], v4 offset:4608
 s_waitcnt lgkmcnt(6)
 s_add_u32 m0, s45, 1024
 s_mov_b32 s47, 0x1c8000
 buffer_load_dwordx4 v7, s[36:39], s47 offen lds
 s_waitcnt vmcnt(36)
 ds_read_b64_tr_b16 a[82:83], v4 offset:5120
 ds_read_b64_tr_b16 a[86:87], v4 offset:5632
 s_waitcnt lgkmcnt(6)
 s_add_u32 m0, s45, 2048
 s_mov_b32 s47, 0x1d0000
 buffer_load_dwordx4 v7, s[36:39], s47 offen lds
 s_waitcnt vmcnt(36)
 ds_read_b64_tr_b16 a[88:89], v4 offset:6144
 ds_read_b64_tr_b16 a[92:93], v4 offset:6656
 s_waitcnt lgkmcnt(6)
 s_add_u32 m0, s45, 3072
 s_mov_b32 s47, 0x1d8000
 buffer_load_dwordx4 v7, s[36:39], s47 offen lds
 s_waitcnt vmcnt(36)
 ds_read_b64_tr_b16 a[90:91], v4 offset:7168
 ds_read_b64_tr_b16 a[94:95], v4 offset:7680
 s_waitcnt lgkmcnt(6)
 s_add_u32 m0, s45, 4096
 s_mov_b32 s47, 0xc0000
 buffer_load_dwordx4 v6, s[32:35], s47 offen lds
 s_waitcnt vmcnt(36)
 ds_read_b64_tr_b16 a[96:97], v4 offset:8192
 ds_read_b64_tr_b16 a[100:101], v4 offset:8704
 s_waitcnt lgkmcnt(6)
 s_add_u32 m0, s45, 5120
 s_mov_b32 s47, 0xc8000
 buffer_load_dwordx4 v6, s[32:35], s47 offen lds
 s_waitcnt vmcnt(36)
 ds_read_b64_tr_b16 a[98:99], v4 offset:9216
 ds_read_b64_tr_b16 a[102:103], v4 offset:9728
 s_waitcnt lgkmcnt(6)
 s_add_u32 m0, s45, 6144
 s_mov_b32 s47, 0xd0000
 buffer_load_dwordx4 v6, s[32:35], s47 offen lds
 s_waitcnt vmcnt(36)
 ds_read_b64_tr_b16 a[104:105], v4 offset:10240
 ds_read_b64_tr_b16 a[108:109], v4 offset:10752
 s_waitcnt lgkmcnt(6)
 s_add_u32 m0, s45, 7168
 s_mov_b32 s47, 0xd8000
 buffer_load_dwordx4 v6, s[32:35], s47 offen lds
 s_waitcnt vmcnt(36)
 ds_read_b64_tr_b16 a[106:107], v4 offset:11264
 ds_read_b64_tr_b16 a[110:111], v4 offset:11776
 s_waitcnt lgkmcnt(6)
 s_add_u32 m0, s45, 8192
 s_mov_b32 s47, 0xe0000
 buffer_load_dwordx4 v6, s[32:35], s47 offen lds
 s_waitcnt vmcnt(36)
 ds_read_b64_tr_b16 a[112:113], v4 offset:12288
 ds_read_b64_tr_b16 a[116:117], v4 offset:12800
 s_waitcnt lgkmcnt(6)
 s_add_u32 m0, s45, 9216
 s_mov_b32 s47, 0xe8000
 buffer_load_dwordx4 v6, s[32:35], s47 offen lds
 s_waitcnt vmcnt(36)
 ds_read_b64_tr_b16 a[114:115], v4 offset:13312
 ds_read_b64_tr_b16 a[118:119], v4 offset:13824
 s_waitcnt lgkmcnt(6)
 s_add_u32 m0, s45, 10240
 s_mov_b32 s47, 0xf0000
 buffer_load_dwordx4 v6, s[32:35], s47 offen lds
 s_waitcnt vmcnt(36)
 ds_read_b64_tr_b16 a[120:121], v4 offset:14336
 ds_read_b64_tr_b16 a[124:125], v4 offset:14848
 s_waitcnt lgkmcnt(6)
 s_add_u32 m0, s45, 11264
 s_mov_b32 s47, 0xf8000
 buffer_load_dwordx4 v6, s[32:35], s47 offen lds
 s_waitcnt vmcnt(36)
 ds_read_b64_tr_b16 a[122:123], v4 offset:15360
 ds_read_b64_tr_b16 a[126:127], v4 offset:15872
 s_waitcnt lgkmcnt(6)
 s_add_u32 m0, s45, 12288
 s_mov_b32 s47, 0x100000
 buffer_load_dwordx4 v6, s[32:35], s47 offen lds
 s_waitcnt vmcnt(36)
 ds_read_b64_tr_b16 a[128:129], v4 offset:16384
 ds_read_b64_tr_b16 a[132:133], v4 offset:16896
 s_waitcnt lgkmcnt(6)
 s_add_u32 m0, s45, 13312
 s_mov_b32 s47, 0x108000
 buffer_load_dwordx4 v6, s[32:35], s47 offen lds
 s_waitcnt vmcnt(36)
 ds_read_b64_tr_b16 a[130:131], v4 offset:17408
 ds_read_b64_tr_b16 a[134:135], v4 offset:17920
 s_waitcnt lgkmcnt(6)
 s_add_u32 m0, s45, 14336
 s_mov_b32 s47, 0x110000
 buffer_load_dwordx4 v6, s[32:35], s47 offen lds
 s_waitcnt vmcnt(36)
 ds_read_b64_tr_b16 a[136:137], v4 offset:18432
 ds_read_b64_tr_b16 a[140:141], v4 offset:18944
 s_waitcnt lgkmcnt(6)
 s_add_u32 m0, s45, 15360
 s_mov_b32 s47, 0x118000
 buffer_load_dwordx4 v6, s[32:35], s47 offen lds
 s_waitcnt vmcnt(36)
 ds_read_b64_tr_b16 a[138:139], v4 offset:19456
 ds_read_b64_tr_b16 a[142:143], v4 offset:19968
 s_waitcnt lgkmcnt(6)
 s_add_u32 m0, s45, 16384
 s_mov_b32 s47, 0x120000
 buffer_load_dwordx4 v6, s[32:35], s47 offen lds
 s_waitcnt vmcnt(36)
 ds_read_b64_tr_b16 a[144:145], v4 offset:20480
 ds_read_b64_tr_b16 a[148:149], v4 offset:20992
 s_waitcnt lgkmcnt(6)
 s_add_u32 m0, s45, 17408
 s_mov_b32 s47, 0x128000
 buffer_load_dwordx4 v6, s[32:35], s47 offen lds
 s_waitcnt vmcnt(36)
 ds_read_b64_tr_b16 a[146:147], v4 offset:21504
 ds_read_b64_tr_b16 a[150:151], v4 offset:22016
 s_waitcnt lgkmcnt(6)
 s_add_u32 m0, s45, 18432
 s_mov_b32 s47, 0x130000
 buffer_load_dwordx4 v6, s[32:35], s47 offen lds
 s_waitcnt vmcnt(36)
 ds_read_b64_tr_b16 a[152:153], v4 offset:22528
 ds_read_b64_tr_b16 a[156:157], v4 offset:23040
 s_waitcnt lgkmcnt(6)
 s_add_u32 m0, s45, 19456
 s_mov_b32 s47, 0x138000
 buffer_load_dwordx4 v6, s[32:35], s47 offen lds
 s_waitcnt vmcnt(36)
 ds_read_b64_tr_b16 a[154:155], v4 offset:23552
 ds_read_b64_tr_b16 a[158:159], v4 offset:24064
 s_waitcnt lgkmcnt(6)
 s_add_u32 m0, s45, 20480
 s_mov_b32 s47, 0x140000
 buffer_load_dwordx4 v6, s[32:35], s47 offen lds
 s_waitcnt vmcnt(36)
 ds_read_b64_tr_b16 a[160:161], v4 offset:24576
 ds_read_b64_tr_b16 a[164:165], v4 offset:25088
 s_waitcnt lgkmcnt(6)
 s_add_u32 m0, s45, 21504
 s_mov_b32 s47, 0x148000
 buffer_load_dwordx4 v6, s[32:35], s47 offen lds
 s_waitcnt vmcnt(36)
 ds_read_b64_tr_b16 a[162:163], v4 offset:25600
 ds_read_b64_tr_b16 a[166:167], v4 offset:26112
 s_waitcnt lgkmcnt(6)
 s_add_u32 m0, s45, 22528
 s_mov_b32 s47, 0x150000
 buffer_load_dwordx4 v6, s[32:35], s47 offen lds
 s_waitcnt vmcnt(36)
 ds_read_b64_tr_b16 a[168:169], v4 offset:26624
 ds_read_b64_tr_b16 a[172:173], v4 offset:27136
 s_waitcnt lgkmcnt(6)
 s_add_u32 m0, s45, 23552
 s_mov_b32 s47, 0x158000
 buffer_load_dwordx4 v6, s[32:35], s47 offen lds
 s_waitcnt vmcnt(36)
 ds_read_b64_tr_b16 a[170:171], v4 offset:27648
 ds_read_b64_tr_b16 a[174:175], v4 offset:28160
 s_waitcnt lgkmcnt(6)
 s_add_u32 m0, s45, 24576
 s_mov_b32 s47, 0x160000
 buffer_load_dwordx4 v6, s[32:35], s47 offen lds
 s_waitcnt vmcnt(36)
 ds_read_b64_tr_b16 a[176:177], v4 offset:28672
 ds_read_b64_tr_b16 a[180:181], v4 offset:29184
 s_waitcnt lgkmcnt(6)
 s_add_u32 m0, s45, 25600
 s_mov_b32 s47, 0x168000
 buffer_load_dwordx4 v6, s[32:35], s47 offen lds
 s_waitcnt vmcnt(36)
 ds_read_b64_tr_b16 a[178:179], v4 offset:29696
 ds_read_b64_tr_b16 a[182:183], v4 offset:30208
 s_waitcnt lgkmcnt(6)
 s_add_u32 m0, s45, 26624
 s_mov_b32 s47, 0x170000
 buffer_load_dwordx4 v6, s[32:35], s47 offen lds
 s_waitcnt vmcnt(36)
 ds_read_b64_tr_b16 a[184:185], v4 offset:30720
 ds_read_b64_tr_b16 a[188:189], v4 offset:31232
 s_waitcnt lgkmcnt(6)
 s_add_u32 m0, s45, 27648
 s_mov_b32 s47, 0x178000
 buffer_load_dwordx4 v6, s[32:35], s47 offen lds
 s_waitcnt vmcnt(36)
 ds_read_b64_tr_b16 a[186:187], v4 offset:31744
 ds_read_b64_tr_b16 a[190:191], v4 offset:32256
 s_waitcnt lgkmcnt(6)
 s_add_u32 m0, s45, 28672
 s_mov_b32 s47, 0x180000
 buffer_load_dwordx4 v6, s[32:35], s47 offen lds
 s_waitcnt vmcnt(36)
 ds_read_b64_tr_b16 a[192:193], v5 offset:0
 ds_read_b64_tr_b16 a[196:197], v5 offset:512
 s_waitcnt lgkmcnt(6)
 s_add_u32 m0, s45, 29696
 s_mov_b32 s47, 0x188000
 buffer_load_dwordx4 v6, s[32:35], s47 offen lds
 s_waitcnt vmcnt(36)
 ds_read_b64_tr_b16 a[194:195], v5 offset:1024
 ds_read_b64_tr_b16 a[198:199], v5 offset:1536
 s_waitcnt lgkmcnt(6)
 s_add_u32 m0, s45, 30720
 s_mov_b32 s47, 0x190000
 buffer_load_dwordx4 v6, s[32:35], s47 offen lds
 s_waitcnt vmcnt(36)
 ds_read_b64_tr_b16 a[200:201], v5 offset:2048
 ds_read_b64_tr_b16 a[204:205], v5 offset:2560
 s_waitcnt lgkmcnt(6)
 s_add_u32 m0, s45, 31744
 s_mov_b32 s47, 0x198000
 buffer_load_dwordx4 v6, s[32:35], s47 offen lds
 s_waitcnt vmcnt(36)
 ds_read_b64_tr_b16 a[202:203], v5 offset:3072
 ds_read_b64_tr_b16 a[206:207], v5 offset:3584
 s_waitcnt lgkmcnt(6)
 s_mov_b32 m0, s46
 s_mov_b32 s47, 0x1e0000
 buffer_load_dwordx4 v7, s[36:39], s47 offen lds
 s_waitcnt vmcnt(36)
 ds_read_b64_tr_b16 a[208:209], v5 offset:4096
 ds_read_b64_tr_b16 a[212:213], v5 offset:4608
 s_waitcnt lgkmcnt(6)
 s_add_u32 m0, s46, 1024
 s_mov_b32 s47, 0x1e8000
 buffer_load_dwordx4 v7, s[36:39], s47 offen lds
 s_waitcnt vmcnt(36)
 ds_read_b64_tr_b16 a[210:211], v5 offset:5120
 ds_read_b64_tr_b16 a[214:215], v5 offset:5632
 s_waitcnt lgkmcnt(6)
 s_add_u32 m0, s46, 2048
 s_mov_b32 s47, 0x1f0000
 buffer_load_dwordx4 v7, s[36:39], s47 offen lds
 s_waitcnt vmcnt(36)
 ds_read_b64_tr_b16 a[216:217], v5 offset:6144
 ds_read_b64_tr_b16 a[220:221], v5 offset:6656
 s_waitcnt lgkmcnt(6)
 s_add_u32 m0, s46, 3072
 s_mov_b32 s47, 0x1f8000
 buffer_load_dwordx4 v7, s[36:39], s47 offen lds
 s_waitcnt vmcnt(36)
 ds_read_b64_tr_b16 a[218:219], v5 offset:7168
 ds_read_b64_tr_b16 a[222:223], v5 offset:7680
 s_waitcnt lgkmcnt(6)
 s_add_u32 m0, s46, 4096
 s_mov_b32 s47, 0x1a0000
 buffer_load_dwordx4 v6, s[32:35], s47 offen lds
 s_waitcnt vmcnt(36)
 ds_read_b64_tr_b16 a[224:225], v4 offset:0
 ds_read_b64_tr_b16 a[228:229], v4 offset:512
 s_waitcnt lgkmcnt(6)
 s_add_u32 m0, s46, 5120
 s_mov_b32 s47, 0x1a8000
 buffer_load_dwordx4 v6, s[32:35], s47 offen lds
 s_waitcnt vmcnt(36)
 ds_read_b64_tr_b16 a[226:227], v4 offset:1024
 ds_read_b64_tr_b16 a[230:231], v4 offset:1536
 s_waitcnt lgkmcnt(6)
 s_add_u32 m0, s46, 6144
 s_mov_b32 s47, 0x1b0000
 buffer_load_dwordx4 v6, s[32:35], s47 offen lds
 s_waitcnt vmcnt(36)
 ds_read_b64_tr_b16 a[232:233], v4 offset:2048
 ds_read_b64_tr_b16 a[236:237], v4 offset:2560
 s_waitcnt lgkmcnt(6)
 s_add_u32 m0, s46, 7168
 s_mov_b32 s47, 0x1b8000
 buffer_load_dwordx4 v6, s[32:35], s47 offen lds
 s_waitcnt vmcnt(36)
 ds_read_b64_tr_b16 a[234:235], v4 offset:3072
 ds_read_b64_tr_b16 a[238:239], v4 offset:3584
 s_waitcnt vmcnt(35)
 ds_read_b64_tr_b16 v[16:17], v4 offset:4096
 ds_read_b64_tr_b16 v[20:21], v4 offset:4608
 s_waitcnt vmcnt(34)
 ds_read_b64_tr_b16 v[18:19], v4 offset:5120
 ds_read_b64_tr_b16 v[22:23], v4 offset:5632
 s_waitcnt vmcnt(33)
 ds_read_b64_tr_b16 v[24:25], v4 offset:6144
 ds_read_b64_tr_b16 v[28:29], v4 offset:6656
 s_waitcnt vmcnt(32)
 ds_read_b64_tr_b16 v[26:27], v4 offset:7168
 ds_read_b64_tr_b16 v[30:31], v4 offset:7680
 s_waitcnt vmcnt(31)
 ds_read_b64_tr_b16 v[32:33], v4 offset:8192
 ds_read_b64_tr_b16 v[36:37], v4 offset:8704
 s_waitcnt vmcnt(30)
 ds_read_b64_tr_b16 v[34:35], v4 offset:9216
 ds_read_b64_tr_b16 v[38:39], v4 offset:9728
 s_waitcnt vmcnt(29)
 ds_read_b64_tr_b16 v[40:41], v4 offset:10240
 ds_read_b64_tr_b16 v[44:45], v4 offset:10752
 s_waitcnt vmcnt(28)
 ds_read_b64_tr_b16 v[42:43], v4 offset:11264
 ds_read_b64_tr_b16 v[46:47], v4 offset:11776
 s_waitcnt vmcnt(27)
 ds_read_b64_tr_b16 v[48:49], v4 offset:12288
 ds_read_b64_tr_b16 v[52:53], v4 offset:12800
 s_waitcnt vmcnt(26)
 ds_read_b64_tr_b16 v[50:51], v4 offset:13312
 ds_read_b64_tr_b16 v[54:55], v4 offset:13824
 s_waitcnt vmcnt(25)
 ds_read_b64_tr_b16 v[56:57], v4 offset:14336
 ds_read_b64_tr_b16 v[60:61], v4 offset:14848
 s_waitcnt vmcnt(24)
 ds_read_b64_tr_b16 v[58:59], v4 offset:15360
 ds_read_b64_tr_b16 v[62:63], v4 offset:15872
 s_waitcnt vmcnt(23)
 ds_read_b64_tr_b16 v[64:65], v4 offset:16384
 ds_read_b64_tr_b16 v[68:69], v4 offset:16896
 s_waitcnt vmcnt(22)
 ds_read_b64_tr_b16 v[66:67], v4 offset:17408
 ds_read_b64_tr_b16 v[70:71], v4 offset:17920
 s_waitcnt vmcnt(21)
 ds_read_b64_tr_b16 v[72:73], v4 offset:18432
 ds_read_b64_tr_b16 v[76:77], v4 offset:18944
 s_waitcnt vmcnt(20)
 ds_read_b64_tr_b16 v[74:75], v4 offset:19456
 ds_read_b64_tr_b16 v[78:79], v4 offset:19968
 s_waitcnt vmcnt(19)
 ds_read_b64_tr_b16 v[80:81], v4 offset:20480
 ds_read_b64_tr_b16 v[84:85], v4 offset:20992
 s_waitcnt vmcnt(18)
 ds_read_b64_tr_b16 v[82:83], v4 offset:21504
 ds_read_b64_tr_b16 v[86:87], v4 offset:22016
 s_waitcnt vmcnt(17)
 ds_read_b64_tr_b16 v[88:89], v4 offset:22528
 ds_read_b64_tr_b16 v[92:93], v4 offset:23040
 s_waitcnt vmcnt(16)
 ds_read_b64_tr_b16 v[90:91], v4 offset:23552
 ds_read_b64_tr_b16 v[94:95], v4 offset:24064
 s_waitcnt vmcnt(15)
 ds_read_b64_tr_b16 v[96:97], v4 offset:24576
 ds_read_b64_tr_b16 v[100:101], v4 offset:25088
 s_waitcnt vmcnt(14)
 ds_read_b64_tr_b16 v[98:99], v4 offset:25600
 ds_read_b64_tr_b16 v[102:103], v4 offset:26112
 s_waitcnt vmcnt(13)
 ds_read_b64_tr_b16 v[104:105], v4 offset:26624
 ds_read_b64_tr_b16 v[108:109], v4 offset:27136
 s_waitcnt vmcnt(12)
 ds_read_b64_tr_b16 v[106:107], v4 offset:27648
 ds_read_b64_tr_b16 v[110:111], v4 offset:28160
 s_waitcnt vmcnt(11)
 ds_read_b64_tr_b16 v[112:113], v4 offset:28672
 ds_read_b64_tr_b16 v[116:117], v4 offset:29184
 s_waitcnt vmcnt(10)
 ds_read_b64_tr_b16 v[114:115], v4 offset:29696
 ds_read_b64_tr_b16 v[118:119], v4 offset:30208
 s_waitcnt vmcnt(9)
 ds_read_b64_tr_b16 v[120:121], v4 offset:30720
 ds_read_b64_tr_b16 v[124:125], v4 offset:31232
 s_waitcnt vmcnt(8)
 ds_read_b64_tr_b16 v[122:123], v4 offset:31744
 ds_read_b64_tr_b16 v[126:127], v4 offset:32256
 v_lshlrev_b32 v8, 4, v0
 v_add_u32 v8, s45, v8
 s_waitcnt lgkmcnt(0)
 ds_write_b128 v8, v[16:19] offset:0
 ds_write_b128 v8, v[20:23] offset:1024
 ds_write_b128 v8, v[24:27] offset:2048
 ds_write_b128 v8, v[28:31] offset:3072
 ds_write_b128 v8, v[32:35] offset:4096
 ds_write_b128 v8, v[36:39] offset:5120
 ds_write_b128 v8, v[40:43] offset:6144
 ds_write_b128 v8, v[44:47] offset:7168
 ds_write_b128 v8, v[48:51] offset:8192
 ds_write_b128 v8, v[52:55] offset:9216
 ds_write_b128 v8, v[56:59] offset:10240
 ds_write_b128 v8, v[60:63] offset:11264
 ds_write_b128 v8, v[64:67] offset:12288
 ds_write_b128 v8, v[68:71] offset:13312
 ds_write_b128 v8, v[72:75] offset:14336
 ds_write_b128 v8, v[76:79] offset:15360
 ds_write_b128 v8, v[80:83] offset:16384
 ds_write_b128 v8, v[84:87] offset:17408
 ds_write_b128 v8, v[88:91] offset:18432
 ds_write_b128 v8, v[92:95] offset:19456
 ds_write_b128 v8, v[96:99] offset:20480
 ds_write_b128 v8, v[100:103] offset:21504
 ds_write_b128 v8, v[104:107] offset:22528
 ds_write_b128 v8, v[108:111] offset:23552
 ds_write_b128 v8, v[112:115] offset:24576
 ds_write_b128 v8, v[116:119] offset:25600
 ds_write_b128 v8, v[120:123] offset:26624
 ds_write_b128 v8, v[124:127] offset:27648
 s_waitcnt lgkmcnt(0)
 s_waitcnt vmcnt(7)
 ds_read_b64_tr_b16 a[240:241], v5 offset:0
 ds_read_b64_tr_b16 a[244:245], v5 offset:512
 s_waitcnt vmcnt(6)
 ds_read_b64_tr_b16 a[242:243], v5 offset:1024
 ds_read_b64_tr_b16 a[246:247], v5 offset:1536
 s_waitcnt vmcnt(5)
 ds_read_b64_tr_b16 a[248:249], v5 offset:2048
 ds_read_b64_tr_b16 a[252:253], v5 offset:2560
 s_waitcnt vmcnt(4)
 ds_read_b64_tr_b16 a[250:251], v5 offset:3072
 ds_read_b64_tr_b16 a[254:255], v5 offset:3584
 s_waitcnt vmcnt(3)
 ds_read_b64_tr_b16 v[16:17], v5 offset:4096
 ds_read_b64_tr_b16 v[20:21], v5 offset:4608
 s_waitcnt vmcnt(2)
 ds_read_b64_tr_b16 v[18:19], v5 offset:5120
 ds_read_b64_tr_b16 v[22:23], v5 offset:5632
 s_waitcnt vmcnt(1)
 ds_read_b64_tr_b16 v[24:25], v5 offset:6144
 ds_read_b64_tr_b16 v[28:29], v5 offset:6656
 s_waitcnt vmcnt(0)
 ds_read_b64_tr_b16 v[26:27], v5 offset:7168
 ds_read_b64_tr_b16 v[30:31], v5 offset:7680
 s_waitcnt lgkmcnt(0)
 ds_write_b128 v8, v[16:19] offset:28672
 ds_write_b128 v8, v[20:23] offset:29696
 ds_write_b128 v8, v[24:27] offset:30720
 ds_write_b128 v8, v[28:31] offset:31744
 s_waitcnt lgkmcnt(0)
 v_mov_b32 v4, v8
 s_and_b32 s47, s40, 1
 s_lshl_b32 s47, s47, 4
 v_and_b32 v16, 15, v0
 v_add_u32 v16, s47, v16
 v_lshrrev_b32 v17, 4, v0
 v_lshlrev_b32 v17, 2, v17
 v_mov_b32 v19, 0xff800000
 v_add_u32 v18, 0, v17
 v_cmp_gt_u32 vcc, v18, v16
 s_nop 1
 v_cndmask_b32 v152, 0, v19, vcc
 v_add_u32 v18, 1, v17
 v_cmp_gt_u32 vcc, v18, v16
 s_nop 1
 v_cndmask_b32 v153, 0, v19, vcc
 v_add_u32 v18, 2, v17
 v_cmp_gt_u32 vcc, v18, v16
 s_nop 1
 v_cndmask_b32 v154, 0, v19, vcc
 v_add_u32 v18, 3, v17
 v_cmp_gt_u32 vcc, v18, v16
 s_nop 1
 v_cndmask_b32 v155, 0, v19, vcc
 v_add_u32 v18, 16, v17
 v_cmp_gt_u32 vcc, v18, v16
 s_nop 1
 v_cndmask_b32 v156, 0, v19, vcc
 v_add_u32 v18, 17, v17
 v_cmp_gt_u32 vcc, v18, v16
 s_nop 1
 v_cndmask_b32 v157, 0, v19, vcc
 v_add_u32 v18, 18, v17
 v_cmp_gt_u32 vcc, v18, v16
 s_nop 1
 v_cndmask_b32 v158, 0, v19, vcc
 v_add_u32 v18, 19, v17
 v_cmp_gt_u32 vcc, v18, v16
 s_nop 1
 v_cndmask_b32 v159, 0, v19, vcc
 v_and_b32 v16, 15, v0
 v_mul_u32_u24 v16, 144, v16
 v_lshl_add_u32 v16, v17, 2, v16
 s_mul_i32 s47, s40, 4608
 s_add_u32 s47, s47, 131072
 v_add_u32 v8, s47, v16
 s_lshl_b32 s47, s40, 3
 v_lshrrev_b32 v16, 3, v0
 v_add_u32 v16, s47, v16
 v_and_b32 v18, 7, v0
 v_mul_u32_u24 v19, 144, v16
 v_lshl_add_u32 v19, v18, 4, v19
 v_add_u32 v9, 131072, v19
 v_lshlrev_b32 v16, 11, v16
 v_lshl_add_u32 v16, v18, 3, v16
 s_lshl_b32 s47, s52, 6
 v_add_u32 v10, s47, v16
 v_and_b32 v16, 7, v0
 v_lshlrev_b32 v16, 4, v16
 v_lshl_add_u32 v11, v17, 5, v16
 v_and_b32 v16, 31, v0
 v_lshlrev_b32 v12, 3, v16
 v_lshlrev_b32 v13, 2, v16
 v_and_b32 v16, 1, v0
 v_lshlrev_b32 v14, 12, v16
 v_cmp_gt_u32 vcc, 32, v0
 v_mov_b32 v15, 0xff800000
 s_nop 0
 v_cndmask_b32 v15, v15, 0, vcc
 s_mov_b32 s32, s4
 s_and_b32 s33, s5, 0xffff
 s_mov_b32 s34, 0x400000
 s_mov_b32 s35, 0x20000
 s_mov_b32 s36, s20
 s_and_b32 s37, s21, 0xffff
 s_mov_b32 s38, 0x400000
 s_mov_b32 s39, 0x20000
 s_mov_b32 s62, 0x3e0293ee
 s_mov_b32 s63, 0x3e0293ee
 s_mov_b32 s64, 0xbe0293ee
 s_lshl_b32 s61, s52, 7
 s_add_u32 s61, s61, 32768
 s_lshl_b32 s60, s51, 8
 s_add_u32 s60, s60, 49152
 s_mov_b32 s53, s51
 s_mov_b32 s59, 1
 s_lshl_b32 s55, s51, 19
 s_add_u32 s55, s55, 0x5000000
 v_mov_b32 v16, 0
gw_37:
 global_load_dword v17, v16, s[22:23] offset:128 sc1
 s_waitcnt vmcnt(0)
 v_readfirstlane_b32 s48, v17
 s_cmp_ge_u32 s48, 192
 s_cbranch_scc1 gwd_38
 s_sub_u32 s26, s26, 1
 s_cbranch_scc1 L_end
 s_sleep 2
 s_branch gw_37
gwd_38:
 v_mov_b32 v16, 0
gw_39:
 global_load_dword v17, v16, s[22:23] offset:192 sc1
 s_waitcnt vmcnt(0)
 v_readfirstlane_b32 s48, v17
 s_cmp_ge_u32 s48, 64
 s_cbranch_scc1 gwd_40
 s_sub_u32 s26, s26, 1
 s_cbranch_scc1 L_end
 s_sleep 2
 s_branch gw_39
gwd_40:
 v_and_b32 v16, 31, v0
 v_lshlrev_b32 v16, 5, v16
 s_and_b32 s47, s2, 7
 s_lshl_b32 s47, s47, 2
 s_add_u32 s47, s47, 0
 buffer_load_dword v17, v16, s[28:31], s47 offen sc1
 s_waitcnt vmcnt(0)
 v_cmp_ne_u32 vcc, s3, v17
 s_cmp_eq_u64 vcc, 0
 s_cselect_b32 s44, 1, 0
 s_barrier
 s_add_u32 s48, s53, 0
 s_mul_i32 s54, s48, 229376
 s_mul_i32 s47, s40, 57344
 s_add_u32 s54, s54, s47
 s_add_u32 s54, s54, 0x4000000
 buffer_load_dwordx4 v[104:107], v3, s[28:31], s54 offen offset:0 sc1
 buffer_load_dwordx4 v[108:111], v3, s[28:31], s54 offen offset:1024 sc1
 buffer_load_dwordx4 v[112:115], v3, s[28:31], s54 offen offset:2048 sc1
 buffer_load_dwordx4 v[116:119], v3, s[28:31], s54 offen offset:3072 sc1
 s_add_u32 s54, s54, 4096
 buffer_load_dwordx4 v[120:123], v3, s[28:31], s54 offen offset:0 sc1
 buffer_load_dwordx4 v[124:127], v3, s[28:31], s54 offen offset:1024 sc1
 buffer_load_dwordx4 v[128:131], v3, s[28:31], s54 offen offset:2048 sc1
 buffer_load_dwordx4 v[132:135], v3, s[28:31], s54 offen offset:3072 sc1
 s_add_u32 s54, s54, 4096
 buffer_load_dwordx4 v[136:139], v3, s[28:31], s54 offen offset:0 sc1
 buffer_load_dwordx4 v[140:143], v3, s[28:31], s54 offen offset:1024 sc1
 buffer_load_dwordx4 v[144:147], v3, s[28:31], s54 offen offset:2048 sc1
 buffer_load_dwordx4 v[48:51], v3, s[28:31], s54 offen offset:3072 sc1
 s_add_u32 s54, s54, 4096
 buffer_load_dwordx4 v[52:55], v3, s[28:31], s54 offen offset:0 sc1
 buffer_load_dwordx4 v[56:59], v3, s[28:31], s54 offen offset:1024 sc1
 buffer_load_dwordx4 v[60:63], v3, s[28:31], s54 offen offset:2048 sc1
 buffer_load_dwordx4 v[64:67], v3, s[28:31], s54 offen offset:3072 sc1
 s_add_u32 s54, s54, 4096
 buffer_load_dwordx4 v[68:71], v3, s[28:31], s54 offen offset:0 sc1
 buffer_load_dwordx4 v[72:75], v3, s[28:31], s54 offen offset:1024 sc1
 buffer_load_dwordx4 v[76:79], v3, s[28:31], s54 offen offset:2048 sc1
 buffer_load_dwordx4 v[80:83], v3, s[28:31], s54 offen offset:3072 sc1
 s_add_u32 s54, s54, 4096
 buffer_load_dwordx4 v[84:87], v3, s[28:31], s54 offen offset:0 sc1
 buffer_load_dwordx4 v[88:91], v3, s[28:31], s54 offen offset:1024 sc1
 buffer_load_dwordx4 v[92:95], v3, s[28:31], s54 offen offset:2048 sc1
 buffer_load_dwordx4 v[96:99], v3, s[28:31], s54 offen offset:3072 sc1
 s_add_u32 s54, s54, 4096
 buffer_load_dwordx4 v[100:103], v3, s[28:31], s54 offen offset:0 sc1
 s_cmp_eq_u32 s44, 1
 s_cbranch_scc0 L_fin_g
L_fin_l:
 s_lshl_b32 s49, s53, 5
 s_add_u32 s49, s49, s52
 s_lshl_b32 s58, s49, 11
 s_lshl_b32 s49, s49, 13
 s_and_b32 s47, s40, 1
 s_lshl_b32 s47, s47, 12
 s_add_u32 s66, s49, s47
 s_add_u32 s66, s66, 0x1000000
 s_add_u32 s67, s49, 0x2000000
 s_add_u32 s68, s67, 4096
 s_lshr_b32 s47, s40, 1
 s_lshl_b32 s48, s47, 12
 s_add_u32 s57, s49, s48
 s_add_u32 s57, s57, 0x3000000
 s_lshl_b32 s47, s47, 10
 s_add_u32 s56, s58, s47
 s_add_u32 s56, s56, 0x800000
 s_add_u32 s58, s58, 0x400000
 s_add_u32 s69, s53, 1
 s_lshl_b32 s65, s53, 16
 buffer_load_dword v1, v14, s[28:31], s61 offen sc1
 buffer_load_dwordx2 v[148:149], v10, s[32:35], s65 offen
 s_waitcnt vmcnt(25)
 v_mfma_f32_16x16x32_bf16 v[16:19], v[160:163], v[104:107], 0
 v_mfma_f32_16x16x32_bf16 v[20:23], v[164:167], v[104:107], 0
 buffer_load_dwordx4 v[104:107], v3, s[28:31], s54 offen offset:1024 sc1
 v_mfma_f32_16x16x32_bf16 v[24:27], v[160:163], v[108:111], 0
 v_mfma_f32_16x16x32_bf16 v[28:31], v[164:167], v[108:111], 0
 buffer_load_dwordx4 v[108:111], v3, s[28:31], s54 offen offset:2048 sc1
 s_waitcnt vmcnt(25)
 v_mfma_f32_16x16x32_bf16 v[16:19], v[168:171], v[112:115], v[16:19]
 v_mfma_f32_16x16x32_bf16 v[20:23], v[172:175], v[112:115], v[20:23]
 buffer_load_dwordx4 v[112:115], v3, s[28:31], s54 offen offset:3072 sc1
 s_add_u32 s54, s54, 4096
 v_mfma_f32_16x16x32_bf16 v[24:27], v[168:171], v[116:119], v[24:27]
 v_mfma_f32_16x16x32_bf16 v[28:31], v[172:175], v[116:119], v[28:31]
 buffer_load_dwordx4 v[116:119], v3, s[28:31], s54 offen offset:0 sc1
 s_waitcnt vmcnt(25)
 v_mfma_f32_16x16x32_bf16 v[16:19], v[176:179], v[120:123], v[16:19]
 v_mfma_f32_16x16x32_bf16 v[20:23], v[180:183], v[120:123], v[20:23]
 buffer_load_dwordx4 v[120:123], v3, s[28:31], s54 offen offset:1024 sc1
 v_mfma_f32_16x16x32_bf16 v[24:27], v[176:179], v[124:127], v[24:27]
 v_mfma_f32_16x16x32_bf16 v[28:31], v[180:183], v[124:127], v[28:31]
 buffer_load_dwordx4 v[124:127], v3, s[28:31], s54 offen offset:2048 sc1
 s_waitcnt vmcnt(25)
 v_mfma_f32_16x16x32_bf16 v[16:19], v[184:187], v[128:131], v[16:19]
 v_mfma_f32_16x16x32_bf16 v[20:23], v[188:191], v[128:131], v[20:23]
 buffer_load_dwordx4 v[128:131], v3, s[28:31], s54 offen offset:3072 sc1
 s_add_u32 s54, s54, 4096
 v_mfma_f32_16x16x32_bf16 v[24:27], v[184:187], v[132:135], v[24:27]
 v_mfma_f32_16x16x32_bf16 v[28:31], v[188:191], v[132:135], v[28:31]
 buffer_load_dwordx4 v[132:135], v3, s[28:31], s54 offen offset:0 sc1
 s_waitcnt vmcnt(25)
 v_mfma_f32_16x16x32_bf16 v[16:19], v[192:195], v[136:139], v[16:19]
 v_mfma_f32_16x16x32_bf16 v[20:23], v[196:199], v[136:139], v[20:23]
 buffer_load_dwordx4 v[136:139], v3, s[28:31], s54 offen offset:1024 sc1
 v_mfma_f32_16x16x32_bf16 v[24:27], v[192:195], v[140:143], v[24:27]
 v_mfma_f32_16x16x32_bf16 v[28:31], v[196:199], v[140:143], v[28:31]
 buffer_load_dwordx4 v[140:143], v3, s[28:31], s54 offen offset:2048 sc1
 s_waitcnt vmcnt(25)
 v_mfma_f32_16x16x32_bf16 v[16:19], v[200:203], v[144:147], v[16:19]
 v_mfma_f32_16x16x32_bf16 v[20:23], v[204:207], v[144:147], v[20:23]
 buffer_load_dwordx4 v[144:147], v3, s[28:31], s54 offen offset:3072 sc1
 s_add_u32 s54, s54, 4096
 v_mfma_f32_16x16x32_bf16 v[24:27], v[200:203], v[48:51], v[24:27]
 v_mfma_f32_16x16x32_bf16 v[28:31], v[204:207], v[48:51], v[28:31]
 buffer_load_dwordx4 v[48:51], v3, s[28:31], s54 offen offset:0 sc1
 s_waitcnt vmcnt(25)
 v_mfma_f32_16x16x32_bf16 v[16:19], v[208:211], v[52:55], v[16:19]
 v_mfma_f32_16x16x32_bf16 v[20:23], v[212:215], v[52:55], v[20:23]
 buffer_load_dwordx4 v[52:55], v3, s[28:31], s54 offen offset:1024 sc1
 v_mfma_f32_16x16x32_bf16 v[24:27], v[208:211], v[56:59], v[24:27]
 v_mfma_f32_16x16x32_bf16 v[28:31], v[212:215], v[56:59], v[28:31]
 buffer_load_dwordx4 v[56:59], v3, s[28:31], s54 offen offset:2048 sc1
 s_waitcnt vmcnt(25)
 v_mfma_f32_16x16x32_bf16 v[16:19], v[216:219], v[60:63], v[16:19]
 v_mfma_f32_16x16x32_bf16 v[20:23], v[220:223], v[60:63], v[20:23]
 buffer_load_dwordx4 v[60:63], v3, s[28:31], s54 offen offset:3072 sc1
 s_add_u32 s54, s54, 4096
 v_mfma_f32_16x16x32_bf16 v[24:27], v[216:219], v[64:67], v[24:27]
 v_mfma_f32_16x16x32_bf16 v[28:31], v[220:223], v[64:67], v[28:31]
 buffer_load_dwordx4 v[64:67], v3, s[28:31], s54 offen offset:0 sc1
 s_waitcnt vmcnt(25)
 v_mfma_f32_16x16x32_bf16 v[16:19], v[224:227], v[68:71], v[16:19]
 v_mfma_f32_16x16x32_bf16 v[20:23], v[228:231], v[68:71], v[20:23]
 buffer_load_dwordx4 v[68:71], v3, s[28:31], s54 offen offset:1024 sc1
 v_mfma_f32_16x16x32_bf16 v[24:27], v[224:227], v[72:75], v[24:27]
 v_mfma_f32_16x16x32_bf16 v[28:31], v[228:231], v[72:75], v[28:31]
 buffer_load_dwordx4 v[72:75], v3, s[28:31], s54 offen offset:2048 sc1
 s_waitcnt vmcnt(25)
 v_mfma_f32_16x16x32_bf16 v[16:19], v[232:235], v[76:79], v[16:19]
 v_mfma_f32_16x16x32_bf16 v[20:23], v[236:239], v[76:79], v[20:23]
 buffer_load_dwordx4 v[76:79], v3, s[28:31], s54 offen offset:3072 sc1
 s_add_u32 s54, s54, 4096
 v_mfma_f32_16x16x32_bf16 v[24:27], v[232:235], v[80:83], v[24:27]
 v_mfma_f32_16x16x32_bf16 v[28:31], v[236:239], v[80:83], v[28:31]
 buffer_load_dwordx4 v[80:83], v3, s[28:31], s54 offen offset:0 sc1
 s_waitcnt vmcnt(25)
 v_mfma_f32_16x16x32_bf16 v[16:19], v[240:243], v[84:87], v[16:19]
 v_mfma_f32_16x16x32_bf16 v[20:23], v[244:247], v[84:87], v[20:23]
 buffer_load_dwordx4 v[84:87], v3, s[28:31], s54 offen offset:1024 sc1
 v_mfma_f32_16x16x32_bf16 v[24:27], v[240:243], v[88:91], v[24:27]
 v_mfma_f32_16x16x32_bf16 v[28:31], v[244:247], v[88:91], v[28:31]
 buffer_load_dwordx4 v[88:91], v3, s[28:31], s54 offen offset:2048 sc1
 s_waitcnt vmcnt(25)
 v_mfma_f32_16x16x32_bf16 v[16:19], v[248:251], v[92:95], v[16:19]
 ds_read_b128 v[32:35], v4 offset:0
 v_mfma_f32_16x16x32_bf16 v[20:23], v[252:255], v[92:95], v[20:23]
 buffer_load_dwordx4 v[92:95], v3, s[28:31], s54 offen offset:3072 sc1
 s_add_u32 s54, s54, 4096
 v_mfma_f32_16x16x32_bf16 v[24:27], v[248:251], v[96:99], v[24:27]
 ds_read_b128 v[36:39], v4 offset:1024
 v_mfma_f32_16x16x32_bf16 v[28:31], v[252:255], v[96:99], v[28:31]
 buffer_load_dwordx4 v[96:99], v3, s[28:31], s54 offen offset:0 sc1
 s_waitcnt vmcnt(23)
 s_waitcnt lgkmcnt(0)
 v_mfma_f32_16x16x32_bf16 v[16:19], v[32:35], v[100:103], v[16:19]
 ds_read_b128 v[40:43], v4 offset:2048
 v_mfma_f32_16x16x32_bf16 v[20:23], v[36:39], v[100:103], v[20:23]
 buffer_load_dwordx4 v[100:103], v3, s[28:31], s54 offen offset:1024 sc1
 v_mfma_f32_16x16x32_bf16 v[24:27], v[32:35], v[104:107], v[24:27]
 ds_read_b128 v[44:47], v4 offset:3072
 v_mfma_f32_16x16x32_bf16 v[28:31], v[36:39], v[104:107], v[28:31]
 buffer_load_dwordx4 v[104:107], v3, s[28:31], s54 offen offset:2048 sc1
 s_waitcnt vmcnt(23)
 s_waitcnt lgkmcnt(0)
 v_mfma_f32_16x16x32_bf16 v[16:19], v[40:43], v[108:111], v[16:19]
 ds_read_b128 v[32:35], v4 offset:4096
 v_mfma_f32_16x16x32_bf16 v[20:23], v[44:47], v[108:111], v[20:23]
 buffer_load_dwordx4 v[108:111], v3, s[28:31], s54 offen offset:3072 sc1
 s_add_u32 s54, s54, 4096
 v_mfma_f32_16x16x32_bf16 v[24:27], v[40:43], v[112:115], v[24:27]
 ds_read_b128 v[36:39], v4 offset:5120
 v_mfma_f32_16x16x32_bf16 v[28:31], v[44:47], v[112:115], v[28:31]
 buffer_load_dwordx4 v[112:115], v3, s[28:31], s54 offen offset:0 sc1
 s_waitcnt vmcnt(23)
 s_waitcnt lgkmcnt(0)
 v_mfma_f32_16x16x32_bf16 v[16:19], v[32:35], v[116:119], v[16:19]
 ds_read_b128 v[40:43], v4 offset:6144
 v_mfma_f32_16x16x32_bf16 v[20:23], v[36:39], v[116:119], v[20:23]
 buffer_load_dwordx4 v[116:119], v3, s[28:31], s54 offen offset:1024 sc1
 v_mfma_f32_16x16x32_bf16 v[24:27], v[32:35], v[120:123], v[24:27]
 ds_read_b128 v[44:47], v4 offset:7168
 v_mfma_f32_16x16x32_bf16 v[28:31], v[36:39], v[120:123], v[28:31]
 buffer_load_dwordx4 v[120:123], v3, s[28:31], s54 offen offset:2048 sc1
 s_waitcnt vmcnt(23)
 s_waitcnt lgkmcnt(0)
 v_mfma_f32_16x16x32_bf16 v[16:19], v[40:43], v[124:127], v[16:19]
 ds_read_b128 v[32:35], v4 offset:8192
 v_mfma_f32_16x16x32_bf16 v[20:23], v[44:47], v[124:127], v[20:23]
 buffer_load_dwordx4 v[124:127], v3, s[28:31], s54 offen offset:3072 sc1
 s_add_u32 s54, s54, 4096
 v_mfma_f32_16x16x32_bf16 v[24:27], v[40:43], v[128:131], v[24:27]
 ds_read_b128 v[36:39], v4 offset:9216
 v_mfma_f32_16x16x32_bf16 v[28:31], v[44:47], v[128:131], v[28:31]
 buffer_load_dwordx4 v[128:131], v3, s[28:31], s67 offen offset:0 sc1
 s_waitcnt vmcnt(23)
 s_waitcnt lgkmcnt(0)
 v_mfma_f32_16x16x32_bf16 v[16:19], v[32:35], v[132:135], v[16:19]
 ds_read_b128 v[40:43], v4 offset:10240
 v_mfma_f32_16x16x32_bf16 v[20:23], v[36:39], v[132:135], v[20:23]
 buffer_load_dwordx4 v[132:135], v3, s[28:31], s67 offen offset:1024 sc1
 v_mfma_f32_16x16x32_bf16 v[24:27], v[32:35], v[136:139], v[24:27]
 ds_read_b128 v[44:47], v4 offset:11264
 v_mfma_f32_16x16x32_bf16 v[28:31], v[36:39], v[136:139], v[28:31]
 buffer_load_dwordx4 v[136:139], v3, s[28:31], s67 offen offset:2048 sc1
 s_waitcnt vmcnt(23)
 s_waitcnt lgkmcnt(0)
 v_mfma_f32_16x16x32_bf16 v[16:19], v[40:43], v[140:143], v[16:19]
 ds_read_b128 v[32:35], v4 offset:12288
 v_mfma_f32_16x16x32_bf16 v[20:23], v[44:47], v[140:143], v[20:23]
 buffer_load_dwordx4 v[140:143], v3, s[28:31], s67 offen offset:3072 sc1
 v_mfma_f32_16x16x32_bf16 v[24:27], v[40:43], v[144:147], v[24:27]
 ds_read_b128 v[36:39], v4 offset:13312
 v_mfma_f32_16x16x32_bf16 v[28:31], v[44:47], v[144:147], v[28:31]
 buffer_load_dwordx4 v[144:147], v3, s[28:31], s68 offen offset:0 sc1
 s_waitcnt vmcnt(23)
 s_waitcnt lgkmcnt(0)
 v_mfma_f32_16x16x32_bf16 v[16:19], v[32:35], v[48:51], v[16:19]
 ds_read_b128 v[40:43], v4 offset:14336
 v_mfma_f32_16x16x32_bf16 v[20:23], v[36:39], v[48:51], v[20:23]
 buffer_load_dwordx4 v[48:51], v3, s[28:31], s68 offen offset:1024 sc1
 v_mfma_f32_16x16x32_bf16 v[24:27], v[32:35], v[52:55], v[24:27]
 ds_read_b128 v[44:47], v4 offset:15360
 v_mfma_f32_16x16x32_bf16 v[28:31], v[36:39], v[52:55], v[28:31]
 buffer_load_dwordx4 v[52:55], v3, s[28:31], s68 offen offset:2048 sc1
 s_waitcnt vmcnt(23)
 s_waitcnt lgkmcnt(0)
 v_mfma_f32_16x16x32_bf16 v[16:19], v[40:43], v[56:59], v[16:19]
 ds_read_b128 v[32:35], v4 offset:16384
 v_mfma_f32_16x16x32_bf16 v[20:23], v[44:47], v[56:59], v[20:23]
 buffer_load_dwordx4 v[56:59], v3, s[28:31], s68 offen offset:3072 sc1
 v_mfma_f32_16x16x32_bf16 v[24:27], v[40:43], v[60:63], v[24:27]
 ds_read_b128 v[36:39], v4 offset:17408
 v_mfma_f32_16x16x32_bf16 v[28:31], v[44:47], v[60:63], v[28:31]
 buffer_load_dwordx4 v[60:63], v3, s[28:31], s66 offen offset:0 sc1
 s_waitcnt vmcnt(23)
 s_waitcnt lgkmcnt(0)
 v_mfma_f32_16x16x32_bf16 v[16:19], v[32:35], v[64:67], v[16:19]
 ds_read_b128 v[40:43], v4 offset:18432
 v_mfma_f32_16x16x32_bf16 v[20:23], v[36:39], v[64:67], v[20:23]
 buffer_load_dwordx4 v[64:67], v3, s[28:31], s66 offen offset:1024 sc1
 v_mfma_f32_16x16x32_bf16 v[24:27], v[32:35], v[68:71], v[24:27]
 ds_read_b128 v[44:47], v4 offset:19456
 v_mfma_f32_16x16x32_bf16 v[28:31], v[36:39], v[68:71], v[28:31]
 buffer_load_dwordx4 v[68:71], v3, s[28:31], s66 offen offset:2048 sc1
 s_waitcnt vmcnt(23)
 s_waitcnt lgkmcnt(0)
 v_mfma_f32_16x16x32_bf16 v[16:19], v[40:43], v[72:75], v[16:19]
 ds_read_b128 v[32:35], v4 offset:20480
 v_mfma_f32_16x16x32_bf16 v[20:23], v[44:47], v[72:75], v[20:23]
 buffer_load_dwordx4 v[72:75], v3, s[28:31], s66 offen offset:3072 sc1
 v_mfma_f32_16x16x32_bf16 v[24:27], v[40:43], v[76:79], v[24:27]
 ds_read_b128 v[36:39], v4 offset:21504
 v_mfma_f32_16x16x32_bf16 v[28:31], v[44:47], v[76:79], v[28:31]
 buffer_load_dwordx4 v[76:79], v3, s[28:31], s57 offen offset:0 sc1
 s_waitcnt vmcnt(23)
 s_waitcnt lgkmcnt(0)
 v_mfma_f32_16x16x32_bf16 v[16:19], v[32:35], v[80:83], v[16:19]
 ds_read_b128 v[40:43], v4 offset:22528
 v_mfma_f32_16x16x32_bf16 v[20:23], v[36:39], v[80:83], v[20:23]
 buffer_load_dwordx4 v[80:83], v3, s[28:31], s57 offen offset:1024 sc1
 v_mfma_f32_16x16x32_bf16 v[24:27], v[32:35], v[84:87], v[24:27]
 ds_read_b128 v[44:47], v4 offset:23552
 v_mfma_f32_16x16x32_bf16 v[28:31], v[36:39], v[84:87], v[28:31]
 buffer_load_dwordx4 v[84:87], v3, s[28:31], s57 offen offset:2048 sc1
 s_waitcnt vmcnt(23)
 s_waitcnt lgkmcnt(0)
 v_mfma_f32_16x16x32_bf16 v[16:19], v[40:43], v[88:91], v[16:19]
 ds_read_b128 v[32:35], v4 offset:24576
 v_mfma_f32_16x16x32_bf16 v[20:23], v[44:47], v[88:91], v[20:23]
 buffer_load_dwordx4 v[88:91], v3, s[28:31], s57 offen offset:3072 sc1
 v_mfma_f32_16x16x32_bf16 v[24:27], v[40:43], v[92:95], v[24:27]
 ds_read_b128 v[36:39], v4 offset:25600
 v_mfma_f32_16x16x32_bf16 v[28:31], v[44:47], v[92:95], v[28:31]
 s_waitcnt vmcnt(48)
 v_cmp_gt_u32 vcc, s69, v1
 s_cbranch_vccnz L_fin_l_late
 s_waitcnt vmcnt(22)
 s_waitcnt lgkmcnt(0)
 v_mfma_f32_16x16x32_bf16 v[16:19], v[32:35], v[96:99], v[16:19]
 ds_read_b128 v[40:43], v4 offset:26624
 v_mfma_f32_16x16x32_bf16 v[20:23], v[36:39], v[96:99], v[20:23]
 buffer_load_dwordx4 v[92:95], v11, s[28:31], s58 offen offset:0 sc1
 v_mfma_f32_16x16x32_bf16 v[24:27], v[32:35], v[100:103], v[24:27]
 ds_read_b128 v[44:47], v4 offset:27648
 v_mfma_f32_16x16x32_bf16 v[28:31], v[36:39], v[100:103], v[28:31]
 buffer_load_dwordx4 v[96:99], v11, s[28:31], s58 offen offset:512 sc1
 s_waitcnt vmcnt(22)
 s_waitcnt lgkmcnt(0)
 v_mfma_f32_16x16x32_bf16 v[16:19], v[40:43], v[104:107], v[16:19]
 ds_read_b128 v[32:35], v4 offset:28672
 v_mfma_f32_16x16x32_bf16 v[20:23], v[44:47], v[104:107], v[20:23]
 buffer_load_dwordx4 v[100:103], v11, s[28:31], s58 offen offset:1024 sc1
 v_mfma_f32_16x16x32_bf16 v[24:27], v[40:43], v[108:111], v[24:27]
 ds_read_b128 v[36:39], v4 offset:29696
 v_mfma_f32_16x16x32_bf16 v[28:31], v[44:47], v[108:111], v[28:31]
 buffer_load_dwordx4 v[104:107], v11, s[28:31], s58 offen offset:1536 sc1
 s_waitcnt vmcnt(22)
 s_waitcnt lgkmcnt(0)
 v_mfma_f32_16x16x32_bf16 v[16:19], v[32:35], v[112:115], v[16:19]
 ds_read_b128 v[40:43], v4 offset:30720
 v_mfma_f32_16x16x32_bf16 v[20:23], v[36:39], v[112:115], v[20:23]
 buffer_load_dwordx2 v[108:109], v12, s[28:31], s56 offen offset:0 sc1
 v_mfma_f32_16x16x32_bf16 v[24:27], v[32:35], v[116:119], v[24:27]
 ds_read_b128 v[44:47], v4 offset:31744
 v_mfma_f32_16x16x32_bf16 v[28:31], v[36:39], v[116:119], v[28:31]
 buffer_load_dwordx2 v[112:113], v12, s[28:31], s56 offen offset:256 sc1
 s_waitcnt vmcnt(22)
 s_waitcnt lgkmcnt(0)
 v_mfma_f32_16x16x32_bf16 v[16:19], v[40:43], v[120:123], v[16:19]
 v_mfma_f32_16x16x32_bf16 v[20:23], v[44:47], v[120:123], v[20:23]
 buffer_load_dwordx2 v[116:117], v12, s[28:31], s56 offen offset:512 sc1
 v_mfma_f32_16x16x32_bf16 v[24:27], v[40:43], v[124:127], v[24:27]
 v_mfma_f32_16x16x32_bf16 v[28:31], v[44:47], v[124:127], v[28:31]
 buffer_load_dwordx2 v[120:121], v12, s[28:31], s56 offen offset:768 sc1
L_fin_l_att:
 v_mov_b32 v110, 0
 v_mov_b32 v111, 0
 v_mov_b32 v114, 0
 v_mov_b32 v115, 0
 v_mov_b32 v118, 0
 v_mov_b32 v119, 0
 v_mov_b32 v122, 0
 v_mov_b32 v123, 0
 s_waitcnt vmcnt(8)
 v_mfma_f32_16x16x32_bf16 v[32:35], v[128:131], v[60:63], 0
 v_mfma_f32_16x16x32_bf16 v[36:39], v[144:147], v[60:63], 0
 v_mfma_f32_16x16x32_bf16 v[32:35], v[132:135], v[64:67], v[32:35]
 v_mfma_f32_16x16x32_bf16 v[36:39], v[48:51], v[64:67], v[36:39]
 v_mfma_f32_16x16x32_bf16 v[32:35], v[136:139], v[68:71], v[32:35]
 v_mfma_f32_16x16x32_bf16 v[36:39], v[52:55], v[68:71], v[36:39]
 v_mfma_f32_16x16x32_bf16 v[32:35], v[140:143], v[72:75], v[32:35]
 v_mfma_f32_16x16x32_bf16 v[36:39], v[56:59], v[72:75], v[36:39]
 s_waitcnt vmcnt(4)
 v_mfma_f32_16x16x32_bf16 v[40:43], v[92:95], v[60:63], 0
 v_mfma_f32_16x16x32_bf16 v[40:43], v[96:99], v[64:67], v[40:43]
 v_mfma_f32_16x16x32_bf16 v[40:43], v[100:103], v[68:71], v[40:43]
 v_mfma_f32_16x16x32_bf16 v[40:43], v[104:107], v[72:75], v[40:43]
 v_pk_add_f32 v[32:33], v[32:33], v[152:153]
 v_pk_add_f32 v[34:35], v[34:35], v[154:155]
 v_pk_add_f32 v[36:37], v[36:37], v[156:157]
 v_pk_add_f32 v[38:39], v[38:39], v[158:159]
 v_mov_b32 v48, 0x3f803f80
 v_mov_b32 v49, 0x3f803f80
 v_mov_b32 v50, 0x3f803f80
 v_mov_b32 v51, 0x3f803f80
 v_mov_b32 v58, 0
 v_mov_b32 v59, 0
 v_max3_f32 v44, v32, v33, v34
 v_max3_f32 v44, v44, v35, v36
 v_max3_f32 v44, v44, v37, v38
 v_max3_f32 v44, v44, v39, v40
 v_max3_f32 v44, v44, v41, v42
 v_max_f32 v44, v44, v43
 v_mov_b32 v45, v44
 s_nop 1
 v_permlane32_swap_b32 v44, v45
 v_max_f32 v44, v44, v45
 v_mov_b32 v45, v44
 s_nop 1
 v_permlane16_swap_b32 v44, v45
 v_max_f32 v44, v44, v45
 v_mul_f32 v44, s64, v44
 v_add_f32 v46, v44, v15
 v_pk_fma_f32 v[32:33], v[32:33], s[62:63], v[44:45] op_sel_hi:[1,1,0]
 v_pk_fma_f32 v[34:35], v[34:35], s[62:63], v[44:45] op_sel_hi:[1,1,0]
 v_pk_fma_f32 v[36:37], v[36:37], s[62:63], v[44:45] op_sel_hi:[1,1,0]
 v_pk_fma_f32 v[38:39], v[38:39], s[62:63], v[44:45] op_sel_hi:[1,1,0]
 v_pk_fma_f32 v[40:41], v[40:41], s[62:63], v[46:47] op_sel_hi:[1,1,0]
 v_pk_fma_f32 v[42:43], v[42:43], s[62:63], v[46:47] op_sel_hi:[1,1,0]
 v_exp_f32 v32, v32
 v_exp_f32 v33, v33
 v_exp_f32 v34, v34
 v_exp_f32 v35, v35
 v_exp_f32 v36, v36
 v_exp_f32 v37, v37
 v_exp_f32 v38, v38
 v_exp_f32 v39, v39
 v_exp_f32 v40, v40
 v_exp_f32 v41, v41
 v_exp_f32 v42, v42
 v_exp_f32 v43, v43
 v_cvt_pk_bf16_f32 v52, v32, v33
 v_cvt_pk_bf16_f32 v53, v34, v35
 v_cvt_pk_bf16_f32 v54, v36, v37
 v_cvt_pk_bf16_f32 v55, v38, v39
 v_cvt_pk_bf16_f32 v56, v40, v41
 v_cvt_pk_bf16_f32 v57, v42, v43
 s_waitcnt vmcnt(0)
 s_nop 0
 v_mfma_f32_16x16x32_bf16 v[144:147], v[48:51], v[52:55], 0
 v_mfma_f32_16x16x32_bf16 v[128:131], v[76:79], v[52:55], 0
 v_mfma_f32_16x16x32_bf16 v[132:135], v[80:83], v[52:55], 0
 v_mfma_f32_16x16x32_bf16 v[136:139], v[84:87], v[52:55], 0
 v_mfma_f32_16x16x32_bf16 v[140:143], v[88:91], v[52:55], 0
 v_mfma_f32_16x16x32_bf16 v[144:147], v[48:51], v[56:59], v[144:147]
 v_mfma_f32_16x16x32_bf16 v[128:131], v[108:111], v[56:59], v[128:131]
 v_mfma_f32_16x16x32_bf16 v[132:135], v[112:115], v[56:59], v[132:135]
 v_mfma_f32_16x16x32_bf16 v[136:139], v[116:119], v[56:59], v[136:139]
 v_mfma_f32_16x16x32_bf16 v[140:143], v[120:123], v[56:59], v[140:143]
 s_lshl_b32 s56, s52, 13
 s_lshr_b32 s47, s40, 1
 s_lshl_b32 s47, s47, 12
 s_add_u32 s56, s56, s47
 s_and_b32 s47, s40, 1
 s_lshl_b32 s47, s47, 10
 s_add_u32 s56, s56, s47
 s_add_u32 s56, s56, s55
 v_rcp_f32 v44, v144
 s_nop 1
 v_pk_mul_f32 v[128:129], v[128:129], v[44:45] op_sel_hi:[1,0]
 v_pk_mul_f32 v[130:131], v[130:131], v[44:45] op_sel_hi:[1,0]
 v_pk_mul_f32 v[132:133], v[132:133], v[44:45] op_sel_hi:[1,0]
 v_pk_mul_f32 v[134:135], v[134:135], v[44:45] op_sel_hi:[1,0]
 v_pk_mul_f32 v[136:137], v[136:137], v[44:45] op_sel_hi:[1,0]
 v_pk_mul_f32 v[138:139], v[138:139], v[44:45] op_sel_hi:[1,0]
 v_pk_mul_f32 v[140:141], v[140:141], v[44:45] op_sel_hi:[1,0]
 v_pk_mul_f32 v[142:143], v[142:143], v[44:45] op_sel_hi:[1,0]
 v_cvt_pk_bf16_f32 v32, v128, v129
 v_cvt_pk_bf16_f32 v33, v130, v131
 v_cvt_pk_bf16_f32 v34, v132, v133
 v_cvt_pk_bf16_f32 v35, v134, v135
 v_cvt_pk_bf16_f32 v36, v136, v137
 v_cvt_pk_bf16_f32 v37, v138, v139
 v_cvt_pk_bf16_f32 v38, v140, v141
 v_cvt_pk_bf16_f32 v39, v142, v143
 buffer_store_dwordx4 v[32:35], v3, s[28:31], s56 offen offset:0
 buffer_store_dwordx4 v[36:39], v3, s[28:31], s56 offen offset:2048
 s_lshl_b32 s47, s52, 2
 s_add_u32 s47, s47, s60
 v_mov_b32 v1, s59
 s_waitcnt vmcnt(0)
 s_barrier
 buffer_store_dword v1, v2, s[28:31], s47 offen
 s_lshl_b32 s66, s40, 16
 s_add_u32 s66, s66, s55
 s_add_u32 s48, s53, 6
 s_mul_i32 s54, s48, 229376
 s_mul_i32 s47, s40, 57344
 s_add_u32 s54, s54, s47
 s_add_u32 s54, s54, 0x4000000
wg_42:
 buffer_load_dword v44, v13, s[28:31], s60 offen sc1
 s_sub_u32 s26, s26, 1
 s_cbranch_scc1 L_end
 s_waitcnt vmcnt(0)
 v_cmp_gt_u32 vcc, s59, v44
 s_cbranch_vccz wg_42_ok
 s_branch wg_42
wg_42_ok:
 buffer_load_dwordx4 v[48:51], v3, s[28:31], s66 offen offset:0 sc1
 buffer_load_dwordx4 v[52:55], v3, s[28:31], s66 offen offset:1024 sc1
 buffer_load_dwordx4 v[56:59], v3, s[28:31], s66 offen offset:2048 sc1
 buffer_load_dwordx4 v[60:63], v3, s[28:31], s66 offen offset:3072 sc1
 s_add_u32 s66, s66, 4096
 buffer_load_dwordx4 v[64:67], v3, s[28:31], s66 offen offset:0 sc1
 buffer_load_dwordx4 v[68:71], v3, s[28:31], s66 offen offset:1024 sc1
 buffer_load_dwordx4 v[72:75], v3, s[28:31], s66 offen offset:2048 sc1
 buffer_load_dwordx4 v[76:79], v3, s[28:31], s66 offen offset:3072 sc1
 s_add_u32 s66, s66, 4096
 buffer_load_dwordx4 v[80:83], v3, s[28:31], s66 offen offset:0 sc1
 buffer_load_dwordx4 v[84:87], v3, s[28:31], s66 offen offset:1024 sc1
 buffer_load_dwordx4 v[88:91], v3, s[28:31], s66 offen offset:2048 sc1
 buffer_load_dwordx4 v[92:95], v3, s[28:31], s66 offen offset:3072 sc1
 s_add_u32 s66, s66, 4096
 buffer_load_dwordx4 v[96:99], v3, s[28:31], s66 offen offset:0 sc1
 buffer_load_dwordx4 v[100:103], v3, s[28:31], s66 offen offset:1024 sc1
 buffer_load_dwordx4 v[104:107], v3, s[28:31], s66 offen offset:2048 sc1
 buffer_load_dwordx4 v[108:111], v3, s[28:31], s66 offen offset:3072 sc1
 s_add_u32 s66, s66, 4096
 buffer_load_dwordx4 v[112:115], v3, s[28:31], s66 offen offset:0 sc1
 buffer_load_dwordx4 v[116:119], v3, s[28:31], s66 offen offset:1024 sc1
 buffer_load_dwordx4 v[120:123], v3, s[28:31], s66 offen offset:2048 sc1
 buffer_load_dwordx4 v[124:127], v3, s[28:31], s66 offen offset:3072 sc1
 s_add_u32 s66, s66, 4096
 buffer_load_dwordx4 v[128:131], v3, s[28:31], s66 offen offset:0 sc1
 buffer_load_dwordx4 v[132:135], v3, s[28:31], s66 offen offset:1024 sc1
 buffer_load_dwordx4 v[136:139], v3, s[28:31], s66 offen offset:2048 sc1
 buffer_load_dwordx4 v[140:143], v3, s[28:31], s66 offen offset:3072 sc1
 s_add_u32 s66, s66, 4096
 buffer_load_dwordx4 v[144:147], v3, s[28:31], s66 offen offset:0 sc1
 s_waitcnt vmcnt(23)
 v_mfma_f32_16x16x32_bf16 v[16:19], a[0:3], v[48:51], v[16:19]
 v_mfma_f32_16x16x32_bf16 v[20:23], a[4:7], v[48:51], v[20:23]
 buffer_load_dwordx4 v[48:51], v3, s[28:31], s66 offen offset:1024 sc1
 v_mfma_f32_16x16x32_bf16 v[24:27], a[0:3], v[52:55], v[24:27]
 v_mfma_f32_16x16x32_bf16 v[28:31], a[4:7], v[52:55], v[28:31]
 buffer_load_dwordx4 v[52:55], v3, s[28:31], s66 offen offset:2048 sc1
 s_waitcnt vmcnt(23)
 v_mfma_f32_16x16x32_bf16 v[16:19], a[8:11], v[56:59], v[16:19]
 v_mfma_f32_16x16x32_bf16 v[20:23], a[12:15], v[56:59], v[20:23]
 buffer_load_dwordx4 v[56:59], v3, s[28:31], s66 offen offset:3072 sc1
 s_add_u32 s66, s66, 4096
 v_mfma_f32_16x16x32_bf16 v[24:27], a[8:11], v[60:63], v[24:27]
 v_mfma_f32_16x16x32_bf16 v[28:31], a[12:15], v[60:63], v[28:31]
 buffer_load_dwordx4 v[60:63], v3, s[28:31], s66 offen offset:0 sc1
 s_waitcnt vmcnt(23)
 v_mfma_f32_16x16x32_bf16 v[16:19], a[16:19], v[64:67], v[16:19]
 v_mfma_f32_16x16x32_bf16 v[20:23], a[20:23], v[64:67], v[20:23]
 buffer_load_dwordx4 v[64:67], v3, s[28:31], s66 offen offset:1024 sc1
 v_mfma_f32_16x16x32_bf16 v[24:27], a[16:19], v[68:71], v[24:27]
 v_mfma_f32_16x16x32_bf16 v[28:31], a[20:23], v[68:71], v[28:31]
 buffer_load_dwordx4 v[68:71], v3, s[28:31], s66 offen offset:2048 sc1
 s_waitcnt vmcnt(23)
 v_mfma_f32_16x16x32_bf16 v[16:19], a[24:27], v[72:75], v[16:19]
 v_mfma_f32_16x16x32_bf16 v[20:23], a[28:31], v[72:75], v[20:23]
 buffer_load_dwordx4 v[72:75], v3, s[28:31], s66 offen offset:3072 sc1
 s_add_u32 s66, s66, 4096
 v_mfma_f32_16x16x32_bf16 v[24:27], a[24:27], v[76:79], v[24:27]
 v_mfma_f32_16x16x32_bf16 v[28:31], a[28:31], v[76:79], v[28:31]
 buffer_load_dwordx4 v[76:79], v3, s[28:31], s66 offen offset:0 sc1
 s_waitcnt vmcnt(23)
 v_mfma_f32_16x16x32_bf16 v[16:19], a[32:35], v[80:83], v[16:19]
 v_mfma_f32_16x16x32_bf16 v[20:23], a[36:39], v[80:83], v[20:23]
 buffer_load_dwordx4 v[80:83], v3, s[28:31], s66 offen offset:1024 sc1
 v_mfma_f32_16x16x32_bf16 v[24:27], a[32:35], v[84:87], v[24:27]
 v_mfma_f32_16x16x32_bf16 v[28:31], a[36:39], v[84:87], v[28:31]
 buffer_load_dwordx4 v[84:87], v3, s[28:31], s66 offen offset:2048 sc1
 s_waitcnt vmcnt(23)
 v_mfma_f32_16x16x32_bf16 v[16:19], a[40:43], v[88:91], v[16:19]
 v_mfma_f32_16x16x32_bf16 v[20:23], a[44:47], v[88:91], v[20:23]
 buffer_load_dwordx4 v[88:91], v3, s[28:31], s66 offen offset:3072 sc1
 s_add_u32 s66, s66, 4096
 v_mfma_f32_16x16x32_bf16 v[24:27], a[40:43], v[92:95], v[24:27]
 v_mfma_f32_16x16x32_bf16 v[28:31], a[44:47], v[92:95], v[28:31]
 buffer_load_dwordx4 v[92:95], v3, s[28:31], s66 offen offset:0 sc1
 s_waitcnt vmcnt(23)
 v_mfma_f32_16x16x32_bf16 v[16:19], a[48:51], v[96:99], v[16:19]
 v_mfma_f32_16x16x32_bf16 v[20:23], a[52:55], v[96:99], v[20:23]
 buffer_load_dwordx4 v[96:99], v3, s[28:31], s66 offen offset:1024 sc1
 v_mfma_f32_16x16x32_bf16 v[24:27], a[48:51], v[100:103], v[24:27]
 v_mfma_f32_16x16x32_bf16 v[28:31], a[52:55], v[100:103], v[28:31]
 buffer_load_dwordx4 v[100:103], v3, s[28:31], s66 offen offset:2048 sc1
 s_waitcnt vmcnt(23)
 v_mfma_f32_16x16x32_bf16 v[16:19], a[56:59], v[104:107], v[16:19]
 v_mfma_f32_16x16x32_bf16 v[20:23], a[60:63], v[104:107], v[20:23]
 buffer_load_dwordx4 v[104:107], v3, s[28:31], s66 offen offset:3072 sc1
 s_add_u32 s66, s66, 4096
 v_mfma_f32_16x16x32_bf16 v[24:27], a[56:59], v[108:111], v[24:27]
 v_mfma_f32_16x16x32_bf16 v[28:31], a[60:63], v[108:111], v[28:31]
 buffer_load_dwordx4 v[108:111], v3, s[28:31], s66 offen offset:0 sc1
 s_waitcnt vmcnt(23)
 v_mfma_f32_16x16x32_bf16 v[16:19], a[64:67], v[112:115], v[16:19]
 v_mfma_f32_16x16x32_bf16 v[20:23], a[68:71], v[112:115], v[20:23]
 buffer_load_dwordx4 v[112:115], v3, s[28:31], s66 offen offset:1024 sc1
 v_mfma_f32_16x16x32_bf16 v[24:27], a[64:67], v[116:119], v[24:27]
 v_mfma_f32_16x16x32_bf16 v[28:31], a[68:71], v[116:119], v[28:31]
 buffer_load_dwordx4 v[116:119], v3, s[28:31], s66 offen offset:2048 sc1
 s_waitcnt vmcnt(23)
 v_mfma_f32_16x16x32_bf16 v[16:19], a[72:75], v[120:123], v[16:19]
 v_mfma_f32_16x16x32_bf16 v[20:23], a[76:79], v[120:123], v[20:23]
 buffer_load_dwordx4 v[120:123], v3, s[28:31], s66 offen offset:3072 sc1
 s_add_u32 s66, s66, 4096
 v_mfma_f32_16x16x32_bf16 v[24:27], a[72:75], v[124:127], v[24:27]
 v_mfma_f32_16x16x32_bf16 v[28:31], a[76:79], v[124:127], v[28:31]
 buffer_load_dwordx4 v[124:127], v3, s[28:31], s66 offen offset:0 sc1
 s_waitcnt vmcnt(23)
 v_mfma_f32_16x16x32_bf16 v[16:19], a[80:83], v[128:131], v[16:19]
 v_mfma_f32_16x16x32_bf16 v[20:23], a[84:87], v[128:131], v[20:23]
 buffer_load_dwordx4 v[128:131], v3, s[28:31], s66 offen offset:1024 sc1
 v_mfma_f32_16x16x32_bf16 v[24:27], a[80:83], v[132:135], v[24:27]
 v_mfma_f32_16x16x32_bf16 v[28:31], a[84:87], v[132:135], v[28:31]
 buffer_load_dwordx4 v[132:135], v3, s[28:31], s66 offen offset:2048 sc1
 s_waitcnt vmcnt(23)
 v_mfma_f32_16x16x32_bf16 v[16:19], a[88:91], v[136:139], v[16:19]
 v_mfma_f32_16x16x32_bf16 v[20:23], a[92:95], v[136:139], v[20:23]
 buffer_load_dwordx4 v[136:139], v3, s[28:31], s66 offen offset:3072 sc1
 s_add_u32 s66, s66, 4096
 v_mfma_f32_16x16x32_bf16 v[24:27], a[88:91], v[140:143], v[24:27]
 v_mfma_f32_16x16x32_bf16 v[28:31], a[92:95], v[140:143], v[28:31]
 buffer_load_dwordx4 v[140:143], v3, s[28:31], s66 offen offset:0 sc1
 s_waitcnt vmcnt(23)
 v_mfma_f32_16x16x32_bf16 v[16:19], a[96:99], v[144:147], v[16:19]
 v_mfma_f32_16x16x32_bf16 v[20:23], a[100:103], v[144:147], v[20:23]
 buffer_load_dwordx4 v[144:147], v3, s[28:31], s66 offen offset:1024 sc1
 v_mfma_f32_16x16x32_bf16 v[24:27], a[96:99], v[48:51], v[24:27]
 v_mfma_f32_16x16x32_bf16 v[28:31], a[100:103], v[48:51], v[28:31]
 buffer_load_dwordx4 v[48:51], v3, s[28:31], s66 offen offset:2048 sc1
 s_waitcnt vmcnt(23)
 v_mfma_f32_16x16x32_bf16 v[16:19], a[104:107], v[52:55], v[16:19]
 v_mfma_f32_16x16x32_bf16 v[20:23], a[108:111], v[52:55], v[20:23]
 buffer_load_dwordx4 v[52:55], v3, s[28:31], s66 offen offset:3072 sc1
 s_add_u32 s66, s66, 4096
 v_mfma_f32_16x16x32_bf16 v[24:27], a[104:107], v[56:59], v[24:27]
 v_mfma_f32_16x16x32_bf16 v[28:31], a[108:111], v[56:59], v[28:31]
 buffer_load_dwordx4 v[56:59], v3, s[28:31], s66 offen offset:0 sc1
 s_waitcnt vmcnt(23)
 v_mfma_f32_16x16x32_bf16 v[16:19], a[112:115], v[60:63], v[16:19]
 v_mfma_f32_16x16x32_bf16 v[20:23], a[116:119], v[60:63], v[20:23]
 buffer_load_dwordx4 v[60:63], v3, s[28:31], s66 offen offset:1024 sc1
 v_mfma_f32_16x16x32_bf16 v[24:27], a[112:115], v[64:67], v[24:27]
 v_mfma_f32_16x16x32_bf16 v[28:31], a[116:119], v[64:67], v[28:31]
 buffer_load_dwordx4 v[64:67], v3, s[28:31], s66 offen offset:2048 sc1
 s_waitcnt vmcnt(23)
 v_mfma_f32_16x16x32_bf16 v[16:19], a[120:123], v[68:71], v[16:19]
 v_mfma_f32_16x16x32_bf16 v[20:23], a[124:127], v[68:71], v[20:23]
 buffer_load_dwordx4 v[68:71], v3, s[28:31], s66 offen offset:3072 sc1
 s_add_u32 s66, s66, 4096
 v_mfma_f32_16x16x32_bf16 v[24:27], a[120:123], v[72:75], v[24:27]
 v_mfma_f32_16x16x32_bf16 v[28:31], a[124:127], v[72:75], v[28:31]
 buffer_load_dwordx4 v[72:75], v3, s[28:31], s66 offen offset:0 sc1
 s_waitcnt vmcnt(23)
 v_mfma_f32_16x16x32_bf16 v[16:19], a[128:131], v[76:79], v[16:19]
 v_mfma_f32_16x16x32_bf16 v[20:23], a[132:135], v[76:79], v[20:23]
 buffer_load_dwordx4 v[76:79], v3, s[28:31], s66 offen offset:1024 sc1
 v_mfma_f32_16x16x32_bf16 v[24:27], a[128:131], v[80:83], v[24:27]
 v_mfma_f32_16x16x32_bf16 v[28:31], a[132:135], v[80:83], v[28:31]
 buffer_load_dwordx4 v[80:83], v3, s[28:31], s66 offen offset:2048 sc1
 s_waitcnt vmcnt(23)
 v_mfma_f32_16x16x32_bf16 v[16:19], a[136:139], v[84:87], v[16:19]
 v_mfma_f32_16x16x32_bf16 v[20:23], a[140:143], v[84:87], v[20:23]
 buffer_load_dwordx4 v[84:87], v3, s[28:31], s66 offen offset:3072 sc1
 s_add_u32 s66, s66, 4096
 v_mfma_f32_16x16x32_bf16 v[24:27], a[136:139], v[88:91], v[24:27]
 v_mfma_f32_16x16x32_bf16 v[28:31], a[140:143], v[88:91], v[28:31]
 buffer_load_dwordx4 v[88:91], v3, s[28:31], s66 offen offset:0 sc1
 s_waitcnt vmcnt(23)
 v_mfma_f32_16x16x32_bf16 v[16:19], a[144:147], v[92:95], v[16:19]
 v_mfma_f32_16x16x32_bf16 v[20:23], a[148:151], v[92:95], v[20:23]
 buffer_load_dwordx4 v[92:95], v3, s[28:31], s66 offen offset:1024 sc1
 v_mfma_f32_16x16x32_bf16 v[24:27], a[144:147], v[96:99], v[24:27]
 v_mfma_f32_16x16x32_bf16 v[28:31], a[148:151], v[96:99], v[28:31]
 buffer_load_dwordx4 v[96:99], v3, s[28:31], s66 offen offset:2048 sc1
 s_waitcnt vmcnt(23)
 v_mfma_f32_16x16x32_bf16 v[16:19], a[152:155], v[100:103], v[16:19]
 v_mfma_f32_16x16x32_bf16 v[20:23], a[156:159], v[100:103], v[20:23]
 buffer_load_dwordx4 v[100:103], v3, s[28:31], s66 offen offset:3072 sc1
 s_add_u32 s66, s66, 4096
 v_mfma_f32_16x16x32_bf16 v[24:27], a[152:155], v[104:107], v[24:27]
 v_mfma_f32_16x16x32_bf16 v[28:31], a[156:159], v[104:107], v[28:31]
 buffer_load_dwordx4 v[104:107], v3, s[28:31], s54 offen offset:0 sc1
 s_waitcnt vmcnt(23)
 v_mfma_f32_16x16x32_bf16 v[16:19], a[160:163], v[108:111], v[16:19]
 v_mfma_f32_16x16x32_bf16 v[20:23], a[164:167], v[108:111], v[20:23]
 buffer_load_dwordx4 v[108:111], v3, s[28:31], s54 offen offset:1024 sc1
 v_mfma_f32_16x16x32_bf16 v[24:27], a[160:163], v[112:115], v[24:27]
 v_mfma_f32_16x16x32_bf16 v[28:31], a[164:167], v[112:115], v[28:31]
 buffer_load_dwordx4 v[112:115], v3, s[28:31], s54 offen offset:2048 sc1
 s_waitcnt vmcnt(23)
 v_mfma_f32_16x16x32_bf16 v[16:19], a[168:171], v[116:119], v[16:19]
 v_mfma_f32_16x16x32_bf16 v[20:23], a[172:175], v[116:119], v[20:23]
 buffer_load_dwordx4 v[116:119], v3, s[28:31], s54 offen offset:3072 sc1
 s_add_u32 s54, s54, 4096
 v_mfma_f32_16x16x32_bf16 v[24:27], a[168:171], v[120:123], v[24:27]
 v_mfma_f32_16x16x32_bf16 v[28:31], a[172:175], v[120:123], v[28:31]
 buffer_load_dwordx4 v[120:123], v3, s[28:31], s54 offen offset:0 sc1
 s_waitcnt vmcnt(23)
 v_mfma_f32_16x16x32_bf16 v[16:19], a[176:179], v[124:127], v[16:19]
 v_mfma_f32_16x16x32_bf16 v[20:23], a[180:183], v[124:127], v[20:23]
 buffer_load_dwordx4 v[124:127], v3, s[28:31], s54 offen offset:1024 sc1
 v_mfma_f32_16x16x32_bf16 v[24:27], a[176:179], v[128:131], v[24:27]
 v_mfma_f32_16x16x32_bf16 v[28:31], a[180:183], v[128:131], v[28:31]
 buffer_load_dwordx4 v[128:131], v3, s[28:31], s54 offen offset:2048 sc1
 s_waitcnt vmcnt(23)
 v_mfma_f32_16x16x32_bf16 v[16:19], a[184:187], v[132:135], v[16:19]
 v_mfma_f32_16x16x32_bf16 v[20:23], a[188:191], v[132:135], v[20:23]
 buffer_load_dwordx4 v[132:135], v3, s[28:31], s54 offen offset:3072 sc1
 s_add_u32 s54, s54, 4096
 v_mfma_f32_16x16x32_bf16 v[24:27], a[184:187], v[136:139], v[24:27]
 v_mfma_f32_16x16x32_bf16 v[28:31], a[188:191], v[136:139], v[28:31]
 buffer_load_dwordx4 v[136:139], v3, s[28:31], s54 offen offset:0 sc1
 s_waitcnt vmcnt(23)
 v_mfma_f32_16x16x32_bf16 v[16:19], a[192:195], v[140:143], v[16:19]
 v_mfma_f32_16x16x32_bf16 v[20:23], a[196:199], v[140:143], v[20:23]
 buffer_load_dwordx4 v[140:143], v3, s[28:31], s54 offen offset:1024 sc1
 v_mfma_f32_16x16x32_bf16 v[24:27], a[192:195], v[144:147], v[24:27]
 v_mfma_f32_16x16x32_bf16 v[28:31], a[196:199], v[144:147], v[28:31]
 buffer_load_dwordx4 v[144:147], v3, s[28:31], s54 offen offset:2048 sc1
 s_waitcnt vmcnt(23)
 v_mfma_f32_16x16x32_bf16 v[16:19], a[200:203], v[48:51], v[16:19]
 v_mfma_f32_16x16x32_bf16 v[20:23], a[204:207], v[48:51], v[20:23]
 buffer_load_dwordx4 v[48:51], v3, s[28:31], s54 offen offset:3072 sc1
 s_add_u32 s54, s54, 4096
 v_mfma_f32_16x16x32_bf16 v[24:27], a[200:203], v[52:55], v[24:27]
 v_mfma_f32_16x16x32_bf16 v[28:31], a[204:207], v[52:55], v[28:31]
 buffer_load_dwordx4 v[52:55], v3, s[28:31], s54 offen offset:0 sc1
 s_waitcnt vmcnt(23)
 v_mfma_f32_16x16x32_bf16 v[16:19], a[208:211], v[56:59], v[16:19]
 v_mfma_f32_16x16x32_bf16 v[20:23], a[212:215], v[56:59], v[20:23]
 buffer_load_dwordx4 v[56:59], v3, s[28:31], s54 offen offset:1024 sc1
 v_mfma_f32_16x16x32_bf16 v[24:27], a[208:211], v[60:63], v[24:27]
 v_mfma_f32_16x16x32_bf16 v[28:31], a[212:215], v[60:63], v[28:31]
 buffer_load_dwordx4 v[60:63], v3, s[28:31], s54 offen offset:2048 sc1
 s_waitcnt vmcnt(23)
 v_mfma_f32_16x16x32_bf16 v[16:19], a[216:219], v[64:67], v[16:19]
 v_mfma_f32_16x16x32_bf16 v[20:23], a[220:223], v[64:67], v[20:23]
 buffer_load_dwordx4 v[64:67], v3, s[28:31], s54 offen offset:3072 sc1
 s_add_u32 s54, s54, 4096
 v_mfma_f32_16x16x32_bf16 v[24:27], a[216:219], v[68:71], v[24:27]
 v_mfma_f32_16x16x32_bf16 v[28:31], a[220:223], v[68:71], v[28:31]
 buffer_load_dwordx4 v[68:71], v3, s[28:31], s54 offen offset:0 sc1
 s_waitcnt vmcnt(23)
 v_mfma_f32_16x16x32_bf16 v[16:19], a[224:227], v[72:75], v[16:19]
 v_mfma_f32_16x16x32_bf16 v[20:23], a[228:231], v[72:75], v[20:23]
 buffer_load_dwordx4 v[72:75], v3, s[28:31], s54 offen offset:1024 sc1
 v_mfma_f32_16x16x32_bf16 v[24:27], a[224:227], v[76:79], v[24:27]
 v_mfma_f32_16x16x32_bf16 v[28:31], a[228:231], v[76:79], v[28:31]
 buffer_load_dwordx4 v[76:79], v3, s[28:31], s54 offen offset:2048 sc1
 s_waitcnt vmcnt(23)
 v_mfma_f32_16x16x32_bf16 v[16:19], a[232:235], v[80:83], v[16:19]
 v_mfma_f32_16x16x32_bf16 v[20:23], a[236:239], v[80:83], v[20:23]
 buffer_load_dwordx4 v[80:83], v3, s[28:31], s54 offen offset:3072 sc1
 s_add_u32 s54, s54, 4096
 v_mfma_f32_16x16x32_bf16 v[24:27], a[232:235], v[84:87], v[24:27]
 v_mfma_f32_16x16x32_bf16 v[28:31], a[236:239], v[84:87], v[28:31]
 buffer_load_dwordx4 v[84:87], v3, s[28:31], s54 offen offset:0 sc1
 s_waitcnt vmcnt(23)
 v_mfma_f32_16x16x32_bf16 v[16:19], a[240:243], v[88:91], v[16:19]
 v_mfma_f32_16x16x32_bf16 v[20:23], a[244:247], v[88:91], v[20:23]
 buffer_load_dwordx4 v[88:91], v3, s[28:31], s54 offen offset:1024 sc1
 v_mfma_f32_16x16x32_bf16 v[24:27], a[240:243], v[92:95], v[24:27]
 v_mfma_f32_16x16x32_bf16 v[28:31], a[244:247], v[92:95], v[28:31]
 buffer_load_dwordx4 v[92:95], v3, s[28:31], s54 offen offset:2048 sc1
 s_waitcnt vmcnt(23)
 v_mfma_f32_16x16x32_bf16 v[16:19], a[248:251], v[96:99], v[16:19]
 v_mfma_f32_16x16x32_bf16 v[20:23], a[252:255], v[96:99], v[20:23]
 buffer_load_dwordx4 v[96:99], v3, s[28:31], s54 offen offset:3072 sc1
 s_add_u32 s54, s54, 4096
 v_mfma_f32_16x16x32_bf16 v[24:27], a[248:251], v[100:103], v[24:27]
 v_mfma_f32_16x16x32_bf16 v[28:31], a[252:255], v[100:103], v[28:31]
 buffer_load_dwordx4 v[100:103], v3, s[28:31], s54 offen offset:0 sc1
 s_nop 7
 ds_write_b128 v8, v[16:19] offset:0
 ds_write_b128 v8, v[20:23] offset:64
 ds_write_b128 v8, v[24:27] offset:2304
 ds_write_b128 v8, v[28:31] offset:2368
 v_lshlrev_b32 v150, 16, v149
 v_and_b32 v151, 0xffff0000, v149
 v_and_b32 v149, 0xffff0000, v148
 v_lshlrev_b32 v148, 16, v148
 s_waitcnt lgkmcnt(0)
 s_barrier
 ds_read_b128 v[32:35], v9 offset:0
 ds_read_b128 v[36:39], v9 offset:4608
 ds_read_b128 v[40:43], v9 offset:9216
 ds_read_b128 v[44:47], v9 offset:13824
 s_xor_b32 s55, s55, 262144
 s_add_u32 s59, s59, 1
 s_add_u32 s53, s53, 6
 s_waitcnt lgkmcnt(0)
 v_pk_add_f32 v[32:33], v[32:33], v[36:37]
 v_pk_add_f32 v[40:41], v[40:41], v[44:45]
 v_pk_add_f32 v[34:35], v[34:35], v[38:39]
 v_pk_add_f32 v[42:43], v[42:43], v[46:47]
 v_pk_add_f32 v[32:33], v[32:33], v[40:41]
 v_pk_add_f32 v[34:35], v[34:35], v[42:43]
 v_pk_add_f32 v[32:33], v[32:33], v[148:149]
 v_pk_add_f32 v[34:35], v[34:35], v[150:151]
 v_cvt_pk_bf16_f32 v36, v32, v33
 v_cvt_pk_bf16_f32 v37, v34, v35
 buffer_store_dwordx2 v[36:37], v10, s[36:39], s65 offen
 s_cmp_lt_u32 s53, 64
 s_cbranch_scc1 L_fin_l
 s_branch L_end
L_fin_l_late:
 s_waitcnt vmcnt(22)
 s_waitcnt lgkmcnt(0)
 v_mfma_f32_16x16x32_bf16 v[16:19], v[32:35], v[96:99], v[16:19]
 ds_read_b128 v[40:43], v4 offset:26624
 v_mfma_f32_16x16x32_bf16 v[20:23], v[36:39], v[96:99], v[20:23]
 v_mfma_f32_16x16x32_bf16 v[24:27], v[32:35], v[100:103], v[24:27]
 ds_read_b128 v[44:47], v4 offset:27648
 v_mfma_f32_16x16x32_bf16 v[28:31], v[36:39], v[100:103], v[28:31]
 s_waitcnt vmcnt(20)
 s_waitcnt lgkmcnt(0)
 v_mfma_f32_16x16x32_bf16 v[16:19], v[40:43], v[104:107], v[16:19]
 ds_read_b128 v[32:35], v4 offset:28672
 v_mfma_f32_16x16x32_bf16 v[20:23], v[44:47], v[104:107], v[20:23]
 v_mfma_f32_16x16x32_bf16 v[24:27], v[40:43], v[108:111], v[24:27]
 ds_read_b128 v[36:39], v4 offset:29696
 v_mfma_f32_16x16x32_bf16 v[28:31], v[44:47], v[108:111], v[28:31]
 s_waitcnt vmcnt(18)
 s_waitcnt lgkmcnt(0)
 v_mfma_f32_16x16x32_bf16 v[16:19], v[32:35], v[112:115], v[16:19]
 ds_read_b128 v[40:43], v4 offset:30720
 v_mfma_f32_16x16x32_bf16 v[20:23], v[36:39], v[112:115], v[20:23]
 v_mfma_f32_16x16x32_bf16 v[24:27], v[32:35], v[116:119], v[24:27]
 ds_read_b128 v[44:47], v4 offset:31744
 v_mfma_f32_16x16x32_bf16 v[28:31], v[36:39], v[116:119], v[28:31]
 s_waitcnt vmcnt(16)
 s_waitcnt lgkmcnt(0)
 v_mfma_f32_16x16x32_bf16 v[16:19], v[40:43], v[120:123], v[16:19]
 v_mfma_f32_16x16x32_bf16 v[20:23], v[44:47], v[120:123], v[20:23]
 v_mfma_f32_16x16x32_bf16 v[24:27], v[40:43], v[124:127], v[24:27]
 v_mfma_f32_16x16x32_bf16 v[28:31], v[44:47], v[124:127], v[28:31]
wg_41:
 buffer_load_dword v1, v14, s[28:31], s61 offen sc1
 s_sub_u32 s26, s26, 1
 s_cbranch_scc1 L_end
 s_waitcnt vmcnt(0)
 v_cmp_gt_u32 vcc, s69, v1
 s_cbranch_vccz wg_41_ok
 s_sleep 2
 s_branch wg_41
wg_41_ok:
 buffer_load_dwordx4 v[92:95], v11, s[28:31], s58 offen offset:0 sc1
 buffer_load_dwordx4 v[96:99], v11, s[28:31], s58 offen offset:512 sc1
 buffer_load_dwordx4 v[100:103], v11, s[28:31], s58 offen offset:1024 sc1
 buffer_load_dwordx4 v[104:107], v11, s[28:31], s58 offen offset:1536 sc1
 buffer_load_dwordx2 v[108:109], v12, s[28:31], s56 offen offset:0 sc1
 buffer_load_dwordx2 v[112:113], v12, s[28:31], s56 offen offset:256 sc1
 buffer_load_dwordx2 v[116:117], v12, s[28:31], s56 offen offset:512 sc1
 buffer_load_dwordx2 v[120:121], v12, s[28:31], s56 offen offset:768 sc1
 s_branch L_fin_l_att
L_fin_g:
 s_lshl_b32 s49, s53, 5
 s_add_u32 s49, s49, s52
 s_lshl_b32 s58, s49, 11
 s_lshl_b32 s49, s49, 13
 s_and_b32 s47, s40, 1
 s_lshl_b32 s47, s47, 12
 s_add_u32 s66, s49, s47
 s_add_u32 s66, s66, 0x1000000
 s_add_u32 s67, s49, 0x2000000
 s_add_u32 s68, s67, 4096
 s_lshr_b32 s47, s40, 1
 s_lshl_b32 s48, s47, 12
 s_add_u32 s57, s49, s48
 s_add_u32 s57, s57, 0x3000000
 s_lshl_b32 s47, s47, 10
 s_add_u32 s56, s58, s47
 s_add_u32 s56, s56, 0x800000
 s_add_u32 s58, s58, 0x400000
 s_add_u32 s69, s53, 1
 s_lshl_b32 s65, s53, 16
 buffer_load_dword v1, v14, s[28:31], s61 offen sc1
 buffer_load_dwordx2 v[148:149], v10, s[32:35], s65 offen
 s_waitcnt vmcnt(25)
 v_mfma_f32_16x16x32_bf16 v[16:19], v[160:163], v[104:107], 0
 v_mfma_f32_16x16x32_bf16 v[20:23], v[164:167], v[104:107], 0
 buffer_load_dwordx4 v[104:107], v3, s[28:31], s54 offen offset:1024 sc1
 v_mfma_f32_16x16x32_bf16 v[24:27], v[160:163], v[108:111], 0
 v_mfma_f32_16x16x32_bf16 v[28:31], v[164:167], v[108:111], 0
 buffer_load_dwordx4 v[108:111], v3, s[28:31], s54 offen offset:2048 sc1
 s_waitcnt vmcnt(25)
 v_mfma_f32_16x16x32_bf16 v[16:19], v[168:171], v[112:115], v[16:19]
 v_mfma_f32_16x16x32_bf16 v[20:23], v[172:175], v[112:115], v[20:23]
 buffer_load_dwordx4 v[112:115], v3, s[28:31], s54 offen offset:3072 sc1
 s_add_u32 s54, s54, 4096
 v_mfma_f32_16x16x32_bf16 v[24:27], v[168:171], v[116:119], v[24:27]
 v_mfma_f32_16x16x32_bf16 v[28:31], v[172:175], v[116:119], v[28:31]
 buffer_load_dwordx4 v[116:119], v3, s[28:31], s54 offen offset:0 sc1
 s_waitcnt vmcnt(25)
 v_mfma_f32_16x16x32_bf16 v[16:19], v[176:179], v[120:123], v[16:19]
 v_mfma_f32_16x16x32_bf16 v[20:23], v[180:183], v[120:123], v[20:23]
 buffer_load_dwordx4 v[120:123], v3, s[28:31], s54 offen offset:1024 sc1
 v_mfma_f32_16x16x32_bf16 v[24:27], v[176:179], v[124:127], v[24:27]
 v_mfma_f32_16x16x32_bf16 v[28:31], v[180:183], v[124:127], v[28:31]
 buffer_load_dwordx4 v[124:127], v3, s[28:31], s54 offen offset:2048 sc1
 s_waitcnt vmcnt(25)
 v_mfma_f32_16x16x32_bf16 v[16:19], v[184:187], v[128:131], v[16:19]
 v_mfma_f32_16x16x32_bf16 v[20:23], v[188:191], v[128:131], v[20:23]
 buffer_load_dwordx4 v[128:131], v3, s[28:31], s54 offen offset:3072 sc1
 s_add_u32 s54, s54, 4096
 v_mfma_f32_16x16x32_bf16 v[24:27], v[184:187], v[132:135], v[24:27]
 v_mfma_f32_16x16x32_bf16 v[28:31], v[188:191], v[132:135], v[28:31]
 buffer_load_dwordx4 v[132:135], v3, s[28:31], s54 offen offset:0 sc1
 s_waitcnt vmcnt(25)
 v_mfma_f32_16x16x32_bf16 v[16:19], v[192:195], v[136:139], v[16:19]
 v_mfma_f32_16x16x32_bf16 v[20:23], v[196:199], v[136:139], v[20:23]
 buffer_load_dwordx4 v[136:139], v3, s[28:31], s54 offen offset:1024 sc1
 v_mfma_f32_16x16x32_bf16 v[24:27], v[192:195], v[140:143], v[24:27]
 v_mfma_f32_16x16x32_bf16 v[28:31], v[196:199], v[140:143], v[28:31]
 buffer_load_dwordx4 v[140:143], v3, s[28:31], s54 offen offset:2048 sc1
 s_waitcnt vmcnt(25)
 v_mfma_f32_16x16x32_bf16 v[16:19], v[200:203], v[144:147], v[16:19]
 v_mfma_f32_16x16x32_bf16 v[20:23], v[204:207], v[144:147], v[20:23]
 buffer_load_dwordx4 v[144:147], v3, s[28:31], s54 offen offset:3072 sc1
 s_add_u32 s54, s54, 4096
 v_mfma_f32_16x16x32_bf16 v[24:27], v[200:203], v[48:51], v[24:27]
 v_mfma_f32_16x16x32_bf16 v[28:31], v[204:207], v[48:51], v[28:31]
 buffer_load_dwordx4 v[48:51], v3, s[28:31], s54 offen offset:0 sc1
 s_waitcnt vmcnt(25)
 v_mfma_f32_16x16x32_bf16 v[16:19], v[208:211], v[52:55], v[16:19]
 v_mfma_f32_16x16x32_bf16 v[20:23], v[212:215], v[52:55], v[20:23]
 buffer_load_dwordx4 v[52:55], v3, s[28:31], s54 offen offset:1024 sc1
 v_mfma_f32_16x16x32_bf16 v[24:27], v[208:211], v[56:59], v[24:27]
 v_mfma_f32_16x16x32_bf16 v[28:31], v[212:215], v[56:59], v[28:31]
 buffer_load_dwordx4 v[56:59], v3, s[28:31], s54 offen offset:2048 sc1
 s_waitcnt vmcnt(25)
 v_mfma_f32_16x16x32_bf16 v[16:19], v[216:219], v[60:63], v[16:19]
 v_mfma_f32_16x16x32_bf16 v[20:23], v[220:223], v[60:63], v[20:23]
 buffer_load_dwordx4 v[60:63], v3, s[28:31], s54 offen offset:3072 sc1
 s_add_u32 s54, s54, 4096
 v_mfma_f32_16x16x32_bf16 v[24:27], v[216:219], v[64:67], v[24:27]
 v_mfma_f32_16x16x32_bf16 v[28:31], v[220:223], v[64:67], v[28:31]
 buffer_load_dwordx4 v[64:67], v3, s[28:31], s54 offen offset:0 sc1
 s_waitcnt vmcnt(25)
 v_mfma_f32_16x16x32_bf16 v[16:19], v[224:227], v[68:71], v[16:19]
 v_mfma_f32_16x16x32_bf16 v[20:23], v[228:231], v[68:71], v[20:23]
 buffer_load_dwordx4 v[68:71], v3, s[28:31], s54 offen offset:1024 sc1
 v_mfma_f32_16x16x32_bf16 v[24:27], v[224:227], v[72:75], v[24:27]
 v_mfma_f32_16x16x32_bf16 v[28:31], v[228:231], v[72:75], v[28:31]
 buffer_load_dwordx4 v[72:75], v3, s[28:31], s54 offen offset:2048 sc1
 s_waitcnt vmcnt(25)
 v_mfma_f32_16x16x32_bf16 v[16:19], v[232:235], v[76:79], v[16:19]
 v_mfma_f32_16x16x32_bf16 v[20:23], v[236:239], v[76:79], v[20:23]
 buffer_load_dwordx4 v[76:79], v3, s[28:31], s54 offen offset:3072 sc1
 s_add_u32 s54, s54, 4096
 v_mfma_f32_16x16x32_bf16 v[24:27], v[232:235], v[80:83], v[24:27]
 v_mfma_f32_16x16x32_bf16 v[28:31], v[236:239], v[80:83], v[28:31]
 buffer_load_dwordx4 v[80:83], v3, s[28:31], s54 offen offset:0 sc1
 s_waitcnt vmcnt(25)
 v_mfma_f32_16x16x32_bf16 v[16:19], v[240:243], v[84:87], v[16:19]
 v_mfma_f32_16x16x32_bf16 v[20:23], v[244:247], v[84:87], v[20:23]
 buffer_load_dwordx4 v[84:87], v3, s[28:31], s54 offen offset:1024 sc1
 v_mfma_f32_16x16x32_bf16 v[24:27], v[240:243], v[88:91], v[24:27]
 v_mfma_f32_16x16x32_bf16 v[28:31], v[244:247], v[88:91], v[28:31]
 buffer_load_dwordx4 v[88:91], v3, s[28:31], s54 offen offset:2048 sc1
 s_waitcnt vmcnt(25)
 v_mfma_f32_16x16x32_bf16 v[16:19], v[248:251], v[92:95], v[16:19]
 ds_read_b128 v[32:35], v4 offset:0
 v_mfma_f32_16x16x32_bf16 v[20:23], v[252:255], v[92:95], v[20:23]
 buffer_load_dwordx4 v[92:95], v3, s[28:31], s54 offen offset:3072 sc1
 s_add_u32 s54, s54, 4096
 v_mfma_f32_16x16x32_bf16 v[24:27], v[248:251], v[96:99], v[24:27]
 ds_read_b128 v[36:39], v4 offset:1024
 v_mfma_f32_16x16x32_bf16 v[28:31], v[252:255], v[96:99], v[28:31]
 buffer_load_dwordx4 v[96:99], v3, s[28:31], s54 offen offset:0 sc1
 s_waitcnt vmcnt(23)
 s_waitcnt lgkmcnt(0)
 v_mfma_f32_16x16x32_bf16 v[16:19], v[32:35], v[100:103], v[16:19]
 ds_read_b128 v[40:43], v4 offset:2048
 v_mfma_f32_16x16x32_bf16 v[20:23], v[36:39], v[100:103], v[20:23]
 buffer_load_dwordx4 v[100:103], v3, s[28:31], s54 offen offset:1024 sc1
 v_mfma_f32_16x16x32_bf16 v[24:27], v[32:35], v[104:107], v[24:27]
 ds_read_b128 v[44:47], v4 offset:3072
 v_mfma_f32_16x16x32_bf16 v[28:31], v[36:39], v[104:107], v[28:31]
 buffer_load_dwordx4 v[104:107], v3, s[28:31], s54 offen offset:2048 sc1
 s_waitcnt vmcnt(23)
 s_waitcnt lgkmcnt(0)
 v_mfma_f32_16x16x32_bf16 v[16:19], v[40:43], v[108:111], v[16:19]
 ds_read_b128 v[32:35], v4 offset:4096
 v_mfma_f32_16x16x32_bf16 v[20:23], v[44:47], v[108:111], v[20:23]
 buffer_load_dwordx4 v[108:111], v3, s[28:31], s54 offen offset:3072 sc1
 s_add_u32 s54, s54, 4096
 v_mfma_f32_16x16x32_bf16 v[24:27], v[40:43], v[112:115], v[24:27]
 ds_read_b128 v[36:39], v4 offset:5120
 v_mfma_f32_16x16x32_bf16 v[28:31], v[44:47], v[112:115], v[28:31]
 buffer_load_dwordx4 v[112:115], v3, s[28:31], s54 offen offset:0 sc1
 s_waitcnt vmcnt(23)
 s_waitcnt lgkmcnt(0)
 v_mfma_f32_16x16x32_bf16 v[16:19], v[32:35], v[116:119], v[16:19]
 ds_read_b128 v[40:43], v4 offset:6144
 v_mfma_f32_16x16x32_bf16 v[20:23], v[36:39], v[116:119], v[20:23]
 buffer_load_dwordx4 v[116:119], v3, s[28:31], s54 offen offset:1024 sc1
 v_mfma_f32_16x16x32_bf16 v[24:27], v[32:35], v[120:123], v[24:27]
 ds_read_b128 v[44:47], v4 offset:7168
 v_mfma_f32_16x16x32_bf16 v[28:31], v[36:39], v[120:123], v[28:31]
 buffer_load_dwordx4 v[120:123], v3, s[28:31], s54 offen offset:2048 sc1
 s_waitcnt vmcnt(23)
 s_waitcnt lgkmcnt(0)
 v_mfma_f32_16x16x32_bf16 v[16:19], v[40:43], v[124:127], v[16:19]
 ds_read_b128 v[32:35], v4 offset:8192
 v_mfma_f32_16x16x32_bf16 v[20:23], v[44:47], v[124:127], v[20:23]
 buffer_load_dwordx4 v[124:127], v3, s[28:31], s54 offen offset:3072 sc1
 s_add_u32 s54, s54, 4096
 v_mfma_f32_16x16x32_bf16 v[24:27], v[40:43], v[128:131], v[24:27]
 ds_read_b128 v[36:39], v4 offset:9216
 v_mfma_f32_16x16x32_bf16 v[28:31], v[44:47], v[128:131], v[28:31]
 buffer_load_dwordx4 v[128:131], v3, s[28:31], s67 offen offset:0 sc1
 s_waitcnt vmcnt(23)
 s_waitcnt lgkmcnt(0)
 v_mfma_f32_16x16x32_bf16 v[16:19], v[32:35], v[132:135], v[16:19]
 ds_read_b128 v[40:43], v4 offset:10240
 v_mfma_f32_16x16x32_bf16 v[20:23], v[36:39], v[132:135], v[20:23]
 buffer_load_dwordx4 v[132:135], v3, s[28:31], s67 offen offset:1024 sc1
 v_mfma_f32_16x16x32_bf16 v[24:27], v[32:35], v[136:139], v[24:27]
 ds_read_b128 v[44:47], v4 offset:11264
 v_mfma_f32_16x16x32_bf16 v[28:31], v[36:39], v[136:139], v[28:31]
 buffer_load_dwordx4 v[136:139], v3, s[28:31], s67 offen offset:2048 sc1
 s_waitcnt vmcnt(23)
 s_waitcnt lgkmcnt(0)
 v_mfma_f32_16x16x32_bf16 v[16:19], v[40:43], v[140:143], v[16:19]
 ds_read_b128 v[32:35], v4 offset:12288
 v_mfma_f32_16x16x32_bf16 v[20:23], v[44:47], v[140:143], v[20:23]
 buffer_load_dwordx4 v[140:143], v3, s[28:31], s67 offen offset:3072 sc1
 v_mfma_f32_16x16x32_bf16 v[24:27], v[40:43], v[144:147], v[24:27]
 ds_read_b128 v[36:39], v4 offset:13312
 v_mfma_f32_16x16x32_bf16 v[28:31], v[44:47], v[144:147], v[28:31]
 buffer_load_dwordx4 v[144:147], v3, s[28:31], s68 offen offset:0 sc1
 s_waitcnt vmcnt(23)
 s_waitcnt lgkmcnt(0)
 v_mfma_f32_16x16x32_bf16 v[16:19], v[32:35], v[48:51], v[16:19]
 ds_read_b128 v[40:43], v4 offset:14336
 v_mfma_f32_16x16x32_bf16 v[20:23], v[36:39], v[48:51], v[20:23]
 buffer_load_dwordx4 v[48:51], v3, s[28:31], s68 offen offset:1024 sc1
 v_mfma_f32_16x16x32_bf16 v[24:27], v[32:35], v[52:55], v[24:27]
 ds_read_b128 v[44:47], v4 offset:15360
 v_mfma_f32_16x16x32_bf16 v[28:31], v[36:39], v[52:55], v[28:31]
 buffer_load_dwordx4 v[52:55], v3, s[28:31], s68 offen offset:2048 sc1
 s_waitcnt vmcnt(23)
 s_waitcnt lgkmcnt(0)
 v_mfma_f32_16x16x32_bf16 v[16:19], v[40:43], v[56:59], v[16:19]
 ds_read_b128 v[32:35], v4 offset:16384
 v_mfma_f32_16x16x32_bf16 v[20:23], v[44:47], v[56:59], v[20:23]
 buffer_load_dwordx4 v[56:59], v3, s[28:31], s68 offen offset:3072 sc1
 v_mfma_f32_16x16x32_bf16 v[24:27], v[40:43], v[60:63], v[24:27]
 ds_read_b128 v[36:39], v4 offset:17408
 v_mfma_f32_16x16x32_bf16 v[28:31], v[44:47], v[60:63], v[28:31]
 buffer_load_dwordx4 v[60:63], v3, s[28:31], s66 offen offset:0 sc1
 s_waitcnt vmcnt(23)
 s_waitcnt lgkmcnt(0)
 v_mfma_f32_16x16x32_bf16 v[16:19], v[32:35], v[64:67], v[16:19]
 ds_read_b128 v[40:43], v4 offset:18432
 v_mfma_f32_16x16x32_bf16 v[20:23], v[36:39], v[64:67], v[20:23]
 buffer_load_dwordx4 v[64:67], v3, s[28:31], s66 offen offset:1024 sc1
 v_mfma_f32_16x16x32_bf16 v[24:27], v[32:35], v[68:71], v[24:27]
 ds_read_b128 v[44:47], v4 offset:19456
 v_mfma_f32_16x16x32_bf16 v[28:31], v[36:39], v[68:71], v[28:31]
 buffer_load_dwordx4 v[68:71], v3, s[28:31], s66 offen offset:2048 sc1
 s_waitcnt vmcnt(23)
 s_waitcnt lgkmcnt(0)
 v_mfma_f32_16x16x32_bf16 v[16:19], v[40:43], v[72:75], v[16:19]
 ds_read_b128 v[32:35], v4 offset:20480
 v_mfma_f32_16x16x32_bf16 v[20:23], v[44:47], v[72:75], v[20:23]
 buffer_load_dwordx4 v[72:75], v3, s[28:31], s66 offen offset:3072 sc1
 v_mfma_f32_16x16x32_bf16 v[24:27], v[40:43], v[76:79], v[24:27]
 ds_read_b128 v[36:39], v4 offset:21504
 v_mfma_f32_16x16x32_bf16 v[28:31], v[44:47], v[76:79], v[28:31]
 buffer_load_dwordx4 v[76:79], v3, s[28:31], s57 offen offset:0 sc1
 s_waitcnt vmcnt(23)
 s_waitcnt lgkmcnt(0)
 v_mfma_f32_16x16x32_bf16 v[16:19], v[32:35], v[80:83], v[16:19]
 ds_read_b128 v[40:43], v4 offset:22528
 v_mfma_f32_16x16x32_bf16 v[20:23], v[36:39], v[80:83], v[20:23]
 buffer_load_dwordx4 v[80:83], v3, s[28:31], s57 offen offset:1024 sc1
 v_mfma_f32_16x16x32_bf16 v[24:27], v[32:35], v[84:87], v[24:27]
 ds_read_b128 v[44:47], v4 offset:23552
 v_mfma_f32_16x16x32_bf16 v[28:31], v[36:39], v[84:87], v[28:31]
 buffer_load_dwordx4 v[84:87], v3, s[28:31], s57 offen offset:2048 sc1
 s_waitcnt vmcnt(23)
 s_waitcnt lgkmcnt(0)
 v_mfma_f32_16x16x32_bf16 v[16:19], v[40:43], v[88:91], v[16:19]
 ds_read_b128 v[32:35], v4 offset:24576
 v_mfma_f32_16x16x32_bf16 v[20:23], v[44:47], v[88:91], v[20:23]
 buffer_load_dwordx4 v[88:91], v3, s[28:31], s57 offen offset:3072 sc1
 v_mfma_f32_16x16x32_bf16 v[24:27], v[40:43], v[92:95], v[24:27]
 ds_read_b128 v[36:39], v4 offset:25600
 v_mfma_f32_16x16x32_bf16 v[28:31], v[44:47], v[92:95], v[28:31]
 s_waitcnt vmcnt(48)
 v_cmp_gt_u32 vcc, s69, v1
 s_cbranch_vccnz L_fin_g_late
 s_waitcnt vmcnt(22)
 s_waitcnt lgkmcnt(0)
 v_mfma_f32_16x16x32_bf16 v[16:19], v[32:35], v[96:99], v[16:19]
 ds_read_b128 v[40:43], v4 offset:26624
 v_mfma_f32_16x16x32_bf16 v[20:23], v[36:39], v[96:99], v[20:23]
 buffer_load_dwordx4 v[92:95], v11, s[28:31], s58 offen offset:0 sc1
 v_mfma_f32_16x16x32_bf16 v[24:27], v[32:35], v[100:103], v[24:27]
 ds_read_b128 v[44:47], v4 offset:27648
 v_mfma_f32_16x16x32_bf16 v[28:31], v[36:39], v[100:103], v[28:31]
 buffer_load_dwordx4 v[96:99], v11, s[28:31], s58 offen offset:512 sc1
 s_waitcnt vmcnt(22)
 s_waitcnt lgkmcnt(0)
 v_mfma_f32_16x16x32_bf16 v[16:19], v[40:43], v[104:107], v[16:19]
 ds_read_b128 v[32:35], v4 offset:28672
 v_mfma_f32_16x16x32_bf16 v[20:23], v[44:47], v[104:107], v[20:23]
 buffer_load_dwordx4 v[100:103], v11, s[28:31], s58 offen offset:1024 sc1
 v_mfma_f32_16x16x32_bf16 v[24:27], v[40:43], v[108:111], v[24:27]
 ds_read_b128 v[36:39], v4 offset:29696
 v_mfma_f32_16x16x32_bf16 v[28:31], v[44:47], v[108:111], v[28:31]
 buffer_load_dwordx4 v[104:107], v11, s[28:31], s58 offen offset:1536 sc1
 s_waitcnt vmcnt(22)
 s_waitcnt lgkmcnt(0)
 v_mfma_f32_16x16x32_bf16 v[16:19], v[32:35], v[112:115], v[16:19]
 ds_read_b128 v[40:43], v4 offset:30720
 v_mfma_f32_16x16x32_bf16 v[20:23], v[36:39], v[112:115], v[20:23]
 buffer_load_dwordx2 v[108:109], v12, s[28:31], s56 offen offset:0 sc1
 v_mfma_f32_16x16x32_bf16 v[24:27], v[32:35], v[116:119], v[24:27]
 ds_read_b128 v[44:47], v4 offset:31744
 v_mfma_f32_16x16x32_bf16 v[28:31], v[36:39], v[116:119], v[28:31]
 buffer_load_dwordx2 v[112:113], v12, s[28:31], s56 offen offset:256 sc1
 s_waitcnt vmcnt(22)
 s_waitcnt lgkmcnt(0)
 v_mfma_f32_16x16x32_bf16 v[16:19], v[40:43], v[120:123], v[16:19]
 v_mfma_f32_16x16x32_bf16 v[20:23], v[44:47], v[120:123], v[20:23]
 buffer_load_dwordx2 v[116:117], v12, s[28:31], s56 offen offset:512 sc1
 v_mfma_f32_16x16x32_bf16 v[24:27], v[40:43], v[124:127], v[24:27]
 v_mfma_f32_16x16x32_bf16 v[28:31], v[44:47], v[124:127], v[28:31]
 buffer_load_dwordx2 v[120:121], v12, s[28:31], s56 offen offset:768 sc1
L_fin_g_att:
 v_mov_b32 v110, 0
 v_mov_b32 v111, 0
 v_mov_b32 v114, 0
 v_mov_b32 v115, 0
 v_mov_b32 v118, 0
 v_mov_b32 v119, 0
 v_mov_b32 v122, 0
 v_mov_b32 v123, 0
 s_waitcnt vmcnt(8)
 v_mfma_f32_16x16x32_bf16 v[32:35], v[128:131], v[60:63], 0
 v_mfma_f32_16x16x32_bf16 v[36:39], v[144:147], v[60:63], 0
 v_mfma_f32_16x16x32_bf16 v[32:35], v[132:135], v[64:67], v[32:35]
 v_mfma_f32_16x16x32_bf16 v[36:39], v[48:51], v[64:67], v[36:39]
 v_mfma_f32_16x16x32_bf16 v[32:35], v[136:139], v[68:71], v[32:35]
 v_mfma_f32_16x16x32_bf16 v[36:39], v[52:55], v[68:71], v[36:39]
 v_mfma_f32_16x16x32_bf16 v[32:35], v[140:143], v[72:75], v[32:35]
 v_mfma_f32_16x16x32_bf16 v[36:39], v[56:59], v[72:75], v[36:39]
 s_waitcnt vmcnt(4)
 v_mfma_f32_16x16x32_bf16 v[40:43], v[92:95], v[60:63], 0
 v_mfma_f32_16x16x32_bf16 v[40:43], v[96:99], v[64:67], v[40:43]
 v_mfma_f32_16x16x32_bf16 v[40:43], v[100:103], v[68:71], v[40:43]
 v_mfma_f32_16x16x32_bf16 v[40:43], v[104:107], v[72:75], v[40:43]
 v_pk_add_f32 v[32:33], v[32:33], v[152:153]
 v_pk_add_f32 v[34:35], v[34:35], v[154:155]
 v_pk_add_f32 v[36:37], v[36:37], v[156:157]
 v_pk_add_f32 v[38:39], v[38:39], v[158:159]
 v_mov_b32 v48, 0x3f803f80
 v_mov_b32 v49, 0x3f803f80
 v_mov_b32 v50, 0x3f803f80
 v_mov_b32 v51, 0x3f803f80
 v_mov_b32 v58, 0
 v_mov_b32 v59, 0
 v_max3_f32 v44, v32, v33, v34
 v_max3_f32 v44, v44, v35, v36
 v_max3_f32 v44, v44, v37, v38
 v_max3_f32 v44, v44, v39, v40
 v_max3_f32 v44, v44, v41, v42
 v_max_f32 v44, v44, v43
 v_mov_b32 v45, v44
 s_nop 1
 v_permlane32_swap_b32 v44, v45
 v_max_f32 v44, v44, v45
 v_mov_b32 v45, v44
 s_nop 1
 v_permlane16_swap_b32 v44, v45
 v_max_f32 v44, v44, v45
 v_mul_f32 v44, s64, v44
 v_add_f32 v46, v44, v15
 v_pk_fma_f32 v[32:33], v[32:33], s[62:63], v[44:45] op_sel_hi:[1,1,0]
 v_pk_fma_f32 v[34:35], v[34:35], s[62:63], v[44:45] op_sel_hi:[1,1,0]
 v_pk_fma_f32 v[36:37], v[36:37], s[62:63], v[44:45] op_sel_hi:[1,1,0]
 v_pk_fma_f32 v[38:39], v[38:39], s[62:63], v[44:45] op_sel_hi:[1,1,0]
 v_pk_fma_f32 v[40:41], v[40:41], s[62:63], v[46:47] op_sel_hi:[1,1,0]
 v_pk_fma_f32 v[42:43], v[42:43], s[62:63], v[46:47] op_sel_hi:[1,1,0]
 v_exp_f32 v32, v32
 v_exp_f32 v33, v33
 v_exp_f32 v34, v34
 v_exp_f32 v35, v35
 v_exp_f32 v36, v36
 v_exp_f32 v37, v37
 v_exp_f32 v38, v38
 v_exp_f32 v39, v39
 v_exp_f32 v40, v40
 v_exp_f32 v41, v41
 v_exp_f32 v42, v42
 v_exp_f32 v43, v43
 v_cvt_pk_bf16_f32 v52, v32, v33
 v_cvt_pk_bf16_f32 v53, v34, v35
 v_cvt_pk_bf16_f32 v54, v36, v37
 v_cvt_pk_bf16_f32 v55, v38, v39
 v_cvt_pk_bf16_f32 v56, v40, v41
 v_cvt_pk_bf16_f32 v57, v42, v43
 s_waitcnt vmcnt(0)
 s_nop 0
 v_mfma_f32_16x16x32_bf16 v[144:147], v[48:51], v[52:55], 0
 v_mfma_f32_16x16x32_bf16 v[128:131], v[76:79], v[52:55], 0
 v_mfma_f32_16x16x32_bf16 v[132:135], v[80:83], v[52:55], 0
 v_mfma_f32_16x16x32_bf16 v[136:139], v[84:87], v[52:55], 0
 v_mfma_f32_16x16x32_bf16 v[140:143], v[88:91], v[52:55], 0
 v_mfma_f32_16x16x32_bf16 v[144:147], v[48:51], v[56:59], v[144:147]
 v_mfma_f32_16x16x32_bf16 v[128:131], v[108:111], v[56:59], v[128:131]
 v_mfma_f32_16x16x32_bf16 v[132:135], v[112:115], v[56:59], v[132:135]
 v_mfma_f32_16x16x32_bf16 v[136:139], v[116:119], v[56:59], v[136:139]
 v_mfma_f32_16x16x32_bf16 v[140:143], v[120:123], v[56:59], v[140:143]
 s_lshl_b32 s56, s52, 13
 s_lshr_b32 s47, s40, 1
 s_lshl_b32 s47, s47, 12
 s_add_u32 s56, s56, s47
 s_and_b32 s47, s40, 1
 s_lshl_b32 s47, s47, 10
 s_add_u32 s56, s56, s47
 s_add_u32 s56, s56, s55
 v_rcp_f32 v44, v144
 s_nop 1
 v_pk_mul_f32 v[128:129], v[128:129], v[44:45] op_sel_hi:[1,0]
 v_pk_mul_f32 v[130:131], v[130:131], v[44:45] op_sel_hi:[1,0]
 v_pk_mul_f32 v[132:133], v[132:133], v[44:45] op_sel_hi:[1,0]
 v_pk_mul_f32 v[134:135], v[134:135], v[44:45] op_sel_hi:[1,0]
 v_pk_mul_f32 v[136:137], v[136:137], v[44:45] op_sel_hi:[1,0]
 v_pk_mul_f32 v[138:139], v[138:139], v[44:45] op_sel_hi:[1,0]
 v_pk_mul_f32 v[140:141], v[140:141], v[44:45] op_sel_hi:[1,0]
 v_pk_mul_f32 v[142:143], v[142:143], v[44:45] op_sel_hi:[1,0]
 v_cvt_pk_bf16_f32 v32, v128, v129
 v_cvt_pk_bf16_f32 v33, v130, v131
 v_cvt_pk_bf16_f32 v34, v132, v133
 v_cvt_pk_bf16_f32 v35, v134, v135
 v_cvt_pk_bf16_f32 v36, v136, v137
 v_cvt_pk_bf16_f32 v37, v138, v139
 v_cvt_pk_bf16_f32 v38, v140, v141
 v_cvt_pk_bf16_f32 v39, v142, v143
 buffer_store_dwordx4 v[32:35], v3, s[28:31], s56 offen offset:0 sc1
 buffer_store_dwordx4 v[36:39], v3, s[28:31], s56 offen offset:2048 sc1
 s_lshl_b32 s47, s52, 2
 s_add_u32 s47, s47, s60
 v_mov_b32 v1, s59
 s_waitcnt vmcnt(0)
 s_barrier
 buffer_store_dword v1, v2, s[28:31], s47 offen sc1
 s_lshl_b32 s66, s40, 16
 s_add_u32 s66, s66, s55
 s_add_u32 s48, s53, 6
 s_mul_i32 s54, s48, 229376
 s_mul_i32 s47, s40, 57344
 s_add_u32 s54, s54, s47
 s_add_u32 s54, s54, 0x4000000
wg_44:
 buffer_load_dword v44, v13, s[28:31], s60 offen sc1
 s_sub_u32 s26, s26, 1
 s_cbranch_scc1 L_end
 s_waitcnt vmcnt(0)
 v_cmp_gt_u32 vcc, s59, v44
 s_cbranch_vccz wg_44_ok
 s_branch wg_44
wg_44_ok:
 buffer_load_dwordx4 v[48:51], v3, s[28:31], s66 offen offset:0 sc1
 buffer_load_dwordx4 v[52:55], v3, s[28:31], s66 offen offset:1024 sc1
 buffer_load_dwordx4 v[56:59], v3, s[28:31], s66 offen offset:2048 sc1
 buffer_load_dwordx4 v[60:63], v3, s[28:31], s66 offen offset:3072 sc1
 s_add_u32 s66, s66, 4096
 buffer_load_dwordx4 v[64:67], v3, s[28:31], s66 offen offset:0 sc1
 buffer_load_dwordx4 v[68:71], v3, s[28:31], s66 offen offset:1024 sc1
 buffer_load_dwordx4 v[72:75], v3, s[28:31], s66 offen offset:2048 sc1
 buffer_load_dwordx4 v[76:79], v3, s[28:31], s66 offen offset:3072 sc1
 s_add_u32 s66, s66, 4096
 buffer_load_dwordx4 v[80:83], v3, s[28:31], s66 offen offset:0 sc1
 buffer_load_dwordx4 v[84:87], v3, s[28:31], s66 offen offset:1024 sc1
 buffer_load_dwordx4 v[88:91], v3, s[28:31], s66 offen offset:2048 sc1
 buffer_load_dwordx4 v[92:95], v3, s[28:31], s66 offen offset:3072 sc1
 s_add_u32 s66, s66, 4096
 buffer_load_dwordx4 v[96:99], v3, s[28:31], s66 offen offset:0 sc1
 buffer_load_dwordx4 v[100:103], v3, s[28:31], s66 offen offset:1024 sc1
 buffer_load_dwordx4 v[104:107], v3, s[28:31], s66 offen offset:2048 sc1
 buffer_load_dwordx4 v[108:111], v3, s[28:31], s66 offen offset:3072 sc1
 s_add_u32 s66, s66, 4096
 buffer_load_dwordx4 v[112:115], v3, s[28:31], s66 offen offset:0 sc1
 buffer_load_dwordx4 v[116:119], v3, s[28:31], s66 offen offset:1024 sc1
 buffer_load_dwordx4 v[120:123], v3, s[28:31], s66 offen offset:2048 sc1
 buffer_load_dwordx4 v[124:127], v3, s[28:31], s66 offen offset:3072 sc1
 s_add_u32 s66, s66, 4096
 buffer_load_dwordx4 v[128:131], v3, s[28:31], s66 offen offset:0 sc1
 buffer_load_dwordx4 v[132:135], v3, s[28:31], s66 offen offset:1024 sc1
 buffer_load_dwordx4 v[136:139], v3, s[28:31], s66 offen offset:2048 sc1
 buffer_load_dwordx4 v[140:143], v3, s[28:31], s66 offen offset:3072 sc1
 s_add_u32 s66, s66, 4096
 buffer_load_dwordx4 v[144:147], v3, s[28:31], s66 offen offset:0 sc1
 s_waitcnt vmcnt(23)
 v_mfma_f32_16x16x32_bf16 v[16:19], a[0:3], v[48:51], v[16:19]
 v_mfma_f32_16x16x32_bf16 v[20:23], a[4:7], v[48:51], v[20:23]
 buffer_load_dwordx4 v[48:51], v3, s[28:31], s66 offen offset:1024 sc1
 v_mfma_f32_16x16x32_bf16 v[24:27], a[0:3], v[52:55], v[24:27]
 v_mfma_f32_16x16x32_bf16 v[28:31], a[4:7], v[52:55], v[28:31]
 buffer_load_dwordx4 v[52:55], v3, s[28:31], s66 offen offset:2048 sc1
 s_waitcnt vmcnt(23)
 v_mfma_f32_16x16x32_bf16 v[16:19], a[8:11], v[56:59], v[16:19]
 v_mfma_f32_16x16x32_bf16 v[20:23], a[12:15], v[56:59], v[20:23]
 buffer_load_dwordx4 v[56:59], v3, s[28:31], s66 offen offset:3072 sc1
 s_add_u32 s66, s66, 4096
 v_mfma_f32_16x16x32_bf16 v[24:27], a[8:11], v[60:63], v[24:27]
 v_mfma_f32_16x16x32_bf16 v[28:31], a[12:15], v[60:63], v[28:31]
 buffer_load_dwordx4 v[60:63], v3, s[28:31], s66 offen offset:0 sc1
 s_waitcnt vmcnt(23)
 v_mfma_f32_16x16x32_bf16 v[16:19], a[16:19], v[64:67], v[16:19]
 v_mfma_f32_16x16x32_bf16 v[20:23], a[20:23], v[64:67], v[20:23]
 buffer_load_dwordx4 v[64:67], v3, s[28:31], s66 offen offset:1024 sc1
 v_mfma_f32_16x16x32_bf16 v[24:27], a[16:19], v[68:71], v[24:27]
 v_mfma_f32_16x16x32_bf16 v[28:31], a[20:23], v[68:71], v[28:31]
 buffer_load_dwordx4 v[68:71], v3, s[28:31], s66 offen offset:2048 sc1
 s_waitcnt vmcnt(23)
 v_mfma_f32_16x16x32_bf16 v[16:19], a[24:27], v[72:75], v[16:19]
 v_mfma_f32_16x16x32_bf16 v[20:23], a[28:31], v[72:75], v[20:23]
 buffer_load_dwordx4 v[72:75], v3, s[28:31], s66 offen offset:3072 sc1
 s_add_u32 s66, s66, 4096
 v_mfma_f32_16x16x32_bf16 v[24:27], a[24:27], v[76:79], v[24:27]
 v_mfma_f32_16x16x32_bf16 v[28:31], a[28:31], v[76:79], v[28:31]
 buffer_load_dwordx4 v[76:79], v3, s[28:31], s66 offen offset:0 sc1
 s_waitcnt vmcnt(23)
 v_mfma_f32_16x16x32_bf16 v[16:19], a[32:35], v[80:83], v[16:19]
 v_mfma_f32_16x16x32_bf16 v[20:23], a[36:39], v[80:83], v[20:23]
 buffer_load_dwordx4 v[80:83], v3, s[28:31], s66 offen offset:1024 sc1
 v_mfma_f32_16x16x32_bf16 v[24:27], a[32:35], v[84:87], v[24:27]
 v_mfma_f32_16x16x32_bf16 v[28:31], a[36:39], v[84:87], v[28:31]
 buffer_load_dwordx4 v[84:87], v3, s[28:31], s66 offen offset:2048 sc1
 s_waitcnt vmcnt(23)
 v_mfma_f32_16x16x32_bf16 v[16:19], a[40:43], v[88:91], v[16:19]
 v_mfma_f32_16x16x32_bf16 v[20:23], a[44:47], v[88:91], v[20:23]
 buffer_load_dwordx4 v[88:91], v3, s[28:31], s66 offen offset:3072 sc1
 s_add_u32 s66, s66, 4096
 v_mfma_f32_16x16x32_bf16 v[24:27], a[40:43], v[92:95], v[24:27]
 v_mfma_f32_16x16x32_bf16 v[28:31], a[44:47], v[92:95], v[28:31]
 buffer_load_dwordx4 v[92:95], v3, s[28:31], s66 offen offset:0 sc1
 s_waitcnt vmcnt(23)
 v_mfma_f32_16x16x32_bf16 v[16:19], a[48:51], v[96:99], v[16:19]
 v_mfma_f32_16x16x32_bf16 v[20:23], a[52:55], v[96:99], v[20:23]
 buffer_load_dwordx4 v[96:99], v3, s[28:31], s66 offen offset:1024 sc1
 v_mfma_f32_16x16x32_bf16 v[24:27], a[48:51], v[100:103], v[24:27]
 v_mfma_f32_16x16x32_bf16 v[28:31], a[52:55], v[100:103], v[28:31]
 buffer_load_dwordx4 v[100:103], v3, s[28:31], s66 offen offset:2048 sc1
 s_waitcnt vmcnt(23)
 v_mfma_f32_16x16x32_bf16 v[16:19], a[56:59], v[104:107], v[16:19]
 v_mfma_f32_16x16x32_bf16 v[20:23], a[60:63], v[104:107], v[20:23]
 buffer_load_dwordx4 v[104:107], v3, s[28:31], s66 offen offset:3072 sc1
 s_add_u32 s66, s66, 4096
 v_mfma_f32_16x16x32_bf16 v[24:27], a[56:59], v[108:111], v[24:27]
 v_mfma_f32_16x16x32_bf16 v[28:31], a[60:63], v[108:111], v[28:31]
 buffer_load_dwordx4 v[108:111], v3, s[28:31], s66 offen offset:0 sc1
 s_waitcnt vmcnt(23)
 v_mfma_f32_16x16x32_bf16 v[16:19], a[64:67], v[112:115], v[16:19]
 v_mfma_f32_16x16x32_bf16 v[20:23], a[68:71], v[112:115], v[20:23]
 buffer_load_dwordx4 v[112:115], v3, s[28:31], s66 offen offset:1024 sc1
 v_mfma_f32_16x16x32_bf16 v[24:27], a[64:67], v[116:119], v[24:27]
 v_mfma_f32_16x16x32_bf16 v[28:31], a[68:71], v[116:119], v[28:31]
 buffer_load_dwordx4 v[116:119], v3, s[28:31], s66 offen offset:2048 sc1
 s_waitcnt vmcnt(23)
 v_mfma_f32_16x16x32_bf16 v[16:19], a[72:75], v[120:123], v[16:19]
 v_mfma_f32_16x16x32_bf16 v[20:23], a[76:79], v[120:123], v[20:23]
 buffer_load_dwordx4 v[120:123], v3, s[28:31], s66 offen offset:3072 sc1
 s_add_u32 s66, s66, 4096
 v_mfma_f32_16x16x32_bf16 v[24:27], a[72:75], v[124:127], v[24:27]
 v_mfma_f32_16x16x32_bf16 v[28:31], a[76:79], v[124:127], v[28:31]
 buffer_load_dwordx4 v[124:127], v3, s[28:31], s66 offen offset:0 sc1
 s_waitcnt vmcnt(23)
 v_mfma_f32_16x16x32_bf16 v[16:19], a[80:83], v[128:131], v[16:19]
 v_mfma_f32_16x16x32_bf16 v[20:23], a[84:87], v[128:131], v[20:23]
 buffer_load_dwordx4 v[128:131], v3, s[28:31], s66 offen offset:1024 sc1
 v_mfma_f32_16x16x32_bf16 v[24:27], a[80:83], v[132:135], v[24:27]
 v_mfma_f32_16x16x32_bf16 v[28:31], a[84:87], v[132:135], v[28:31]
 buffer_load_dwordx4 v[132:135], v3, s[28:31], s66 offen offset:2048 sc1
 s_waitcnt vmcnt(23)
 v_mfma_f32_16x16x32_bf16 v[16:19], a[88:91], v[136:139], v[16:19]
 v_mfma_f32_16x16x32_bf16 v[20:23], a[92:95], v[136:139], v[20:23]
 buffer_load_dwordx4 v[136:139], v3, s[28:31], s66 offen offset:3072 sc1
 s_add_u32 s66, s66, 4096
 v_mfma_f32_16x16x32_bf16 v[24:27], a[88:91], v[140:143], v[24:27]
 v_mfma_f32_16x16x32_bf16 v[28:31], a[92:95], v[140:143], v[28:31]
 buffer_load_dwordx4 v[140:143], v3, s[28:31], s66 offen offset:0 sc1
 s_waitcnt vmcnt(23)
 v_mfma_f32_16x16x32_bf16 v[16:19], a[96:99], v[144:147], v[16:19]
 v_mfma_f32_16x16x32_bf16 v[20:23], a[100:103], v[144:147], v[20:23]
 buffer_load_dwordx4 v[144:147], v3, s[28:31], s66 offen offset:1024 sc1
 v_mfma_f32_16x16x32_bf16 v[24:27], a[96:99], v[48:51], v[24:27]
 v_mfma_f32_16x16x32_bf16 v[28:31], a[100:103], v[48:51], v[28:31]
 buffer_load_dwordx4 v[48:51], v3, s[28:31], s66 offen offset:2048 sc1
 s_waitcnt vmcnt(23)
 v_mfma_f32_16x16x32_bf16 v[16:19], a[104:107], v[52:55], v[16:19]
 v_mfma_f32_16x16x32_bf16 v[20:23], a[108:111], v[52:55], v[20:23]
 buffer_load_dwordx4 v[52:55], v3, s[28:31], s66 offen offset:3072 sc1
 s_add_u32 s66, s66, 4096
 v_mfma_f32_16x16x32_bf16 v[24:27], a[104:107], v[56:59], v[24:27]
 v_mfma_f32_16x16x32_bf16 v[28:31], a[108:111], v[56:59], v[28:31]
 buffer_load_dwordx4 v[56:59], v3, s[28:31], s66 offen offset:0 sc1
 s_waitcnt vmcnt(23)
 v_mfma_f32_16x16x32_bf16 v[16:19], a[112:115], v[60:63], v[16:19]
 v_mfma_f32_16x16x32_bf16 v[20:23], a[116:119], v[60:63], v[20:23]
 buffer_load_dwordx4 v[60:63], v3, s[28:31], s66 offen offset:1024 sc1
 v_mfma_f32_16x16x32_bf16 v[24:27], a[112:115], v[64:67], v[24:27]
 v_mfma_f32_16x16x32_bf16 v[28:31], a[116:119], v[64:67], v[28:31]
 buffer_load_dwordx4 v[64:67], v3, s[28:31], s66 offen offset:2048 sc1
 s_waitcnt vmcnt(23)
 v_mfma_f32_16x16x32_bf16 v[16:19], a[120:123], v[68:71], v[16:19]
 v_mfma_f32_16x16x32_bf16 v[20:23], a[124:127], v[68:71], v[20:23]
 buffer_load_dwordx4 v[68:71], v3, s[28:31], s66 offen offset:3072 sc1
 s_add_u32 s66, s66, 4096
 v_mfma_f32_16x16x32_bf16 v[24:27], a[120:123], v[72:75], v[24:27]
 v_mfma_f32_16x16x32_bf16 v[28:31], a[124:127], v[72:75], v[28:31]
 buffer_load_dwordx4 v[72:75], v3, s[28:31], s66 offen offset:0 sc1
 s_waitcnt vmcnt(23)
 v_mfma_f32_16x16x32_bf16 v[16:19], a[128:131], v[76:79], v[16:19]
 v_mfma_f32_16x16x32_bf16 v[20:23], a[132:135], v[76:79], v[20:23]
 buffer_load_dwordx4 v[76:79], v3, s[28:31], s66 offen offset:1024 sc1
 v_mfma_f32_16x16x32_bf16 v[24:27], a[128:131], v[80:83], v[24:27]
 v_mfma_f32_16x16x32_bf16 v[28:31], a[132:135], v[80:83], v[28:31]
 buffer_load_dwordx4 v[80:83], v3, s[28:31], s66 offen offset:2048 sc1
 s_waitcnt vmcnt(23)
 v_mfma_f32_16x16x32_bf16 v[16:19], a[136:139], v[84:87], v[16:19]
 v_mfma_f32_16x16x32_bf16 v[20:23], a[140:143], v[84:87], v[20:23]
 buffer_load_dwordx4 v[84:87], v3, s[28:31], s66 offen offset:3072 sc1
 s_add_u32 s66, s66, 4096
 v_mfma_f32_16x16x32_bf16 v[24:27], a[136:139], v[88:91], v[24:27]
 v_mfma_f32_16x16x32_bf16 v[28:31], a[140:143], v[88:91], v[28:31]
 buffer_load_dwordx4 v[88:91], v3, s[28:31], s66 offen offset:0 sc1
 s_waitcnt vmcnt(23)
 v_mfma_f32_16x16x32_bf16 v[16:19], a[144:147], v[92:95], v[16:19]
 v_mfma_f32_16x16x32_bf16 v[20:23], a[148:151], v[92:95], v[20:23]
 buffer_load_dwordx4 v[92:95], v3, s[28:31], s66 offen offset:1024 sc1
 v_mfma_f32_16x16x32_bf16 v[24:27], a[144:147], v[96:99], v[24:27]
 v_mfma_f32_16x16x32_bf16 v[28:31], a[148:151], v[96:99], v[28:31]
 buffer_load_dwordx4 v[96:99], v3, s[28:31], s66 offen offset:2048 sc1
 s_waitcnt vmcnt(23)
 v_mfma_f32_16x16x32_bf16 v[16:19], a[152:155], v[100:103], v[16:19]
 v_mfma_f32_16x16x32_bf16 v[20:23], a[156:159], v[100:103], v[20:23]
 buffer_load_dwordx4 v[100:103], v3, s[28:31], s66 offen offset:3072 sc1
 s_add_u32 s66, s66, 4096
 v_mfma_f32_16x16x32_bf16 v[24:27], a[152:155], v[104:107], v[24:27]
 v_mfma_f32_16x16x32_bf16 v[28:31], a[156:159], v[104:107], v[28:31]
 buffer_load_dwordx4 v[104:107], v3, s[28:31], s54 offen offset:0 sc1
 s_waitcnt vmcnt(23)
 v_mfma_f32_16x16x32_bf16 v[16:19], a[160:163], v[108:111], v[16:19]
 v_mfma_f32_16x16x32_bf16 v[20:23], a[164:167], v[108:111], v[20:23]
 buffer_load_dwordx4 v[108:111], v3, s[28:31], s54 offen offset:1024 sc1
 v_mfma_f32_16x16x32_bf16 v[24:27], a[160:163], v[112:115], v[24:27]
 v_mfma_f32_16x16x32_bf16 v[28:31], a[164:167], v[112:115], v[28:31]
 buffer_load_dwordx4 v[112:115], v3, s[28:31], s54 offen offset:2048 sc1
 s_waitcnt vmcnt(23)
 v_mfma_f32_16x16x32_bf16 v[16:19], a[168:171], v[116:119], v[16:19]
 v_mfma_f32_16x16x32_bf16 v[20:23], a[172:175], v[116:119], v[20:23]
 buffer_load_dwordx4 v[116:119], v3, s[28:31], s54 offen offset:3072 sc1
 s_add_u32 s54, s54, 4096
 v_mfma_f32_16x16x32_bf16 v[24:27], a[168:171], v[120:123], v[24:27]
 v_mfma_f32_16x16x32_bf16 v[28:31], a[172:175], v[120:123], v[28:31]
 buffer_load_dwordx4 v[120:123], v3, s[28:31], s54 offen offset:0 sc1
 s_waitcnt vmcnt(23)
 v_mfma_f32_16x16x32_bf16 v[16:19], a[176:179], v[124:127], v[16:19]
 v_mfma_f32_16x16x32_bf16 v[20:23], a[180:183], v[124:127], v[20:23]
 buffer_load_dwordx4 v[124:127], v3, s[28:31], s54 offen offset:1024 sc1
 v_mfma_f32_16x16x32_bf16 v[24:27], a[176:179], v[128:131], v[24:27]
 v_mfma_f32_16x16x32_bf16 v[28:31], a[180:183], v[128:131], v[28:31]
 buffer_load_dwordx4 v[128:131], v3, s[28:31], s54 offen offset:2048 sc1
 s_waitcnt vmcnt(23)
 v_mfma_f32_16x16x32_bf16 v[16:19], a[184:187], v[132:135], v[16:19]
 v_mfma_f32_16x16x32_bf16 v[20:23], a[188:191], v[132:135], v[20:23]
 buffer_load_dwordx4 v[132:135], v3, s[28:31], s54 offen offset:3072 sc1
 s_add_u32 s54, s54, 4096
 v_mfma_f32_16x16x32_bf16 v[24:27], a[184:187], v[136:139], v[24:27]
 v_mfma_f32_16x16x32_bf16 v[28:31], a[188:191], v[136:139], v[28:31]
 buffer_load_dwordx4 v[136:139], v3, s[28:31], s54 offen offset:0 sc1
 s_waitcnt vmcnt(23)
 v_mfma_f32_16x16x32_bf16 v[16:19], a[192:195], v[140:143], v[16:19]
 v_mfma_f32_16x16x32_bf16 v[20:23], a[196:199], v[140:143], v[20:23]
 buffer_load_dwordx4 v[140:143], v3, s[28:31], s54 offen offset:1024 sc1
 v_mfma_f32_16x16x32_bf16 v[24:27], a[192:195], v[144:147], v[24:27]
 v_mfma_f32_16x16x32_bf16 v[28:31], a[196:199], v[144:147], v[28:31]
 buffer_load_dwordx4 v[144:147], v3, s[28:31], s54 offen offset:2048 sc1
 s_waitcnt vmcnt(23)
 v_mfma_f32_16x16x32_bf16 v[16:19], a[200:203], v[48:51], v[16:19]
 v_mfma_f32_16x16x32_bf16 v[20:23], a[204:207], v[48:51], v[20:23]
 buffer_load_dwordx4 v[48:51], v3, s[28:31], s54 offen offset:3072 sc1
 s_add_u32 s54, s54, 4096
 v_mfma_f32_16x16x32_bf16 v[24:27], a[200:203], v[52:55], v[24:27]
 v_mfma_f32_16x16x32_bf16 v[28:31], a[204:207], v[52:55], v[28:31]
 buffer_load_dwordx4 v[52:55], v3, s[28:31], s54 offen offset:0 sc1
 s_waitcnt vmcnt(23)
 v_mfma_f32_16x16x32_bf16 v[16:19], a[208:211], v[56:59], v[16:19]
 v_mfma_f32_16x16x32_bf16 v[20:23], a[212:215], v[56:59], v[20:23]
 buffer_load_dwordx4 v[56:59], v3, s[28:31], s54 offen offset:1024 sc1
 v_mfma_f32_16x16x32_bf16 v[24:27], a[208:211], v[60:63], v[24:27]
 v_mfma_f32_16x16x32_bf16 v[28:31], a[212:215], v[60:63], v[28:31]
 buffer_load_dwordx4 v[60:63], v3, s[28:31], s54 offen offset:2048 sc1
 s_waitcnt vmcnt(23)
 v_mfma_f32_16x16x32_bf16 v[16:19], a[216:219], v[64:67], v[16:19]
 v_mfma_f32_16x16x32_bf16 v[20:23], a[220:223], v[64:67], v[20:23]
 buffer_load_dwordx4 v[64:67], v3, s[28:31], s54 offen offset:3072 sc1
 s_add_u32 s54, s54, 4096
 v_mfma_f32_16x16x32_bf16 v[24:27], a[216:219], v[68:71], v[24:27]
 v_mfma_f32_16x16x32_bf16 v[28:31], a[220:223], v[68:71], v[28:31]
 buffer_load_dwordx4 v[68:71], v3, s[28:31], s54 offen offset:0 sc1
 s_waitcnt vmcnt(23)
 v_mfma_f32_16x16x32_bf16 v[16:19], a[224:227], v[72:75], v[16:19]
 v_mfma_f32_16x16x32_bf16 v[20:23], a[228:231], v[72:75], v[20:23]
 buffer_load_dwordx4 v[72:75], v3, s[28:31], s54 offen offset:1024 sc1
 v_mfma_f32_16x16x32_bf16 v[24:27], a[224:227], v[76:79], v[24:27]
 v_mfma_f32_16x16x32_bf16 v[28:31], a[228:231], v[76:79], v[28:31]
 buffer_load_dwordx4 v[76:79], v3, s[28:31], s54 offen offset:2048 sc1
 s_waitcnt vmcnt(23)
 v_mfma_f32_16x16x32_bf16 v[16:19], a[232:235], v[80:83], v[16:19]
 v_mfma_f32_16x16x32_bf16 v[20:23], a[236:239], v[80:83], v[20:23]
 buffer_load_dwordx4 v[80:83], v3, s[28:31], s54 offen offset:3072 sc1
 s_add_u32 s54, s54, 4096
 v_mfma_f32_16x16x32_bf16 v[24:27], a[232:235], v[84:87], v[24:27]
 v_mfma_f32_16x16x32_bf16 v[28:31], a[236:239], v[84:87], v[28:31]
 buffer_load_dwordx4 v[84:87], v3, s[28:31], s54 offen offset:0 sc1
 s_waitcnt vmcnt(23)
 v_mfma_f32_16x16x32_bf16 v[16:19], a[240:243], v[88:91], v[16:19]
 v_mfma_f32_16x16x32_bf16 v[20:23], a[244:247], v[88:91], v[20:23]
 buffer_load_dwordx4 v[88:91], v3, s[28:31], s54 offen offset:1024 sc1
 v_mfma_f32_16x16x32_bf16 v[24:27], a[240:243], v[92:95], v[24:27]
 v_mfma_f32_16x16x32_bf16 v[28:31], a[244:247], v[92:95], v[28:31]
 buffer_load_dwordx4 v[92:95], v3, s[28:31], s54 offen offset:2048 sc1
 s_waitcnt vmcnt(23)
 v_mfma_f32_16x16x32_bf16 v[16:19], a[248:251], v[96:99], v[16:19]
 v_mfma_f32_16x16x32_bf16 v[20:23], a[252:255], v[96:99], v[20:23]
 buffer_load_dwordx4 v[96:99], v3, s[28:31], s54 offen offset:3072 sc1
 s_add_u32 s54, s54, 4096
 v_mfma_f32_16x16x32_bf16 v[24:27], a[248:251], v[100:103], v[24:27]
 v_mfma_f32_16x16x32_bf16 v[28:31], a[252:255], v[100:103], v[28:31]
 buffer_load_dwordx4 v[100:103], v3, s[28:31], s54 offen offset:0 sc1
 s_nop 7
 ds_write_b128 v8, v[16:19] offset:0
 ds_write_b128 v8, v[20:23] offset:64
 ds_write_b128 v8, v[24:27] offset:2304
 ds_write_b128 v8, v[28:31] offset:2368
 v_lshlrev_b32 v150, 16, v149
 v_and_b32 v151, 0xffff0000, v149
 v_and_b32 v149, 0xffff0000, v148
 v_lshlrev_b32 v148, 16, v148
 s_waitcnt lgkmcnt(0)
 s_barrier
 ds_read_b128 v[32:35], v9 offset:0
 ds_read_b128 v[36:39], v9 offset:4608
 ds_read_b128 v[40:43], v9 offset:9216
 ds_read_b128 v[44:47], v9 offset:13824
 s_xor_b32 s55, s55, 262144
 s_add_u32 s59, s59, 1
 s_add_u32 s53, s53, 6
 s_waitcnt lgkmcnt(0)
 v_pk_add_f32 v[32:33], v[32:33], v[36:37]
 v_pk_add_f32 v[40:41], v[40:41], v[44:45]
 v_pk_add_f32 v[34:35], v[34:35], v[38:39]
 v_pk_add_f32 v[42:43], v[42:43], v[46:47]
 v_pk_add_f32 v[32:33], v[32:33], v[40:41]
 v_pk_add_f32 v[34:35], v[34:35], v[42:43]
 v_pk_add_f32 v[32:33], v[32:33], v[148:149]
 v_pk_add_f32 v[34:35], v[34:35], v[150:151]
 v_cvt_pk_bf16_f32 v36, v32, v33
 v_cvt_pk_bf16_f32 v37, v34, v35
 buffer_store_dwordx2 v[36:37], v10, s[36:39], s65 offen
 s_cmp_lt_u32 s53, 64
 s_cbranch_scc1 L_fin_g
 s_branch L_end
L_fin_g_late:
 s_waitcnt vmcnt(22)
 s_waitcnt lgkmcnt(0)
 v_mfma_f32_16x16x32_bf16 v[16:19], v[32:35], v[96:99], v[16:19]
 ds_read_b128 v[40:43], v4 offset:26624
 v_mfma_f32_16x16x32_bf16 v[20:23], v[36:39], v[96:99], v[20:23]
 v_mfma_f32_16x16x32_bf16 v[24:27], v[32:35], v[100:103], v[24:27]
 ds_read_b128 v[44:47], v4 offset:27648
 v_mfma_f32_16x16x32_bf16 v[28:31], v[36:39], v[100:103], v[28:31]
 s_waitcnt vmcnt(20)
 s_waitcnt lgkmcnt(0)
 v_mfma_f32_16x16x32_bf16 v[16:19], v[40:43], v[104:107], v[16:19]
 ds_read_b128 v[32:35], v4 offset:28672
 v_mfma_f32_16x16x32_bf16 v[20:23], v[44:47], v[104:107], v[20:23]
 v_mfma_f32_16x16x32_bf16 v[24:27], v[40:43], v[108:111], v[24:27]
 ds_read_b128 v[36:39], v4 offset:29696
 v_mfma_f32_16x16x32_bf16 v[28:31], v[44:47], v[108:111], v[28:31]
 s_waitcnt vmcnt(18)
 s_waitcnt lgkmcnt(0)
 v_mfma_f32_16x16x32_bf16 v[16:19], v[32:35], v[112:115], v[16:19]
 ds_read_b128 v[40:43], v4 offset:30720
 v_mfma_f32_16x16x32_bf16 v[20:23], v[36:39], v[112:115], v[20:23]
 v_mfma_f32_16x16x32_bf16 v[24:27], v[32:35], v[116:119], v[24:27]
 ds_read_b128 v[44:47], v4 offset:31744
 v_mfma_f32_16x16x32_bf16 v[28:31], v[36:39], v[116:119], v[28:31]
 s_waitcnt vmcnt(16)
 s_waitcnt lgkmcnt(0)
 v_mfma_f32_16x16x32_bf16 v[16:19], v[40:43], v[120:123], v[16:19]
 v_mfma_f32_16x16x32_bf16 v[20:23], v[44:47], v[120:123], v[20:23]
 v_mfma_f32_16x16x32_bf16 v[24:27], v[40:43], v[124:127], v[24:27]
 v_mfma_f32_16x16x32_bf16 v[28:31], v[44:47], v[124:127], v[28:31]
wg_43:
 buffer_load_dword v1, v14, s[28:31], s61 offen sc1
 s_sub_u32 s26, s26, 1
 s_cbranch_scc1 L_end
 s_waitcnt vmcnt(0)
 v_cmp_gt_u32 vcc, s69, v1
 s_cbranch_vccz wg_43_ok
 s_sleep 2
 s_branch wg_43
wg_43_ok:
 buffer_load_dwordx4 v[92:95], v11, s[28:31], s58 offen offset:0 sc1
 buffer_load_dwordx4 v[96:99], v11, s[28:31], s58 offen offset:512 sc1
 buffer_load_dwordx4 v[100:103], v11, s[28:31], s58 offen offset:1024 sc1
 buffer_load_dwordx4 v[104:107], v11, s[28:31], s58 offen offset:1536 sc1
 buffer_load_dwordx2 v[108:109], v12, s[28:31], s56 offen offset:0 sc1
 buffer_load_dwordx2 v[112:113], v12, s[28:31], s56 offen offset:256 sc1
 buffer_load_dwordx2 v[116:117], v12, s[28:31], s56 offen offset:512 sc1
 buffer_load_dwordx2 v[120:121], v12, s[28:31], s56 offen offset:768 sc1
 s_branch L_fin_g_att
L_end:
 s_endpgm
.section .rodata,"a"
.p2align 6
.amdhsa_kernel parallel_sum__memory_aug_recurrent_mem_tr__dense_activation_relu__prompt_kernel
  .amdhsa_next_free_vgpr 512
  .amdhsa_next_free_sgpr 102
  .amdhsa_accum_offset 256
  .amdhsa_group_segment_fixed_size 0
  .amdhsa_kernarg_size 104
  .amdhsa_user_sgpr_count 2
  .amdhsa_user_sgpr_kernarg_segment_ptr 1
  .amdhsa_system_sgpr_workgroup_id_x 1
  .amdhsa_float_denorm_mode_32 3
.end_amdhsa_kernel
```
